```python
import torch

def _softmax(x, axis=-1):
    return torch.softmax(x, dim=axis)

def _gelu(x):
    return torch.nn.functional.gelu(x, approximate='tanh')

def _silu(x):
    return torch.nn.functional.silu(x)

def _sigmoid(x):
    return torch.sigmoid(x)

def _layernorm(x, axis=-1, eps=1e-05):
    m = x.mean(dim=axis, keepdim=True)
    v = x.var(dim=axis, keepdim=True, unbiased=False)
    return (x - m) / torch.sqrt(v + eps)

def _scatter_add(tgt, idx, src, axis=0):
    return tgt.clone().index_add_(axis, idx, src)

def _segment_sum(src, seg, n):
    out = torch.zeros((n,) + src.shape[1:], dtype=src.dtype)
    return out.index_add_(0, seg, src)

def _pad(x, pw):
    flat = tuple((v for pair in reversed(pw) for v in pair))
    return torch.nn.functional.pad(x, flat)
kernel_name = 'adaLN_cond__mha_block_cached__moe_arch_mod__prompt'

def setup_inputs():

    _w = lambda a: (lambda t: t.to(torch.bfloat16) if t.is_floating_point() else t)(torch.as_tensor(a))

    def _A_setup():
        B, Sq, D = (1, 2048, 1024)
        H, Sk, Dh = (32, 2048, 128)
        return {'x': _w((lambda *s: torch.randn(*s, dtype=torch.bfloat16) * 0.1)(B, Sq, D)), 'k_cache': _w((lambda *s: torch.randn(*s, dtype=torch.bfloat16) * 0.8)(B, H, Sk, Dh)), 'v_cache': _w((lambda *s: torch.randn(*s, dtype=torch.bfloat16) * 0.8)(B, H, Sk, Dh)), 'wq': _w((lambda *s: torch.randn(*s, dtype=torch.bfloat16) * 0.8)(D, H * Dh) * D ** (-0.5)), 'wo': _w((lambda *s: torch.randn(*s, dtype=torch.bfloat16) * 0.8)(H * Dh, D) * (H * Dh) ** (-0.5))}
    _A_in = _A_setup()

    def _B_setup():
        B, S, D, F, C = (1, 2048, 1024, 3584, 2)
        return {'x': _w((lambda *s: torch.randn(*s, dtype=torch.bfloat16) * 0.1)(B, S, D)), 'w_r': _w((lambda *s: torch.randn(*s, dtype=torch.bfloat16) * 3.2)(D)), 'w_gate': _w((lambda *s: torch.randn(*s, dtype=torch.bfloat16) * 0.2)(D, F)), 'w_up': _w((lambda *s: torch.randn(*s, dtype=torch.bfloat16) * 0.2)(D, F)), 'w_down': _w((lambda *s: torch.randn(*s, dtype=torch.bfloat16) * 0.2)(F, D))}
    _B_in = _B_setup()
    return {'A_x': _A_in['x'], 'A_k_cache': _A_in['k_cache'], 'A_v_cache': _A_in['v_cache'], 'A_wq': _A_in['wq'], 'A_wo': _A_in['wo'], 'B_x': _B_in['x'], 'B_w_r': _B_in['w_r'], 'B_w_gate': _B_in['w_gate'], 'B_w_up': _B_in['w_up'], 'B_w_down': _B_in['w_down'], 'c': _w((lambda *s: torch.randn(*s, dtype=torch.bfloat16) * 0.2)(1, 1024) * 8.0), 'w_mod': _w((lambda *s: torch.randn(*s, dtype=torch.bfloat16) * 0.2)(1024, 6 * 1024) * 1024 ** (-0.5) * 8.0)}

def reference(A_x, A_k_cache, A_v_cache, A_wq, A_wo, B_x, B_w_r, B_w_gate, B_w_up, B_w_down, c, w_mod):

    def _A_ref(x, k_cache, v_cache, wq, wo):
        B, Sq, D = x.shape
        H, Dh = (32, 128)
        q = (lambda x, *d: x.permute(*d))((x @ wq).reshape(B, Sq, H, Dh), 0, 2, 1, 3)
        scores = torch.einsum('bhqd,bhkd->bhqk', q, k_cache) * Dh ** (-0.5)
        p = _softmax(scores, axis=-1)
        o = torch.einsum('bhqk,bhkd->bhqd', p, v_cache)
        return (lambda x, *d: x.permute(*d))(o, 0, 2, 1, 3).reshape(B, Sq, H * Dh) @ wo

    def _B_ref(x, w_r, w_gate, w_up, w_down):
        B, S, D = x.shape
        C = 2
        r = x @ w_r
        idx = torch.argsort(-r, axis=-1)[:, :C]
        idx_e = (lambda x, n, axis: torch.repeat_interleave(x, n, dim=axis))(idx.reshape(B, C, 1), D, axis=2)
        x_sel = (lambda x, i, axis: torch.take_along_dim(x, i, dim=axis))(x, idx_e, axis=1)
        g = _silu(x_sel @ w_gate)
        u = x_sel @ w_up
        y = g * u @ w_down
        r_sel = _sigmoid((lambda x, i, axis: torch.take_along_dim(x, i, dim=axis))(r, idx, axis=1))
        y = y * r_sel.reshape(B, C, 1)
        b_off = (torch.arange(B) * S).reshape(B, 1)
        flat_idx = (idx + b_off).reshape(B * C)
        zero = (x * 0.0).reshape(B * S, D)
        upd = _scatter_add(zero, flat_idx, y.reshape(B * C, D), axis=0)
        return x + upd.reshape(B, S, D)
    x = A_x
    mod = (_silu(c) @ w_mod).reshape(c.shape[0], 6, 1, -1)
    sa, ca, ga, sb, cb, gb = (mod[:, 0].clone(), mod[:, 1].clone(), mod[:, 2].clone(), mod[:, 3].clone(), mod[:, 4].clone(), mod[:, 5].clone())
    h = _layernorm(x, axis=-1) * (1 + ca) + sa
    x = x + ga * _A_ref(h, A_k_cache, A_v_cache, A_wq, A_wo)
    h = _layernorm(x, axis=-1) * (1 + cb) + sb
    x = x + gb * _B_ref(h, B_w_r, B_w_gate, B_w_up, B_w_down)
    return x
```

```asm
; @launch grid=(256,1,1) block=(256,1,1) lds=163840
.amdgcn_target "amdgcn-amd-amdhsa--gfx950"
.text
.globl adaLN_cond__mha_block_cached__moe_arch_mod__prompt_kernel
.p2align 8
.type adaLN_cond__mha_block_cached__moe_arch_mod__prompt_kernel,@function
adaLN_cond__mha_block_cached__moe_arch_mod__prompt_kernel:
    s_load_dwordx8 s[56:63], s[0:1], 64
    s_load_dwordx2 s[68:69], s[0:1], 112
    s_load_dwordx16 s[40:55], s[0:1], 0
    s_load_dwordx2 s[64:65], s[0:1], 96
    s_cmp_ge_u32 s2, 256
    s_cbranch_scc1 attn_end
    v_lshrrev_b32 v13, 6, v0
    s_lshr_b32 s36, s2, 3
    s_lshl_b32 s36, s36, 4
    s_add_u32 s36, s36, 128
    v_lshrrev_b32 v14, 1, v0
    v_lshrrev_b32 v15, 4, v0
    v_add_u32 v15, s36, v15
    v_and_b32 v80, 1, v0
    v_cmp_eq_u32 vcc, 1, v80
    s_nop 1
    v_cndmask_b32 v14, v14, v15, vcc
    s_getpc_b64 s[36:37]
    s_add_u32 s36, s36, attn_c0-.
    s_addc_u32 s37, s37, 0
    v_min_u32 v14, ((attn_slow-attn_c0)>>7)-1, v14
    v_lshlrev_b32 v14, 7, v14
    global_load_dword v247, v14, s[36:37]
attn_c0:
    v_lshrrev_b32 v14, 3, v0
    v_readfirstlane_b32 s28, v13
    v_and_b32 v15, 7, v0
    v_mul_u32_u24 v80, 49152, v14
    v_lshl_add_u32 v80, v15, 4, v80
    v_lshlrev_b32 v81, 3, v14
    v_lshlrev_b32 v224, 4, v0
    v_lshlrev_b32 v82, 2, v0
    v_and_b32 v0, 63, v0
    v_lshlrev_b32 v12, 4, v0
    v_lshrrev_b32 v87, 5, v0
    v_mul_u32_u24 v87, 1536, v87
    v_add_u32 v87, v87, v12
    s_and_b32 s3, s2, 7
    s_lshl_b32 s3, s3, 2
    s_bfe_u32 s35, s2, 0x20003
    s_add_u32 s3, s3, s35
    s_lshr_b32 s94, s2, 3
    s_and_b32 s89, s2, 7
    s_lshl_b32 s39, s89, 5
    s_add_u32 s39, s39, s94
    s_lshl_b32 s39, s39, 14
    s_lshl_b32 s4, s28, 12
    s_add_u32 s39, s39, s4
    s_lshr_b32 s38, s2, 5
    s_mul_i32 s4, s38, 1572864
    s_and_b32 s37, s2, 31
    s_lshl_b32 s5, s37, 7
    s_add_u32 s4, s4, s5
    s_add_u32 s5, s4, 12288
    s_add_u32 s6, s4, 24576
    s_add_u32 s7, s4, 36864
    s_lshl_b32 s36, s38, 8
    s_mov_b32 s85, 29458432
    s_waitcnt lgkmcnt(0)
    s_load_dword s85, s[68:69], s85
    s_mov_b32 s20, s40
    s_mov_b32 s21, s41
    s_mov_b32 s22, 4194304
    s_mov_b32 s23, 0x20000
    s_mov_b32 s80, s60
    s_mov_b32 s81, s61
    s_mov_b32 s82, 2048
    s_mov_b32 s83, 0x20000
    buffer_load_dwordx2 v[112:113], v81, s[80:83], s36 offen
    buffer_load_dwordx4 v[176:179], v87, s[20:23], s39 offen offset:0 nt
    buffer_load_dwordx4 v[180:183], v87, s[20:23], s39 offen offset:512 nt
    buffer_load_dwordx4 v[184:187], v87, s[20:23], s39 offen offset:1024 nt
    buffer_load_dwordx4 v[188:191], v87, s[20:23], s39 offen offset:1536 nt
    s_mov_b32 s60, s62
    s_mov_b32 s61, s63
    s_mov_b32 s62, 12582912
    s_mov_b32 s63, 0x20000
    buffer_load_dwordx4 v[96:99], v80, s[60:63], s4 offen nt
    buffer_load_dwordx4 v[100:103], v80, s[60:63], s5 offen nt
    buffer_load_dwordx4 v[104:107], v80, s[60:63], s6 offen nt
    buffer_load_dwordx4 v[108:111], v80, s[60:63], s7 offen nt
    s_mov_b32 s70, 59768832
    s_mov_b32 s71, 0x20000
    v_mov_b32 v240, -1
    v_mov_b32 v241, -1
    v_mov_b32 v242, -1
    v_mov_b32 v243, -1
    s_lshl_b32 s36, s2, 12
    s_add_u32 s36, s36, 29622272
    buffer_store_dwordx4 v[240:243], v224, s[68:71], s36 offen sc1
    s_mul_i32 s87, s38, 8448
    s_lshl_b32 s37, s37, 8
    s_add_u32 s87, s87, s37
    s_add_u32 s87, s87, 29360128
    v_lshlrev_b32 v83, 9, v13
    v_lshl_add_u32 v83, v15, 5, v83
    v_bfe_u32 v13, v0, 4, 1
    v_lshl_add_u32 v83, v13, 4, v83
    v_lshrrev_b32 v13, 5, v0
    v_lshl_add_u32 v83, v13, 8, v83
    v_bfe_u32 v14, v0, 3, 1
    v_xor_b32 v14, v14, v13
    v_lshl_add_u32 v83, v14, 11, v83
    v_lshrrev_b32 v13, 4, v0
    s_lshr_b32 s35, s2, 5
    s_lshl_b32 s35, s35, 2
    s_lshl_b32 s89, s89, 2
    s_add_u32 s89, s89, s28
    s_add_u32 s35, s35, s28
    s_mul_i32 s30, s28, 2112
    s_lshr_b32 s36, s28, 1
    s_mul_i32 s36, s36, 0
    s_add_u32 s30, s30, s36
    s_add_u32 s30, s30, 83200
    v_and_b32 v14, 15, v0
    v_lshlrev_b32 v84, 11, v14
    v_lshl_add_u32 v84, v13, 4, v84
    v_lshlrev_b32 v15, 4, v14
    s_lshr_b32 s36, s28, 1
    s_lshl_b32 s36, s36, 16
    s_and_b32 s37, s28, 1
    s_lshl_b32 s37, s37, 14
    s_add_u32 s36, s36, s37
    v_and_b32 v14, 1, v13
    v_lshl_add_u32 v10, v14, 17, v15
    v_lshrrev_b32 v14, 1, v13
    v_lshl_add_u32 v10, v14, 15, v10
    v_add_u32 v10, s36, v10
    v_add_u32 v11, 7136, v10
    s_lshl_b32 s93, s89, 17
    s_lshl_b32 s36, s94, 6
    v_add_u32 v84, s36, v84
    s_lshl_b32 s86, s2, 2
    s_add_u32 s86, s86, s28
    s_lshl_b32 s86, s86, 7
    v_bfe_u32 v15, v0, 1, 3
    v_lshlrev_b32 v231, 13, v15
    v_and_b32 v15, 1, v0
    v_lshl_add_u32 v231, v15, 7, v231
    s_lshl_b32 s36, s35, 16
    v_add_u32 v231, s36, v231
    s_lshl_b32 s36, s3, 8
    s_mov_b32 s90, 0
    s_and_b32 s92, s90, 6291456
    s_add_u32 s16, s46, s36
    s_addc_u32 s17, s47, 0
    s_mov_b32 s18, 8380672
    s_mov_b32 s19, 0x20000
    s_mul_i32 s29, s28, 4160
    s_lshl_b32 s36, s3, 19
    s_add_u32 s8, s42, s36
    s_addc_u32 s9, s43, 0
    s_sub_u32 s8, s8, 4096
    s_subb_u32 s9, s9, 0
    s_mov_b32 s10, 528384
    s_mov_b32 s11, 0x20000
    s_add_u32 s12, s44, s36
    s_addc_u32 s13, s45, 0
    s_sub_u32 s12, s12, 12288
    s_subb_u32 s13, s13, 0
    s_mov_b32 s14, 536576
    s_mov_b32 s15, 0x20000
    s_mov_b32 s42, 4194304
    s_mov_b32 s43, 0x20000
    s_mov_b32 s44, s54
    s_mov_b32 s45, s55
    s_mov_b32 s46, 7340032
    s_mov_b32 s47, 0x20000
    s_mov_b32 s50, 8388608
    s_mov_b32 s51, 0x20000
    s_mov_b32 s54, 2048
    s_mov_b32 s55, 0x20000
    s_mov_b32 s24, s58
    s_mov_b32 s25, s59
    s_mov_b32 s26, 7340032
    s_mov_b32 s27, 0x20000
    s_mov_b32 s58, 7340032
    s_mov_b32 s59, 0x20000
    s_mov_b32 s66, 4194304
    s_mov_b32 s67, 0x20000
    s_mov_b32 s31, 4294959104
    s_lshl_b32 s36, s28, 9
    s_add_u32 s36, s36, 4096
    v_lshrrev_b32 v13, 4, v0
    v_and_b32 v15, 15, v0
    v_lshlrev_b32 v15, 4, v15
    v_lshl_add_u32 v6, v13, 11, v15
    v_add_u32 v6, s36, v6
    v_add_u32 v7, 4294966496, v6
    v_add_u32 v8, 4294965216, v6
    v_add_u32 v9, 4294964416, v6
    v_bfe_u32 v15, v0, 1, 2
    v_mul_u32_u24 v1, 4160, v15
    v_and_b32 v15, 1, v0
    v_mul_u32_u24 v15, 1056, v15
    v_add_u32 v1, v1, v15
    v_bfe_u32 v15, v0, 3, 1
    v_lshl_add_u32 v1, v15, 8, v1
    v_lshl_add_u32 v1, v13, 4, v1
    v_bfe_u32 v15, v0, 3, 2
    v_mul_u32_u24 v2, 4160, v15
    v_bfe_u32 v15, v0, 2, 1
    v_mul_u32_u24 v15, 1056, v15
    v_add_u32 v2, v2, v15
    v_lshrrev_b32 v15, 5, v0
    v_lshl_add_u32 v2, v15, 8, v2
    v_and_b32 v14, 3, v0
    v_lshl_add_u32 v2, v14, 3, v2
    v_add_u32 v2, 2080, v2
    v_add_u32 v3, 49920, v1
    v_add_u32 v4, 49920, v2
    v_bfe_u32 v13, v0, 2, 3
    v_mul_u32_u24 v5, 1056, v13
    v_lshrrev_b32 v13, 2, v13
    v_mad_u32_u24 v5, v13, 0, v5
    v_lshl_add_u32 v5, v15, 8, v5
    v_lshl_add_u32 v5, v14, 4, v5
    v_add_u32 v5, 83200, v5
    s_mov_b32 s34, 0
    v_lshrrev_b32 v13, 3, v0
    v_mul_u32_u24 v244, 12288, v13
    v_and_b32 v14, 7, v0
    v_lshl_add_u32 v244, v14, 4, v244
    s_lshl_b32 s36, s2, 2
    s_add_u32 s36, s36, s28
    s_lshr_b32 s37, s36, 8
    s_lshl_b32 s37, s37, 21
    s_and_b32 s38, s36, 255
    s_lshl_b32 s38, s38, 12
    s_add_u32 s37, s37, s38
    s_and_b32 s38, s38, 0
    s_add_u32 s37, s37, s38
    s_add_u32 s37, s37, 1048576
    v_and_b32 v13, 7, v0
    v_lshl_add_u32 v246, v13, 7, s37
    s_mov_b32 s78, 1024
    s_lshr_b32 s96, s2, 6
    s_lshl_b32 s96, s96, 2
    s_add_u32 s96, s96, s28
    s_mul_i32 s75, s96, 786432
    s_and_b32 s95, s2, 1
    s_lshl_b32 s95, s95, 5
    s_lshr_b32 s38, s2, 3
    s_and_b32 s95, s2, 63
    s_lshl_b32 s38, s95, 7
    s_add_u32 s75, s75, s38
    s_add_u32 s75, s75, 4096
    v_bfe_u32 v13, v0, 3, 2
    v_lshlrev_b32 v13, 3, v13
    v_lshl_add_u32 v13, v15, 2, v13
    v_bfe_u32 v14, v0, 1, 2
    v_add_u32 v13, v13, v14
    v_mul_u32_u24 v245, 7168, v13
    v_and_b32 v14, 1, v0
    v_lshl_add_u32 v245, v14, 4, v245
    s_and_b32 s36, s2, 7
    s_mul_i32 s36, s36, 28
    s_lshr_b32 s37, s2, 3
    s_add_u32 s36, s36, s37
    s_lshl_b32 s36, s36, 5
    s_mul_i32 s76, s28, 1835008
    s_add_u32 s76, s76, s36
    s_cmp_ge_u32 s2, 224
    s_cselect_b32 s76, 0x10000000, s76
    s_mul_i32 s74, s28, 12288
    s_add_u32 s74, s74, 114688
    s_mov_b32 s73, 0
    s_mov_b32 s72, 6
    v_and_b32 v13, 7, v0
    v_lshlrev_b32 v85, 2, v13
    v_bfe_u32 v14, v0, 3, 1
    v_lshl_add_u32 v85, v14, 12, v85
    v_lshrrev_b32 v15, 4, v0
    v_lshl_add_u32 v85, v15, 5, v85
    v_cvt_f32_u32 v88, v14
    v_bfe_u32 v14, v0, 1, 3
    v_lshlrev_b32 v86, 7, v14
    v_and_b32 v14, 1, v0
    v_lshl_add_u32 v86, v14, 3, v86
    v_and_b32 v14, 31, v0
    v_lshlrev_b32 v230, 7, v14
    s_lshl_b32 s36, s94, 7
    s_add_u32 s20, s36, 29360128
    s_lshl_b32 s21, s89, 12
    s_add_u32 s6, s21, s36
    s_add_u32 s6, s6, 30670848
    s_add_u32 s21, s21, 30801920
    s_lshl_b32 s23, s35, 12
    s_and_b32 s36, s2, 0
    s_lshl_b32 s36, s36, 7
    s_add_u32 s23, s23, s36
    s_add_u32 s23, s23, 30670848
    v_and_b32 v229, 31, v0
    v_lshlrev_b32 v229, 2, v229
    s_mul_i32 s91, s35, 5120
    s_mul_i32 s5, s94, 163840
    s_mul_i32 s36, s89, 5120
    s_add_u32 s5, s5, s36
    s_add_u32 s86, s86, 29491200
    v_lshrrev_b32 v13, 3, v0
    v_add_u32 v13, 0, v13
    v_add_u32 v232, 4, v13
    v_mul_u32_u24 v232, 37, v232
    v_lshrrev_b32 v232, 8, v232
    v_add_u32 v13, v13, v232
    v_and_b32 v232, 0x70, v12
    v_lshl_add_u32 v232, v13, 7, v232
    v_lshrrev_b32 v13, 3, v0
    v_add_u32 v13, 8, v13
    v_add_u32 v233, 4, v13
    v_mul_u32_u24 v233, 37, v233
    v_lshrrev_b32 v233, 8, v233
    v_add_u32 v13, v13, v233
    v_and_b32 v233, 0x70, v12
    v_lshl_add_u32 v233, v13, 7, v233
    v_lshrrev_b32 v13, 3, v0
    v_add_u32 v13, 16, v13
    v_add_u32 v234, 4, v13
    v_mul_u32_u24 v234, 37, v234
    v_lshrrev_b32 v234, 8, v234
    v_add_u32 v13, v13, v234
    v_and_b32 v234, 0x70, v12
    v_lshl_add_u32 v234, v13, 7, v234
    v_lshrrev_b32 v13, 3, v0
    v_add_u32 v13, 24, v13
    v_add_u32 v235, 4, v13
    v_mul_u32_u24 v235, 37, v235
    v_lshrrev_b32 v235, 8, v235
    v_add_u32 v13, v13, v235
    v_and_b32 v235, 0x70, v12
    v_lshl_add_u32 v235, v13, 7, v235
    s_waitcnt vmcnt(9)
    v_lshlrev_b32 v116, 16, v112
    v_and_b32 v117, 0xffff0000, v112
    v_lshlrev_b32 v118, 16, v113
    v_and_b32 v119, 0xffff0000, v113
    v_mul_f32 v136, 3216550459, v116
    v_mul_f32 v137, 3216550459, v117
    v_mul_f32 v138, 3216550459, v118
    v_mul_f32 v139, 3216550459, v119
    v_exp_f32 v136, v136
    v_exp_f32 v137, v137
    v_exp_f32 v138, v138
    v_exp_f32 v139, v139
    v_add_f32 v136, 1.0, v136
    v_add_f32 v137, 1.0, v137
    v_add_f32 v138, 1.0, v138
    v_add_f32 v139, 1.0, v139
    v_rcp_f32 v136, v136
    v_rcp_f32 v137, v137
    v_rcp_f32 v138, v138
    v_rcp_f32 v139, v139
    v_mul_f32 v116, v116, v136
    v_mul_f32 v117, v117, v137
    v_mul_f32 v118, v118, v138
    v_mul_f32 v119, v119, v139
    v_cvt_pk_bf16_f32 v116, v116, 0
    v_cvt_pk_bf16_f32 v117, v117, 0
    v_cvt_pk_bf16_f32 v118, v118, 0
    v_cvt_pk_bf16_f32 v119, v119, 0
    v_and_b32 v14, 1, v0
    v_lshlrev_b32 v14, 4, v14
    v_bfe_u32 v15, v0, 1, 2
    v_lshlrev_b32 v116, v14, v116
    v_lshlrev_b32 v117, v14, v117
    v_lshlrev_b32 v118, v14, v118
    v_lshlrev_b32 v119, v14, v119
    v_cmp_eq_u32 vcc, 0, v15
    s_nop 1
    v_cndmask_b32 v120, 0, v116, vcc
    v_cndmask_b32 v124, 0, v117, vcc
    v_cndmask_b32 v128, 0, v118, vcc
    v_cndmask_b32 v132, 0, v119, vcc
    v_cmp_eq_u32 vcc, 1, v15
    s_nop 1
    v_cndmask_b32 v121, 0, v116, vcc
    v_cndmask_b32 v125, 0, v117, vcc
    v_cndmask_b32 v129, 0, v118, vcc
    v_cndmask_b32 v133, 0, v119, vcc
    v_cmp_eq_u32 vcc, 2, v15
    s_nop 1
    v_cndmask_b32 v122, 0, v116, vcc
    v_cndmask_b32 v126, 0, v117, vcc
    v_cndmask_b32 v130, 0, v118, vcc
    v_cndmask_b32 v134, 0, v119, vcc
    v_cmp_eq_u32 vcc, 3, v15
    s_nop 1
    v_cndmask_b32 v123, 0, v116, vcc
    v_cndmask_b32 v127, 0, v117, vcc
    v_cndmask_b32 v131, 0, v118, vcc
    v_cndmask_b32 v135, 0, v119, vcc
    v_mov_b32 v14, 0x3f803f80
    v_and_b32 v15, 7, v0
    v_lshlrev_b32 v15, 4, v15
    v_lshrrev_b32 v13, 5, v0
    v_lshl_add_u32 v15, v13, 3, v15
    s_lshr_b32 s4, s39, 5
    s_add_u32 s4, s4, 30801920
    s_waitcnt lgkmcnt(0)
    s_add_u32 s85, s85, 1
    s_cmp_eq_u32 s85, -1
    s_cselect_b32 s85, 0, s85
    s_and_b32 s84, s85, 255
    v_mov_b32 v141, s85
    s_waitcnt vmcnt(5)
    v_dot2_f32_bf16 v136, v176, v14, 0
    v_dot2_f32_bf16 v137, v176, v176, 0
    v_dot2_f32_bf16 v138, v177, v14, 0
    v_dot2_f32_bf16 v139, v177, v177, 0
    v_dot2_f32_bf16 v136, v178, v14, v136
    v_dot2_f32_bf16 v137, v178, v178, v137
    v_dot2_f32_bf16 v138, v179, v14, v138
    v_dot2_f32_bf16 v139, v179, v179, v139
    v_dot2_f32_bf16 v136, v180, v14, v136
    v_dot2_f32_bf16 v137, v180, v180, v137
    v_dot2_f32_bf16 v138, v181, v14, v138
    v_dot2_f32_bf16 v139, v181, v181, v139
    v_dot2_f32_bf16 v136, v182, v14, v136
    v_dot2_f32_bf16 v137, v182, v182, v137
    v_dot2_f32_bf16 v138, v183, v14, v138
    v_dot2_f32_bf16 v139, v183, v183, v139
    v_dot2_f32_bf16 v136, v184, v14, v136
    v_dot2_f32_bf16 v137, v184, v184, v137
    v_dot2_f32_bf16 v138, v185, v14, v138
    v_dot2_f32_bf16 v139, v185, v185, v139
    v_dot2_f32_bf16 v136, v186, v14, v136
    v_dot2_f32_bf16 v137, v186, v186, v137
    v_dot2_f32_bf16 v138, v187, v14, v138
    v_dot2_f32_bf16 v139, v187, v187, v139
    v_dot2_f32_bf16 v136, v188, v14, v136
    v_dot2_f32_bf16 v137, v188, v188, v137
    v_dot2_f32_bf16 v138, v189, v14, v138
    v_dot2_f32_bf16 v139, v189, v189, v139
    v_dot2_f32_bf16 v136, v190, v14, v136
    v_dot2_f32_bf16 v137, v190, v190, v137
    v_dot2_f32_bf16 v138, v191, v14, v138
    v_dot2_f32_bf16 v139, v191, v191, v139
    s_nop 2
    v_pk_add_f32 v[136:137], v[136:137], v[138:139]
    s_nop 1
    v_add_f32_dpp v136, v136, v136 row_ror:8 row_mask:0xf bank_mask:0xf
    v_add_f32_dpp v137, v137, v137 row_ror:8 row_mask:0xf bank_mask:0xf
    s_nop 0
    v_add_f32_dpp v136, v136, v136 row_ror:4 row_mask:0xf bank_mask:0xf
    v_add_f32_dpp v137, v137, v137 row_ror:4 row_mask:0xf bank_mask:0xf
    s_nop 0
    v_add_f32_dpp v136, v136, v136 row_ror:2 row_mask:0xf bank_mask:0xf
    v_add_f32_dpp v137, v137, v137 row_ror:2 row_mask:0xf bank_mask:0xf
    s_nop 0
    v_add_f32_dpp v136, v136, v136 row_ror:1 row_mask:0xf bank_mask:0xf
    v_add_f32_dpp v137, v137, v137 row_ror:1 row_mask:0xf bank_mask:0xf
    v_mov_b32 v138, v136
    v_mov_b32 v139, v137
    s_nop 0
    v_permlane16_swap_b32 v136, v138
    v_permlane16_swap_b32 v137, v139
    v_add_f32 v136, v136, v138
    v_add_f32 v137, v137, v139
    v_mul_f32 v136, 981467136, v136
    v_mul_f32 v137, 981467136, v137
    v_fma_f32 v137, -v136, v136, v137
    v_max_f32 v137, 0, v137
    v_cvt_pk_bf16_f32 v138, v136, v137
    v_lshlrev_b32 v136, 16, v138
    v_and_b32 v137, 0xffff0000, v138
    v_add_f32 v137, 925353388, v137
    v_cvt_pk_bf16_f32 v137, v137, v137
    v_lshlrev_b32 v137, 16, v137
    v_sqrt_f32 v137, v137
    s_nop 0
    v_cvt_pk_bf16_f32 v140, v136, v137
    buffer_store_dwordx2 v[140:141], v15, s[68:71], s4 offen sc1
    s_add_u32 s36, s93, 0
    buffer_load_dwordx4 v[144:147], v84, s[40:43], s36 offen nt
    s_add_u32 s36, s93, 32768
    buffer_load_dwordx4 v[148:151], v84, s[40:43], s36 offen nt
    s_add_u32 s36, s93, 65536
    buffer_load_dwordx4 v[152:155], v84, s[40:43], s36 offen nt
    s_add_u32 s36, s93, 98304
    buffer_load_dwordx4 v[156:159], v84, s[40:43], s36 offen nt
    s_add_u32 m0, s30, 0
    s_xor_b32 s32, s90, 0
    buffer_load_dwordx4 v10, s[16:19], s32 offen nt lds
    buffer_load_dwordx4 v11, s[16:19], s32 offen offset:1056 nt lds
    s_add_u32 m0, s30, 8448
    s_xor_b32 s32, s90, 262144
    buffer_load_dwordx4 v10, s[16:19], s32 offen nt lds
    buffer_load_dwordx4 v11, s[16:19], s32 offen offset:1056 nt lds
    s_xor_b32 s36, s92, 2097152
    buffer_load_dword v247, v231, s[16:19], s36 offen nt
    s_waitcnt vmcnt(14)
    v_mfma_f32_16x16x32_bf16 v[116:119], v[120:123], v[96:99], 0
    s_waitcnt vmcnt(13)
    v_mfma_f32_16x16x32_bf16 v[116:119], v[124:127], v[100:103], v[116:119]
    s_waitcnt vmcnt(12)
    v_mfma_f32_16x16x32_bf16 v[116:119], v[128:131], v[104:107], v[116:119]
    s_waitcnt vmcnt(11)
    v_mfma_f32_16x16x32_bf16 v[116:119], v[132:135], v[108:111], v[116:119]
    s_nop 7
    ds_write_b128 v83, v[116:119]
    s_waitcnt vmcnt(10) lgkmcnt(0)
    s_barrier
    s_cmp_lg_u32 s28, 0
    s_cbranch_scc1 attn_np
    ds_read2st64_b32 v[120:121], v82 offset0:0 offset1:1
    ds_read2st64_b32 v[122:123], v82 offset0:2 offset1:3
    ds_read2st64_b32 v[124:125], v82 offset0:4 offset1:5
    ds_read2st64_b32 v[126:127], v82 offset0:6 offset1:7
    s_waitcnt lgkmcnt(0)
    v_pk_add_f32 v[120:121], v[120:121], v[122:123]
    v_pk_add_f32 v[124:125], v[124:125], v[126:127]
    v_pk_add_f32 v[120:121], v[120:121], v[124:125]
    v_add_f32 v120, v120, v121
    v_add_u32 v120, 0x80, v120
    v_and_b32 v120, 0xffffff00, v120
    v_or_b32 v120, s84, v120
    buffer_store_dword v120, v82, s[68:71], s87 offen sc1
attn_np:
    s_waitcnt vmcnt(0)
    s_barrier
    s_add_u32 s36, s20, 0
    buffer_load_dword v96, v85, s[68:71], s36 offen sc1
    s_add_u32 s36, s20, 8448
    buffer_load_dword v97, v85, s[68:71], s36 offen sc1
    s_add_u32 s36, s20, 16896
    buffer_load_dword v98, v85, s[68:71], s36 offen sc1
    s_add_u32 s36, s20, 25344
    buffer_load_dword v99, v85, s[68:71], s36 offen sc1
    s_add_u32 s36, s20, 33792
    buffer_load_dword v100, v85, s[68:71], s36 offen sc1
    s_add_u32 s36, s20, 42240
    buffer_load_dword v101, v85, s[68:71], s36 offen sc1
    s_add_u32 s36, s20, 50688
    buffer_load_dword v102, v85, s[68:71], s36 offen sc1
    s_add_u32 s36, s20, 59136
    buffer_load_dword v103, v85, s[68:71], s36 offen sc1
    buffer_load_dwordx2 v[104:105], v86, s[68:71], s21 offen offset:0 sc1
    buffer_load_dwordx2 v[106:107], v86, s[68:71], s21 offen offset:1024 sc1
    buffer_load_dwordx2 v[108:109], v86, s[68:71], s21 offen offset:2048 sc1
    buffer_load_dwordx2 v[110:111], v86, s[68:71], s21 offen offset:3072 sc1
    v_lshlrev_b32 v16, 16, v144
    v_and_b32 v17, 0xffff0000, v144
    v_lshlrev_b32 v18, 16, v145
    v_and_b32 v19, 0xffff0000, v145
    v_lshlrev_b32 v20, 16, v146
    v_and_b32 v21, 0xffff0000, v146
    v_lshlrev_b32 v22, 16, v147
    v_and_b32 v23, 0xffff0000, v147
    v_lshlrev_b32 v24, 16, v148
    v_and_b32 v25, 0xffff0000, v148
    v_lshlrev_b32 v26, 16, v149
    v_and_b32 v27, 0xffff0000, v149
    v_lshlrev_b32 v28, 16, v150
    v_and_b32 v29, 0xffff0000, v150
    v_lshlrev_b32 v30, 16, v151
    v_and_b32 v31, 0xffff0000, v151
    v_lshlrev_b32 v32, 16, v152
    v_and_b32 v33, 0xffff0000, v152
    v_lshlrev_b32 v34, 16, v153
    v_and_b32 v35, 0xffff0000, v153
    v_lshlrev_b32 v36, 16, v154
    v_and_b32 v37, 0xffff0000, v154
    v_lshlrev_b32 v38, 16, v155
    v_and_b32 v39, 0xffff0000, v155
    v_lshlrev_b32 v40, 16, v156
    v_and_b32 v41, 0xffff0000, v156
    v_lshlrev_b32 v42, 16, v157
    v_and_b32 v43, 0xffff0000, v157
    v_lshlrev_b32 v44, 16, v158
    v_and_b32 v45, 0xffff0000, v158
    v_lshlrev_b32 v46, 16, v159
    v_and_b32 v47, 0xffff0000, v159
    v_mov_b32 v91, 1040356334
    s_waitcnt vmcnt(0)
    v_xor_b32 v96, s84, v96
    v_xor_b32 v97, s84, v97
    v_xor_b32 v98, s84, v98
    v_xor_b32 v99, s84, v99
    v_xor_b32 v100, s84, v100
    v_xor_b32 v101, s84, v101
    v_xor_b32 v102, s84, v102
    v_xor_b32 v103, s84, v103
    v_xor_b32 v105, s85, v105
    v_xor_b32 v107, s85, v107
    v_xor_b32 v109, s85, v109
    v_xor_b32 v111, s85, v111
    v_or_b32 v80, v96, v97
    v_or_b32 v81, v98, v99
    v_or3_b32 v80, v80, v100, v101
    v_or3_b32 v81, v81, v102, v103
    v_or3_b32 v89, v105, v107, v109
    v_or_b32 v80, v80, v81
    v_and_b32 v80, 255, v80
    v_or3_b32 v80, v80, v89, v111
    v_cmp_ne_u32 vcc, 0, v80
    s_mov_b32 s4, 0
    s_nop 0
    s_cbranch_vccnz attn_p1_r
attn_p1_k:
    v_pk_add_f32 v[96:97], v[96:97], v[98:99]
    v_pk_add_f32 v[100:101], v[100:101], v[102:103]
    v_pk_add_f32 v[96:97], v[96:97], v[100:101]
    v_add_f32 v90, v96, v97
    v_cvt_pk_bf16_f32 v90, v90, v90
    v_lshlrev_b32 v90, 16, v90
    v_add_f32 v90, v88, v90
    v_cvt_pk_bf16_f32 v90, v90, v90
    v_lshlrev_b32 v90, 16, v90
    v_and_b32 v105, 0xffff0000, v104
    v_and_b32 v107, 0xffff0000, v106
    v_and_b32 v109, 0xffff0000, v108
    v_and_b32 v111, 0xffff0000, v110
    v_rcp_f32 v105, v105
    v_rcp_f32 v107, v107
    v_rcp_f32 v109, v109
    v_rcp_f32 v111, v111
    v_lshlrev_b32 v104, 16, v104
    v_lshlrev_b32 v106, 16, v106
    v_lshlrev_b32 v108, 16, v108
    v_lshlrev_b32 v110, 16, v110
    v_mul_f32 v105, 1040356334, v105
    v_mul_f32 v107, 1040356334, v107
    v_mul_f32 v109, 1040356334, v109
    v_mul_f32 v111, 1040356334, v111
    v_mul_f32 v104, v104, v105
    v_mul_f32 v106, v106, v107
    v_mul_f32 v108, v108, v109
    v_mul_f32 v110, v110, v111
    v_mov_b32_dpp v112, v90 row_newbcast:8 row_mask:0xf bank_mask:0xf
    v_mov_b32_dpp v113, v90 row_newbcast:9 row_mask:0xf bank_mask:0xf
    v_mov_b32_dpp v114, v90 row_newbcast:10 row_mask:0xf bank_mask:0xf
    v_mov_b32_dpp v115, v90 row_newbcast:11 row_mask:0xf bank_mask:0xf
    v_mov_b32_dpp v116, v90 row_newbcast:12 row_mask:0xf bank_mask:0xf
    v_mov_b32_dpp v117, v90 row_newbcast:13 row_mask:0xf bank_mask:0xf
    v_mov_b32_dpp v118, v90 row_newbcast:14 row_mask:0xf bank_mask:0xf
    v_mov_b32_dpp v119, v90 row_newbcast:15 row_mask:0xf bank_mask:0xf
    v_mul_f32_dpp v96, v90, v91 row_newbcast:0 row_mask:0xf bank_mask:0xf
    v_mul_f32_dpp v97, v90, v91 row_newbcast:1 row_mask:0xf bank_mask:0xf
    v_mul_f32_dpp v98, v90, v91 row_newbcast:2 row_mask:0xf bank_mask:0xf
    v_mul_f32_dpp v99, v90, v91 row_newbcast:3 row_mask:0xf bank_mask:0xf
    v_mul_f32_dpp v100, v90, v91 row_newbcast:4 row_mask:0xf bank_mask:0xf
    v_mul_f32_dpp v101, v90, v91 row_newbcast:5 row_mask:0xf bank_mask:0xf
    v_mul_f32_dpp v102, v90, v91 row_newbcast:6 row_mask:0xf bank_mask:0xf
    v_mul_f32_dpp v103, v90, v91 row_newbcast:7 row_mask:0xf bank_mask:0xf
    v_pk_fma_f32 v[16:17], v[16:17], v[104:105], v[104:105] op_sel:[0,1,0] op_sel_hi:[1,1,0] neg_lo:[0,0,1] neg_hi:[0,0,1]
    v_pk_fma_f32 v[18:19], v[18:19], v[104:105], v[104:105] op_sel:[0,1,0] op_sel_hi:[1,1,0] neg_lo:[0,0,1] neg_hi:[0,0,1]
    v_pk_fma_f32 v[20:21], v[20:21], v[104:105], v[104:105] op_sel:[0,1,0] op_sel_hi:[1,1,0] neg_lo:[0,0,1] neg_hi:[0,0,1]
    v_pk_fma_f32 v[22:23], v[22:23], v[104:105], v[104:105] op_sel:[0,1,0] op_sel_hi:[1,1,0] neg_lo:[0,0,1] neg_hi:[0,0,1]
    v_pk_fma_f32 v[16:17], v[16:17], v[112:113], v[96:97]
    v_pk_fma_f32 v[18:19], v[18:19], v[114:115], v[98:99]
    v_pk_fma_f32 v[20:21], v[20:21], v[116:117], v[100:101]
    v_pk_fma_f32 v[22:23], v[22:23], v[118:119], v[102:103]
    v_cvt_pk_bf16_f32 v144, v16, v17
    v_cvt_pk_bf16_f32 v145, v18, v19
    v_cvt_pk_bf16_f32 v146, v20, v21
    v_cvt_pk_bf16_f32 v147, v22, v23
    buffer_store_dwordx4 v[144:147], v232, s[68:71], s5 offen sc1
    v_pk_fma_f32 v[24:25], v[24:25], v[106:107], v[106:107] op_sel:[0,1,0] op_sel_hi:[1,1,0] neg_lo:[0,0,1] neg_hi:[0,0,1]
    v_pk_fma_f32 v[26:27], v[26:27], v[106:107], v[106:107] op_sel:[0,1,0] op_sel_hi:[1,1,0] neg_lo:[0,0,1] neg_hi:[0,0,1]
    v_pk_fma_f32 v[28:29], v[28:29], v[106:107], v[106:107] op_sel:[0,1,0] op_sel_hi:[1,1,0] neg_lo:[0,0,1] neg_hi:[0,0,1]
    v_pk_fma_f32 v[30:31], v[30:31], v[106:107], v[106:107] op_sel:[0,1,0] op_sel_hi:[1,1,0] neg_lo:[0,0,1] neg_hi:[0,0,1]
    v_pk_fma_f32 v[24:25], v[24:25], v[112:113], v[96:97]
    v_pk_fma_f32 v[26:27], v[26:27], v[114:115], v[98:99]
    v_pk_fma_f32 v[28:29], v[28:29], v[116:117], v[100:101]
    v_pk_fma_f32 v[30:31], v[30:31], v[118:119], v[102:103]
    v_cvt_pk_bf16_f32 v148, v24, v25
    v_cvt_pk_bf16_f32 v149, v26, v27
    v_cvt_pk_bf16_f32 v150, v28, v29
    v_cvt_pk_bf16_f32 v151, v30, v31
    buffer_store_dwordx4 v[148:151], v233, s[68:71], s5 offen sc1
    v_pk_fma_f32 v[32:33], v[32:33], v[108:109], v[108:109] op_sel:[0,1,0] op_sel_hi:[1,1,0] neg_lo:[0,0,1] neg_hi:[0,0,1]
    v_pk_fma_f32 v[34:35], v[34:35], v[108:109], v[108:109] op_sel:[0,1,0] op_sel_hi:[1,1,0] neg_lo:[0,0,1] neg_hi:[0,0,1]
    v_pk_fma_f32 v[36:37], v[36:37], v[108:109], v[108:109] op_sel:[0,1,0] op_sel_hi:[1,1,0] neg_lo:[0,0,1] neg_hi:[0,0,1]
    v_pk_fma_f32 v[38:39], v[38:39], v[108:109], v[108:109] op_sel:[0,1,0] op_sel_hi:[1,1,0] neg_lo:[0,0,1] neg_hi:[0,0,1]
    v_pk_fma_f32 v[32:33], v[32:33], v[112:113], v[96:97]
    v_pk_fma_f32 v[34:35], v[34:35], v[114:115], v[98:99]
    v_pk_fma_f32 v[36:37], v[36:37], v[116:117], v[100:101]
    v_pk_fma_f32 v[38:39], v[38:39], v[118:119], v[102:103]
    v_cvt_pk_bf16_f32 v152, v32, v33
    v_cvt_pk_bf16_f32 v153, v34, v35
    v_cvt_pk_bf16_f32 v154, v36, v37
    v_cvt_pk_bf16_f32 v155, v38, v39
    buffer_store_dwordx4 v[152:155], v234, s[68:71], s5 offen sc1
    v_pk_fma_f32 v[40:41], v[40:41], v[110:111], v[110:111] op_sel:[0,1,0] op_sel_hi:[1,1,0] neg_lo:[0,0,1] neg_hi:[0,0,1]
    v_pk_fma_f32 v[42:43], v[42:43], v[110:111], v[110:111] op_sel:[0,1,0] op_sel_hi:[1,1,0] neg_lo:[0,0,1] neg_hi:[0,0,1]
    v_pk_fma_f32 v[44:45], v[44:45], v[110:111], v[110:111] op_sel:[0,1,0] op_sel_hi:[1,1,0] neg_lo:[0,0,1] neg_hi:[0,0,1]
    v_pk_fma_f32 v[46:47], v[46:47], v[110:111], v[110:111] op_sel:[0,1,0] op_sel_hi:[1,1,0] neg_lo:[0,0,1] neg_hi:[0,0,1]
    v_pk_fma_f32 v[40:41], v[40:41], v[112:113], v[96:97]
    v_pk_fma_f32 v[42:43], v[42:43], v[114:115], v[98:99]
    v_pk_fma_f32 v[44:45], v[44:45], v[116:117], v[100:101]
    v_pk_fma_f32 v[46:47], v[46:47], v[118:119], v[102:103]
    v_cvt_pk_bf16_f32 v156, v40, v41
    v_cvt_pk_bf16_f32 v157, v42, v43
    v_cvt_pk_bf16_f32 v158, v44, v45
    v_cvt_pk_bf16_f32 v159, v46, v47
    buffer_store_dwordx4 v[156:159], v235, s[68:71], s5 offen sc1
    v_mov_b32 v15, s85
    s_waitcnt vmcnt(0)
    buffer_store_dword v15, v229, s[68:71], s6 offen sc1
    s_add_u32 m0, s30, 16896
    s_xor_b32 s32, s90, 524288
    buffer_load_dwordx4 v10, s[16:19], s32 offen nt lds
    buffer_load_dwordx4 v11, s[16:19], s32 offen offset:1056 nt lds
    s_add_u32 m0, s30, 25344
    s_xor_b32 s32, s90, 786432
    buffer_load_dwordx4 v10, s[16:19], s32 offen nt lds
    buffer_load_dwordx4 v11, s[16:19], s32 offen offset:1056 nt lds
    s_add_u32 m0, s30, 33792
    s_xor_b32 s32, s90, 1048576
    buffer_load_dwordx4 v10, s[16:19], s32 offen nt lds
    buffer_load_dwordx4 v11, s[16:19], s32 offen offset:1056 nt lds
    s_add_u32 m0, s30, 42240
    s_xor_b32 s32, s90, 1310720
    buffer_load_dwordx4 v10, s[16:19], s32 offen nt lds
    buffer_load_dwordx4 v11, s[16:19], s32 offen offset:1056 nt lds
    s_add_u32 m0, s30, 50688
    s_xor_b32 s32, s90, 1572864
    buffer_load_dwordx4 v10, s[16:19], s32 offen nt lds
    buffer_load_dwordx4 v11, s[16:19], s32 offen offset:1056 nt lds
    s_add_u32 m0, s30, 59136
    s_xor_b32 s32, s90, 1835008
    buffer_load_dwordx4 v10, s[16:19], s32 offen nt lds
    buffer_load_dwordx4 v11, s[16:19], s32 offen offset:1056 nt lds
    s_xor_b32 s36, s92, 4194304
    buffer_load_dword v247, v231, s[16:19], s36 offen nt
    s_barrier
    ds_read_b64_tr_b16 a[0:1], v5 offset:0
    ds_read_b64_tr_b16 a[2:3], v5 offset:512
    ds_read_b64_tr_b16 a[4:5], v5 offset:8448
    ds_read_b64_tr_b16 a[6:7], v5 offset:8960
    ds_read_b64_tr_b16 a[8:9], v5 offset:8
    ds_read_b64_tr_b16 a[10:11], v5 offset:520
    ds_read_b64_tr_b16 a[12:13], v5 offset:8456
    ds_read_b64_tr_b16 a[14:15], v5 offset:8968
    ds_read_b64_tr_b16 a[16:17], v5 offset:64
    ds_read_b64_tr_b16 a[18:19], v5 offset:576
    ds_read_b64_tr_b16 a[20:21], v5 offset:8512
    ds_read_b64_tr_b16 a[22:23], v5 offset:9024
    ds_read_b64_tr_b16 a[24:25], v5 offset:72
    ds_read_b64_tr_b16 a[26:27], v5 offset:584
    ds_read_b64_tr_b16 a[28:29], v5 offset:8520
    ds_read_b64_tr_b16 a[30:31], v5 offset:9032
    s_waitcnt vmcnt(0)
    buffer_load_dword v14, v230, s[68:71], s23 offen sc1
    s_waitcnt vmcnt(0)
    v_cmp_ne_u32 vcc, s85, v14
    s_mov_b32 s4, 0
    s_nop 0
    s_cbranch_vccnz attn_p2_r
attn_p2_k:
    s_add_u32 s33, s91, 0
    buffer_load_dwordx4 a[128:131], v232, s[68:71], s33 offen sc1
    buffer_load_dwordx4 a[132:135], v233, s[68:71], s33 offen sc1
    buffer_load_dwordx4 a[136:139], v234, s[68:71], s33 offen sc1
    buffer_load_dwordx4 a[140:143], v235, s[68:71], s33 offen sc1
    s_add_u32 s33, s91, 163840
    buffer_load_dwordx4 a[144:147], v232, s[68:71], s33 offen sc1
    buffer_load_dwordx4 a[148:151], v233, s[68:71], s33 offen sc1
    buffer_load_dwordx4 a[152:155], v234, s[68:71], s33 offen sc1
    buffer_load_dwordx4 a[156:159], v235, s[68:71], s33 offen sc1
    s_waitcnt vmcnt(0) lgkmcnt(0)
    v_mfma_f32_16x16x32_bf16 v[16:19], a[0:3], a[128:131], 0
    v_mfma_f32_16x16x32_bf16 v[16:19], a[4:7], a[144:147], v[16:19]
    s_add_u32 s33, s91, 327680
    buffer_load_dwordx4 a[160:163], v232, s[68:71], s33 offen sc1
    v_mfma_f32_16x16x32_bf16 v[20:23], a[4:7], a[148:151], 0
    ds_read_b64_tr_b16 a[32:33], v5 offset:128
    ds_read_b64_tr_b16 a[34:35], v5 offset:640
    v_mfma_f32_16x16x32_bf16 v[20:23], a[0:3], a[132:135], v[20:23]
    buffer_load_dwordx4 a[164:167], v233, s[68:71], s33 offen sc1
    v_mfma_f32_16x16x32_bf16 v[24:27], a[0:3], a[136:139], 0
    ds_read_b64_tr_b16 a[36:37], v5 offset:8576
    ds_read_b64_tr_b16 a[38:39], v5 offset:9088
    v_mfma_f32_16x16x32_bf16 v[24:27], a[4:7], a[152:155], v[24:27]
    buffer_load_dwordx4 a[168:171], v234, s[68:71], s33 offen sc1
    v_mfma_f32_16x16x32_bf16 v[28:31], a[4:7], a[156:159], 0
    ds_read_b64_tr_b16 a[40:41], v5 offset:136
    ds_read_b64_tr_b16 a[42:43], v5 offset:648
    v_mfma_f32_16x16x32_bf16 v[28:31], a[0:3], a[140:143], v[28:31]
    buffer_load_dwordx4 a[172:175], v235, s[68:71], s33 offen sc1
    v_mfma_f32_16x16x32_bf16 v[44:47], a[8:11], a[140:143], 0
    ds_read_b64_tr_b16 a[44:45], v5 offset:8584
    ds_read_b64_tr_b16 a[46:47], v5 offset:9096
    v_mfma_f32_16x16x32_bf16 v[44:47], a[12:15], a[156:159], v[44:47]
    s_add_u32 s33, s91, 491520
    buffer_load_dwordx4 a[176:179], v232, s[68:71], s33 offen sc1
    v_mfma_f32_16x16x32_bf16 v[40:43], a[12:15], a[152:155], 0
    ds_read_b64_tr_b16 a[48:49], v5 offset:192
    ds_read_b64_tr_b16 a[50:51], v5 offset:704
    v_mfma_f32_16x16x32_bf16 v[40:43], a[8:11], a[136:139], v[40:43]
    buffer_load_dwordx4 a[180:183], v233, s[68:71], s33 offen sc1
    v_mfma_f32_16x16x32_bf16 v[36:39], a[8:11], a[132:135], 0
    ds_read_b64_tr_b16 a[52:53], v5 offset:8640
    ds_read_b64_tr_b16 a[54:55], v5 offset:9152
    v_mfma_f32_16x16x32_bf16 v[36:39], a[12:15], a[148:151], v[36:39]
    buffer_load_dwordx4 a[184:187], v234, s[68:71], s33 offen sc1
    v_mfma_f32_16x16x32_bf16 v[32:35], a[12:15], a[144:147], 0
    ds_read_b64_tr_b16 a[56:57], v5 offset:200
    ds_read_b64_tr_b16 a[58:59], v5 offset:712
    v_mfma_f32_16x16x32_bf16 v[32:35], a[8:11], a[128:131], v[32:35]
    buffer_load_dwordx4 a[188:191], v235, s[68:71], s33 offen sc1
    v_mfma_f32_16x16x32_bf16 v[48:51], a[16:19], a[128:131], 0
    ds_read_b64_tr_b16 a[60:61], v5 offset:8648
    ds_read_b64_tr_b16 a[62:63], v5 offset:9160
    v_mfma_f32_16x16x32_bf16 v[48:51], a[20:23], a[144:147], v[48:51]
    v_mfma_f32_16x16x32_bf16 v[52:55], a[20:23], a[148:151], 0
    v_mfma_f32_16x16x32_bf16 v[52:55], a[16:19], a[132:135], v[52:55]
    v_mfma_f32_16x16x32_bf16 v[56:59], a[16:19], a[136:139], 0
    v_mfma_f32_16x16x32_bf16 v[56:59], a[20:23], a[152:155], v[56:59]
    v_mfma_f32_16x16x32_bf16 v[60:63], a[20:23], a[156:159], 0
    v_mfma_f32_16x16x32_bf16 v[60:63], a[16:19], a[140:143], v[60:63]
    v_mfma_f32_16x16x32_bf16 v[76:79], a[24:27], a[140:143], 0
    v_mfma_f32_16x16x32_bf16 v[76:79], a[28:31], a[156:159], v[76:79]
    v_mfma_f32_16x16x32_bf16 v[72:75], a[28:31], a[152:155], 0
    v_mfma_f32_16x16x32_bf16 v[72:75], a[24:27], a[136:139], v[72:75]
    v_mfma_f32_16x16x32_bf16 v[68:71], a[24:27], a[132:135], 0
    v_mfma_f32_16x16x32_bf16 v[68:71], a[28:31], a[148:151], v[68:71]
    v_mfma_f32_16x16x32_bf16 v[64:67], a[28:31], a[144:147], 0
    v_mfma_f32_16x16x32_bf16 v[64:67], a[24:27], a[128:131], v[64:67]
    s_waitcnt vmcnt(8) lgkmcnt(0)
    s_barrier
    v_mfma_f32_16x16x32_bf16 v[80:83], a[32:35], a[128:131], 0
    s_add_u32 m0, s30, 0
    s_xor_b32 s32, s90, 2097152
    v_mfma_f32_16x16x32_bf16 v[80:83], a[36:39], a[144:147], v[80:83]
    s_add_u32 s33, s91, 655360
    buffer_load_dwordx4 a[192:195], v232, s[68:71], s33 offen sc1
    v_mfma_f32_16x16x32_bf16 v[84:87], a[36:39], a[148:151], 0
    ds_read_b64_tr_b16 a[0:1], v5 offset:16896
    ds_read_b64_tr_b16 a[2:3], v5 offset:17408
    v_mfma_f32_16x16x32_bf16 v[84:87], a[32:35], a[132:135], v[84:87]
    buffer_load_dwordx4 a[196:199], v233, s[68:71], s33 offen sc1
    v_mfma_f32_16x16x32_bf16 v[88:91], a[32:35], a[136:139], 0
    ds_read_b64_tr_b16 a[4:5], v5 offset:25344
    ds_read_b64_tr_b16 a[6:7], v5 offset:25856
    v_mfma_f32_16x16x32_bf16 v[88:91], a[36:39], a[152:155], v[88:91]
    buffer_load_dwordx4 a[200:203], v234, s[68:71], s33 offen sc1
    v_mfma_f32_16x16x32_bf16 v[92:95], a[36:39], a[156:159], 0
    ds_read_b64_tr_b16 a[8:9], v5 offset:16904
    ds_read_b64_tr_b16 a[10:11], v5 offset:17416
    v_mfma_f32_16x16x32_bf16 v[92:95], a[32:35], a[140:143], v[92:95]
    buffer_load_dwordx4 a[204:207], v235, s[68:71], s33 offen sc1
    v_mfma_f32_16x16x32_bf16 v[108:111], a[40:43], a[140:143], 0
    ds_read_b64_tr_b16 a[12:13], v5 offset:25352
    ds_read_b64_tr_b16 a[14:15], v5 offset:25864
    v_mfma_f32_16x16x32_bf16 v[108:111], a[44:47], a[156:159], v[108:111]
    s_add_u32 s33, s91, 819200
    buffer_load_dwordx4 a[208:211], v232, s[68:71], s33 offen sc1
    v_mfma_f32_16x16x32_bf16 v[104:107], a[44:47], a[152:155], 0
    ds_read_b64_tr_b16 a[16:17], v5 offset:16960
    ds_read_b64_tr_b16 a[18:19], v5 offset:17472
    v_mfma_f32_16x16x32_bf16 v[104:107], a[40:43], a[136:139], v[104:107]
    buffer_load_dwordx4 a[212:215], v233, s[68:71], s33 offen sc1
    v_mfma_f32_16x16x32_bf16 v[100:103], a[40:43], a[132:135], 0
    ds_read_b64_tr_b16 a[20:21], v5 offset:25408
    ds_read_b64_tr_b16 a[22:23], v5 offset:25920
    v_mfma_f32_16x16x32_bf16 v[100:103], a[44:47], a[148:151], v[100:103]
    buffer_load_dwordx4 a[216:219], v234, s[68:71], s33 offen sc1
    v_mfma_f32_16x16x32_bf16 v[96:99], a[44:47], a[144:147], 0
    ds_read_b64_tr_b16 a[24:25], v5 offset:16968
    ds_read_b64_tr_b16 a[26:27], v5 offset:17480
    v_mfma_f32_16x16x32_bf16 v[96:99], a[40:43], a[128:131], v[96:99]
    buffer_load_dwordx4 a[220:223], v235, s[68:71], s33 offen sc1
    v_mfma_f32_16x16x32_bf16 v[112:115], a[48:51], a[128:131], 0
    ds_read_b64_tr_b16 a[28:29], v5 offset:25416
    ds_read_b64_tr_b16 a[30:31], v5 offset:25928
    v_mfma_f32_16x16x32_bf16 v[112:115], a[52:55], a[144:147], v[112:115]
    v_mfma_f32_16x16x32_bf16 v[116:119], a[52:55], a[148:151], 0
    v_mfma_f32_16x16x32_bf16 v[116:119], a[48:51], a[132:135], v[116:119]
    buffer_load_dwordx4 v10, s[16:19], s32 offen nt lds
    v_mfma_f32_16x16x32_bf16 v[120:123], a[48:51], a[136:139], 0
    v_mfma_f32_16x16x32_bf16 v[120:123], a[52:55], a[152:155], v[120:123]
    v_mfma_f32_16x16x32_bf16 v[124:127], a[52:55], a[156:159], 0
    v_mfma_f32_16x16x32_bf16 v[124:127], a[48:51], a[140:143], v[124:127]
    buffer_load_dwordx4 v11, s[16:19], s32 offen offset:1056 nt lds
    v_mfma_f32_16x16x32_bf16 v[140:143], a[56:59], a[140:143], 0
    v_mfma_f32_16x16x32_bf16 v[140:143], a[60:63], a[156:159], v[140:143]
    v_mfma_f32_16x16x32_bf16 v[136:139], a[60:63], a[152:155], 0
    v_mfma_f32_16x16x32_bf16 v[136:139], a[56:59], a[136:139], v[136:139]
    v_mfma_f32_16x16x32_bf16 v[132:135], a[56:59], a[132:135], 0
    v_mfma_f32_16x16x32_bf16 v[132:135], a[60:63], a[148:151], v[132:135]
    v_mfma_f32_16x16x32_bf16 v[128:131], a[60:63], a[144:147], 0
    v_mfma_f32_16x16x32_bf16 v[128:131], a[56:59], a[128:131], v[128:131]
    s_waitcnt vmcnt(10) lgkmcnt(0)
    v_mfma_f32_16x16x32_bf16 v[16:19], a[0:3], a[160:163], v[16:19]
    s_add_u32 m0, s30, 8448
    s_xor_b32 s32, s90, 2359296
    v_mfma_f32_16x16x32_bf16 v[16:19], a[4:7], a[176:179], v[16:19]
    s_add_u32 s33, s91, 983040
    v_mfma_f32_16x16x32_bf16 v[20:23], a[4:7], a[180:183], v[20:23]
    ds_read_b64_tr_b16 a[32:33], v5 offset:17024
    ds_read_b64_tr_b16 a[34:35], v5 offset:17536
    v_mfma_f32_16x16x32_bf16 v[20:23], a[0:3], a[164:167], v[20:23]
    buffer_load_dwordx4 a[224:227], v232, s[68:71], s33 offen sc1
    v_mfma_f32_16x16x32_bf16 v[24:27], a[0:3], a[168:171], v[24:27]
    ds_read_b64_tr_b16 a[36:37], v5 offset:25472
    ds_read_b64_tr_b16 a[38:39], v5 offset:25984
    v_mfma_f32_16x16x32_bf16 v[24:27], a[4:7], a[184:187], v[24:27]
    v_mfma_f32_16x16x32_bf16 v[28:31], a[4:7], a[188:191], v[28:31]
    ds_read_b64_tr_b16 a[40:41], v5 offset:17032
    ds_read_b64_tr_b16 a[42:43], v5 offset:17544
    v_mfma_f32_16x16x32_bf16 v[28:31], a[0:3], a[172:175], v[28:31]
    buffer_load_dwordx4 a[228:231], v233, s[68:71], s33 offen sc1
    v_mfma_f32_16x16x32_bf16 v[44:47], a[8:11], a[172:175], v[44:47]
    ds_read_b64_tr_b16 a[44:45], v5 offset:25480
    ds_read_b64_tr_b16 a[46:47], v5 offset:25992
    v_mfma_f32_16x16x32_bf16 v[44:47], a[12:15], a[188:191], v[44:47]
    v_mfma_f32_16x16x32_bf16 v[40:43], a[12:15], a[184:187], v[40:43]
    ds_read_b64_tr_b16 a[48:49], v5 offset:17088
    ds_read_b64_tr_b16 a[50:51], v5 offset:17600
    v_mfma_f32_16x16x32_bf16 v[40:43], a[8:11], a[168:171], v[40:43]
    buffer_load_dwordx4 a[232:235], v234, s[68:71], s33 offen sc1
    v_mfma_f32_16x16x32_bf16 v[36:39], a[8:11], a[164:167], v[36:39]
    ds_read_b64_tr_b16 a[52:53], v5 offset:25536
    ds_read_b64_tr_b16 a[54:55], v5 offset:26048
    v_mfma_f32_16x16x32_bf16 v[36:39], a[12:15], a[180:183], v[36:39]
    v_mfma_f32_16x16x32_bf16 v[32:35], a[12:15], a[176:179], v[32:35]
    ds_read_b64_tr_b16 a[56:57], v5 offset:17096
    ds_read_b64_tr_b16 a[58:59], v5 offset:17608
    v_mfma_f32_16x16x32_bf16 v[32:35], a[8:11], a[160:163], v[32:35]
    buffer_load_dwordx4 a[236:239], v235, s[68:71], s33 offen sc1
    v_mfma_f32_16x16x32_bf16 v[48:51], a[16:19], a[160:163], v[48:51]
    ds_read_b64_tr_b16 a[60:61], v5 offset:25544
    ds_read_b64_tr_b16 a[62:63], v5 offset:26056
    v_mfma_f32_16x16x32_bf16 v[48:51], a[20:23], a[176:179], v[48:51]
    v_mfma_f32_16x16x32_bf16 v[52:55], a[20:23], a[180:183], v[52:55]
    v_mfma_f32_16x16x32_bf16 v[52:55], a[16:19], a[164:167], v[52:55]
    buffer_load_dwordx4 v10, s[16:19], s32 offen nt lds
    v_mfma_f32_16x16x32_bf16 v[56:59], a[16:19], a[168:171], v[56:59]
    v_mfma_f32_16x16x32_bf16 v[56:59], a[20:23], a[184:187], v[56:59]
    v_mfma_f32_16x16x32_bf16 v[60:63], a[20:23], a[188:191], v[60:63]
    v_mfma_f32_16x16x32_bf16 v[60:63], a[16:19], a[172:175], v[60:63]
    buffer_load_dwordx4 v11, s[16:19], s32 offen offset:1056 nt lds
    v_mfma_f32_16x16x32_bf16 v[76:79], a[24:27], a[172:175], v[76:79]
    v_mfma_f32_16x16x32_bf16 v[76:79], a[28:31], a[188:191], v[76:79]
    v_mfma_f32_16x16x32_bf16 v[72:75], a[28:31], a[184:187], v[72:75]
    v_mfma_f32_16x16x32_bf16 v[72:75], a[24:27], a[168:171], v[72:75]
    v_mfma_f32_16x16x32_bf16 v[68:71], a[24:27], a[164:167], v[68:71]
    v_mfma_f32_16x16x32_bf16 v[68:71], a[28:31], a[180:183], v[68:71]
    v_mfma_f32_16x16x32_bf16 v[64:67], a[28:31], a[176:179], v[64:67]
    v_mfma_f32_16x16x32_bf16 v[64:67], a[24:27], a[160:163], v[64:67]
    s_waitcnt vmcnt(16) lgkmcnt(0)
    s_barrier
    v_mfma_f32_16x16x32_bf16 v[80:83], a[32:35], a[160:163], v[80:83]
    s_add_u32 m0, s30, 16896
    s_xor_b32 s32, s90, 2621440
    v_mfma_f32_16x16x32_bf16 v[80:83], a[36:39], a[176:179], v[80:83]
    s_add_u32 s33, s91, 1146880
    v_mfma_f32_16x16x32_bf16 v[84:87], a[36:39], a[180:183], v[84:87]
    ds_read_b64_tr_b16 a[0:1], v5 offset:33792
    ds_read_b64_tr_b16 a[2:3], v5 offset:34304
    v_mfma_f32_16x16x32_bf16 v[84:87], a[32:35], a[164:167], v[84:87]
    buffer_load_dwordx4 a[240:243], v232, s[68:71], s33 offen sc1
    v_mfma_f32_16x16x32_bf16 v[88:91], a[32:35], a[168:171], v[88:91]
    ds_read_b64_tr_b16 a[4:5], v5 offset:42240
    ds_read_b64_tr_b16 a[6:7], v5 offset:42752
    v_mfma_f32_16x16x32_bf16 v[88:91], a[36:39], a[184:187], v[88:91]
    v_mfma_f32_16x16x32_bf16 v[92:95], a[36:39], a[188:191], v[92:95]
    ds_read_b64_tr_b16 a[8:9], v5 offset:33800
    ds_read_b64_tr_b16 a[10:11], v5 offset:34312
    v_mfma_f32_16x16x32_bf16 v[92:95], a[32:35], a[172:175], v[92:95]
    buffer_load_dwordx4 a[244:247], v233, s[68:71], s33 offen sc1
    v_mfma_f32_16x16x32_bf16 v[108:111], a[40:43], a[172:175], v[108:111]
    ds_read_b64_tr_b16 a[12:13], v5 offset:42248
    ds_read_b64_tr_b16 a[14:15], v5 offset:42760
    v_mfma_f32_16x16x32_bf16 v[108:111], a[44:47], a[188:191], v[108:111]
    v_mfma_f32_16x16x32_bf16 v[104:107], a[44:47], a[184:187], v[104:107]
    ds_read_b64_tr_b16 a[16:17], v5 offset:33856
    ds_read_b64_tr_b16 a[18:19], v5 offset:34368
    v_mfma_f32_16x16x32_bf16 v[104:107], a[40:43], a[168:171], v[104:107]
    buffer_load_dwordx4 a[248:251], v234, s[68:71], s33 offen sc1
    v_mfma_f32_16x16x32_bf16 v[100:103], a[40:43], a[164:167], v[100:103]
    ds_read_b64_tr_b16 a[20:21], v5 offset:42304
    ds_read_b64_tr_b16 a[22:23], v5 offset:42816
    v_mfma_f32_16x16x32_bf16 v[100:103], a[44:47], a[180:183], v[100:103]
    v_mfma_f32_16x16x32_bf16 v[96:99], a[44:47], a[176:179], v[96:99]
    ds_read_b64_tr_b16 a[24:25], v5 offset:33864
    ds_read_b64_tr_b16 a[26:27], v5 offset:34376
    v_mfma_f32_16x16x32_bf16 v[96:99], a[40:43], a[160:163], v[96:99]
    buffer_load_dwordx4 a[252:255], v235, s[68:71], s33 offen sc1
    v_mfma_f32_16x16x32_bf16 v[112:115], a[48:51], a[160:163], v[112:115]
    ds_read_b64_tr_b16 a[28:29], v5 offset:42312
    ds_read_b64_tr_b16 a[30:31], v5 offset:42824
    v_mfma_f32_16x16x32_bf16 v[112:115], a[52:55], a[176:179], v[112:115]
    v_mfma_f32_16x16x32_bf16 v[116:119], a[52:55], a[180:183], v[116:119]
    v_mfma_f32_16x16x32_bf16 v[116:119], a[48:51], a[164:167], v[116:119]
    buffer_load_dwordx4 v10, s[16:19], s32 offen nt lds
    v_mfma_f32_16x16x32_bf16 v[120:123], a[48:51], a[168:171], v[120:123]
    v_mfma_f32_16x16x32_bf16 v[120:123], a[52:55], a[184:187], v[120:123]
    v_mfma_f32_16x16x32_bf16 v[124:127], a[52:55], a[188:191], v[124:127]
    v_mfma_f32_16x16x32_bf16 v[124:127], a[48:51], a[172:175], v[124:127]
    buffer_load_dwordx4 v11, s[16:19], s32 offen offset:1056 nt lds
    v_mfma_f32_16x16x32_bf16 v[140:143], a[56:59], a[172:175], v[140:143]
    v_mfma_f32_16x16x32_bf16 v[140:143], a[60:63], a[188:191], v[140:143]
    v_mfma_f32_16x16x32_bf16 v[136:139], a[60:63], a[184:187], v[136:139]
    v_mfma_f32_16x16x32_bf16 v[136:139], a[56:59], a[168:171], v[136:139]
    v_mfma_f32_16x16x32_bf16 v[132:135], a[56:59], a[164:167], v[132:135]
    v_mfma_f32_16x16x32_bf16 v[132:135], a[60:63], a[180:183], v[132:135]
    v_mfma_f32_16x16x32_bf16 v[128:131], a[60:63], a[176:179], v[128:131]
    v_mfma_f32_16x16x32_bf16 v[128:131], a[56:59], a[160:163], v[128:131]
    s_waitcnt vmcnt(14) lgkmcnt(0)
    v_mfma_f32_16x16x32_bf16 v[16:19], a[0:3], a[192:195], v[16:19]
    s_add_u32 m0, s30, 25344
    s_xor_b32 s32, s90, 2883584
    v_mfma_f32_16x16x32_bf16 v[16:19], a[4:7], a[208:211], v[16:19]
    s_add_u32 s33, s91, 1310720
    v_mfma_f32_16x16x32_bf16 v[20:23], a[4:7], a[212:215], v[20:23]
    ds_read_b64_tr_b16 a[32:33], v5 offset:33920
    ds_read_b64_tr_b16 a[34:35], v5 offset:34432
    v_mfma_f32_16x16x32_bf16 v[20:23], a[0:3], a[196:199], v[20:23]
    buffer_load_dwordx4 a[128:131], v232, s[68:71], s33 offen sc1
    v_mfma_f32_16x16x32_bf16 v[24:27], a[0:3], a[200:203], v[24:27]
    ds_read_b64_tr_b16 a[36:37], v5 offset:42368
    ds_read_b64_tr_b16 a[38:39], v5 offset:42880
    v_mfma_f32_16x16x32_bf16 v[24:27], a[4:7], a[216:219], v[24:27]
    v_mfma_f32_16x16x32_bf16 v[28:31], a[4:7], a[220:223], v[28:31]
    ds_read_b64_tr_b16 a[40:41], v5 offset:33928
    ds_read_b64_tr_b16 a[42:43], v5 offset:34440
    v_mfma_f32_16x16x32_bf16 v[28:31], a[0:3], a[204:207], v[28:31]
    buffer_load_dwordx4 a[132:135], v233, s[68:71], s33 offen sc1
    v_mfma_f32_16x16x32_bf16 v[44:47], a[8:11], a[204:207], v[44:47]
    ds_read_b64_tr_b16 a[44:45], v5 offset:42376
    ds_read_b64_tr_b16 a[46:47], v5 offset:42888
    v_mfma_f32_16x16x32_bf16 v[44:47], a[12:15], a[220:223], v[44:47]
    v_mfma_f32_16x16x32_bf16 v[40:43], a[12:15], a[216:219], v[40:43]
    ds_read_b64_tr_b16 a[48:49], v5 offset:33984
    ds_read_b64_tr_b16 a[50:51], v5 offset:34496
    v_mfma_f32_16x16x32_bf16 v[40:43], a[8:11], a[200:203], v[40:43]
    buffer_load_dwordx4 a[136:139], v234, s[68:71], s33 offen sc1
    v_mfma_f32_16x16x32_bf16 v[36:39], a[8:11], a[196:199], v[36:39]
    ds_read_b64_tr_b16 a[52:53], v5 offset:42432
    ds_read_b64_tr_b16 a[54:55], v5 offset:42944
    v_mfma_f32_16x16x32_bf16 v[36:39], a[12:15], a[212:215], v[36:39]
    v_mfma_f32_16x16x32_bf16 v[32:35], a[12:15], a[208:211], v[32:35]
    ds_read_b64_tr_b16 a[56:57], v5 offset:33992
    ds_read_b64_tr_b16 a[58:59], v5 offset:34504
    v_mfma_f32_16x16x32_bf16 v[32:35], a[8:11], a[192:195], v[32:35]
    buffer_load_dwordx4 a[140:143], v235, s[68:71], s33 offen sc1
    v_mfma_f32_16x16x32_bf16 v[48:51], a[16:19], a[192:195], v[48:51]
    ds_read_b64_tr_b16 a[60:61], v5 offset:42440
    ds_read_b64_tr_b16 a[62:63], v5 offset:42952
    v_mfma_f32_16x16x32_bf16 v[48:51], a[20:23], a[208:211], v[48:51]
    v_mfma_f32_16x16x32_bf16 v[52:55], a[20:23], a[212:215], v[52:55]
    v_mfma_f32_16x16x32_bf16 v[52:55], a[16:19], a[196:199], v[52:55]
    buffer_load_dwordx4 v10, s[16:19], s32 offen nt lds
    v_mfma_f32_16x16x32_bf16 v[56:59], a[16:19], a[200:203], v[56:59]
    v_mfma_f32_16x16x32_bf16 v[56:59], a[20:23], a[216:219], v[56:59]
    v_mfma_f32_16x16x32_bf16 v[60:63], a[20:23], a[220:223], v[60:63]
    v_mfma_f32_16x16x32_bf16 v[60:63], a[16:19], a[204:207], v[60:63]
    buffer_load_dwordx4 v11, s[16:19], s32 offen offset:1056 nt lds
    v_mfma_f32_16x16x32_bf16 v[76:79], a[24:27], a[204:207], v[76:79]
    v_mfma_f32_16x16x32_bf16 v[76:79], a[28:31], a[220:223], v[76:79]
    v_mfma_f32_16x16x32_bf16 v[72:75], a[28:31], a[216:219], v[72:75]
    v_mfma_f32_16x16x32_bf16 v[72:75], a[24:27], a[200:203], v[72:75]
    v_mfma_f32_16x16x32_bf16 v[68:71], a[24:27], a[196:199], v[68:71]
    v_mfma_f32_16x16x32_bf16 v[68:71], a[28:31], a[212:215], v[68:71]
    v_mfma_f32_16x16x32_bf16 v[64:67], a[28:31], a[208:211], v[64:67]
    v_mfma_f32_16x16x32_bf16 v[64:67], a[24:27], a[192:195], v[64:67]
    s_waitcnt vmcnt(20) lgkmcnt(0)
    s_barrier
    v_mfma_f32_16x16x32_bf16 v[80:83], a[32:35], a[192:195], v[80:83]
    s_add_u32 m0, s30, 33792
    s_xor_b32 s32, s90, 3145728
    v_mfma_f32_16x16x32_bf16 v[80:83], a[36:39], a[208:211], v[80:83]
    s_add_u32 s33, s91, 1474560
    v_mfma_f32_16x16x32_bf16 v[84:87], a[36:39], a[212:215], v[84:87]
    ds_read_b64_tr_b16 a[0:1], v5 offset:50688
    ds_read_b64_tr_b16 a[2:3], v5 offset:51200
    v_mfma_f32_16x16x32_bf16 v[84:87], a[32:35], a[196:199], v[84:87]
    buffer_load_dwordx4 a[144:147], v232, s[68:71], s33 offen sc1
    v_mfma_f32_16x16x32_bf16 v[88:91], a[32:35], a[200:203], v[88:91]
    ds_read_b64_tr_b16 a[4:5], v5 offset:59136
    ds_read_b64_tr_b16 a[6:7], v5 offset:59648
    v_mfma_f32_16x16x32_bf16 v[88:91], a[36:39], a[216:219], v[88:91]
    v_mfma_f32_16x16x32_bf16 v[92:95], a[36:39], a[220:223], v[92:95]
    ds_read_b64_tr_b16 a[8:9], v5 offset:50696
    ds_read_b64_tr_b16 a[10:11], v5 offset:51208
    v_mfma_f32_16x16x32_bf16 v[92:95], a[32:35], a[204:207], v[92:95]
    buffer_load_dwordx4 a[148:151], v233, s[68:71], s33 offen sc1
    v_mfma_f32_16x16x32_bf16 v[108:111], a[40:43], a[204:207], v[108:111]
    ds_read_b64_tr_b16 a[12:13], v5 offset:59144
    ds_read_b64_tr_b16 a[14:15], v5 offset:59656
    v_mfma_f32_16x16x32_bf16 v[108:111], a[44:47], a[220:223], v[108:111]
    v_mfma_f32_16x16x32_bf16 v[104:107], a[44:47], a[216:219], v[104:107]
    ds_read_b64_tr_b16 a[16:17], v5 offset:50752
    ds_read_b64_tr_b16 a[18:19], v5 offset:51264
    v_mfma_f32_16x16x32_bf16 v[104:107], a[40:43], a[200:203], v[104:107]
    buffer_load_dwordx4 a[152:155], v234, s[68:71], s33 offen sc1
    v_mfma_f32_16x16x32_bf16 v[100:103], a[40:43], a[196:199], v[100:103]
    ds_read_b64_tr_b16 a[20:21], v5 offset:59200
    ds_read_b64_tr_b16 a[22:23], v5 offset:59712
    v_mfma_f32_16x16x32_bf16 v[100:103], a[44:47], a[212:215], v[100:103]
    v_mfma_f32_16x16x32_bf16 v[96:99], a[44:47], a[208:211], v[96:99]
    ds_read_b64_tr_b16 a[24:25], v5 offset:50760
    ds_read_b64_tr_b16 a[26:27], v5 offset:51272
    v_mfma_f32_16x16x32_bf16 v[96:99], a[40:43], a[192:195], v[96:99]
    buffer_load_dwordx4 a[156:159], v235, s[68:71], s33 offen sc1
    v_mfma_f32_16x16x32_bf16 v[112:115], a[48:51], a[192:195], v[112:115]
    ds_read_b64_tr_b16 a[28:29], v5 offset:59208
    ds_read_b64_tr_b16 a[30:31], v5 offset:59720
    v_mfma_f32_16x16x32_bf16 v[112:115], a[52:55], a[208:211], v[112:115]
    v_mfma_f32_16x16x32_bf16 v[116:119], a[52:55], a[212:215], v[116:119]
    v_mfma_f32_16x16x32_bf16 v[116:119], a[48:51], a[196:199], v[116:119]
    buffer_load_dwordx4 v10, s[16:19], s32 offen nt lds
    v_mfma_f32_16x16x32_bf16 v[120:123], a[48:51], a[200:203], v[120:123]
    v_mfma_f32_16x16x32_bf16 v[120:123], a[52:55], a[216:219], v[120:123]
    v_mfma_f32_16x16x32_bf16 v[124:127], a[52:55], a[220:223], v[124:127]
    v_mfma_f32_16x16x32_bf16 v[124:127], a[48:51], a[204:207], v[124:127]
    buffer_load_dwordx4 v11, s[16:19], s32 offen offset:1056 nt lds
    v_mfma_f32_16x16x32_bf16 v[140:143], a[56:59], a[204:207], v[140:143]
    v_mfma_f32_16x16x32_bf16 v[140:143], a[60:63], a[220:223], v[140:143]
    v_mfma_f32_16x16x32_bf16 v[136:139], a[60:63], a[216:219], v[136:139]
    v_mfma_f32_16x16x32_bf16 v[136:139], a[56:59], a[200:203], v[136:139]
    v_mfma_f32_16x16x32_bf16 v[132:135], a[56:59], a[196:199], v[132:135]
    v_mfma_f32_16x16x32_bf16 v[132:135], a[60:63], a[212:215], v[132:135]
    v_mfma_f32_16x16x32_bf16 v[128:131], a[60:63], a[208:211], v[128:131]
    v_mfma_f32_16x16x32_bf16 v[128:131], a[56:59], a[192:195], v[128:131]
    s_waitcnt vmcnt(14) lgkmcnt(0)
    v_mfma_f32_16x16x32_bf16 v[16:19], a[0:3], a[224:227], v[16:19]
    s_add_u32 m0, s30, 42240
    s_xor_b32 s32, s90, 3407872
    v_mfma_f32_16x16x32_bf16 v[16:19], a[4:7], a[240:243], v[16:19]
    s_add_u32 s33, s91, 1638400
    v_mfma_f32_16x16x32_bf16 v[20:23], a[4:7], a[244:247], v[20:23]
    ds_read_b64_tr_b16 a[32:33], v5 offset:50816
    ds_read_b64_tr_b16 a[34:35], v5 offset:51328
    v_mfma_f32_16x16x32_bf16 v[20:23], a[0:3], a[228:231], v[20:23]
    buffer_load_dwordx4 a[160:163], v232, s[68:71], s33 offen sc1
    v_mfma_f32_16x16x32_bf16 v[24:27], a[0:3], a[232:235], v[24:27]
    ds_read_b64_tr_b16 a[36:37], v5 offset:59264
    ds_read_b64_tr_b16 a[38:39], v5 offset:59776
    v_mfma_f32_16x16x32_bf16 v[24:27], a[4:7], a[248:251], v[24:27]
    v_mfma_f32_16x16x32_bf16 v[28:31], a[4:7], a[252:255], v[28:31]
    ds_read_b64_tr_b16 a[40:41], v5 offset:50824
    ds_read_b64_tr_b16 a[42:43], v5 offset:51336
    v_mfma_f32_16x16x32_bf16 v[28:31], a[0:3], a[236:239], v[28:31]
    buffer_load_dwordx4 a[164:167], v233, s[68:71], s33 offen sc1
    v_mfma_f32_16x16x32_bf16 v[44:47], a[8:11], a[236:239], v[44:47]
    ds_read_b64_tr_b16 a[44:45], v5 offset:59272
    ds_read_b64_tr_b16 a[46:47], v5 offset:59784
    v_mfma_f32_16x16x32_bf16 v[44:47], a[12:15], a[252:255], v[44:47]
    v_mfma_f32_16x16x32_bf16 v[40:43], a[12:15], a[248:251], v[40:43]
    ds_read_b64_tr_b16 a[48:49], v5 offset:50880
    ds_read_b64_tr_b16 a[50:51], v5 offset:51392
    v_mfma_f32_16x16x32_bf16 v[40:43], a[8:11], a[232:235], v[40:43]
    buffer_load_dwordx4 a[168:171], v234, s[68:71], s33 offen sc1
    v_mfma_f32_16x16x32_bf16 v[36:39], a[8:11], a[228:231], v[36:39]
    ds_read_b64_tr_b16 a[52:53], v5 offset:59328
    ds_read_b64_tr_b16 a[54:55], v5 offset:59840
    v_mfma_f32_16x16x32_bf16 v[36:39], a[12:15], a[244:247], v[36:39]
    v_mfma_f32_16x16x32_bf16 v[32:35], a[12:15], a[240:243], v[32:35]
    ds_read_b64_tr_b16 a[56:57], v5 offset:50888
    ds_read_b64_tr_b16 a[58:59], v5 offset:51400
    v_mfma_f32_16x16x32_bf16 v[32:35], a[8:11], a[224:227], v[32:35]
    buffer_load_dwordx4 a[172:175], v235, s[68:71], s33 offen sc1
    v_mfma_f32_16x16x32_bf16 v[48:51], a[16:19], a[224:227], v[48:51]
    ds_read_b64_tr_b16 a[60:61], v5 offset:59336
    ds_read_b64_tr_b16 a[62:63], v5 offset:59848
    v_mfma_f32_16x16x32_bf16 v[48:51], a[20:23], a[240:243], v[48:51]
    v_mfma_f32_16x16x32_bf16 v[52:55], a[20:23], a[244:247], v[52:55]
    v_mfma_f32_16x16x32_bf16 v[52:55], a[16:19], a[228:231], v[52:55]
    buffer_load_dwordx4 v10, s[16:19], s32 offen nt lds
    v_mfma_f32_16x16x32_bf16 v[56:59], a[16:19], a[232:235], v[56:59]
    v_mfma_f32_16x16x32_bf16 v[56:59], a[20:23], a[248:251], v[56:59]
    v_mfma_f32_16x16x32_bf16 v[60:63], a[20:23], a[252:255], v[60:63]
    v_mfma_f32_16x16x32_bf16 v[60:63], a[16:19], a[236:239], v[60:63]
    buffer_load_dwordx4 v11, s[16:19], s32 offen offset:1056 nt lds
    v_mfma_f32_16x16x32_bf16 v[76:79], a[24:27], a[236:239], v[76:79]
    v_mfma_f32_16x16x32_bf16 v[76:79], a[28:31], a[252:255], v[76:79]
    v_mfma_f32_16x16x32_bf16 v[72:75], a[28:31], a[248:251], v[72:75]
    v_mfma_f32_16x16x32_bf16 v[72:75], a[24:27], a[232:235], v[72:75]
    v_mfma_f32_16x16x32_bf16 v[68:71], a[24:27], a[228:231], v[68:71]
    v_mfma_f32_16x16x32_bf16 v[68:71], a[28:31], a[244:247], v[68:71]
    v_mfma_f32_16x16x32_bf16 v[64:67], a[28:31], a[240:243], v[64:67]
    v_mfma_f32_16x16x32_bf16 v[64:67], a[24:27], a[224:227], v[64:67]
    s_waitcnt vmcnt(20) lgkmcnt(0)
    s_barrier
    v_mfma_f32_16x16x32_bf16 v[80:83], a[32:35], a[224:227], v[80:83]
    s_add_u32 m0, s30, 50688
    s_xor_b32 s32, s90, 3670016
    v_mfma_f32_16x16x32_bf16 v[80:83], a[36:39], a[240:243], v[80:83]
    s_add_u32 s33, s91, 1802240
    v_mfma_f32_16x16x32_bf16 v[84:87], a[36:39], a[244:247], v[84:87]
    ds_read_b64_tr_b16 a[0:1], v5 offset:0
    ds_read_b64_tr_b16 a[2:3], v5 offset:512
    v_mfma_f32_16x16x32_bf16 v[84:87], a[32:35], a[228:231], v[84:87]
    buffer_load_dwordx4 a[176:179], v232, s[68:71], s33 offen sc1
    v_mfma_f32_16x16x32_bf16 v[88:91], a[32:35], a[232:235], v[88:91]
    ds_read_b64_tr_b16 a[4:5], v5 offset:8448
    ds_read_b64_tr_b16 a[6:7], v5 offset:8960
    v_mfma_f32_16x16x32_bf16 v[88:91], a[36:39], a[248:251], v[88:91]
    v_mfma_f32_16x16x32_bf16 v[92:95], a[36:39], a[252:255], v[92:95]
    ds_read_b64_tr_b16 a[8:9], v5 offset:8
    ds_read_b64_tr_b16 a[10:11], v5 offset:520
    v_mfma_f32_16x16x32_bf16 v[92:95], a[32:35], a[236:239], v[92:95]
    buffer_load_dwordx4 a[180:183], v233, s[68:71], s33 offen sc1
    v_mfma_f32_16x16x32_bf16 v[108:111], a[40:43], a[236:239], v[108:111]
    ds_read_b64_tr_b16 a[12:13], v5 offset:8456
    ds_read_b64_tr_b16 a[14:15], v5 offset:8968
    v_mfma_f32_16x16x32_bf16 v[108:111], a[44:47], a[252:255], v[108:111]
    v_mfma_f32_16x16x32_bf16 v[104:107], a[44:47], a[248:251], v[104:107]
    ds_read_b64_tr_b16 a[16:17], v5 offset:64
    ds_read_b64_tr_b16 a[18:19], v5 offset:576
    v_mfma_f32_16x16x32_bf16 v[104:107], a[40:43], a[232:235], v[104:107]
    buffer_load_dwordx4 a[184:187], v234, s[68:71], s33 offen sc1
    v_mfma_f32_16x16x32_bf16 v[100:103], a[40:43], a[228:231], v[100:103]
    ds_read_b64_tr_b16 a[20:21], v5 offset:8512
    ds_read_b64_tr_b16 a[22:23], v5 offset:9024
    v_mfma_f32_16x16x32_bf16 v[100:103], a[44:47], a[244:247], v[100:103]
    v_mfma_f32_16x16x32_bf16 v[96:99], a[44:47], a[240:243], v[96:99]
    ds_read_b64_tr_b16 a[24:25], v5 offset:72
    ds_read_b64_tr_b16 a[26:27], v5 offset:584
    v_mfma_f32_16x16x32_bf16 v[96:99], a[40:43], a[224:227], v[96:99]
    buffer_load_dwordx4 a[188:191], v235, s[68:71], s33 offen sc1
    v_mfma_f32_16x16x32_bf16 v[112:115], a[48:51], a[224:227], v[112:115]
    ds_read_b64_tr_b16 a[28:29], v5 offset:8520
    ds_read_b64_tr_b16 a[30:31], v5 offset:9032
    v_mfma_f32_16x16x32_bf16 v[112:115], a[52:55], a[240:243], v[112:115]
    v_mfma_f32_16x16x32_bf16 v[116:119], a[52:55], a[244:247], v[116:119]
    v_mfma_f32_16x16x32_bf16 v[116:119], a[48:51], a[228:231], v[116:119]
    buffer_load_dwordx4 v10, s[16:19], s32 offen nt lds
    v_mfma_f32_16x16x32_bf16 v[120:123], a[48:51], a[232:235], v[120:123]
    v_mfma_f32_16x16x32_bf16 v[120:123], a[52:55], a[248:251], v[120:123]
    v_mfma_f32_16x16x32_bf16 v[124:127], a[52:55], a[252:255], v[124:127]
    v_mfma_f32_16x16x32_bf16 v[124:127], a[48:51], a[236:239], v[124:127]
    buffer_load_dwordx4 v11, s[16:19], s32 offen offset:1056 nt lds
    v_mfma_f32_16x16x32_bf16 v[140:143], a[56:59], a[236:239], v[140:143]
    v_mfma_f32_16x16x32_bf16 v[140:143], a[60:63], a[252:255], v[140:143]
    v_mfma_f32_16x16x32_bf16 v[136:139], a[60:63], a[248:251], v[136:139]
    v_mfma_f32_16x16x32_bf16 v[136:139], a[56:59], a[232:235], v[136:139]
    v_mfma_f32_16x16x32_bf16 v[132:135], a[56:59], a[228:231], v[132:135]
    v_mfma_f32_16x16x32_bf16 v[132:135], a[60:63], a[244:247], v[132:135]
    v_mfma_f32_16x16x32_bf16 v[128:131], a[60:63], a[240:243], v[128:131]
    v_mfma_f32_16x16x32_bf16 v[128:131], a[56:59], a[224:227], v[128:131]
    s_waitcnt vmcnt(14) lgkmcnt(0)
    v_mfma_f32_16x16x32_bf16 v[16:19], a[0:3], a[128:131], v[16:19]
    s_add_u32 m0, s30, 59136
    s_xor_b32 s32, s90, 3932160
    v_mfma_f32_16x16x32_bf16 v[16:19], a[4:7], a[144:147], v[16:19]
    s_add_u32 s33, s91, 1966080
    v_mfma_f32_16x16x32_bf16 v[20:23], a[4:7], a[148:151], v[20:23]
    ds_read_b64_tr_b16 a[32:33], v5 offset:128
    ds_read_b64_tr_b16 a[34:35], v5 offset:640
    v_mfma_f32_16x16x32_bf16 v[20:23], a[0:3], a[132:135], v[20:23]
    buffer_load_dwordx4 a[192:195], v232, s[68:71], s33 offen sc1
    v_mfma_f32_16x16x32_bf16 v[24:27], a[0:3], a[136:139], v[24:27]
    ds_read_b64_tr_b16 a[36:37], v5 offset:8576
    ds_read_b64_tr_b16 a[38:39], v5 offset:9088
    v_mfma_f32_16x16x32_bf16 v[24:27], a[4:7], a[152:155], v[24:27]
    v_mfma_f32_16x16x32_bf16 v[28:31], a[4:7], a[156:159], v[28:31]
    ds_read_b64_tr_b16 a[40:41], v5 offset:136
    ds_read_b64_tr_b16 a[42:43], v5 offset:648
    v_mfma_f32_16x16x32_bf16 v[28:31], a[0:3], a[140:143], v[28:31]
    buffer_load_dwordx4 a[196:199], v233, s[68:71], s33 offen sc1
    v_mfma_f32_16x16x32_bf16 v[44:47], a[8:11], a[140:143], v[44:47]
    ds_read_b64_tr_b16 a[44:45], v5 offset:8584
    ds_read_b64_tr_b16 a[46:47], v5 offset:9096
    v_mfma_f32_16x16x32_bf16 v[44:47], a[12:15], a[156:159], v[44:47]
    v_mfma_f32_16x16x32_bf16 v[40:43], a[12:15], a[152:155], v[40:43]
    ds_read_b64_tr_b16 a[48:49], v5 offset:192
    ds_read_b64_tr_b16 a[50:51], v5 offset:704
    v_mfma_f32_16x16x32_bf16 v[40:43], a[8:11], a[136:139], v[40:43]
    buffer_load_dwordx4 a[200:203], v234, s[68:71], s33 offen sc1
    v_mfma_f32_16x16x32_bf16 v[36:39], a[8:11], a[132:135], v[36:39]
    ds_read_b64_tr_b16 a[52:53], v5 offset:8640
    ds_read_b64_tr_b16 a[54:55], v5 offset:9152
    v_mfma_f32_16x16x32_bf16 v[36:39], a[12:15], a[148:151], v[36:39]
    v_mfma_f32_16x16x32_bf16 v[32:35], a[12:15], a[144:147], v[32:35]
    ds_read_b64_tr_b16 a[56:57], v5 offset:200
    ds_read_b64_tr_b16 a[58:59], v5 offset:712
    v_mfma_f32_16x16x32_bf16 v[32:35], a[8:11], a[128:131], v[32:35]
    buffer_load_dwordx4 a[204:207], v235, s[68:71], s33 offen sc1
    v_mfma_f32_16x16x32_bf16 v[48:51], a[16:19], a[128:131], v[48:51]
    ds_read_b64_tr_b16 a[60:61], v5 offset:8648
    ds_read_b64_tr_b16 a[62:63], v5 offset:9160
    v_mfma_f32_16x16x32_bf16 v[48:51], a[20:23], a[144:147], v[48:51]
    v_mfma_f32_16x16x32_bf16 v[52:55], a[20:23], a[148:151], v[52:55]
    v_mfma_f32_16x16x32_bf16 v[52:55], a[16:19], a[132:135], v[52:55]
    buffer_load_dwordx4 v10, s[16:19], s32 offen nt lds
    v_mfma_f32_16x16x32_bf16 v[56:59], a[16:19], a[136:139], v[56:59]
    v_mfma_f32_16x16x32_bf16 v[56:59], a[20:23], a[152:155], v[56:59]
    v_mfma_f32_16x16x32_bf16 v[60:63], a[20:23], a[156:159], v[60:63]
    v_mfma_f32_16x16x32_bf16 v[60:63], a[16:19], a[140:143], v[60:63]
    buffer_load_dwordx4 v11, s[16:19], s32 offen offset:1056 nt lds
    v_mfma_f32_16x16x32_bf16 v[76:79], a[24:27], a[140:143], v[76:79]
    v_mfma_f32_16x16x32_bf16 v[76:79], a[28:31], a[156:159], v[76:79]
    v_mfma_f32_16x16x32_bf16 v[72:75], a[28:31], a[152:155], v[72:75]
    v_mfma_f32_16x16x32_bf16 v[72:75], a[24:27], a[136:139], v[72:75]
    v_mfma_f32_16x16x32_bf16 v[68:71], a[24:27], a[132:135], v[68:71]
    v_mfma_f32_16x16x32_bf16 v[68:71], a[28:31], a[148:151], v[68:71]
    v_mfma_f32_16x16x32_bf16 v[64:67], a[28:31], a[144:147], v[64:67]
    v_mfma_f32_16x16x32_bf16 v[64:67], a[24:27], a[128:131], v[64:67]
    s_waitcnt vmcnt(20) lgkmcnt(0)
    s_barrier
    v_mfma_f32_16x16x32_bf16 v[80:83], a[32:35], a[128:131], v[80:83]
    s_add_u32 m0, s30, 0
    s_xor_b32 s32, s90, 4194304
    v_mfma_f32_16x16x32_bf16 v[80:83], a[36:39], a[144:147], v[80:83]
    s_add_u32 s33, s91, 2129920
    v_mfma_f32_16x16x32_bf16 v[84:87], a[36:39], a[148:151], v[84:87]
    ds_read_b64_tr_b16 a[0:1], v5 offset:16896
    ds_read_b64_tr_b16 a[2:3], v5 offset:17408
    v_mfma_f32_16x16x32_bf16 v[84:87], a[32:35], a[132:135], v[84:87]
    buffer_load_dwordx4 a[208:211], v232, s[68:71], s33 offen sc1
    v_mfma_f32_16x16x32_bf16 v[88:91], a[32:35], a[136:139], v[88:91]
    ds_read_b64_tr_b16 a[4:5], v5 offset:25344
    ds_read_b64_tr_b16 a[6:7], v5 offset:25856
    v_mfma_f32_16x16x32_bf16 v[88:91], a[36:39], a[152:155], v[88:91]
    v_mfma_f32_16x16x32_bf16 v[92:95], a[36:39], a[156:159], v[92:95]
    ds_read_b64_tr_b16 a[8:9], v5 offset:16904
    ds_read_b64_tr_b16 a[10:11], v5 offset:17416
    v_mfma_f32_16x16x32_bf16 v[92:95], a[32:35], a[140:143], v[92:95]
    buffer_load_dwordx4 a[212:215], v233, s[68:71], s33 offen sc1
    v_mfma_f32_16x16x32_bf16 v[108:111], a[40:43], a[140:143], v[108:111]
    ds_read_b64_tr_b16 a[12:13], v5 offset:25352
    ds_read_b64_tr_b16 a[14:15], v5 offset:25864
    v_mfma_f32_16x16x32_bf16 v[108:111], a[44:47], a[156:159], v[108:111]
    v_mfma_f32_16x16x32_bf16 v[104:107], a[44:47], a[152:155], v[104:107]
    ds_read_b64_tr_b16 a[16:17], v5 offset:16960
    ds_read_b64_tr_b16 a[18:19], v5 offset:17472
    v_mfma_f32_16x16x32_bf16 v[104:107], a[40:43], a[136:139], v[104:107]
    buffer_load_dwordx4 a[216:219], v234, s[68:71], s33 offen sc1
    v_mfma_f32_16x16x32_bf16 v[100:103], a[40:43], a[132:135], v[100:103]
    ds_read_b64_tr_b16 a[20:21], v5 offset:25408
    ds_read_b64_tr_b16 a[22:23], v5 offset:25920
    v_mfma_f32_16x16x32_bf16 v[100:103], a[44:47], a[148:151], v[100:103]
    v_mfma_f32_16x16x32_bf16 v[96:99], a[44:47], a[144:147], v[96:99]
    ds_read_b64_tr_b16 a[24:25], v5 offset:16968
    ds_read_b64_tr_b16 a[26:27], v5 offset:17480
    v_mfma_f32_16x16x32_bf16 v[96:99], a[40:43], a[128:131], v[96:99]
    buffer_load_dwordx4 a[220:223], v235, s[68:71], s33 offen sc1
    v_mfma_f32_16x16x32_bf16 v[112:115], a[48:51], a[128:131], v[112:115]
    ds_read_b64_tr_b16 a[28:29], v5 offset:25416
    ds_read_b64_tr_b16 a[30:31], v5 offset:25928
    v_mfma_f32_16x16x32_bf16 v[112:115], a[52:55], a[144:147], v[112:115]
    v_mfma_f32_16x16x32_bf16 v[116:119], a[52:55], a[148:151], v[116:119]
    v_mfma_f32_16x16x32_bf16 v[116:119], a[48:51], a[132:135], v[116:119]
    buffer_load_dwordx4 v10, s[16:19], s32 offen nt lds
    v_mfma_f32_16x16x32_bf16 v[120:123], a[48:51], a[136:139], v[120:123]
    v_mfma_f32_16x16x32_bf16 v[120:123], a[52:55], a[152:155], v[120:123]
    v_mfma_f32_16x16x32_bf16 v[124:127], a[52:55], a[156:159], v[124:127]
    v_mfma_f32_16x16x32_bf16 v[124:127], a[48:51], a[140:143], v[124:127]
    buffer_load_dwordx4 v11, s[16:19], s32 offen offset:1056 nt lds
    v_mfma_f32_16x16x32_bf16 v[140:143], a[56:59], a[140:143], v[140:143]
    v_mfma_f32_16x16x32_bf16 v[140:143], a[60:63], a[156:159], v[140:143]
    v_mfma_f32_16x16x32_bf16 v[136:139], a[60:63], a[152:155], v[136:139]
    v_mfma_f32_16x16x32_bf16 v[136:139], a[56:59], a[136:139], v[136:139]
    v_mfma_f32_16x16x32_bf16 v[132:135], a[56:59], a[132:135], v[132:135]
    v_mfma_f32_16x16x32_bf16 v[132:135], a[60:63], a[148:151], v[132:135]
    v_mfma_f32_16x16x32_bf16 v[128:131], a[60:63], a[144:147], v[128:131]
    v_mfma_f32_16x16x32_bf16 v[128:131], a[56:59], a[128:131], v[128:131]
    s_waitcnt vmcnt(14) lgkmcnt(0)
    v_mfma_f32_16x16x32_bf16 v[16:19], a[0:3], a[160:163], v[16:19]
    s_add_u32 m0, s30, 8448
    s_xor_b32 s32, s90, 4456448
    v_mfma_f32_16x16x32_bf16 v[16:19], a[4:7], a[176:179], v[16:19]
    s_add_u32 s33, s91, 2293760
    v_mfma_f32_16x16x32_bf16 v[20:23], a[4:7], a[180:183], v[20:23]
    ds_read_b64_tr_b16 a[32:33], v5 offset:17024
    ds_read_b64_tr_b16 a[34:35], v5 offset:17536
    v_mfma_f32_16x16x32_bf16 v[20:23], a[0:3], a[164:167], v[20:23]
    buffer_load_dwordx4 a[224:227], v232, s[68:71], s33 offen sc1
    v_mfma_f32_16x16x32_bf16 v[24:27], a[0:3], a[168:171], v[24:27]
    ds_read_b64_tr_b16 a[36:37], v5 offset:25472
    ds_read_b64_tr_b16 a[38:39], v5 offset:25984
    v_mfma_f32_16x16x32_bf16 v[24:27], a[4:7], a[184:187], v[24:27]
    v_mfma_f32_16x16x32_bf16 v[28:31], a[4:7], a[188:191], v[28:31]
    ds_read_b64_tr_b16 a[40:41], v5 offset:17032
    ds_read_b64_tr_b16 a[42:43], v5 offset:17544
    v_mfma_f32_16x16x32_bf16 v[28:31], a[0:3], a[172:175], v[28:31]
    buffer_load_dwordx4 a[228:231], v233, s[68:71], s33 offen sc1
    v_mfma_f32_16x16x32_bf16 v[44:47], a[8:11], a[172:175], v[44:47]
    ds_read_b64_tr_b16 a[44:45], v5 offset:25480
    ds_read_b64_tr_b16 a[46:47], v5 offset:25992
    v_mfma_f32_16x16x32_bf16 v[44:47], a[12:15], a[188:191], v[44:47]
    v_mfma_f32_16x16x32_bf16 v[40:43], a[12:15], a[184:187], v[40:43]
    ds_read_b64_tr_b16 a[48:49], v5 offset:17088
    ds_read_b64_tr_b16 a[50:51], v5 offset:17600
    v_mfma_f32_16x16x32_bf16 v[40:43], a[8:11], a[168:171], v[40:43]
    buffer_load_dwordx4 a[232:235], v234, s[68:71], s33 offen sc1
    v_mfma_f32_16x16x32_bf16 v[36:39], a[8:11], a[164:167], v[36:39]
    ds_read_b64_tr_b16 a[52:53], v5 offset:25536
    ds_read_b64_tr_b16 a[54:55], v5 offset:26048
    v_mfma_f32_16x16x32_bf16 v[36:39], a[12:15], a[180:183], v[36:39]
    v_mfma_f32_16x16x32_bf16 v[32:35], a[12:15], a[176:179], v[32:35]
    ds_read_b64_tr_b16 a[56:57], v5 offset:17096
    ds_read_b64_tr_b16 a[58:59], v5 offset:17608
    v_mfma_f32_16x16x32_bf16 v[32:35], a[8:11], a[160:163], v[32:35]
    buffer_load_dwordx4 a[236:239], v235, s[68:71], s33 offen sc1
    v_mfma_f32_16x16x32_bf16 v[48:51], a[16:19], a[160:163], v[48:51]
    ds_read_b64_tr_b16 a[60:61], v5 offset:25544
    ds_read_b64_tr_b16 a[62:63], v5 offset:26056
    v_mfma_f32_16x16x32_bf16 v[48:51], a[20:23], a[176:179], v[48:51]
    v_mfma_f32_16x16x32_bf16 v[52:55], a[20:23], a[180:183], v[52:55]
    v_mfma_f32_16x16x32_bf16 v[52:55], a[16:19], a[164:167], v[52:55]
    buffer_load_dwordx4 v10, s[16:19], s32 offen nt lds
    v_mfma_f32_16x16x32_bf16 v[56:59], a[16:19], a[168:171], v[56:59]
    v_mfma_f32_16x16x32_bf16 v[56:59], a[20:23], a[184:187], v[56:59]
    v_mfma_f32_16x16x32_bf16 v[60:63], a[20:23], a[188:191], v[60:63]
    v_mfma_f32_16x16x32_bf16 v[60:63], a[16:19], a[172:175], v[60:63]
    buffer_load_dwordx4 v11, s[16:19], s32 offen offset:1056 nt lds
    v_mfma_f32_16x16x32_bf16 v[76:79], a[24:27], a[172:175], v[76:79]
    v_mfma_f32_16x16x32_bf16 v[76:79], a[28:31], a[188:191], v[76:79]
    v_mfma_f32_16x16x32_bf16 v[72:75], a[28:31], a[184:187], v[72:75]
    v_mfma_f32_16x16x32_bf16 v[72:75], a[24:27], a[168:171], v[72:75]
    v_mfma_f32_16x16x32_bf16 v[68:71], a[24:27], a[164:167], v[68:71]
    v_mfma_f32_16x16x32_bf16 v[68:71], a[28:31], a[180:183], v[68:71]
    v_mfma_f32_16x16x32_bf16 v[64:67], a[28:31], a[176:179], v[64:67]
    v_mfma_f32_16x16x32_bf16 v[64:67], a[24:27], a[160:163], v[64:67]
    s_waitcnt vmcnt(20) lgkmcnt(0)
    s_barrier
    v_mfma_f32_16x16x32_bf16 v[80:83], a[32:35], a[160:163], v[80:83]
    s_add_u32 m0, s30, 16896
    s_xor_b32 s32, s90, 4718592
    v_mfma_f32_16x16x32_bf16 v[80:83], a[36:39], a[176:179], v[80:83]
    s_add_u32 s33, s91, 2457600
    v_mfma_f32_16x16x32_bf16 v[84:87], a[36:39], a[180:183], v[84:87]
    ds_read_b64_tr_b16 a[0:1], v5 offset:33792
    ds_read_b64_tr_b16 a[2:3], v5 offset:34304
    v_mfma_f32_16x16x32_bf16 v[84:87], a[32:35], a[164:167], v[84:87]
    buffer_load_dwordx4 a[240:243], v232, s[68:71], s33 offen sc1
    v_mfma_f32_16x16x32_bf16 v[88:91], a[32:35], a[168:171], v[88:91]
    ds_read_b64_tr_b16 a[4:5], v5 offset:42240
    ds_read_b64_tr_b16 a[6:7], v5 offset:42752
    v_mfma_f32_16x16x32_bf16 v[88:91], a[36:39], a[184:187], v[88:91]
    v_mfma_f32_16x16x32_bf16 v[92:95], a[36:39], a[188:191], v[92:95]
    ds_read_b64_tr_b16 a[8:9], v5 offset:33800
    ds_read_b64_tr_b16 a[10:11], v5 offset:34312
    v_mfma_f32_16x16x32_bf16 v[92:95], a[32:35], a[172:175], v[92:95]
    buffer_load_dwordx4 a[244:247], v233, s[68:71], s33 offen sc1
    v_mfma_f32_16x16x32_bf16 v[108:111], a[40:43], a[172:175], v[108:111]
    ds_read_b64_tr_b16 a[12:13], v5 offset:42248
    ds_read_b64_tr_b16 a[14:15], v5 offset:42760
    v_mfma_f32_16x16x32_bf16 v[108:111], a[44:47], a[188:191], v[108:111]
    v_mfma_f32_16x16x32_bf16 v[104:107], a[44:47], a[184:187], v[104:107]
    ds_read_b64_tr_b16 a[16:17], v5 offset:33856
    ds_read_b64_tr_b16 a[18:19], v5 offset:34368
    v_mfma_f32_16x16x32_bf16 v[104:107], a[40:43], a[168:171], v[104:107]
    buffer_load_dwordx4 a[248:251], v234, s[68:71], s33 offen sc1
    v_mfma_f32_16x16x32_bf16 v[100:103], a[40:43], a[164:167], v[100:103]
    ds_read_b64_tr_b16 a[20:21], v5 offset:42304
    ds_read_b64_tr_b16 a[22:23], v5 offset:42816
    v_mfma_f32_16x16x32_bf16 v[100:103], a[44:47], a[180:183], v[100:103]
    v_mfma_f32_16x16x32_bf16 v[96:99], a[44:47], a[176:179], v[96:99]
    ds_read_b64_tr_b16 a[24:25], v5 offset:33864
    ds_read_b64_tr_b16 a[26:27], v5 offset:34376
    v_mfma_f32_16x16x32_bf16 v[96:99], a[40:43], a[160:163], v[96:99]
    buffer_load_dwordx4 a[252:255], v235, s[68:71], s33 offen sc1
    v_mfma_f32_16x16x32_bf16 v[112:115], a[48:51], a[160:163], v[112:115]
    ds_read_b64_tr_b16 a[28:29], v5 offset:42312
    ds_read_b64_tr_b16 a[30:31], v5 offset:42824
    v_mfma_f32_16x16x32_bf16 v[112:115], a[52:55], a[176:179], v[112:115]
    v_mfma_f32_16x16x32_bf16 v[116:119], a[52:55], a[180:183], v[116:119]
    v_mfma_f32_16x16x32_bf16 v[116:119], a[48:51], a[164:167], v[116:119]
    buffer_load_dwordx4 v10, s[16:19], s32 offen nt lds
    v_mfma_f32_16x16x32_bf16 v[120:123], a[48:51], a[168:171], v[120:123]
    v_mfma_f32_16x16x32_bf16 v[120:123], a[52:55], a[184:187], v[120:123]
    v_mfma_f32_16x16x32_bf16 v[124:127], a[52:55], a[188:191], v[124:127]
    v_mfma_f32_16x16x32_bf16 v[124:127], a[48:51], a[172:175], v[124:127]
    buffer_load_dwordx4 v11, s[16:19], s32 offen offset:1056 nt lds
    v_mfma_f32_16x16x32_bf16 v[140:143], a[56:59], a[172:175], v[140:143]
    v_mfma_f32_16x16x32_bf16 v[140:143], a[60:63], a[188:191], v[140:143]
    v_mfma_f32_16x16x32_bf16 v[136:139], a[60:63], a[184:187], v[136:139]
    v_mfma_f32_16x16x32_bf16 v[136:139], a[56:59], a[168:171], v[136:139]
    v_mfma_f32_16x16x32_bf16 v[132:135], a[56:59], a[164:167], v[132:135]
    v_mfma_f32_16x16x32_bf16 v[132:135], a[60:63], a[180:183], v[132:135]
    v_mfma_f32_16x16x32_bf16 v[128:131], a[60:63], a[176:179], v[128:131]
    v_mfma_f32_16x16x32_bf16 v[128:131], a[56:59], a[160:163], v[128:131]
    s_waitcnt vmcnt(14) lgkmcnt(0)
    v_mfma_f32_16x16x32_bf16 v[16:19], a[0:3], a[192:195], v[16:19]
    s_add_u32 m0, s30, 25344
    s_xor_b32 s32, s90, 4980736
    v_mfma_f32_16x16x32_bf16 v[16:19], a[4:7], a[208:211], v[16:19]
    s_add_u32 s33, s91, 2621440
    v_mfma_f32_16x16x32_bf16 v[20:23], a[4:7], a[212:215], v[20:23]
    ds_read_b64_tr_b16 a[32:33], v5 offset:33920
    ds_read_b64_tr_b16 a[34:35], v5 offset:34432
    v_mfma_f32_16x16x32_bf16 v[20:23], a[0:3], a[196:199], v[20:23]
    buffer_load_dwordx4 a[128:131], v232, s[68:71], s33 offen sc1
    v_mfma_f32_16x16x32_bf16 v[24:27], a[0:3], a[200:203], v[24:27]
    ds_read_b64_tr_b16 a[36:37], v5 offset:42368
    ds_read_b64_tr_b16 a[38:39], v5 offset:42880
    v_mfma_f32_16x16x32_bf16 v[24:27], a[4:7], a[216:219], v[24:27]
    v_mfma_f32_16x16x32_bf16 v[28:31], a[4:7], a[220:223], v[28:31]
    ds_read_b64_tr_b16 a[40:41], v5 offset:33928
    ds_read_b64_tr_b16 a[42:43], v5 offset:34440
    v_mfma_f32_16x16x32_bf16 v[28:31], a[0:3], a[204:207], v[28:31]
    buffer_load_dwordx4 a[132:135], v233, s[68:71], s33 offen sc1
    v_mfma_f32_16x16x32_bf16 v[44:47], a[8:11], a[204:207], v[44:47]
    ds_read_b64_tr_b16 a[44:45], v5 offset:42376
    ds_read_b64_tr_b16 a[46:47], v5 offset:42888
    v_mfma_f32_16x16x32_bf16 v[44:47], a[12:15], a[220:223], v[44:47]
    v_mfma_f32_16x16x32_bf16 v[40:43], a[12:15], a[216:219], v[40:43]
    ds_read_b64_tr_b16 a[48:49], v5 offset:33984
    ds_read_b64_tr_b16 a[50:51], v5 offset:34496
    v_mfma_f32_16x16x32_bf16 v[40:43], a[8:11], a[200:203], v[40:43]
    buffer_load_dwordx4 a[136:139], v234, s[68:71], s33 offen sc1
    v_mfma_f32_16x16x32_bf16 v[36:39], a[8:11], a[196:199], v[36:39]
    ds_read_b64_tr_b16 a[52:53], v5 offset:42432
    ds_read_b64_tr_b16 a[54:55], v5 offset:42944
    v_mfma_f32_16x16x32_bf16 v[36:39], a[12:15], a[212:215], v[36:39]
    v_mfma_f32_16x16x32_bf16 v[32:35], a[12:15], a[208:211], v[32:35]
    ds_read_b64_tr_b16 a[56:57], v5 offset:33992
    ds_read_b64_tr_b16 a[58:59], v5 offset:34504
    v_mfma_f32_16x16x32_bf16 v[32:35], a[8:11], a[192:195], v[32:35]
    buffer_load_dwordx4 a[140:143], v235, s[68:71], s33 offen sc1
    v_mfma_f32_16x16x32_bf16 v[48:51], a[16:19], a[192:195], v[48:51]
    ds_read_b64_tr_b16 a[60:61], v5 offset:42440
    ds_read_b64_tr_b16 a[62:63], v5 offset:42952
    v_mfma_f32_16x16x32_bf16 v[48:51], a[20:23], a[208:211], v[48:51]
    v_mfma_f32_16x16x32_bf16 v[52:55], a[20:23], a[212:215], v[52:55]
    v_mfma_f32_16x16x32_bf16 v[52:55], a[16:19], a[196:199], v[52:55]
    buffer_load_dwordx4 v10, s[16:19], s32 offen nt lds
    v_mfma_f32_16x16x32_bf16 v[56:59], a[16:19], a[200:203], v[56:59]
    v_mfma_f32_16x16x32_bf16 v[56:59], a[20:23], a[216:219], v[56:59]
    v_mfma_f32_16x16x32_bf16 v[60:63], a[20:23], a[220:223], v[60:63]
    v_mfma_f32_16x16x32_bf16 v[60:63], a[16:19], a[204:207], v[60:63]
    buffer_load_dwordx4 v11, s[16:19], s32 offen offset:1056 nt lds
    v_mfma_f32_16x16x32_bf16 v[76:79], a[24:27], a[204:207], v[76:79]
    v_mfma_f32_16x16x32_bf16 v[76:79], a[28:31], a[220:223], v[76:79]
    v_mfma_f32_16x16x32_bf16 v[72:75], a[28:31], a[216:219], v[72:75]
    v_mfma_f32_16x16x32_bf16 v[72:75], a[24:27], a[200:203], v[72:75]
    v_mfma_f32_16x16x32_bf16 v[68:71], a[24:27], a[196:199], v[68:71]
    v_mfma_f32_16x16x32_bf16 v[68:71], a[28:31], a[212:215], v[68:71]
    v_mfma_f32_16x16x32_bf16 v[64:67], a[28:31], a[208:211], v[64:67]
    v_mfma_f32_16x16x32_bf16 v[64:67], a[24:27], a[192:195], v[64:67]
    s_waitcnt vmcnt(20) lgkmcnt(0)
    s_barrier
    v_mfma_f32_16x16x32_bf16 v[80:83], a[32:35], a[192:195], v[80:83]
    s_add_u32 m0, s30, 33792
    s_xor_b32 s32, s90, 5242880
    v_mfma_f32_16x16x32_bf16 v[80:83], a[36:39], a[208:211], v[80:83]
    s_add_u32 s33, s91, 2785280
    v_mfma_f32_16x16x32_bf16 v[84:87], a[36:39], a[212:215], v[84:87]
    ds_read_b64_tr_b16 a[0:1], v5 offset:50688
    ds_read_b64_tr_b16 a[2:3], v5 offset:51200
    v_mfma_f32_16x16x32_bf16 v[84:87], a[32:35], a[196:199], v[84:87]
    buffer_load_dwordx4 a[144:147], v232, s[68:71], s33 offen sc1
    v_mfma_f32_16x16x32_bf16 v[88:91], a[32:35], a[200:203], v[88:91]
    ds_read_b64_tr_b16 a[4:5], v5 offset:59136
    ds_read_b64_tr_b16 a[6:7], v5 offset:59648
    v_mfma_f32_16x16x32_bf16 v[88:91], a[36:39], a[216:219], v[88:91]
    v_mfma_f32_16x16x32_bf16 v[92:95], a[36:39], a[220:223], v[92:95]
    ds_read_b64_tr_b16 a[8:9], v5 offset:50696
    ds_read_b64_tr_b16 a[10:11], v5 offset:51208
    v_mfma_f32_16x16x32_bf16 v[92:95], a[32:35], a[204:207], v[92:95]
    buffer_load_dwordx4 a[148:151], v233, s[68:71], s33 offen sc1
    v_mfma_f32_16x16x32_bf16 v[108:111], a[40:43], a[204:207], v[108:111]
    ds_read_b64_tr_b16 a[12:13], v5 offset:59144
    ds_read_b64_tr_b16 a[14:15], v5 offset:59656
    v_mfma_f32_16x16x32_bf16 v[108:111], a[44:47], a[220:223], v[108:111]
    v_mfma_f32_16x16x32_bf16 v[104:107], a[44:47], a[216:219], v[104:107]
    ds_read_b64_tr_b16 a[16:17], v5 offset:50752
    ds_read_b64_tr_b16 a[18:19], v5 offset:51264
    v_mfma_f32_16x16x32_bf16 v[104:107], a[40:43], a[200:203], v[104:107]
    buffer_load_dwordx4 a[152:155], v234, s[68:71], s33 offen sc1
    v_mfma_f32_16x16x32_bf16 v[100:103], a[40:43], a[196:199], v[100:103]
    ds_read_b64_tr_b16 a[20:21], v5 offset:59200
    ds_read_b64_tr_b16 a[22:23], v5 offset:59712
    v_mfma_f32_16x16x32_bf16 v[100:103], a[44:47], a[212:215], v[100:103]
    v_mfma_f32_16x16x32_bf16 v[96:99], a[44:47], a[208:211], v[96:99]
    ds_read_b64_tr_b16 a[24:25], v5 offset:50760
    ds_read_b64_tr_b16 a[26:27], v5 offset:51272
    v_mfma_f32_16x16x32_bf16 v[96:99], a[40:43], a[192:195], v[96:99]
    buffer_load_dwordx4 a[156:159], v235, s[68:71], s33 offen sc1
    v_mfma_f32_16x16x32_bf16 v[112:115], a[48:51], a[192:195], v[112:115]
    ds_read_b64_tr_b16 a[28:29], v5 offset:59208
    ds_read_b64_tr_b16 a[30:31], v5 offset:59720
    v_mfma_f32_16x16x32_bf16 v[112:115], a[52:55], a[208:211], v[112:115]
    v_mfma_f32_16x16x32_bf16 v[116:119], a[52:55], a[212:215], v[116:119]
    v_mfma_f32_16x16x32_bf16 v[116:119], a[48:51], a[196:199], v[116:119]
    buffer_load_dwordx4 v10, s[16:19], s32 offen nt lds
    v_mfma_f32_16x16x32_bf16 v[120:123], a[48:51], a[200:203], v[120:123]
    v_mfma_f32_16x16x32_bf16 v[120:123], a[52:55], a[216:219], v[120:123]
    v_mfma_f32_16x16x32_bf16 v[124:127], a[52:55], a[220:223], v[124:127]
    v_mfma_f32_16x16x32_bf16 v[124:127], a[48:51], a[204:207], v[124:127]
    buffer_load_dwordx4 v11, s[16:19], s32 offen offset:1056 nt lds
    v_mfma_f32_16x16x32_bf16 v[140:143], a[56:59], a[204:207], v[140:143]
    v_mfma_f32_16x16x32_bf16 v[140:143], a[60:63], a[220:223], v[140:143]
    v_mfma_f32_16x16x32_bf16 v[136:139], a[60:63], a[216:219], v[136:139]
    v_mfma_f32_16x16x32_bf16 v[136:139], a[56:59], a[200:203], v[136:139]
    v_mfma_f32_16x16x32_bf16 v[132:135], a[56:59], a[196:199], v[132:135]
    v_mfma_f32_16x16x32_bf16 v[132:135], a[60:63], a[212:215], v[132:135]
    v_mfma_f32_16x16x32_bf16 v[128:131], a[60:63], a[208:211], v[128:131]
    v_mfma_f32_16x16x32_bf16 v[128:131], a[56:59], a[192:195], v[128:131]
    s_waitcnt vmcnt(14) lgkmcnt(0)
    v_mfma_f32_16x16x32_bf16 v[16:19], a[0:3], a[224:227], v[16:19]
    s_add_u32 m0, s30, 42240
    s_xor_b32 s32, s90, 5505024
    v_mfma_f32_16x16x32_bf16 v[16:19], a[4:7], a[240:243], v[16:19]
    s_add_u32 s33, s91, 2949120
    v_mfma_f32_16x16x32_bf16 v[20:23], a[4:7], a[244:247], v[20:23]
    ds_read_b64_tr_b16 a[32:33], v5 offset:50816
    ds_read_b64_tr_b16 a[34:35], v5 offset:51328
    v_mfma_f32_16x16x32_bf16 v[20:23], a[0:3], a[228:231], v[20:23]
    buffer_load_dwordx4 a[160:163], v232, s[68:71], s33 offen sc1
    v_mfma_f32_16x16x32_bf16 v[24:27], a[0:3], a[232:235], v[24:27]
    ds_read_b64_tr_b16 a[36:37], v5 offset:59264
    ds_read_b64_tr_b16 a[38:39], v5 offset:59776
    v_mfma_f32_16x16x32_bf16 v[24:27], a[4:7], a[248:251], v[24:27]
    v_mfma_f32_16x16x32_bf16 v[28:31], a[4:7], a[252:255], v[28:31]
    ds_read_b64_tr_b16 a[40:41], v5 offset:50824
    ds_read_b64_tr_b16 a[42:43], v5 offset:51336
    v_mfma_f32_16x16x32_bf16 v[28:31], a[0:3], a[236:239], v[28:31]
    buffer_load_dwordx4 a[164:167], v233, s[68:71], s33 offen sc1
    v_mfma_f32_16x16x32_bf16 v[44:47], a[8:11], a[236:239], v[44:47]
    ds_read_b64_tr_b16 a[44:45], v5 offset:59272
    ds_read_b64_tr_b16 a[46:47], v5 offset:59784
    v_mfma_f32_16x16x32_bf16 v[44:47], a[12:15], a[252:255], v[44:47]
    v_mfma_f32_16x16x32_bf16 v[40:43], a[12:15], a[248:251], v[40:43]
    ds_read_b64_tr_b16 a[48:49], v5 offset:50880
    ds_read_b64_tr_b16 a[50:51], v5 offset:51392
    v_mfma_f32_16x16x32_bf16 v[40:43], a[8:11], a[232:235], v[40:43]
    buffer_load_dwordx4 a[168:171], v234, s[68:71], s33 offen sc1
    v_mfma_f32_16x16x32_bf16 v[36:39], a[8:11], a[228:231], v[36:39]
    ds_read_b64_tr_b16 a[52:53], v5 offset:59328
    ds_read_b64_tr_b16 a[54:55], v5 offset:59840
    v_mfma_f32_16x16x32_bf16 v[36:39], a[12:15], a[244:247], v[36:39]
    v_mfma_f32_16x16x32_bf16 v[32:35], a[12:15], a[240:243], v[32:35]
    ds_read_b64_tr_b16 a[56:57], v5 offset:50888
    ds_read_b64_tr_b16 a[58:59], v5 offset:51400
    v_mfma_f32_16x16x32_bf16 v[32:35], a[8:11], a[224:227], v[32:35]
    buffer_load_dwordx4 a[172:175], v235, s[68:71], s33 offen sc1
    v_mfma_f32_16x16x32_bf16 v[48:51], a[16:19], a[224:227], v[48:51]
    ds_read_b64_tr_b16 a[60:61], v5 offset:59336
    ds_read_b64_tr_b16 a[62:63], v5 offset:59848
    v_mfma_f32_16x16x32_bf16 v[48:51], a[20:23], a[240:243], v[48:51]
    v_mfma_f32_16x16x32_bf16 v[52:55], a[20:23], a[244:247], v[52:55]
    v_mfma_f32_16x16x32_bf16 v[52:55], a[16:19], a[228:231], v[52:55]
    buffer_load_dwordx4 v10, s[16:19], s32 offen nt lds
    v_mfma_f32_16x16x32_bf16 v[56:59], a[16:19], a[232:235], v[56:59]
    v_mfma_f32_16x16x32_bf16 v[56:59], a[20:23], a[248:251], v[56:59]
    v_mfma_f32_16x16x32_bf16 v[60:63], a[20:23], a[252:255], v[60:63]
    v_mfma_f32_16x16x32_bf16 v[60:63], a[16:19], a[236:239], v[60:63]
    buffer_load_dwordx4 v11, s[16:19], s32 offen offset:1056 nt lds
    v_mfma_f32_16x16x32_bf16 v[76:79], a[24:27], a[236:239], v[76:79]
    v_mfma_f32_16x16x32_bf16 v[76:79], a[28:31], a[252:255], v[76:79]
    v_mfma_f32_16x16x32_bf16 v[72:75], a[28:31], a[248:251], v[72:75]
    v_mfma_f32_16x16x32_bf16 v[72:75], a[24:27], a[232:235], v[72:75]
    v_mfma_f32_16x16x32_bf16 v[68:71], a[24:27], a[228:231], v[68:71]
    v_mfma_f32_16x16x32_bf16 v[68:71], a[28:31], a[244:247], v[68:71]
    v_mfma_f32_16x16x32_bf16 v[64:67], a[28:31], a[240:243], v[64:67]
    v_mfma_f32_16x16x32_bf16 v[64:67], a[24:27], a[224:227], v[64:67]
    s_waitcnt vmcnt(20) lgkmcnt(0)
    s_barrier
    v_mfma_f32_16x16x32_bf16 v[80:83], a[32:35], a[224:227], v[80:83]
    s_add_u32 m0, s30, 50688
    s_xor_b32 s32, s90, 5767168
    v_mfma_f32_16x16x32_bf16 v[80:83], a[36:39], a[240:243], v[80:83]
    s_add_u32 s33, s91, 3112960
    v_mfma_f32_16x16x32_bf16 v[84:87], a[36:39], a[244:247], v[84:87]
    ds_read_b64_tr_b16 a[0:1], v5 offset:0
    ds_read_b64_tr_b16 a[2:3], v5 offset:512
    v_mfma_f32_16x16x32_bf16 v[84:87], a[32:35], a[228:231], v[84:87]
    buffer_load_dwordx4 a[176:179], v232, s[68:71], s33 offen sc1
    v_mfma_f32_16x16x32_bf16 v[88:91], a[32:35], a[232:235], v[88:91]
    ds_read_b64_tr_b16 a[4:5], v5 offset:8448
    ds_read_b64_tr_b16 a[6:7], v5 offset:8960
    v_mfma_f32_16x16x32_bf16 v[88:91], a[36:39], a[248:251], v[88:91]
    v_mfma_f32_16x16x32_bf16 v[92:95], a[36:39], a[252:255], v[92:95]
    ds_read_b64_tr_b16 a[8:9], v5 offset:8
    ds_read_b64_tr_b16 a[10:11], v5 offset:520
    v_mfma_f32_16x16x32_bf16 v[92:95], a[32:35], a[236:239], v[92:95]
    buffer_load_dwordx4 a[180:183], v233, s[68:71], s33 offen sc1
    v_mfma_f32_16x16x32_bf16 v[108:111], a[40:43], a[236:239], v[108:111]
    ds_read_b64_tr_b16 a[12:13], v5 offset:8456
    ds_read_b64_tr_b16 a[14:15], v5 offset:8968
    v_mfma_f32_16x16x32_bf16 v[108:111], a[44:47], a[252:255], v[108:111]
    v_mfma_f32_16x16x32_bf16 v[104:107], a[44:47], a[248:251], v[104:107]
    ds_read_b64_tr_b16 a[16:17], v5 offset:64
    ds_read_b64_tr_b16 a[18:19], v5 offset:576
    v_mfma_f32_16x16x32_bf16 v[104:107], a[40:43], a[232:235], v[104:107]
    buffer_load_dwordx4 a[184:187], v234, s[68:71], s33 offen sc1
    v_mfma_f32_16x16x32_bf16 v[100:103], a[40:43], a[228:231], v[100:103]
    ds_read_b64_tr_b16 a[20:21], v5 offset:8512
    ds_read_b64_tr_b16 a[22:23], v5 offset:9024
    v_mfma_f32_16x16x32_bf16 v[100:103], a[44:47], a[244:247], v[100:103]
    v_mfma_f32_16x16x32_bf16 v[96:99], a[44:47], a[240:243], v[96:99]
    ds_read_b64_tr_b16 a[24:25], v5 offset:72
    ds_read_b64_tr_b16 a[26:27], v5 offset:584
    v_mfma_f32_16x16x32_bf16 v[96:99], a[40:43], a[224:227], v[96:99]
    buffer_load_dwordx4 a[188:191], v235, s[68:71], s33 offen sc1
    v_mfma_f32_16x16x32_bf16 v[112:115], a[48:51], a[224:227], v[112:115]
    ds_read_b64_tr_b16 a[28:29], v5 offset:8520
    ds_read_b64_tr_b16 a[30:31], v5 offset:9032
    v_mfma_f32_16x16x32_bf16 v[112:115], a[52:55], a[240:243], v[112:115]
    v_mfma_f32_16x16x32_bf16 v[116:119], a[52:55], a[244:247], v[116:119]
    v_mfma_f32_16x16x32_bf16 v[116:119], a[48:51], a[228:231], v[116:119]
    buffer_load_dwordx4 v10, s[16:19], s32 offen nt lds
    v_mfma_f32_16x16x32_bf16 v[120:123], a[48:51], a[232:235], v[120:123]
    v_mfma_f32_16x16x32_bf16 v[120:123], a[52:55], a[248:251], v[120:123]
    v_mfma_f32_16x16x32_bf16 v[124:127], a[52:55], a[252:255], v[124:127]
    v_mfma_f32_16x16x32_bf16 v[124:127], a[48:51], a[236:239], v[124:127]
    buffer_load_dwordx4 v11, s[16:19], s32 offen offset:1056 nt lds
    v_mfma_f32_16x16x32_bf16 v[140:143], a[56:59], a[236:239], v[140:143]
    v_mfma_f32_16x16x32_bf16 v[140:143], a[60:63], a[252:255], v[140:143]
    v_mfma_f32_16x16x32_bf16 v[136:139], a[60:63], a[248:251], v[136:139]
    v_mfma_f32_16x16x32_bf16 v[136:139], a[56:59], a[232:235], v[136:139]
    v_mfma_f32_16x16x32_bf16 v[132:135], a[56:59], a[228:231], v[132:135]
    v_mfma_f32_16x16x32_bf16 v[132:135], a[60:63], a[244:247], v[132:135]
    v_mfma_f32_16x16x32_bf16 v[128:131], a[60:63], a[240:243], v[128:131]
    v_mfma_f32_16x16x32_bf16 v[128:131], a[56:59], a[224:227], v[128:131]
    s_waitcnt vmcnt(14) lgkmcnt(0)
    v_mfma_f32_16x16x32_bf16 v[16:19], a[0:3], a[128:131], v[16:19]
    s_add_u32 m0, s30, 59136
    s_xor_b32 s32, s90, 6029312
    v_mfma_f32_16x16x32_bf16 v[16:19], a[4:7], a[144:147], v[16:19]
    s_add_u32 s33, s91, 3276800
    v_mfma_f32_16x16x32_bf16 v[20:23], a[4:7], a[148:151], v[20:23]
    ds_read_b64_tr_b16 a[32:33], v5 offset:128
    ds_read_b64_tr_b16 a[34:35], v5 offset:640
    v_mfma_f32_16x16x32_bf16 v[20:23], a[0:3], a[132:135], v[20:23]
    buffer_load_dwordx4 a[192:195], v232, s[68:71], s33 offen sc1
    v_mfma_f32_16x16x32_bf16 v[24:27], a[0:3], a[136:139], v[24:27]
    ds_read_b64_tr_b16 a[36:37], v5 offset:8576
    ds_read_b64_tr_b16 a[38:39], v5 offset:9088
    v_mfma_f32_16x16x32_bf16 v[24:27], a[4:7], a[152:155], v[24:27]
    v_mfma_f32_16x16x32_bf16 v[28:31], a[4:7], a[156:159], v[28:31]
    ds_read_b64_tr_b16 a[40:41], v5 offset:136
    ds_read_b64_tr_b16 a[42:43], v5 offset:648
    v_mfma_f32_16x16x32_bf16 v[28:31], a[0:3], a[140:143], v[28:31]
    buffer_load_dwordx4 a[196:199], v233, s[68:71], s33 offen sc1
    v_mfma_f32_16x16x32_bf16 v[44:47], a[8:11], a[140:143], v[44:47]
    ds_read_b64_tr_b16 a[44:45], v5 offset:8584
    ds_read_b64_tr_b16 a[46:47], v5 offset:9096
    v_mfma_f32_16x16x32_bf16 v[44:47], a[12:15], a[156:159], v[44:47]
    v_mfma_f32_16x16x32_bf16 v[40:43], a[12:15], a[152:155], v[40:43]
    ds_read_b64_tr_b16 a[48:49], v5 offset:192
    ds_read_b64_tr_b16 a[50:51], v5 offset:704
    v_mfma_f32_16x16x32_bf16 v[40:43], a[8:11], a[136:139], v[40:43]
    buffer_load_dwordx4 a[200:203], v234, s[68:71], s33 offen sc1
    v_mfma_f32_16x16x32_bf16 v[36:39], a[8:11], a[132:135], v[36:39]
    ds_read_b64_tr_b16 a[52:53], v5 offset:8640
    ds_read_b64_tr_b16 a[54:55], v5 offset:9152
    v_mfma_f32_16x16x32_bf16 v[36:39], a[12:15], a[148:151], v[36:39]
    v_mfma_f32_16x16x32_bf16 v[32:35], a[12:15], a[144:147], v[32:35]
    ds_read_b64_tr_b16 a[56:57], v5 offset:200
    ds_read_b64_tr_b16 a[58:59], v5 offset:712
    v_mfma_f32_16x16x32_bf16 v[32:35], a[8:11], a[128:131], v[32:35]
    buffer_load_dwordx4 a[204:207], v235, s[68:71], s33 offen sc1
    v_mfma_f32_16x16x32_bf16 v[48:51], a[16:19], a[128:131], v[48:51]
    ds_read_b64_tr_b16 a[60:61], v5 offset:8648
    ds_read_b64_tr_b16 a[62:63], v5 offset:9160
    v_mfma_f32_16x16x32_bf16 v[48:51], a[20:23], a[144:147], v[48:51]
    v_mfma_f32_16x16x32_bf16 v[52:55], a[20:23], a[148:151], v[52:55]
    v_mfma_f32_16x16x32_bf16 v[52:55], a[16:19], a[132:135], v[52:55]
    buffer_load_dwordx4 v10, s[16:19], s32 offen nt lds
    v_mfma_f32_16x16x32_bf16 v[56:59], a[16:19], a[136:139], v[56:59]
    v_mfma_f32_16x16x32_bf16 v[56:59], a[20:23], a[152:155], v[56:59]
    v_mfma_f32_16x16x32_bf16 v[60:63], a[20:23], a[156:159], v[60:63]
    v_mfma_f32_16x16x32_bf16 v[60:63], a[16:19], a[140:143], v[60:63]
    buffer_load_dwordx4 v11, s[16:19], s32 offen offset:1056 nt lds
    v_mfma_f32_16x16x32_bf16 v[76:79], a[24:27], a[140:143], v[76:79]
    v_mfma_f32_16x16x32_bf16 v[76:79], a[28:31], a[156:159], v[76:79]
    v_mfma_f32_16x16x32_bf16 v[72:75], a[28:31], a[152:155], v[72:75]
    v_mfma_f32_16x16x32_bf16 v[72:75], a[24:27], a[136:139], v[72:75]
    v_mfma_f32_16x16x32_bf16 v[68:71], a[24:27], a[132:135], v[68:71]
    v_mfma_f32_16x16x32_bf16 v[68:71], a[28:31], a[148:151], v[68:71]
    v_mfma_f32_16x16x32_bf16 v[64:67], a[28:31], a[144:147], v[64:67]
    v_mfma_f32_16x16x32_bf16 v[64:67], a[24:27], a[128:131], v[64:67]
    s_waitcnt vmcnt(20) lgkmcnt(0)
    s_barrier
    v_mfma_f32_16x16x32_bf16 v[80:83], a[32:35], a[128:131], v[80:83]
    s_add_u32 m0, s30, 0
    s_xor_b32 s32, s90, 6291456
    v_mfma_f32_16x16x32_bf16 v[80:83], a[36:39], a[144:147], v[80:83]
    s_add_u32 s33, s91, 3440640
    v_mfma_f32_16x16x32_bf16 v[84:87], a[36:39], a[148:151], v[84:87]
    ds_read_b64_tr_b16 a[0:1], v5 offset:16896
    ds_read_b64_tr_b16 a[2:3], v5 offset:17408
    v_mfma_f32_16x16x32_bf16 v[84:87], a[32:35], a[132:135], v[84:87]
    buffer_load_dwordx4 a[208:211], v232, s[68:71], s33 offen sc1
    v_mfma_f32_16x16x32_bf16 v[88:91], a[32:35], a[136:139], v[88:91]
    ds_read_b64_tr_b16 a[4:5], v5 offset:25344
    ds_read_b64_tr_b16 a[6:7], v5 offset:25856
    v_mfma_f32_16x16x32_bf16 v[88:91], a[36:39], a[152:155], v[88:91]
    v_mfma_f32_16x16x32_bf16 v[92:95], a[36:39], a[156:159], v[92:95]
    ds_read_b64_tr_b16 a[8:9], v5 offset:16904
    ds_read_b64_tr_b16 a[10:11], v5 offset:17416
    v_mfma_f32_16x16x32_bf16 v[92:95], a[32:35], a[140:143], v[92:95]
    buffer_load_dwordx4 a[212:215], v233, s[68:71], s33 offen sc1
    v_mfma_f32_16x16x32_bf16 v[108:111], a[40:43], a[140:143], v[108:111]
    ds_read_b64_tr_b16 a[12:13], v5 offset:25352
    ds_read_b64_tr_b16 a[14:15], v5 offset:25864
    v_mfma_f32_16x16x32_bf16 v[108:111], a[44:47], a[156:159], v[108:111]
    v_mfma_f32_16x16x32_bf16 v[104:107], a[44:47], a[152:155], v[104:107]
    ds_read_b64_tr_b16 a[16:17], v5 offset:16960
    ds_read_b64_tr_b16 a[18:19], v5 offset:17472
    v_mfma_f32_16x16x32_bf16 v[104:107], a[40:43], a[136:139], v[104:107]
    buffer_load_dwordx4 a[216:219], v234, s[68:71], s33 offen sc1
    v_mfma_f32_16x16x32_bf16 v[100:103], a[40:43], a[132:135], v[100:103]
    ds_read_b64_tr_b16 a[20:21], v5 offset:25408
    ds_read_b64_tr_b16 a[22:23], v5 offset:25920
    v_mfma_f32_16x16x32_bf16 v[100:103], a[44:47], a[148:151], v[100:103]
    v_mfma_f32_16x16x32_bf16 v[96:99], a[44:47], a[144:147], v[96:99]
    ds_read_b64_tr_b16 a[24:25], v5 offset:16968
    ds_read_b64_tr_b16 a[26:27], v5 offset:17480
    v_mfma_f32_16x16x32_bf16 v[96:99], a[40:43], a[128:131], v[96:99]
    buffer_load_dwordx4 a[220:223], v235, s[68:71], s33 offen sc1
    v_mfma_f32_16x16x32_bf16 v[112:115], a[48:51], a[128:131], v[112:115]
    ds_read_b64_tr_b16 a[28:29], v5 offset:25416
    ds_read_b64_tr_b16 a[30:31], v5 offset:25928
    v_mfma_f32_16x16x32_bf16 v[112:115], a[52:55], a[144:147], v[112:115]
    v_mfma_f32_16x16x32_bf16 v[116:119], a[52:55], a[148:151], v[116:119]
    v_mfma_f32_16x16x32_bf16 v[116:119], a[48:51], a[132:135], v[116:119]
    buffer_load_dwordx4 v10, s[16:19], s32 offen nt lds
    v_mfma_f32_16x16x32_bf16 v[120:123], a[48:51], a[136:139], v[120:123]
    v_mfma_f32_16x16x32_bf16 v[120:123], a[52:55], a[152:155], v[120:123]
    v_mfma_f32_16x16x32_bf16 v[124:127], a[52:55], a[156:159], v[124:127]
    v_mfma_f32_16x16x32_bf16 v[124:127], a[48:51], a[140:143], v[124:127]
    buffer_load_dwordx4 v11, s[16:19], s32 offen offset:1056 nt lds
    v_mfma_f32_16x16x32_bf16 v[140:143], a[56:59], a[140:143], v[140:143]
    v_mfma_f32_16x16x32_bf16 v[140:143], a[60:63], a[156:159], v[140:143]
    v_mfma_f32_16x16x32_bf16 v[136:139], a[60:63], a[152:155], v[136:139]
    v_mfma_f32_16x16x32_bf16 v[136:139], a[56:59], a[136:139], v[136:139]
    v_mfma_f32_16x16x32_bf16 v[132:135], a[56:59], a[132:135], v[132:135]
    v_mfma_f32_16x16x32_bf16 v[132:135], a[60:63], a[148:151], v[132:135]
    v_mfma_f32_16x16x32_bf16 v[128:131], a[60:63], a[144:147], v[128:131]
    v_mfma_f32_16x16x32_bf16 v[128:131], a[56:59], a[128:131], v[128:131]
    s_waitcnt vmcnt(14) lgkmcnt(0)
    v_mfma_f32_16x16x32_bf16 v[16:19], a[0:3], a[160:163], v[16:19]
    s_add_u32 m0, s30, 8448
    s_xor_b32 s32, s90, 6553600
    v_mfma_f32_16x16x32_bf16 v[16:19], a[4:7], a[176:179], v[16:19]
    s_add_u32 s33, s91, 3604480
    v_mfma_f32_16x16x32_bf16 v[20:23], a[4:7], a[180:183], v[20:23]
    ds_read_b64_tr_b16 a[32:33], v5 offset:17024
    ds_read_b64_tr_b16 a[34:35], v5 offset:17536
    v_mfma_f32_16x16x32_bf16 v[20:23], a[0:3], a[164:167], v[20:23]
    buffer_load_dwordx4 a[224:227], v232, s[68:71], s33 offen sc1
    v_mfma_f32_16x16x32_bf16 v[24:27], a[0:3], a[168:171], v[24:27]
    ds_read_b64_tr_b16 a[36:37], v5 offset:25472
    ds_read_b64_tr_b16 a[38:39], v5 offset:25984
    v_mfma_f32_16x16x32_bf16 v[24:27], a[4:7], a[184:187], v[24:27]
    v_mfma_f32_16x16x32_bf16 v[28:31], a[4:7], a[188:191], v[28:31]
    ds_read_b64_tr_b16 a[40:41], v5 offset:17032
    ds_read_b64_tr_b16 a[42:43], v5 offset:17544
    v_mfma_f32_16x16x32_bf16 v[28:31], a[0:3], a[172:175], v[28:31]
    buffer_load_dwordx4 a[228:231], v233, s[68:71], s33 offen sc1
    v_mfma_f32_16x16x32_bf16 v[44:47], a[8:11], a[172:175], v[44:47]
    ds_read_b64_tr_b16 a[44:45], v5 offset:25480
    ds_read_b64_tr_b16 a[46:47], v5 offset:25992
    v_mfma_f32_16x16x32_bf16 v[44:47], a[12:15], a[188:191], v[44:47]
    v_mfma_f32_16x16x32_bf16 v[40:43], a[12:15], a[184:187], v[40:43]
    ds_read_b64_tr_b16 a[48:49], v5 offset:17088
    ds_read_b64_tr_b16 a[50:51], v5 offset:17600
    v_mfma_f32_16x16x32_bf16 v[40:43], a[8:11], a[168:171], v[40:43]
    buffer_load_dwordx4 a[232:235], v234, s[68:71], s33 offen sc1
    v_mfma_f32_16x16x32_bf16 v[36:39], a[8:11], a[164:167], v[36:39]
    ds_read_b64_tr_b16 a[52:53], v5 offset:25536
    ds_read_b64_tr_b16 a[54:55], v5 offset:26048
    v_mfma_f32_16x16x32_bf16 v[36:39], a[12:15], a[180:183], v[36:39]
    v_mfma_f32_16x16x32_bf16 v[32:35], a[12:15], a[176:179], v[32:35]
    ds_read_b64_tr_b16 a[56:57], v5 offset:17096
    ds_read_b64_tr_b16 a[58:59], v5 offset:17608
    v_mfma_f32_16x16x32_bf16 v[32:35], a[8:11], a[160:163], v[32:35]
    buffer_load_dwordx4 a[236:239], v235, s[68:71], s33 offen sc1
    v_mfma_f32_16x16x32_bf16 v[48:51], a[16:19], a[160:163], v[48:51]
    ds_read_b64_tr_b16 a[60:61], v5 offset:25544
    ds_read_b64_tr_b16 a[62:63], v5 offset:26056
    v_mfma_f32_16x16x32_bf16 v[48:51], a[20:23], a[176:179], v[48:51]
    v_mfma_f32_16x16x32_bf16 v[52:55], a[20:23], a[180:183], v[52:55]
    v_mfma_f32_16x16x32_bf16 v[52:55], a[16:19], a[164:167], v[52:55]
    buffer_load_dwordx4 v10, s[16:19], s32 offen nt lds
    v_mfma_f32_16x16x32_bf16 v[56:59], a[16:19], a[168:171], v[56:59]
    v_mfma_f32_16x16x32_bf16 v[56:59], a[20:23], a[184:187], v[56:59]
    v_mfma_f32_16x16x32_bf16 v[60:63], a[20:23], a[188:191], v[60:63]
    v_mfma_f32_16x16x32_bf16 v[60:63], a[16:19], a[172:175], v[60:63]
    buffer_load_dwordx4 v11, s[16:19], s32 offen offset:1056 nt lds
    v_mfma_f32_16x16x32_bf16 v[76:79], a[24:27], a[172:175], v[76:79]
    v_mfma_f32_16x16x32_bf16 v[76:79], a[28:31], a[188:191], v[76:79]
    v_mfma_f32_16x16x32_bf16 v[72:75], a[28:31], a[184:187], v[72:75]
    v_mfma_f32_16x16x32_bf16 v[72:75], a[24:27], a[168:171], v[72:75]
    v_mfma_f32_16x16x32_bf16 v[68:71], a[24:27], a[164:167], v[68:71]
    v_mfma_f32_16x16x32_bf16 v[68:71], a[28:31], a[180:183], v[68:71]
    v_mfma_f32_16x16x32_bf16 v[64:67], a[28:31], a[176:179], v[64:67]
    v_mfma_f32_16x16x32_bf16 v[64:67], a[24:27], a[160:163], v[64:67]
    s_waitcnt vmcnt(20) lgkmcnt(0)
    s_barrier
    v_mfma_f32_16x16x32_bf16 v[80:83], a[32:35], a[160:163], v[80:83]
    s_add_u32 m0, s30, 16896
    s_xor_b32 s32, s90, 6815744
    v_mfma_f32_16x16x32_bf16 v[80:83], a[36:39], a[176:179], v[80:83]
    s_add_u32 s33, s91, 3768320
    v_mfma_f32_16x16x32_bf16 v[84:87], a[36:39], a[180:183], v[84:87]
    ds_read_b64_tr_b16 a[0:1], v5 offset:33792
    ds_read_b64_tr_b16 a[2:3], v5 offset:34304
    v_mfma_f32_16x16x32_bf16 v[84:87], a[32:35], a[164:167], v[84:87]
    buffer_load_dwordx4 a[240:243], v232, s[68:71], s33 offen sc1
    v_mfma_f32_16x16x32_bf16 v[88:91], a[32:35], a[168:171], v[88:91]
    ds_read_b64_tr_b16 a[4:5], v5 offset:42240
    ds_read_b64_tr_b16 a[6:7], v5 offset:42752
    v_mfma_f32_16x16x32_bf16 v[88:91], a[36:39], a[184:187], v[88:91]
    v_mfma_f32_16x16x32_bf16 v[92:95], a[36:39], a[188:191], v[92:95]
    ds_read_b64_tr_b16 a[8:9], v5 offset:33800
    ds_read_b64_tr_b16 a[10:11], v5 offset:34312
    v_mfma_f32_16x16x32_bf16 v[92:95], a[32:35], a[172:175], v[92:95]
    buffer_load_dwordx4 a[244:247], v233, s[68:71], s33 offen sc1
    v_mfma_f32_16x16x32_bf16 v[108:111], a[40:43], a[172:175], v[108:111]
    ds_read_b64_tr_b16 a[12:13], v5 offset:42248
    ds_read_b64_tr_b16 a[14:15], v5 offset:42760
    v_mfma_f32_16x16x32_bf16 v[108:111], a[44:47], a[188:191], v[108:111]
    v_mfma_f32_16x16x32_bf16 v[104:107], a[44:47], a[184:187], v[104:107]
    ds_read_b64_tr_b16 a[16:17], v5 offset:33856
    ds_read_b64_tr_b16 a[18:19], v5 offset:34368
    v_mfma_f32_16x16x32_bf16 v[104:107], a[40:43], a[168:171], v[104:107]
    buffer_load_dwordx4 a[248:251], v234, s[68:71], s33 offen sc1
    v_mfma_f32_16x16x32_bf16 v[100:103], a[40:43], a[164:167], v[100:103]
    ds_read_b64_tr_b16 a[20:21], v5 offset:42304
    ds_read_b64_tr_b16 a[22:23], v5 offset:42816
    v_mfma_f32_16x16x32_bf16 v[100:103], a[44:47], a[180:183], v[100:103]
    v_mfma_f32_16x16x32_bf16 v[96:99], a[44:47], a[176:179], v[96:99]
    ds_read_b64_tr_b16 a[24:25], v5 offset:33864
    ds_read_b64_tr_b16 a[26:27], v5 offset:34376
    v_mfma_f32_16x16x32_bf16 v[96:99], a[40:43], a[160:163], v[96:99]
    buffer_load_dwordx4 a[252:255], v235, s[68:71], s33 offen sc1
    v_mfma_f32_16x16x32_bf16 v[112:115], a[48:51], a[160:163], v[112:115]
    ds_read_b64_tr_b16 a[28:29], v5 offset:42312
    ds_read_b64_tr_b16 a[30:31], v5 offset:42824
    v_mfma_f32_16x16x32_bf16 v[112:115], a[52:55], a[176:179], v[112:115]
    v_mfma_f32_16x16x32_bf16 v[116:119], a[52:55], a[180:183], v[116:119]
    v_mfma_f32_16x16x32_bf16 v[116:119], a[48:51], a[164:167], v[116:119]
    buffer_load_dwordx4 v10, s[16:19], s32 offen nt lds
    v_mfma_f32_16x16x32_bf16 v[120:123], a[48:51], a[168:171], v[120:123]
    v_mfma_f32_16x16x32_bf16 v[120:123], a[52:55], a[184:187], v[120:123]
    v_mfma_f32_16x16x32_bf16 v[124:127], a[52:55], a[188:191], v[124:127]
    v_mfma_f32_16x16x32_bf16 v[124:127], a[48:51], a[172:175], v[124:127]
    buffer_load_dwordx4 v11, s[16:19], s32 offen offset:1056 nt lds
    v_mfma_f32_16x16x32_bf16 v[140:143], a[56:59], a[172:175], v[140:143]
    v_mfma_f32_16x16x32_bf16 v[140:143], a[60:63], a[188:191], v[140:143]
    v_mfma_f32_16x16x32_bf16 v[136:139], a[60:63], a[184:187], v[136:139]
    v_mfma_f32_16x16x32_bf16 v[136:139], a[56:59], a[168:171], v[136:139]
    v_mfma_f32_16x16x32_bf16 v[132:135], a[56:59], a[164:167], v[132:135]
    v_mfma_f32_16x16x32_bf16 v[132:135], a[60:63], a[180:183], v[132:135]
    v_mfma_f32_16x16x32_bf16 v[128:131], a[60:63], a[176:179], v[128:131]
    v_mfma_f32_16x16x32_bf16 v[128:131], a[56:59], a[160:163], v[128:131]
    s_waitcnt vmcnt(14) lgkmcnt(0)
    v_mfma_f32_16x16x32_bf16 v[16:19], a[0:3], a[192:195], v[16:19]
    s_add_u32 m0, s30, 25344
    s_xor_b32 s32, s90, 7077888
    v_mfma_f32_16x16x32_bf16 v[16:19], a[4:7], a[208:211], v[16:19]
    s_add_u32 s33, s91, 3932160
    v_mfma_f32_16x16x32_bf16 v[20:23], a[4:7], a[212:215], v[20:23]
    ds_read_b64_tr_b16 a[32:33], v5 offset:33920
    ds_read_b64_tr_b16 a[34:35], v5 offset:34432
    v_mfma_f32_16x16x32_bf16 v[20:23], a[0:3], a[196:199], v[20:23]
    buffer_load_dwordx4 a[128:131], v232, s[68:71], s33 offen sc1
    v_mfma_f32_16x16x32_bf16 v[24:27], a[0:3], a[200:203], v[24:27]
    ds_read_b64_tr_b16 a[36:37], v5 offset:42368
    ds_read_b64_tr_b16 a[38:39], v5 offset:42880
    v_mfma_f32_16x16x32_bf16 v[24:27], a[4:7], a[216:219], v[24:27]
    v_mfma_f32_16x16x32_bf16 v[28:31], a[4:7], a[220:223], v[28:31]
    ds_read_b64_tr_b16 a[40:41], v5 offset:33928
    ds_read_b64_tr_b16 a[42:43], v5 offset:34440
    v_mfma_f32_16x16x32_bf16 v[28:31], a[0:3], a[204:207], v[28:31]
    buffer_load_dwordx4 a[132:135], v233, s[68:71], s33 offen sc1
    v_mfma_f32_16x16x32_bf16 v[44:47], a[8:11], a[204:207], v[44:47]
    ds_read_b64_tr_b16 a[44:45], v5 offset:42376
    ds_read_b64_tr_b16 a[46:47], v5 offset:42888
    v_mfma_f32_16x16x32_bf16 v[44:47], a[12:15], a[220:223], v[44:47]
    v_mfma_f32_16x16x32_bf16 v[40:43], a[12:15], a[216:219], v[40:43]
    ds_read_b64_tr_b16 a[48:49], v5 offset:33984
    ds_read_b64_tr_b16 a[50:51], v5 offset:34496
    v_mfma_f32_16x16x32_bf16 v[40:43], a[8:11], a[200:203], v[40:43]
    buffer_load_dwordx4 a[136:139], v234, s[68:71], s33 offen sc1
    v_mfma_f32_16x16x32_bf16 v[36:39], a[8:11], a[196:199], v[36:39]
    ds_read_b64_tr_b16 a[52:53], v5 offset:42432
    ds_read_b64_tr_b16 a[54:55], v5 offset:42944
    v_mfma_f32_16x16x32_bf16 v[36:39], a[12:15], a[212:215], v[36:39]
    v_mfma_f32_16x16x32_bf16 v[32:35], a[12:15], a[208:211], v[32:35]
    ds_read_b64_tr_b16 a[56:57], v5 offset:33992
    ds_read_b64_tr_b16 a[58:59], v5 offset:34504
    v_mfma_f32_16x16x32_bf16 v[32:35], a[8:11], a[192:195], v[32:35]
    buffer_load_dwordx4 a[140:143], v235, s[68:71], s33 offen sc1
    v_mfma_f32_16x16x32_bf16 v[48:51], a[16:19], a[192:195], v[48:51]
    ds_read_b64_tr_b16 a[60:61], v5 offset:42440
    ds_read_b64_tr_b16 a[62:63], v5 offset:42952
    v_mfma_f32_16x16x32_bf16 v[48:51], a[20:23], a[208:211], v[48:51]
    v_mfma_f32_16x16x32_bf16 v[52:55], a[20:23], a[212:215], v[52:55]
    v_mfma_f32_16x16x32_bf16 v[52:55], a[16:19], a[196:199], v[52:55]
    buffer_load_dwordx4 v10, s[16:19], s32 offen nt lds
    v_mfma_f32_16x16x32_bf16 v[56:59], a[16:19], a[200:203], v[56:59]
    v_mfma_f32_16x16x32_bf16 v[56:59], a[20:23], a[216:219], v[56:59]
    v_mfma_f32_16x16x32_bf16 v[60:63], a[20:23], a[220:223], v[60:63]
    v_mfma_f32_16x16x32_bf16 v[60:63], a[16:19], a[204:207], v[60:63]
    buffer_load_dwordx4 v11, s[16:19], s32 offen offset:1056 nt lds
    v_mfma_f32_16x16x32_bf16 v[76:79], a[24:27], a[204:207], v[76:79]
    v_mfma_f32_16x16x32_bf16 v[76:79], a[28:31], a[220:223], v[76:79]
    v_mfma_f32_16x16x32_bf16 v[72:75], a[28:31], a[216:219], v[72:75]
    v_mfma_f32_16x16x32_bf16 v[72:75], a[24:27], a[200:203], v[72:75]
    v_mfma_f32_16x16x32_bf16 v[68:71], a[24:27], a[196:199], v[68:71]
    v_mfma_f32_16x16x32_bf16 v[68:71], a[28:31], a[212:215], v[68:71]
    v_mfma_f32_16x16x32_bf16 v[64:67], a[28:31], a[208:211], v[64:67]
    v_mfma_f32_16x16x32_bf16 v[64:67], a[24:27], a[192:195], v[64:67]
    s_waitcnt vmcnt(20) lgkmcnt(0)
    s_barrier
    v_mfma_f32_16x16x32_bf16 v[80:83], a[32:35], a[192:195], v[80:83]
    s_add_u32 m0, s30, 33792
    s_xor_b32 s32, s90, 7340032
    v_mfma_f32_16x16x32_bf16 v[80:83], a[36:39], a[208:211], v[80:83]
    s_add_u32 s33, s91, 4096000
    v_mfma_f32_16x16x32_bf16 v[84:87], a[36:39], a[212:215], v[84:87]
    ds_read_b64_tr_b16 a[0:1], v5 offset:50688
    ds_read_b64_tr_b16 a[2:3], v5 offset:51200
    v_mfma_f32_16x16x32_bf16 v[84:87], a[32:35], a[196:199], v[84:87]
    buffer_load_dwordx4 a[144:147], v232, s[68:71], s33 offen sc1
    v_mfma_f32_16x16x32_bf16 v[88:91], a[32:35], a[200:203], v[88:91]
    ds_read_b64_tr_b16 a[4:5], v5 offset:59136
    ds_read_b64_tr_b16 a[6:7], v5 offset:59648
    v_mfma_f32_16x16x32_bf16 v[88:91], a[36:39], a[216:219], v[88:91]
    v_mfma_f32_16x16x32_bf16 v[92:95], a[36:39], a[220:223], v[92:95]
    ds_read_b64_tr_b16 a[8:9], v5 offset:50696
    ds_read_b64_tr_b16 a[10:11], v5 offset:51208
    v_mfma_f32_16x16x32_bf16 v[92:95], a[32:35], a[204:207], v[92:95]
    buffer_load_dwordx4 a[148:151], v233, s[68:71], s33 offen sc1
    v_mfma_f32_16x16x32_bf16 v[108:111], a[40:43], a[204:207], v[108:111]
    ds_read_b64_tr_b16 a[12:13], v5 offset:59144
    ds_read_b64_tr_b16 a[14:15], v5 offset:59656
    v_mfma_f32_16x16x32_bf16 v[108:111], a[44:47], a[220:223], v[108:111]
    v_mfma_f32_16x16x32_bf16 v[104:107], a[44:47], a[216:219], v[104:107]
    ds_read_b64_tr_b16 a[16:17], v5 offset:50752
    ds_read_b64_tr_b16 a[18:19], v5 offset:51264
    v_mfma_f32_16x16x32_bf16 v[104:107], a[40:43], a[200:203], v[104:107]
    buffer_load_dwordx4 a[152:155], v234, s[68:71], s33 offen sc1
    v_mfma_f32_16x16x32_bf16 v[100:103], a[40:43], a[196:199], v[100:103]
    ds_read_b64_tr_b16 a[20:21], v5 offset:59200
    ds_read_b64_tr_b16 a[22:23], v5 offset:59712
    v_mfma_f32_16x16x32_bf16 v[100:103], a[44:47], a[212:215], v[100:103]
    v_mfma_f32_16x16x32_bf16 v[96:99], a[44:47], a[208:211], v[96:99]
    ds_read_b64_tr_b16 a[24:25], v5 offset:50760
    ds_read_b64_tr_b16 a[26:27], v5 offset:51272
    v_mfma_f32_16x16x32_bf16 v[96:99], a[40:43], a[192:195], v[96:99]
    buffer_load_dwordx4 a[156:159], v235, s[68:71], s33 offen sc1
    v_mfma_f32_16x16x32_bf16 v[112:115], a[48:51], a[192:195], v[112:115]
    ds_read_b64_tr_b16 a[28:29], v5 offset:59208
    ds_read_b64_tr_b16 a[30:31], v5 offset:59720
    v_mfma_f32_16x16x32_bf16 v[112:115], a[52:55], a[208:211], v[112:115]
    v_mfma_f32_16x16x32_bf16 v[116:119], a[52:55], a[212:215], v[116:119]
    v_mfma_f32_16x16x32_bf16 v[116:119], a[48:51], a[196:199], v[116:119]
    buffer_load_dwordx4 v10, s[16:19], s32 offen nt lds
    v_mfma_f32_16x16x32_bf16 v[120:123], a[48:51], a[200:203], v[120:123]
    v_mfma_f32_16x16x32_bf16 v[120:123], a[52:55], a[216:219], v[120:123]
    v_mfma_f32_16x16x32_bf16 v[124:127], a[52:55], a[220:223], v[124:127]
    v_mfma_f32_16x16x32_bf16 v[124:127], a[48:51], a[204:207], v[124:127]
    buffer_load_dwordx4 v11, s[16:19], s32 offen offset:1056 nt lds
    v_mfma_f32_16x16x32_bf16 v[140:143], a[56:59], a[204:207], v[140:143]
    v_mfma_f32_16x16x32_bf16 v[140:143], a[60:63], a[220:223], v[140:143]
    v_mfma_f32_16x16x32_bf16 v[136:139], a[60:63], a[216:219], v[136:139]
    v_mfma_f32_16x16x32_bf16 v[136:139], a[56:59], a[200:203], v[136:139]
    v_mfma_f32_16x16x32_bf16 v[132:135], a[56:59], a[196:199], v[132:135]
    v_mfma_f32_16x16x32_bf16 v[132:135], a[60:63], a[212:215], v[132:135]
    v_mfma_f32_16x16x32_bf16 v[128:131], a[60:63], a[208:211], v[128:131]
    v_mfma_f32_16x16x32_bf16 v[128:131], a[56:59], a[192:195], v[128:131]
    s_waitcnt vmcnt(14) lgkmcnt(0)
    v_mfma_f32_16x16x32_bf16 v[16:19], a[0:3], a[224:227], v[16:19]
    s_add_u32 m0, s30, 42240
    s_xor_b32 s32, s90, 7602176
    v_mfma_f32_16x16x32_bf16 v[16:19], a[4:7], a[240:243], v[16:19]
    s_add_u32 s33, s91, 4259840
    v_mfma_f32_16x16x32_bf16 v[20:23], a[4:7], a[244:247], v[20:23]
    ds_read_b64_tr_b16 a[32:33], v5 offset:50816
    ds_read_b64_tr_b16 a[34:35], v5 offset:51328
    v_mfma_f32_16x16x32_bf16 v[20:23], a[0:3], a[228:231], v[20:23]
    buffer_load_dwordx4 a[160:163], v232, s[68:71], s33 offen sc1
    v_mfma_f32_16x16x32_bf16 v[24:27], a[0:3], a[232:235], v[24:27]
    ds_read_b64_tr_b16 a[36:37], v5 offset:59264
    ds_read_b64_tr_b16 a[38:39], v5 offset:59776
    v_mfma_f32_16x16x32_bf16 v[24:27], a[4:7], a[248:251], v[24:27]
    v_mfma_f32_16x16x32_bf16 v[28:31], a[4:7], a[252:255], v[28:31]
    ds_read_b64_tr_b16 a[40:41], v5 offset:50824
    ds_read_b64_tr_b16 a[42:43], v5 offset:51336
    v_mfma_f32_16x16x32_bf16 v[28:31], a[0:3], a[236:239], v[28:31]
    buffer_load_dwordx4 a[164:167], v233, s[68:71], s33 offen sc1
    v_mfma_f32_16x16x32_bf16 v[44:47], a[8:11], a[236:239], v[44:47]
    ds_read_b64_tr_b16 a[44:45], v5 offset:59272
    ds_read_b64_tr_b16 a[46:47], v5 offset:59784
    v_mfma_f32_16x16x32_bf16 v[44:47], a[12:15], a[252:255], v[44:47]
    v_mfma_f32_16x16x32_bf16 v[40:43], a[12:15], a[248:251], v[40:43]
    ds_read_b64_tr_b16 a[48:49], v5 offset:50880
    ds_read_b64_tr_b16 a[50:51], v5 offset:51392
    v_mfma_f32_16x16x32_bf16 v[40:43], a[8:11], a[232:235], v[40:43]
    buffer_load_dwordx4 a[168:171], v234, s[68:71], s33 offen sc1
    v_mfma_f32_16x16x32_bf16 v[36:39], a[8:11], a[228:231], v[36:39]
    ds_read_b64_tr_b16 a[52:53], v5 offset:59328
    ds_read_b64_tr_b16 a[54:55], v5 offset:59840
    v_mfma_f32_16x16x32_bf16 v[36:39], a[12:15], a[244:247], v[36:39]
    v_mfma_f32_16x16x32_bf16 v[32:35], a[12:15], a[240:243], v[32:35]
    ds_read_b64_tr_b16 a[56:57], v5 offset:50888
    ds_read_b64_tr_b16 a[58:59], v5 offset:51400
    v_mfma_f32_16x16x32_bf16 v[32:35], a[8:11], a[224:227], v[32:35]
    buffer_load_dwordx4 a[172:175], v235, s[68:71], s33 offen sc1
    v_mfma_f32_16x16x32_bf16 v[48:51], a[16:19], a[224:227], v[48:51]
    ds_read_b64_tr_b16 a[60:61], v5 offset:59336
    ds_read_b64_tr_b16 a[62:63], v5 offset:59848
    v_mfma_f32_16x16x32_bf16 v[48:51], a[20:23], a[240:243], v[48:51]
    v_mfma_f32_16x16x32_bf16 v[52:55], a[20:23], a[244:247], v[52:55]
    v_mfma_f32_16x16x32_bf16 v[52:55], a[16:19], a[228:231], v[52:55]
    buffer_load_dwordx4 v10, s[16:19], s32 offen nt lds
    v_mfma_f32_16x16x32_bf16 v[56:59], a[16:19], a[232:235], v[56:59]
    v_mfma_f32_16x16x32_bf16 v[56:59], a[20:23], a[248:251], v[56:59]
    v_mfma_f32_16x16x32_bf16 v[60:63], a[20:23], a[252:255], v[60:63]
    v_mfma_f32_16x16x32_bf16 v[60:63], a[16:19], a[236:239], v[60:63]
    buffer_load_dwordx4 v11, s[16:19], s32 offen offset:1056 nt lds
    v_mfma_f32_16x16x32_bf16 v[76:79], a[24:27], a[236:239], v[76:79]
    v_mfma_f32_16x16x32_bf16 v[76:79], a[28:31], a[252:255], v[76:79]
    v_mfma_f32_16x16x32_bf16 v[72:75], a[28:31], a[248:251], v[72:75]
    v_mfma_f32_16x16x32_bf16 v[72:75], a[24:27], a[232:235], v[72:75]
    v_mfma_f32_16x16x32_bf16 v[68:71], a[24:27], a[228:231], v[68:71]
    v_mfma_f32_16x16x32_bf16 v[68:71], a[28:31], a[244:247], v[68:71]
    v_mfma_f32_16x16x32_bf16 v[64:67], a[28:31], a[240:243], v[64:67]
    v_mfma_f32_16x16x32_bf16 v[64:67], a[24:27], a[224:227], v[64:67]
    s_waitcnt vmcnt(20) lgkmcnt(0)
    s_barrier
    v_mfma_f32_16x16x32_bf16 v[80:83], a[32:35], a[224:227], v[80:83]
    s_add_u32 m0, s30, 50688
    s_xor_b32 s32, s90, 7864320
    v_mfma_f32_16x16x32_bf16 v[80:83], a[36:39], a[240:243], v[80:83]
    s_add_u32 s33, s91, 4423680
    v_mfma_f32_16x16x32_bf16 v[84:87], a[36:39], a[244:247], v[84:87]
    ds_read_b64_tr_b16 a[0:1], v5 offset:0
    ds_read_b64_tr_b16 a[2:3], v5 offset:512
    v_mfma_f32_16x16x32_bf16 v[84:87], a[32:35], a[228:231], v[84:87]
    buffer_load_dwordx4 a[176:179], v232, s[68:71], s33 offen sc1
    v_mfma_f32_16x16x32_bf16 v[88:91], a[32:35], a[232:235], v[88:91]
    ds_read_b64_tr_b16 a[4:5], v5 offset:8448
    ds_read_b64_tr_b16 a[6:7], v5 offset:8960
    v_mfma_f32_16x16x32_bf16 v[88:91], a[36:39], a[248:251], v[88:91]
    v_mfma_f32_16x16x32_bf16 v[92:95], a[36:39], a[252:255], v[92:95]
    ds_read_b64_tr_b16 a[8:9], v5 offset:8
    ds_read_b64_tr_b16 a[10:11], v5 offset:520
    v_mfma_f32_16x16x32_bf16 v[92:95], a[32:35], a[236:239], v[92:95]
    buffer_load_dwordx4 a[180:183], v233, s[68:71], s33 offen sc1
    v_mfma_f32_16x16x32_bf16 v[108:111], a[40:43], a[236:239], v[108:111]
    ds_read_b64_tr_b16 a[12:13], v5 offset:8456
    ds_read_b64_tr_b16 a[14:15], v5 offset:8968
    v_mfma_f32_16x16x32_bf16 v[108:111], a[44:47], a[252:255], v[108:111]
    v_mfma_f32_16x16x32_bf16 v[104:107], a[44:47], a[248:251], v[104:107]
    ds_read_b64_tr_b16 a[16:17], v5 offset:64
    ds_read_b64_tr_b16 a[18:19], v5 offset:576
    v_mfma_f32_16x16x32_bf16 v[104:107], a[40:43], a[232:235], v[104:107]
    buffer_load_dwordx4 a[184:187], v234, s[68:71], s33 offen sc1
    v_mfma_f32_16x16x32_bf16 v[100:103], a[40:43], a[228:231], v[100:103]
    ds_read_b64_tr_b16 a[20:21], v5 offset:8512
    ds_read_b64_tr_b16 a[22:23], v5 offset:9024
    v_mfma_f32_16x16x32_bf16 v[100:103], a[44:47], a[244:247], v[100:103]
    v_mfma_f32_16x16x32_bf16 v[96:99], a[44:47], a[240:243], v[96:99]
    ds_read_b64_tr_b16 a[24:25], v5 offset:72
    ds_read_b64_tr_b16 a[26:27], v5 offset:584
    v_mfma_f32_16x16x32_bf16 v[96:99], a[40:43], a[224:227], v[96:99]
    buffer_load_dwordx4 a[188:191], v235, s[68:71], s33 offen sc1
    v_mfma_f32_16x16x32_bf16 v[112:115], a[48:51], a[224:227], v[112:115]
    ds_read_b64_tr_b16 a[28:29], v5 offset:8520
    ds_read_b64_tr_b16 a[30:31], v5 offset:9032
    v_mfma_f32_16x16x32_bf16 v[112:115], a[52:55], a[240:243], v[112:115]
    v_mfma_f32_16x16x32_bf16 v[116:119], a[52:55], a[244:247], v[116:119]
    v_mfma_f32_16x16x32_bf16 v[116:119], a[48:51], a[228:231], v[116:119]
    buffer_load_dwordx4 v10, s[16:19], s32 offen nt lds
    v_mfma_f32_16x16x32_bf16 v[120:123], a[48:51], a[232:235], v[120:123]
    v_mfma_f32_16x16x32_bf16 v[120:123], a[52:55], a[248:251], v[120:123]
    v_mfma_f32_16x16x32_bf16 v[124:127], a[52:55], a[252:255], v[124:127]
    v_mfma_f32_16x16x32_bf16 v[124:127], a[48:51], a[236:239], v[124:127]
    buffer_load_dwordx4 v11, s[16:19], s32 offen offset:1056 nt lds
    v_mfma_f32_16x16x32_bf16 v[140:143], a[56:59], a[236:239], v[140:143]
    v_mfma_f32_16x16x32_bf16 v[140:143], a[60:63], a[252:255], v[140:143]
    v_mfma_f32_16x16x32_bf16 v[136:139], a[60:63], a[248:251], v[136:139]
    v_mfma_f32_16x16x32_bf16 v[136:139], a[56:59], a[232:235], v[136:139]
    v_mfma_f32_16x16x32_bf16 v[132:135], a[56:59], a[228:231], v[132:135]
    v_mfma_f32_16x16x32_bf16 v[132:135], a[60:63], a[244:247], v[132:135]
    v_mfma_f32_16x16x32_bf16 v[128:131], a[60:63], a[240:243], v[128:131]
    v_mfma_f32_16x16x32_bf16 v[128:131], a[56:59], a[224:227], v[128:131]
    s_waitcnt vmcnt(14) lgkmcnt(0)
    v_mfma_f32_16x16x32_bf16 v[16:19], a[0:3], a[128:131], v[16:19]
    s_add_u32 m0, s30, 59136
    s_xor_b32 s32, s90, 8126464
    v_mfma_f32_16x16x32_bf16 v[16:19], a[4:7], a[144:147], v[16:19]
    s_add_u32 s33, s91, 4587520
    v_mfma_f32_16x16x32_bf16 v[20:23], a[4:7], a[148:151], v[20:23]
    ds_read_b64_tr_b16 a[32:33], v5 offset:128
    ds_read_b64_tr_b16 a[34:35], v5 offset:640
    v_mfma_f32_16x16x32_bf16 v[20:23], a[0:3], a[132:135], v[20:23]
    buffer_load_dwordx4 a[192:195], v232, s[68:71], s33 offen sc1
    v_mfma_f32_16x16x32_bf16 v[24:27], a[0:3], a[136:139], v[24:27]
    ds_read_b64_tr_b16 a[36:37], v5 offset:8576
    ds_read_b64_tr_b16 a[38:39], v5 offset:9088
    v_mfma_f32_16x16x32_bf16 v[24:27], a[4:7], a[152:155], v[24:27]
    v_mfma_f32_16x16x32_bf16 v[28:31], a[4:7], a[156:159], v[28:31]
    ds_read_b64_tr_b16 a[40:41], v5 offset:136
    ds_read_b64_tr_b16 a[42:43], v5 offset:648
    v_mfma_f32_16x16x32_bf16 v[28:31], a[0:3], a[140:143], v[28:31]
    buffer_load_dwordx4 a[196:199], v233, s[68:71], s33 offen sc1
    v_mfma_f32_16x16x32_bf16 v[44:47], a[8:11], a[140:143], v[44:47]
    ds_read_b64_tr_b16 a[44:45], v5 offset:8584
    ds_read_b64_tr_b16 a[46:47], v5 offset:9096
    v_mfma_f32_16x16x32_bf16 v[44:47], a[12:15], a[156:159], v[44:47]
    v_mfma_f32_16x16x32_bf16 v[40:43], a[12:15], a[152:155], v[40:43]
    ds_read_b64_tr_b16 a[48:49], v5 offset:192
    ds_read_b64_tr_b16 a[50:51], v5 offset:704
    v_mfma_f32_16x16x32_bf16 v[40:43], a[8:11], a[136:139], v[40:43]
    buffer_load_dwordx4 a[200:203], v234, s[68:71], s33 offen sc1
    v_mfma_f32_16x16x32_bf16 v[36:39], a[8:11], a[132:135], v[36:39]
    ds_read_b64_tr_b16 a[52:53], v5 offset:8640
    ds_read_b64_tr_b16 a[54:55], v5 offset:9152
    v_mfma_f32_16x16x32_bf16 v[36:39], a[12:15], a[148:151], v[36:39]
    v_mfma_f32_16x16x32_bf16 v[32:35], a[12:15], a[144:147], v[32:35]
    ds_read_b64_tr_b16 a[56:57], v5 offset:200
    ds_read_b64_tr_b16 a[58:59], v5 offset:712
    v_mfma_f32_16x16x32_bf16 v[32:35], a[8:11], a[128:131], v[32:35]
    buffer_load_dwordx4 a[204:207], v235, s[68:71], s33 offen sc1
    v_mfma_f32_16x16x32_bf16 v[48:51], a[16:19], a[128:131], v[48:51]
    ds_read_b64_tr_b16 a[60:61], v5 offset:8648
    ds_read_b64_tr_b16 a[62:63], v5 offset:9160
    v_mfma_f32_16x16x32_bf16 v[48:51], a[20:23], a[144:147], v[48:51]
    v_mfma_f32_16x16x32_bf16 v[52:55], a[20:23], a[148:151], v[52:55]
    v_mfma_f32_16x16x32_bf16 v[52:55], a[16:19], a[132:135], v[52:55]
    buffer_load_dwordx4 v10, s[16:19], s32 offen nt lds
    v_mfma_f32_16x16x32_bf16 v[56:59], a[16:19], a[136:139], v[56:59]
    v_mfma_f32_16x16x32_bf16 v[56:59], a[20:23], a[152:155], v[56:59]
    v_mfma_f32_16x16x32_bf16 v[60:63], a[20:23], a[156:159], v[60:63]
    v_mfma_f32_16x16x32_bf16 v[60:63], a[16:19], a[140:143], v[60:63]
    buffer_load_dwordx4 v11, s[16:19], s32 offen offset:1056 nt lds
    v_mfma_f32_16x16x32_bf16 v[76:79], a[24:27], a[140:143], v[76:79]
    s_add_u32 m0, s29, 16640
    s_add_u32 s31, s31, 8192
    v_mfma_f32_16x16x32_bf16 v[76:79], a[28:31], a[156:159], v[76:79]
    buffer_load_dwordx4 v6, s[8:11], s31 offen nt lds
    v_mfma_f32_16x16x32_bf16 v[72:75], a[28:31], a[152:155], v[72:75]
    v_mfma_f32_16x16x32_bf16 v[72:75], a[24:27], a[136:139], v[72:75]
    v_mfma_f32_16x16x32_bf16 v[68:71], a[24:27], a[132:135], v[68:71]
    buffer_load_dwordx4 v7, s[8:11], s31 offen offset:1056 nt lds
    v_mfma_f32_16x16x32_bf16 v[68:71], a[28:31], a[148:151], v[68:71]
    v_mfma_f32_16x16x32_bf16 v[64:67], a[28:31], a[144:147], v[64:67]
    v_mfma_f32_16x16x32_bf16 v[64:67], a[24:27], a[128:131], v[64:67]
    s_waitcnt vmcnt(22) lgkmcnt(0)
    s_barrier
    v_mfma_f32_16x16x32_bf16 v[80:83], a[32:35], a[128:131], v[80:83]
    v_mfma_f32_16x16x32_bf16 v[80:83], a[36:39], a[144:147], v[80:83]
    s_add_u32 s33, s91, 4751360
    v_mfma_f32_16x16x32_bf16 v[84:87], a[36:39], a[148:151], v[84:87]
    ds_read_b64_tr_b16 a[0:1], v5 offset:16896
    ds_read_b64_tr_b16 a[2:3], v5 offset:17408
    v_mfma_f32_16x16x32_bf16 v[84:87], a[32:35], a[132:135], v[84:87]
    buffer_load_dwordx4 a[208:211], v232, s[68:71], s33 offen sc1
    v_mfma_f32_16x16x32_bf16 v[88:91], a[32:35], a[136:139], v[88:91]
    ds_read_b64_tr_b16 a[4:5], v5 offset:25344
    ds_read_b64_tr_b16 a[6:7], v5 offset:25856
    v_mfma_f32_16x16x32_bf16 v[88:91], a[36:39], a[152:155], v[88:91]
    v_mfma_f32_16x16x32_bf16 v[92:95], a[36:39], a[156:159], v[92:95]
    ds_read_b64_tr_b16 a[8:9], v5 offset:16904
    ds_read_b64_tr_b16 a[10:11], v5 offset:17416
    v_mfma_f32_16x16x32_bf16 v[92:95], a[32:35], a[140:143], v[92:95]
    buffer_load_dwordx4 a[212:215], v233, s[68:71], s33 offen sc1
    v_mfma_f32_16x16x32_bf16 v[108:111], a[40:43], a[140:143], v[108:111]
    ds_read_b64_tr_b16 a[12:13], v5 offset:25352
    ds_read_b64_tr_b16 a[14:15], v5 offset:25864
    v_mfma_f32_16x16x32_bf16 v[108:111], a[44:47], a[156:159], v[108:111]
    v_mfma_f32_16x16x32_bf16 v[104:107], a[44:47], a[152:155], v[104:107]
    ds_read_b64_tr_b16 a[16:17], v5 offset:16960
    ds_read_b64_tr_b16 a[18:19], v5 offset:17472
    v_mfma_f32_16x16x32_bf16 v[104:107], a[40:43], a[136:139], v[104:107]
    buffer_load_dwordx4 a[216:219], v234, s[68:71], s33 offen sc1
    v_mfma_f32_16x16x32_bf16 v[100:103], a[40:43], a[132:135], v[100:103]
    ds_read_b64_tr_b16 a[20:21], v5 offset:25408
    ds_read_b64_tr_b16 a[22:23], v5 offset:25920
    v_mfma_f32_16x16x32_bf16 v[100:103], a[44:47], a[148:151], v[100:103]
    v_mfma_f32_16x16x32_bf16 v[96:99], a[44:47], a[144:147], v[96:99]
    ds_read_b64_tr_b16 a[24:25], v5 offset:16968
    ds_read_b64_tr_b16 a[26:27], v5 offset:17480
    v_mfma_f32_16x16x32_bf16 v[96:99], a[40:43], a[128:131], v[96:99]
    buffer_load_dwordx4 a[220:223], v235, s[68:71], s33 offen sc1
    v_mfma_f32_16x16x32_bf16 v[112:115], a[48:51], a[128:131], v[112:115]
    ds_read_b64_tr_b16 a[28:29], v5 offset:25416
    ds_read_b64_tr_b16 a[30:31], v5 offset:25928
    v_mfma_f32_16x16x32_bf16 v[112:115], a[52:55], a[144:147], v[112:115]
    v_mfma_f32_16x16x32_bf16 v[116:119], a[52:55], a[148:151], v[116:119]
    s_add_u32 m0, s29, 33280
    s_add_u32 s31, s31, 8192
    v_mfma_f32_16x16x32_bf16 v[116:119], a[48:51], a[132:135], v[116:119]
    buffer_load_dwordx4 v6, s[8:11], s31 offen nt lds
    v_mfma_f32_16x16x32_bf16 v[120:123], a[48:51], a[136:139], v[120:123]
    v_mfma_f32_16x16x32_bf16 v[120:123], a[52:55], a[152:155], v[120:123]
    v_mfma_f32_16x16x32_bf16 v[124:127], a[52:55], a[156:159], v[124:127]
    buffer_load_dwordx4 v7, s[8:11], s31 offen offset:1056 nt lds
    v_mfma_f32_16x16x32_bf16 v[124:127], a[48:51], a[140:143], v[124:127]
    v_mfma_f32_16x16x32_bf16 v[140:143], a[56:59], a[140:143], v[140:143]
    v_mfma_f32_16x16x32_bf16 v[140:143], a[60:63], a[156:159], v[140:143]
    buffer_load_dwordx4 v8, s[12:15], s31 offen offset:2080 nt lds
    v_mfma_f32_16x16x32_bf16 v[136:139], a[60:63], a[152:155], v[136:139]
    v_mfma_f32_16x16x32_bf16 v[136:139], a[56:59], a[136:139], v[136:139]
    v_mfma_f32_16x16x32_bf16 v[132:135], a[56:59], a[132:135], v[132:135]
    buffer_load_dwordx4 v9, s[12:15], s31 offen offset:3136 nt lds
    v_mfma_f32_16x16x32_bf16 v[132:135], a[60:63], a[148:151], v[132:135]
    v_mfma_f32_16x16x32_bf16 v[128:131], a[60:63], a[144:147], v[128:131]
    v_mfma_f32_16x16x32_bf16 v[128:131], a[56:59], a[128:131], v[128:131]
    s_waitcnt vmcnt(18) lgkmcnt(0)
    v_mfma_f32_16x16x32_bf16 v[16:19], a[0:3], a[160:163], v[16:19]
    v_mfma_f32_16x16x32_bf16 v[16:19], a[4:7], a[176:179], v[16:19]
    s_add_u32 s33, s91, 4915200
    v_mfma_f32_16x16x32_bf16 v[20:23], a[4:7], a[180:183], v[20:23]
    ds_read_b64_tr_b16 a[32:33], v5 offset:17024
    ds_read_b64_tr_b16 a[34:35], v5 offset:17536
    v_mfma_f32_16x16x32_bf16 v[20:23], a[0:3], a[164:167], v[20:23]
    buffer_load_dwordx4 a[224:227], v232, s[68:71], s33 offen sc1
    v_mfma_f32_16x16x32_bf16 v[24:27], a[0:3], a[168:171], v[24:27]
    ds_read_b64_tr_b16 a[36:37], v5 offset:25472
    ds_read_b64_tr_b16 a[38:39], v5 offset:25984
    v_mfma_f32_16x16x32_bf16 v[24:27], a[4:7], a[184:187], v[24:27]
    v_mfma_f32_16x16x32_bf16 v[28:31], a[4:7], a[188:191], v[28:31]
    ds_read_b64_tr_b16 a[40:41], v5 offset:17032
    ds_read_b64_tr_b16 a[42:43], v5 offset:17544
    v_mfma_f32_16x16x32_bf16 v[28:31], a[0:3], a[172:175], v[28:31]
    buffer_load_dwordx4 a[228:231], v233, s[68:71], s33 offen sc1
    v_mfma_f32_16x16x32_bf16 v[44:47], a[8:11], a[172:175], v[44:47]
    ds_read_b64_tr_b16 a[44:45], v5 offset:25480
    ds_read_b64_tr_b16 a[46:47], v5 offset:25992
    v_mfma_f32_16x16x32_bf16 v[44:47], a[12:15], a[188:191], v[44:47]
    v_mfma_f32_16x16x32_bf16 v[40:43], a[12:15], a[184:187], v[40:43]
    ds_read_b64_tr_b16 a[48:49], v5 offset:17088
    ds_read_b64_tr_b16 a[50:51], v5 offset:17600
    v_mfma_f32_16x16x32_bf16 v[40:43], a[8:11], a[168:171], v[40:43]
    buffer_load_dwordx4 a[232:235], v234, s[68:71], s33 offen sc1
    v_mfma_f32_16x16x32_bf16 v[36:39], a[8:11], a[164:167], v[36:39]
    ds_read_b64_tr_b16 a[52:53], v5 offset:25536
    ds_read_b64_tr_b16 a[54:55], v5 offset:26048
    v_mfma_f32_16x16x32_bf16 v[36:39], a[12:15], a[180:183], v[36:39]
    v_mfma_f32_16x16x32_bf16 v[32:35], a[12:15], a[176:179], v[32:35]
    ds_read_b64_tr_b16 a[56:57], v5 offset:17096
    ds_read_b64_tr_b16 a[58:59], v5 offset:17608
    v_mfma_f32_16x16x32_bf16 v[32:35], a[8:11], a[160:163], v[32:35]
    buffer_load_dwordx4 a[236:239], v235, s[68:71], s33 offen sc1
    v_mfma_f32_16x16x32_bf16 v[48:51], a[16:19], a[160:163], v[48:51]
    ds_read_b64_tr_b16 a[60:61], v5 offset:25544
    ds_read_b64_tr_b16 a[62:63], v5 offset:26056
    v_mfma_f32_16x16x32_bf16 v[48:51], a[20:23], a[176:179], v[48:51]
    v_mfma_f32_16x16x32_bf16 v[52:55], a[20:23], a[180:183], v[52:55]
    s_add_u32 m0, s29, 49920
    s_add_u32 s31, s31, 8192
    v_mfma_f32_16x16x32_bf16 v[52:55], a[16:19], a[164:167], v[52:55]
    buffer_load_dwordx4 v6, s[8:11], s31 offen nt lds
    v_mfma_f32_16x16x32_bf16 v[56:59], a[16:19], a[168:171], v[56:59]
    v_mfma_f32_16x16x32_bf16 v[56:59], a[20:23], a[184:187], v[56:59]
    v_mfma_f32_16x16x32_bf16 v[60:63], a[20:23], a[188:191], v[60:63]
    buffer_load_dwordx4 v7, s[8:11], s31 offen offset:1056 nt lds
    v_mfma_f32_16x16x32_bf16 v[60:63], a[16:19], a[172:175], v[60:63]
    v_mfma_f32_16x16x32_bf16 v[76:79], a[24:27], a[172:175], v[76:79]
    v_mfma_f32_16x16x32_bf16 v[76:79], a[28:31], a[188:191], v[76:79]
    buffer_load_dwordx4 v8, s[12:15], s31 offen offset:2080 nt lds
    v_mfma_f32_16x16x32_bf16 v[72:75], a[28:31], a[184:187], v[72:75]
    v_mfma_f32_16x16x32_bf16 v[72:75], a[24:27], a[168:171], v[72:75]
    v_mfma_f32_16x16x32_bf16 v[68:71], a[24:27], a[164:167], v[68:71]
    buffer_load_dwordx4 v9, s[12:15], s31 offen offset:3136 nt lds
    v_mfma_f32_16x16x32_bf16 v[68:71], a[28:31], a[180:183], v[68:71]
    v_mfma_f32_16x16x32_bf16 v[64:67], a[28:31], a[176:179], v[64:67]
    v_mfma_f32_16x16x32_bf16 v[64:67], a[24:27], a[160:163], v[64:67]
    s_waitcnt vmcnt(26) lgkmcnt(0)
    s_barrier
    v_mfma_f32_16x16x32_bf16 v[80:83], a[32:35], a[160:163], v[80:83]
    v_mfma_f32_16x16x32_bf16 v[80:83], a[36:39], a[176:179], v[80:83]
    s_add_u32 s33, s91, 5079040
    v_mfma_f32_16x16x32_bf16 v[84:87], a[36:39], a[180:183], v[84:87]
    ds_read_b64_tr_b16 a[0:1], v5 offset:33792
    ds_read_b64_tr_b16 a[2:3], v5 offset:34304
    v_mfma_f32_16x16x32_bf16 v[84:87], a[32:35], a[164:167], v[84:87]
    buffer_load_dwordx4 a[240:243], v232, s[68:71], s33 offen sc1
    v_mfma_f32_16x16x32_bf16 v[88:91], a[32:35], a[168:171], v[88:91]
    ds_read_b64_tr_b16 a[4:5], v5 offset:42240
    ds_read_b64_tr_b16 a[6:7], v5 offset:42752
    v_mfma_f32_16x16x32_bf16 v[88:91], a[36:39], a[184:187], v[88:91]
    v_mfma_f32_16x16x32_bf16 v[92:95], a[36:39], a[188:191], v[92:95]
    ds_read_b64_tr_b16 a[8:9], v5 offset:33800
    ds_read_b64_tr_b16 a[10:11], v5 offset:34312
    v_mfma_f32_16x16x32_bf16 v[92:95], a[32:35], a[172:175], v[92:95]
    buffer_load_dwordx4 a[244:247], v233, s[68:71], s33 offen sc1
    v_mfma_f32_16x16x32_bf16 v[108:111], a[40:43], a[172:175], v[108:111]
    ds_read_b64_tr_b16 a[12:13], v5 offset:42248
    ds_read_b64_tr_b16 a[14:15], v5 offset:42760
    v_mfma_f32_16x16x32_bf16 v[108:111], a[44:47], a[188:191], v[108:111]
    v_mfma_f32_16x16x32_bf16 v[104:107], a[44:47], a[184:187], v[104:107]
    ds_read_b64_tr_b16 a[16:17], v5 offset:33856
    ds_read_b64_tr_b16 a[18:19], v5 offset:34368
    v_mfma_f32_16x16x32_bf16 v[104:107], a[40:43], a[168:171], v[104:107]
    buffer_load_dwordx4 a[248:251], v234, s[68:71], s33 offen sc1
    v_mfma_f32_16x16x32_bf16 v[100:103], a[40:43], a[164:167], v[100:103]
    ds_read_b64_tr_b16 a[20:21], v5 offset:42304
    ds_read_b64_tr_b16 a[22:23], v5 offset:42816
    v_mfma_f32_16x16x32_bf16 v[100:103], a[44:47], a[180:183], v[100:103]
    v_mfma_f32_16x16x32_bf16 v[96:99], a[44:47], a[176:179], v[96:99]
    ds_read_b64_tr_b16 a[24:25], v5 offset:33864
    ds_read_b64_tr_b16 a[26:27], v5 offset:34376
    v_mfma_f32_16x16x32_bf16 v[96:99], a[40:43], a[160:163], v[96:99]
    buffer_load_dwordx4 a[252:255], v235, s[68:71], s33 offen sc1
    v_mfma_f32_16x16x32_bf16 v[112:115], a[48:51], a[160:163], v[112:115]
    ds_read_b64_tr_b16 a[28:29], v5 offset:42312
    ds_read_b64_tr_b16 a[30:31], v5 offset:42824
    v_mfma_f32_16x16x32_bf16 v[112:115], a[52:55], a[176:179], v[112:115]
    v_mfma_f32_16x16x32_bf16 v[116:119], a[52:55], a[180:183], v[116:119]
    s_add_u32 m0, s29, 66560
    s_add_u32 s31, s31, 8192
    v_mfma_f32_16x16x32_bf16 v[116:119], a[48:51], a[164:167], v[116:119]
    buffer_load_dwordx4 v6, s[8:11], s31 offen nt lds
    v_mfma_f32_16x16x32_bf16 v[120:123], a[48:51], a[168:171], v[120:123]
    v_mfma_f32_16x16x32_bf16 v[120:123], a[52:55], a[184:187], v[120:123]
    v_mfma_f32_16x16x32_bf16 v[124:127], a[52:55], a[188:191], v[124:127]
    buffer_load_dwordx4 v7, s[8:11], s31 offen offset:1056 nt lds
    v_mfma_f32_16x16x32_bf16 v[124:127], a[48:51], a[172:175], v[124:127]
    v_mfma_f32_16x16x32_bf16 v[140:143], a[56:59], a[172:175], v[140:143]
    v_mfma_f32_16x16x32_bf16 v[140:143], a[60:63], a[188:191], v[140:143]
    buffer_load_dwordx4 v8, s[12:15], s31 offen offset:2080 nt lds
    v_mfma_f32_16x16x32_bf16 v[136:139], a[60:63], a[184:187], v[136:139]
    v_mfma_f32_16x16x32_bf16 v[136:139], a[56:59], a[168:171], v[136:139]
    v_mfma_f32_16x16x32_bf16 v[132:135], a[56:59], a[164:167], v[132:135]
    buffer_load_dwordx4 v9, s[12:15], s31 offen offset:3136 nt lds
    v_mfma_f32_16x16x32_bf16 v[132:135], a[60:63], a[180:183], v[132:135]
    v_mfma_f32_16x16x32_bf16 v[128:131], a[60:63], a[176:179], v[128:131]
    v_mfma_f32_16x16x32_bf16 v[128:131], a[56:59], a[160:163], v[128:131]
    s_waitcnt vmcnt(20) lgkmcnt(0)
    v_mfma_f32_16x16x32_bf16 v[16:19], a[0:3], a[192:195], v[16:19]
    v_mfma_f32_16x16x32_bf16 v[16:19], a[4:7], a[208:211], v[16:19]
    s_bfe_u32 s16, s2, 0x20001
    s_lshl_b32 s16, s16, 2
    v_mfma_f32_16x16x32_bf16 v[20:23], a[4:7], a[212:215], v[20:23]
    ds_read_b64_tr_b16 a[32:33], v5 offset:33920
    ds_read_b64_tr_b16 a[34:35], v5 offset:34432
    v_mfma_f32_16x16x32_bf16 v[20:23], a[0:3], a[196:199], v[20:23]
    s_lshr_b32 s36, s2, 6
    s_add_u32 s16, s16, s36
    v_mfma_f32_16x16x32_bf16 v[24:27], a[0:3], a[200:203], v[24:27]
    ds_read_b64_tr_b16 a[36:37], v5 offset:42368
    ds_read_b64_tr_b16 a[38:39], v5 offset:42880
    v_mfma_f32_16x16x32_bf16 v[24:27], a[4:7], a[216:219], v[24:27]
    s_bfe_u32 s17, s2, 0x40002
    s_andn2_b32 s17, s17, 1
    v_mfma_f32_16x16x32_bf16 v[28:31], a[4:7], a[220:223], v[28:31]
    ds_read_b64_tr_b16 a[40:41], v5 offset:33928
    ds_read_b64_tr_b16 a[42:43], v5 offset:34440
    v_mfma_f32_16x16x32_bf16 v[28:31], a[0:3], a[204:207], v[28:31]
    s_and_b32 s36, s2, 1
    s_or_b32 s17, s17, s36
    v_mfma_f32_16x16x32_bf16 v[44:47], a[8:11], a[204:207], v[44:47]
    ds_read_b64_tr_b16 a[44:45], v5 offset:42376
    ds_read_b64_tr_b16 a[46:47], v5 offset:42888
    v_mfma_f32_16x16x32_bf16 v[44:47], a[12:15], a[220:223], v[44:47]
    s_xor_b32 s17, s17, 4
    s_and_b32 s37, s28, 1
    v_mfma_f32_16x16x32_bf16 v[40:43], a[12:15], a[216:219], v[40:43]
    ds_read_b64_tr_b16 a[48:49], v5 offset:33984
    ds_read_b64_tr_b16 a[50:51], v5 offset:34496
    v_mfma_f32_16x16x32_bf16 v[40:43], a[8:11], a[200:203], v[40:43]
    s_lshr_b32 s38, s28, 1
    s_and_b32 s39, s17, 1
    v_mfma_f32_16x16x32_bf16 v[36:39], a[8:11], a[196:199], v[36:39]
    ds_read_b64_tr_b16 a[52:53], v5 offset:42432
    ds_read_b64_tr_b16 a[54:55], v5 offset:42944
    v_mfma_f32_16x16x32_bf16 v[36:39], a[12:15], a[212:215], v[36:39]
    s_lshl_b32 s19, s39, 1
    s_add_u32 s19, s19, s38
    v_mfma_f32_16x16x32_bf16 v[32:35], a[12:15], a[208:211], v[32:35]
    ds_read_b64_tr_b16 a[56:57], v5 offset:33992
    ds_read_b64_tr_b16 a[58:59], v5 offset:34504
    v_mfma_f32_16x16x32_bf16 v[32:35], a[8:11], a[192:195], v[32:35]
    s_lshl_b32 s18, s16, 2
    s_lshl_b32 s36, s37, 1
    v_mfma_f32_16x16x32_bf16 v[48:51], a[16:19], a[192:195], v[48:51]
    ds_read_b64_tr_b16 a[60:61], v5 offset:42440
    ds_read_b64_tr_b16 a[62:63], v5 offset:42952
    v_mfma_f32_16x16x32_bf16 v[48:51], a[20:23], a[208:211], v[48:51]
    s_add_u32 s18, s18, s36
    s_add_u32 s18, s18, s38
    v_mfma_f32_16x16x32_bf16 v[52:55], a[20:23], a[212:215], v[52:55]
    v_mfma_f32_16x16x32_bf16 v[52:55], a[16:19], a[196:199], v[52:55]
    v_mfma_f32_16x16x32_bf16 v[56:59], a[16:19], a[200:203], v[56:59]
    s_mul_i32 s4, s38, 8448
    s_mul_i32 s36, s37, 4224
    v_mfma_f32_16x16x32_bf16 v[56:59], a[20:23], a[216:219], v[56:59]
    s_add_u32 s30, s4, s36
    s_lshl_b32 s36, s39, 7
    v_mfma_f32_16x16x32_bf16 v[60:63], a[20:23], a[220:223], v[60:63]
    v_mfma_f32_16x16x32_bf16 v[60:63], a[16:19], a[204:207], v[60:63]
    s_add_u32 s4, s4, s36
    s_sub_u32 s4, s4, 83200
    v_mfma_f32_16x16x32_bf16 v[76:79], a[24:27], a[204:207], v[76:79]
    v_add_u32 v254, s4, v5
    s_lshl_b32 s36, s39, 8
    v_mfma_f32_16x16x32_bf16 v[76:79], a[28:31], a[220:223], v[76:79]
    v_mfma_f32_16x16x32_bf16 v[72:75], a[28:31], a[216:219], v[72:75]
    s_sub_u32 s88, 128, s36
    s_lshl_b32 s32, s19, 21
    v_mfma_f32_16x16x32_bf16 v[72:75], a[24:27], a[200:203], v[72:75]
    s_lshr_b32 s36, s17, 1
    s_lshl_b32 s36, s36, 8
    v_mfma_f32_16x16x32_bf16 v[68:71], a[24:27], a[196:199], v[68:71]
    v_mfma_f32_16x16x32_bf16 v[68:71], a[28:31], a[212:215], v[68:71]
    v_mfma_f32_16x16x32_bf16 v[64:67], a[28:31], a[208:211], v[64:67]
    v_mfma_f32_16x16x32_bf16 v[64:67], a[24:27], a[192:195], v[64:67]
    s_waitcnt vmcnt(20) lgkmcnt(0)
    s_barrier
    v_mfma_f32_16x16x32_bf16 v[80:83], a[32:35], a[192:195], v[80:83]
    v_mfma_f32_16x16x32_bf16 v[80:83], a[36:39], a[208:211], v[80:83]
    s_add_u32 s32, s32, s36
    s_sub_u32 s32, s32, 65536
    v_mfma_f32_16x16x32_bf16 v[84:87], a[36:39], a[212:215], v[84:87]
    ds_read_b64_tr_b16 a[0:1], v5 offset:50688
    ds_read_b64_tr_b16 a[2:3], v5 offset:51200
    v_mfma_f32_16x16x32_bf16 v[84:87], a[32:35], a[196:199], v[84:87]
    v_lshrrev_b32 v14, 4, v0
    v_and_b32 v13, 15, v0
    v_mfma_f32_16x16x32_bf16 v[88:91], a[32:35], a[200:203], v[88:91]
    ds_read_b64_tr_b16 a[4:5], v5 offset:50696
    ds_read_b64_tr_b16 a[6:7], v5 offset:51208
    v_mfma_f32_16x16x32_bf16 v[88:91], a[36:39], a[216:219], v[88:91]
    v_lshlrev_b32 v252, 14, v14
    v_lshl_add_u32 v252, v13, 4, v252
    v_mfma_f32_16x16x32_bf16 v[92:95], a[36:39], a[220:223], v[92:95]
    ds_read_b64_tr_b16 a[8:9], v5 offset:50752
    ds_read_b64_tr_b16 a[10:11], v5 offset:51264
    v_mfma_f32_16x16x32_bf16 v[92:95], a[32:35], a[204:207], v[92:95]
    s_lshl_b32 s36, s37, 13
    v_add_u32 v252, s36, v252
    v_mfma_f32_16x16x32_bf16 v[108:111], a[40:43], a[204:207], v[108:111]
    ds_read_b64_tr_b16 a[12:13], v5 offset:50760
    ds_read_b64_tr_b16 a[14:15], v5 offset:51272
    v_mfma_f32_16x16x32_bf16 v[108:111], a[44:47], a[220:223], v[108:111]
    s_lshl_b32 s89, s38, 4
    s_lshr_b32 s36, s18, 1
    v_mfma_f32_16x16x32_bf16 v[104:107], a[44:47], a[216:219], v[104:107]
    ds_read_b64_tr_b16 a[16:17], v5 offset:50816
    ds_read_b64_tr_b16 a[18:19], v5 offset:51328
    v_mfma_f32_16x16x32_bf16 v[104:107], a[40:43], a[200:203], v[104:107]
    s_mul_i32 s33, s36, 5120
    s_mul_i32 s37, s19, 5242880
    v_mfma_f32_16x16x32_bf16 v[100:103], a[40:43], a[196:199], v[100:103]
    ds_read_b64_tr_b16 a[20:21], v5 offset:50824
    ds_read_b64_tr_b16 a[22:23], v5 offset:51336
    v_mfma_f32_16x16x32_bf16 v[100:103], a[44:47], a[212:215], v[100:103]
    s_add_u32 s33, s33, s37
    s_add_u32 s33, s33, 37584896
    v_mfma_f32_16x16x32_bf16 v[96:99], a[44:47], a[208:211], v[96:99]
    ds_read_b64_tr_b16 a[24:25], v5 offset:50880
    ds_read_b64_tr_b16 a[26:27], v5 offset:51392
    v_mfma_f32_16x16x32_bf16 v[96:99], a[40:43], a[192:195], v[96:99]
    s_lshr_b32 s20, s36, 2
    s_lshl_b32 s20, s20, 14
    v_mfma_f32_16x16x32_bf16 v[112:115], a[48:51], a[192:195], v[112:115]
    ds_read_b64_tr_b16 a[28:29], v5 offset:50888
    ds_read_b64_tr_b16 a[30:31], v5 offset:51400
    v_mfma_f32_16x16x32_bf16 v[112:115], a[52:55], a[208:211], v[112:115]
    s_and_b32 s37, s36, 3
    s_lshl_b32 s37, s37, 7
    v_mfma_f32_16x16x32_bf16 v[116:119], a[52:55], a[212:215], v[116:119]
    s_add_u32 s20, s20, s37
    s_lshl_b32 s37, s19, 10
    v_mfma_f32_16x16x32_bf16 v[116:119], a[48:51], a[196:199], v[116:119]
    s_add_u32 s20, s20, s37
    s_add_u32 s20, s20, 29491200
    v_mfma_f32_16x16x32_bf16 v[120:123], a[48:51], a[200:203], v[120:123]
    v_and_b32 v13, 3, v0
    v_lshlrev_b32 v253, 12, v13
    v_mfma_f32_16x16x32_bf16 v[120:123], a[52:55], a[216:219], v[120:123]
    v_bfe_u32 v13, v0, 2, 1
    v_lshl_add_u32 v253, v13, 9, v253
    v_mfma_f32_16x16x32_bf16 v[124:127], a[52:55], a[220:223], v[124:127]
    s_mov_b32 s87, s86
    s_mul_i32 s21, s35, 5120
    v_mfma_f32_16x16x32_bf16 v[124:127], a[48:51], a[204:207], v[124:127]
    s_mul_i32 s37, s3, 655360
    s_add_u32 s21, s21, s37
    v_mfma_f32_16x16x32_bf16 v[140:143], a[56:59], a[204:207], v[140:143]
    s_add_u32 s21, s21, 37748736
    s_lshl_b32 s23, s96, 7
    v_mfma_f32_16x16x32_bf16 v[140:143], a[60:63], a[220:223], v[140:143]
    s_mul_i32 s22, s96, 16640
    s_lshl_b32 s37, s95, 8
    v_mfma_f32_16x16x32_bf16 v[136:139], a[60:63], a[216:219], v[136:139]
    s_add_u32 s22, s22, s37
    s_add_u32 s22, s22, 29622272
    v_mfma_f32_16x16x32_bf16 v[136:139], a[56:59], a[200:203], v[136:139]
    s_lshl_b32 s36, s18, 4
    s_add_u32 s36, s36, s17
    v_mfma_f32_16x16x32_bf16 v[132:135], a[56:59], a[196:199], v[132:135]
    s_lshl_b32 s36, s36, 13
    s_add_u32 s77, s36, 20971520
    v_mfma_f32_16x16x32_bf16 v[132:135], a[60:63], a[212:215], v[132:135]
    s_mov_b32 s97, s77
    v_mov_b64 v[10:11], v[232:233]
    v_mfma_f32_16x16x32_bf16 v[128:131], a[60:63], a[208:211], v[128:131]
    v_mov_b64 v[248:249], v[234:235]
    v_mfma_f32_16x16x32_bf16 v[128:131], a[56:59], a[192:195], v[128:131]
    s_waitcnt vmcnt(12) lgkmcnt(0)
    s_barrier
    v_mfma_f32_16x16x32_bf16 v[16:19], a[0:3], a[224:227], v[16:19]
    v_mfma_f32_16x16x32_bf16 v[20:23], a[0:3], a[228:231], v[20:23]
    s_and_b32 s36, s2, 7
    s_mul_i32 s36, s36, 28
    v_mfma_f32_16x16x32_bf16 v[24:27], a[0:3], a[232:235], v[24:27]
    ds_read_b64_tr_b16 a[32:33], v5 offset:59136
    ds_read_b64_tr_b16 a[34:35], v5 offset:59648
    v_mfma_f32_16x16x32_bf16 v[28:31], a[0:3], a[236:239], v[28:31]
    s_lshr_b32 s37, s2, 3
    s_min_u32 s37, s37, 27
    v_mfma_f32_16x16x32_bf16 v[44:47], a[4:7], a[236:239], v[44:47]
    ds_read_b64_tr_b16 a[36:37], v5 offset:59144
    ds_read_b64_tr_b16 a[38:39], v5 offset:59656
    v_mfma_f32_16x16x32_bf16 v[40:43], a[4:7], a[232:235], v[40:43]
    s_add_u32 s36, s36, s37
    s_lshl_b32 s36, s36, 15
    v_mfma_f32_16x16x32_bf16 v[36:39], a[4:7], a[228:231], v[36:39]
    ds_read_b64_tr_b16 a[40:41], v5 offset:59200
    ds_read_b64_tr_b16 a[42:43], v5 offset:59712
    v_mfma_f32_16x16x32_bf16 v[32:35], a[4:7], a[224:227], v[32:35]
    s_lshl_b32 s37, s28, 13
    s_add_u32 s36, s36, s37
    v_mfma_f32_16x16x32_bf16 v[48:51], a[8:11], a[224:227], v[48:51]
    ds_read_b64_tr_b16 a[44:45], v5 offset:59208
    ds_read_b64_tr_b16 a[46:47], v5 offset:59720
    v_mfma_f32_16x16x32_bf16 v[52:55], a[8:11], a[228:231], v[52:55]
    v_and_b32 v13, 7, v0
    v_lshl_add_u32 v250, v13, 7, s36
    v_mfma_f32_16x16x32_bf16 v[56:59], a[8:11], a[232:235], v[56:59]
    ds_read_b64_tr_b16 a[48:49], v5 offset:59264
    ds_read_b64_tr_b16 a[50:51], v5 offset:59776
    v_mfma_f32_16x16x32_bf16 v[60:63], a[8:11], a[236:239], v[60:63]
    s_lshl_b32 s36, s18, 16
    s_lshl_b32 s37, s17, 7
    v_mfma_f32_16x16x32_bf16 v[76:79], a[12:15], a[236:239], v[76:79]
    ds_read_b64_tr_b16 a[52:53], v5 offset:59272
    ds_read_b64_tr_b16 a[54:55], v5 offset:59784
    v_mfma_f32_16x16x32_bf16 v[72:75], a[12:15], a[232:235], v[72:75]
    s_add_u32 s36, s36, s37
    v_and_b32 v13, 3, v0
    v_mfma_f32_16x16x32_bf16 v[68:71], a[12:15], a[228:231], v[68:71]
    ds_read_b64_tr_b16 a[56:57], v5 offset:59328
    ds_read_b64_tr_b16 a[58:59], v5 offset:59840
    v_mfma_f32_16x16x32_bf16 v[64:67], a[12:15], a[224:227], v[64:67]
    v_lshl_add_u32 v251, v13, 11, s36
    v_mfma_f32_16x16x32_bf16 v[80:83], a[16:19], a[224:227], v[80:83]
    ds_read_b64_tr_b16 a[60:61], v5 offset:59336
    ds_read_b64_tr_b16 a[62:63], v5 offset:59848
    v_mfma_f32_16x16x32_bf16 v[84:87], a[16:19], a[228:231], v[84:87]
    v_mfma_f32_16x16x32_bf16 v[88:91], a[16:19], a[232:235], v[88:91]
    ds_read_b128 a[96:99], v1 offset:16640
    ds_read_b128 a[100:103], v1 offset:16704
    v_mfma_f32_16x16x32_bf16 v[92:95], a[16:19], a[236:239], v[92:95]
    ds_read_b128 a[104:107], v1 offset:16768
    ds_read_b128 a[108:111], v1 offset:16832
    v_mfma_f32_16x16x32_bf16 v[108:111], a[20:23], a[236:239], v[108:111]
    ds_read_b128 a[112:115], v1 offset:17152
    ds_read_b128 a[116:119], v1 offset:17216
    v_mfma_f32_16x16x32_bf16 v[104:107], a[20:23], a[232:235], v[104:107]
    ds_read_b128 a[120:123], v1 offset:17280
    ds_read_b128 a[124:127], v1 offset:17344
    v_mfma_f32_16x16x32_bf16 v[100:103], a[20:23], a[228:231], v[100:103]
    ds_read_b128 a[64:67], v1 offset:33280
    ds_read_b128 a[68:71], v1 offset:33344
    v_mfma_f32_16x16x32_bf16 v[96:99], a[20:23], a[224:227], v[96:99]
    ds_read_b128 a[72:75], v1 offset:33408
    ds_read_b128 a[76:79], v1 offset:33472
    v_mfma_f32_16x16x32_bf16 v[112:115], a[24:27], a[224:227], v[112:115]
    ds_read_b128 a[80:83], v1 offset:33792
    ds_read_b128 a[84:87], v1 offset:33856
    v_mfma_f32_16x16x32_bf16 v[116:119], a[24:27], a[228:231], v[116:119]
    ds_read_b128 a[88:91], v1 offset:33920
    ds_read_b128 a[92:95], v1 offset:33984
    v_mfma_f32_16x16x32_bf16 v[120:123], a[24:27], a[232:235], v[120:123]
    v_mfma_f32_16x16x32_bf16 v[124:127], a[24:27], a[236:239], v[124:127]
    v_mfma_f32_16x16x32_bf16 v[140:143], a[28:31], a[236:239], v[140:143]
    v_mfma_f32_16x16x32_bf16 v[136:139], a[28:31], a[232:235], v[136:139]
    v_mfma_f32_16x16x32_bf16 v[132:135], a[28:31], a[228:231], v[132:135]
    v_mfma_f32_16x16x32_bf16 v[128:131], a[28:31], a[224:227], v[128:131]
attn_a:
    s_waitcnt vmcnt(4) lgkmcnt(0)
    s_barrier
    v_mfma_f32_16x16x32_bf16 v[16:19], a[32:35], a[240:243], v[16:19]
    ds_read_b64_tr_b16 a[180:181], v2 offset:33280
    ds_read_b64_tr_b16 a[182:183], v2 offset:33792
    v_mfma_f32_16x16x32_bf16 v[32:35], a[36:39], a[240:243], v[32:35]
    ds_read_b64_tr_b16 a[184:185], v2 offset:33312
    ds_read_b64_tr_b16 a[186:187], v2 offset:33824
    v_mfma_f32_16x16x32_bf16 v[48:51], a[40:43], a[240:243], v[48:51]
    ds_read_b64_tr_b16 a[188:189], v2 offset:33344
    ds_read_b64_tr_b16 a[190:191], v2 offset:33856
    v_mfma_f32_16x16x32_bf16 v[64:67], a[44:47], a[240:243], v[64:67]
    ds_read_b64_tr_b16 a[192:193], v2 offset:33376
    ds_read_b64_tr_b16 a[194:195], v2 offset:33888
    v_mfma_f32_16x16x32_bf16 v[80:83], a[48:51], a[240:243], v[80:83]
    v_lshlrev_b32 v5, 4, v14
    v_and_b32 v13, 3, v0
    v_mfma_f32_16x16x32_bf16 v[96:99], a[52:55], a[240:243], v[96:99]
    v_cmp_eq_u32 vcc, 0, v13
    v_mov_b32 v13, 0x3f803f80
    v_mfma_f32_16x16x32_bf16 v[112:115], a[56:59], a[240:243], v[112:115]
    s_nop 0
    v_cndmask_b32 v13, 0, v13, vcc
    v_mfma_f32_16x16x32_bf16 v[128:131], a[60:63], a[240:243], v[128:131]
    v_cvt_pk_bf16_f32 v212, v16, v17
    v_cvt_pk_bf16_f32 v213, v18, v19
    v_mfma_f32_16x16x32_bf16 v[20:23], a[32:35], a[244:247], v[20:23]
    s_add_u32 m0, s29, 83200
    v_cvt_pk_bf16_f32 v214, v32, v33
    v_mfma_f32_16x16x32_bf16 v[36:39], a[36:39], a[244:247], v[36:39]
    v_cvt_pk_bf16_f32 v215, v34, v35
    v_accvgpr_write_b32 a0, v212
    v_mfma_f32_16x16x32_bf16 v[52:55], a[40:43], a[244:247], v[52:55]
    v_accvgpr_write_b32 a1, v213
    v_accvgpr_write_b32 a2, v214
    v_mfma_f32_16x16x32_bf16 v[68:71], a[44:47], a[244:247], v[68:71]
    s_add_u32 s31, s31, 8192
    v_accvgpr_write_b32 a3, v215
    v_mfma_f32_16x16x32_bf16 v[84:87], a[48:51], a[244:247], v[84:87]
    v_cvt_pk_bf16_f32 v220, v48, v49
    v_cvt_pk_bf16_f32 v221, v50, v51
    v_mfma_f32_16x16x32_bf16 v[100:103], a[52:55], a[244:247], v[100:103]
    v_cvt_pk_bf16_f32 v222, v64, v65
    v_cvt_pk_bf16_f32 v223, v66, v67
    v_mfma_f32_16x16x32_bf16 v[116:119], a[56:59], a[244:247], v[116:119]
    buffer_load_dwordx4 v6, s[8:11], s31 offen nt lds
    v_accvgpr_write_b32 a4, v220
    v_mfma_f32_16x16x32_bf16 v[132:135], a[60:63], a[244:247], v[132:135]
    v_accvgpr_write_b32 a5, v221
    v_accvgpr_write_b32 a6, v222
    v_mfma_f32_16x16x32_bf16 v[24:27], a[32:35], a[248:251], v[24:27]
    v_accvgpr_write_b32 a7, v223
    v_cvt_pk_bf16_f32 v228, v80, v81
    v_mfma_f32_16x16x32_bf16 v[40:43], a[36:39], a[248:251], v[40:43]
    buffer_load_dwordx4 v7, s[8:11], s31 offen offset:1056 nt lds
    v_cvt_pk_bf16_f32 v229, v82, v83
    v_mfma_f32_16x16x32_bf16 v[56:59], a[40:43], a[248:251], v[56:59]
    v_cvt_pk_bf16_f32 v230, v96, v97
    v_cvt_pk_bf16_f32 v231, v98, v99
    v_mfma_f32_16x16x32_bf16 v[72:75], a[44:47], a[248:251], v[72:75]
    v_accvgpr_write_b32 a8, v228
    v_accvgpr_write_b32 a9, v229
    v_mfma_f32_16x16x32_bf16 v[88:91], a[48:51], a[248:251], v[88:91]
    buffer_load_dwordx4 v8, s[12:15], s31 offen offset:2080 nt lds
    v_accvgpr_write_b32 a10, v230
    v_mfma_f32_16x16x32_bf16 v[104:107], a[52:55], a[248:251], v[104:107]
    v_accvgpr_write_b32 a11, v231
    v_cvt_pk_bf16_f32 v236, v112, v113
    v_mfma_f32_16x16x32_bf16 v[120:123], a[56:59], a[248:251], v[120:123]
    v_cvt_pk_bf16_f32 v237, v114, v115
    v_cvt_pk_bf16_f32 v238, v128, v129
    v_mfma_f32_16x16x32_bf16 v[136:139], a[60:63], a[248:251], v[136:139]
    buffer_load_dwordx4 v9, s[12:15], s31 offen offset:3136 nt lds
    v_cvt_pk_bf16_f32 v239, v130, v131
    v_mfma_f32_16x16x32_bf16 v[28:31], a[32:35], a[252:255], v[28:31]
    v_accvgpr_write_b32 a12, v236
    v_accvgpr_write_b32 a13, v237
    v_mfma_f32_16x16x32_bf16 v[44:47], a[36:39], a[252:255], v[44:47]
    v_accvgpr_write_b32 a14, v238
    v_accvgpr_write_b32 a15, v239
    v_mfma_f32_16x16x32_bf16 v[60:63], a[40:43], a[252:255], v[60:63]
    s_add_u32 m0, s29, 0
    v_cvt_pk_bf16_f32 v212, v20, v21
    v_mfma_f32_16x16x32_bf16 v[76:79], a[44:47], a[252:255], v[76:79]
    v_cvt_pk_bf16_f32 v213, v22, v23
    v_cvt_pk_bf16_f32 v214, v36, v37
    v_mfma_f32_16x16x32_bf16 v[92:95], a[48:51], a[252:255], v[92:95]
    v_cvt_pk_bf16_f32 v215, v38, v39
    v_accvgpr_write_b32 a16, v212
    v_mfma_f32_16x16x32_bf16 v[108:111], a[52:55], a[252:255], v[108:111]
    s_add_u32 s31, s31, 8192
    v_accvgpr_write_b32 a17, v213
    v_mfma_f32_16x16x32_bf16 v[124:127], a[56:59], a[252:255], v[124:127]
    v_accvgpr_write_b32 a18, v214
    v_accvgpr_write_b32 a19, v215
    v_mfma_f32_16x16x32_bf16 v[140:143], a[60:63], a[252:255], v[140:143]
    v_cvt_pk_bf16_f32 v220, v52, v53
    v_cvt_pk_bf16_f32 v221, v54, v55
    v_mfma_f32_16x16x32_bf16 v[144:147], a[96:99], a[0:3], 0
    buffer_load_dwordx4 v6, s[8:11], s31 offen nt lds
    v_cvt_pk_bf16_f32 v222, v68, v69
    v_mfma_f32_16x16x32_bf16 v[144:147], a[100:103], a[4:7], v[144:147]
    v_cvt_pk_bf16_f32 v223, v70, v71
    v_accvgpr_write_b32 a20, v220
    v_mfma_f32_16x16x32_bf16 v[144:147], a[104:107], a[8:11], v[144:147]
    v_accvgpr_write_b32 a21, v221
    v_accvgpr_write_b32 a22, v222
    v_mfma_f32_16x16x32_bf16 v[144:147], a[108:111], a[12:15], v[144:147]
    buffer_load_dwordx4 v7, s[8:11], s31 offen offset:1056 nt lds
    v_accvgpr_write_b32 a23, v223
    v_mfma_f32_16x16x32_bf16 v[148:151], a[112:115], a[0:3], 0
    v_cvt_pk_bf16_f32 v228, v84, v85
    v_cvt_pk_bf16_f32 v229, v86, v87
    v_mfma_f32_16x16x32_bf16 v[148:151], a[116:119], a[4:7], v[148:151]
    v_cvt_pk_bf16_f32 v230, v100, v101
    v_cvt_pk_bf16_f32 v231, v102, v103
    v_mfma_f32_16x16x32_bf16 v[148:151], a[120:123], a[8:11], v[148:151]
    buffer_load_dwordx4 v8, s[12:15], s31 offen offset:2080 nt lds
    v_accvgpr_write_b32 a24, v228
    v_mfma_f32_16x16x32_bf16 v[148:151], a[124:127], a[12:15], v[148:151]
    v_accvgpr_write_b32 a25, v229
    v_accvgpr_write_b32 a26, v230
    v_mfma_f32_16x16x32_bf16 v[176:179], a[64:67], a[0:3], 0
    v_accvgpr_write_b32 a27, v231
    v_cvt_pk_bf16_f32 v236, v116, v117
    v_mfma_f32_16x16x32_bf16 v[176:179], a[68:71], a[4:7], v[176:179]
    buffer_load_dwordx4 v9, s[12:15], s31 offen offset:3136 nt lds
    v_cvt_pk_bf16_f32 v237, v118, v119
    v_mfma_f32_16x16x32_bf16 v[176:179], a[72:75], a[8:11], v[176:179]
    v_cvt_pk_bf16_f32 v238, v132, v133
    v_cvt_pk_bf16_f32 v239, v134, v135
    v_mfma_f32_16x16x32_bf16 v[176:179], a[76:79], a[12:15], v[176:179]
    v_accvgpr_write_b32 a28, v236
    v_accvgpr_write_b32 a29, v237
    v_mfma_f32_16x16x32_bf16 v[180:183], a[80:83], a[0:3], 0
    v_accvgpr_write_b32 a144, v13
    v_accvgpr_write_b32 a30, v238
    v_mfma_f32_16x16x32_bf16 v[180:183], a[84:87], a[4:7], v[180:183]
    v_accvgpr_write_b32 a31, v239
    v_cvt_pk_bf16_f32 v212, v24, v25
    v_mfma_f32_16x16x32_bf16 v[180:183], a[88:91], a[8:11], v[180:183]
    v_cvt_pk_bf16_f32 v213, v26, v27
    v_cvt_pk_bf16_f32 v214, v40, v41
    v_mfma_f32_16x16x32_bf16 v[180:183], a[92:95], a[12:15], v[180:183]
    v_accvgpr_write_b32 a145, v13
    v_cvt_pk_bf16_f32 v215, v42, v43
    v_mfma_f32_16x16x32_bf16 v[152:155], a[96:99], a[16:19], 0
    v_accvgpr_write_b32 a32, v212
    v_accvgpr_write_b32 a33, v213
    v_mfma_f32_16x16x32_bf16 v[152:155], a[100:103], a[20:23], v[152:155]
    v_accvgpr_write_b32 a34, v214
    v_accvgpr_write_b32 a35, v215
    v_mfma_f32_16x16x32_bf16 v[152:155], a[104:107], a[24:27], v[152:155]
    v_accvgpr_write_b32 a146, v13
    v_cvt_pk_bf16_f32 v220, v56, v57
    v_mfma_f32_16x16x32_bf16 v[152:155], a[108:111], a[28:31], v[152:155]
    v_cvt_pk_bf16_f32 v221, v58, v59
    v_cvt_pk_bf16_f32 v222, v72, v73
    v_mfma_f32_16x16x32_bf16 v[156:159], a[112:115], a[16:19], 0
    v_cvt_pk_bf16_f32 v223, v74, v75
    v_accvgpr_write_b32 a36, v220
    v_mfma_f32_16x16x32_bf16 v[156:159], a[116:119], a[20:23], v[156:159]
    v_accvgpr_write_b32 a147, v13
    v_accvgpr_write_b32 a37, v221
    v_mfma_f32_16x16x32_bf16 v[156:159], a[120:123], a[24:27], v[156:159]
    v_accvgpr_write_b32 a38, v222
    v_accvgpr_write_b32 a39, v223
    v_mfma_f32_16x16x32_bf16 v[156:159], a[124:127], a[28:31], v[156:159]
    v_cvt_pk_bf16_f32 v228, v88, v89
    v_cvt_pk_bf16_f32 v229, v90, v91
    v_mfma_f32_16x16x32_bf16 v[184:187], a[64:67], a[16:19], 0
    s_mov_b32 s34, 1
    v_cvt_pk_bf16_f32 v230, v104, v105
    v_mfma_f32_16x16x32_bf16 v[184:187], a[68:71], a[20:23], v[184:187]
    v_cvt_pk_bf16_f32 v231, v106, v107
    v_accvgpr_write_b32 a40, v228
    v_mfma_f32_16x16x32_bf16 v[184:187], a[72:75], a[24:27], v[184:187]
    v_accvgpr_write_b32 a41, v229
    v_accvgpr_write_b32 a42, v230
    v_mfma_f32_16x16x32_bf16 v[184:187], a[76:79], a[28:31], v[184:187]
    s_mov_b32 s93, 0x2000
    v_accvgpr_write_b32 a43, v231
    v_mfma_f32_16x16x32_bf16 v[188:191], a[80:83], a[16:19], 0
    v_cvt_pk_bf16_f32 v236, v120, v121
    v_cvt_pk_bf16_f32 v237, v122, v123
    v_mfma_f32_16x16x32_bf16 v[188:191], a[84:87], a[20:23], v[188:191]
    v_cvt_pk_bf16_f32 v238, v136, v137
    v_cvt_pk_bf16_f32 v239, v138, v139
    v_mfma_f32_16x16x32_bf16 v[188:191], a[88:91], a[24:27], v[188:191]
    s_mov_b32 s92, s74
    v_accvgpr_write_b32 a44, v236
    v_mfma_f32_16x16x32_bf16 v[188:191], a[92:95], a[28:31], v[188:191]
    v_accvgpr_write_b32 a45, v237
    v_accvgpr_write_b32 a46, v238
    v_accvgpr_write_b32 a47, v239
    s_nop 1
    v_mfma_f32_16x16x32_bf16 v[160:163], a[96:99], a[32:35], 0
    v_cvt_pk_bf16_f32 v212, v28, v29
    v_cvt_pk_bf16_f32 v213, v30, v31
    v_mfma_f32_16x16x32_bf16 v[160:163], a[100:103], a[36:39], v[160:163]
    ds_read_b64_tr_b16 a[196:197], v2 offset:33408
    v_cvt_pk_bf16_f32 v214, v44, v45
    v_mfma_f32_16x16x32_bf16 v[160:163], a[104:107], a[40:43], v[160:163]
    v_cvt_pk_bf16_f32 v215, v46, v47
    v_accvgpr_write_b32 a48, v212
    v_mfma_f32_16x16x32_bf16 v[160:163], a[108:111], a[44:47], v[160:163]
    v_accvgpr_write_b32 a49, v213
    v_accvgpr_write_b32 a50, v214
    v_mfma_f32_16x16x32_bf16 v[164:167], a[112:115], a[32:35], 0
    ds_read_b64_tr_b16 a[198:199], v2 offset:33920
    v_accvgpr_write_b32 a51, v215
    v_mfma_f32_16x16x32_bf16 v[164:167], a[116:119], a[36:39], v[164:167]
    v_cvt_pk_bf16_f32 v220, v60, v61
    v_cvt_pk_bf16_f32 v221, v62, v63
    v_mfma_f32_16x16x32_bf16 v[164:167], a[120:123], a[40:43], v[164:167]
    v_cvt_pk_bf16_f32 v222, v76, v77
    v_cvt_pk_bf16_f32 v223, v78, v79
    v_mfma_f32_16x16x32_bf16 v[164:167], a[124:127], a[44:47], v[164:167]
    ds_read_b64_tr_b16 a[200:201], v2 offset:33440
    v_accvgpr_write_b32 a52, v220
    v_mfma_f32_16x16x32_bf16 v[192:195], a[64:67], a[32:35], 0
    v_accvgpr_write_b32 a53, v221
    v_accvgpr_write_b32 a54, v222
    v_mfma_f32_16x16x32_bf16 v[192:195], a[68:71], a[36:39], v[192:195]
    v_accvgpr_write_b32 a55, v223
    v_cvt_pk_bf16_f32 v228, v92, v93
    v_mfma_f32_16x16x32_bf16 v[192:195], a[72:75], a[40:43], v[192:195]
    ds_read_b64_tr_b16 a[202:203], v2 offset:33952
    v_cvt_pk_bf16_f32 v229, v94, v95
    v_mfma_f32_16x16x32_bf16 v[192:195], a[76:79], a[44:47], v[192:195]
    v_cvt_pk_bf16_f32 v230, v108, v109
    v_cvt_pk_bf16_f32 v231, v110, v111
    v_mfma_f32_16x16x32_bf16 v[196:199], a[80:83], a[32:35], 0
    v_accvgpr_write_b32 a56, v228
    v_accvgpr_write_b32 a57, v229
    v_mfma_f32_16x16x32_bf16 v[196:199], a[84:87], a[36:39], v[196:199]
    ds_read_b64_tr_b16 a[204:205], v2 offset:33472
    v_accvgpr_write_b32 a58, v230
    v_mfma_f32_16x16x32_bf16 v[196:199], a[88:91], a[40:43], v[196:199]
    v_accvgpr_write_b32 a59, v231
    v_cvt_pk_bf16_f32 v236, v124, v125
    v_mfma_f32_16x16x32_bf16 v[196:199], a[92:95], a[44:47], v[196:199]
    v_cvt_pk_bf16_f32 v237, v126, v127
    v_cvt_pk_bf16_f32 v238, v140, v141
    v_cvt_pk_bf16_f32 v239, v142, v143
    v_accvgpr_write_b32 a60, v236
    v_accvgpr_write_b32 a61, v237
    v_accvgpr_write_b32 a62, v238
    v_accvgpr_write_b32 a63, v239
    s_nop 1
    v_mfma_f32_16x16x32_bf16 v[168:171], a[96:99], a[48:51], 0
    ds_read_b64_tr_b16 a[206:207], v2 offset:33984
    v_mfma_f32_16x16x32_bf16 v[168:171], a[100:103], a[52:55], v[168:171]
    v_exp_f32 v144, v144
    v_mfma_f32_16x16x32_bf16 v[168:171], a[104:107], a[56:59], v[168:171]
    v_exp_f32 v145, v145
    v_mfma_f32_16x16x32_bf16 v[168:171], a[108:111], a[60:63], v[168:171]
    ds_read_b64_tr_b16 a[208:209], v2 offset:33504
    v_mfma_f32_16x16x32_bf16 v[172:175], a[112:115], a[48:51], 0
    v_exp_f32 v146, v146
    v_mfma_f32_16x16x32_bf16 v[172:175], a[116:119], a[52:55], v[172:175]
    v_exp_f32 v147, v147
    v_mfma_f32_16x16x32_bf16 v[172:175], a[120:123], a[56:59], v[172:175]
    ds_read_b64_tr_b16 a[210:211], v2 offset:34016
    v_mfma_f32_16x16x32_bf16 v[172:175], a[124:127], a[60:63], v[172:175]
    v_exp_f32 v148, v148
    v_mfma_f32_16x16x32_bf16 v[200:203], a[64:67], a[48:51], 0
    v_exp_f32 v149, v149
    v_mfma_f32_16x16x32_bf16 v[200:203], a[68:71], a[52:55], v[200:203]
    v_exp_f32 v150, v150
    v_mfma_f32_16x16x32_bf16 v[200:203], a[72:75], a[56:59], v[200:203]
    v_exp_f32 v151, v151
    v_mfma_f32_16x16x32_bf16 v[200:203], a[76:79], a[60:63], v[200:203]
    v_exp_f32 v152, v152
    v_mfma_f32_16x16x32_bf16 v[204:207], a[80:83], a[48:51], 0
    v_exp_f32 v153, v153
    v_mfma_f32_16x16x32_bf16 v[204:207], a[84:87], a[52:55], v[204:207]
    v_exp_f32 v154, v154
    v_mfma_f32_16x16x32_bf16 v[204:207], a[88:91], a[56:59], v[204:207]
    v_exp_f32 v155, v155
    v_mfma_f32_16x16x32_bf16 v[204:207], a[92:95], a[60:63], v[204:207]
    v_exp_f32 v156, v156
    v_exp_f32 v157, v157
    v_exp_f32 v158, v158
    v_exp_f32 v159, v159
    v_cvt_pk_bf16_f32 v208, v144, v145
    v_cvt_pk_bf16_f32 v209, v146, v147
    v_cvt_pk_bf16_f32 v210, v148, v149
    v_cvt_pk_bf16_f32 v211, v150, v151
    v_exp_f32 v160, v160
    v_exp_f32 v161, v161
    v_exp_f32 v162, v162
    v_exp_f32 v163, v163
    v_exp_f32 v164, v164
    v_exp_f32 v165, v165
    v_exp_f32 v166, v166
    v_exp_f32 v167, v167
    v_cvt_pk_bf16_f32 v216, v152, v153
    v_cvt_pk_bf16_f32 v217, v154, v155
    v_cvt_pk_bf16_f32 v218, v156, v157
    v_cvt_pk_bf16_f32 v219, v158, v159
    v_exp_f32 v168, v168
    v_exp_f32 v169, v169
    v_exp_f32 v170, v170
    v_exp_f32 v171, v171
    v_exp_f32 v172, v172
    v_exp_f32 v173, v173
    v_exp_f32 v174, v174
    v_exp_f32 v175, v175
    v_cvt_pk_bf16_f32 v224, v160, v161
    v_cvt_pk_bf16_f32 v225, v162, v163
    v_cvt_pk_bf16_f32 v226, v164, v165
    v_cvt_pk_bf16_f32 v227, v166, v167
    s_nop 0
    v_cvt_pk_bf16_f32 v232, v168, v169
    v_cvt_pk_bf16_f32 v233, v170, v171
    v_cvt_pk_bf16_f32 v234, v172, v173
    v_cvt_pk_bf16_f32 v235, v174, v175
    s_waitcnt lgkmcnt(0)
    v_mfma_f32_16x16x32_bf16 a[136:139], a[144:147], v[224:227], 0
    ds_read_b128 a[64:67], v3 offset:0
    ds_read_b128 a[68:71], v3 offset:64
    v_mfma_f32_16x16x32_bf16 a[140:143], a[144:147], v[232:235], 0
    ds_read_b128 a[72:75], v3 offset:128
    ds_read_b128 a[76:79], v3 offset:192
    v_mfma_f32_16x16x32_bf16 v[28:31], a[180:183], v[232:235], 0
    ds_read_b128 a[80:83], v3 offset:512
    ds_read_b128 a[84:87], v3 offset:576
    v_mfma_f32_16x16x32_bf16 v[24:27], a[180:183], v[224:227], 0
    ds_read_b128 a[88:91], v3 offset:640
    ds_read_b128 a[92:95], v3 offset:704
    v_mfma_f32_16x16x32_bf16 v[40:43], a[184:187], v[224:227], 0
    s_add_u32 m0, s29, 16640
    v_mfma_f32_16x16x32_bf16 v[44:47], a[184:187], v[232:235], 0
    v_exp_f32 v176, v176
    v_mfma_f32_16x16x32_bf16 v[60:63], a[188:191], v[232:235], 0
    v_exp_f32 v177, v177
    v_mfma_f32_16x16x32_bf16 v[56:59], a[188:191], v[224:227], 0
    s_add_u32 s31, s31, 8192
    v_mfma_f32_16x16x32_bf16 v[72:75], a[192:195], v[224:227], 0
    v_exp_f32 v178, v178
    v_mfma_f32_16x16x32_bf16 v[76:79], a[192:195], v[232:235], 0
    v_exp_f32 v179, v179
    v_mfma_f32_16x16x32_bf16 v[92:95], a[196:199], v[232:235], 0
    buffer_load_dwordx4 v6, s[8:11], s31 offen nt lds
    v_cvt_pk_bf16_f32 v212, v176, v177
    v_mfma_f32_16x16x32_bf16 v[88:91], a[196:199], v[224:227], 0
    v_exp_f32 v180, v180
    v_mfma_f32_16x16x32_bf16 v[104:107], a[200:203], v[224:227], 0
    v_exp_f32 v181, v181
    v_mfma_f32_16x16x32_bf16 v[108:111], a[200:203], v[232:235], 0
    buffer_load_dwordx4 v7, s[8:11], s31 offen offset:1056 nt lds
    v_cvt_pk_bf16_f32 v213, v178, v179
    v_mfma_f32_16x16x32_bf16 v[124:127], a[204:207], v[232:235], 0
    v_exp_f32 v182, v182
    v_mfma_f32_16x16x32_bf16 v[120:123], a[204:207], v[224:227], 0
    v_exp_f32 v183, v183
    v_mfma_f32_16x16x32_bf16 v[136:139], a[208:211], v[224:227], 0
    s_waitcnt lgkmcnt(0)
    buffer_load_dwordx4 v8, s[12:15], s31 offen offset:2080 nt lds
    v_mfma_f32_16x16x32_bf16 v[140:143], a[208:211], v[232:235], 0
    v_cvt_pk_bf16_f32 v214, v180, v181
    v_mfma_f32_16x16x32_bf16 v[160:163], a[64:67], a[32:35], 0
    ds_read_b64_tr_b16 a[96:97], v4 offset:0
    ds_read_b64_tr_b16 a[98:99], v4 offset:512
    v_mfma_f32_16x16x32_bf16 v[160:163], a[68:71], a[36:39], v[160:163]
    ds_read_b64_tr_b16 a[100:101], v4 offset:32
    ds_read_b64_tr_b16 a[102:103], v4 offset:544
    v_mfma_f32_16x16x32_bf16 v[160:163], a[72:75], a[40:43], v[160:163]
    ds_read_b64_tr_b16 a[104:105], v4 offset:64
    ds_read_b64_tr_b16 a[106:107], v4 offset:576
    v_mfma_f32_16x16x32_bf16 v[160:163], a[76:79], a[44:47], v[160:163]
    ds_read_b64_tr_b16 a[108:109], v4 offset:96
    ds_read_b64_tr_b16 a[110:111], v4 offset:608
    v_mfma_f32_16x16x32_bf16 v[164:167], a[92:95], a[44:47], 0
    ds_read_b64_tr_b16 a[112:113], v4 offset:128
    ds_read_b64_tr_b16 a[114:115], v4 offset:640
    v_mfma_f32_16x16x32_bf16 v[164:167], a[88:91], a[40:43], v[164:167]
    ds_read_b64_tr_b16 a[116:117], v4 offset:160
    ds_read_b64_tr_b16 a[118:119], v4 offset:672
    v_mfma_f32_16x16x32_bf16 v[164:167], a[84:87], a[36:39], v[164:167]
    ds_read_b64_tr_b16 a[120:121], v4 offset:192
    ds_read_b64_tr_b16 a[122:123], v4 offset:704
    v_mfma_f32_16x16x32_bf16 v[164:167], a[80:83], a[32:35], v[164:167]
    ds_read_b64_tr_b16 a[124:125], v4 offset:224
    ds_read_b64_tr_b16 a[126:127], v4 offset:736
    v_mfma_f32_16x16x32_bf16 v[172:175], a[80:83], a[48:51], 0
    buffer_load_dwordx4 v9, s[12:15], s31 offen offset:3136 nt lds
    s_and_b32 s5, s93, 0x2003
    v_mfma_f32_16x16x32_bf16 v[172:175], a[84:87], a[52:55], v[172:175]
    s_mul_i32 s5, s5, s78
    v_mfma_f32_16x16x32_bf16 v[172:175], a[88:91], a[56:59], v[172:175]
    buffer_load_dword v247, v246, s[48:51], s5 offen
    v_mfma_f32_16x16x32_bf16 v[172:175], a[92:95], a[60:63], v[172:175]
    v_exp_f32 v184, v184
    v_mfma_f32_16x16x32_bf16 v[168:171], a[76:79], a[60:63], 0
    v_exp_f32 v185, v185
    v_mfma_f32_16x16x32_bf16 v[168:171], a[72:75], a[56:59], v[168:171]
    v_cvt_pk_bf16_f32 v215, v182, v183
    v_mfma_f32_16x16x32_bf16 v[168:171], a[68:71], a[52:55], v[168:171]
    v_exp_f32 v186, v186
    v_mfma_f32_16x16x32_bf16 v[168:171], a[64:67], a[48:51], v[168:171]
    v_exp_f32 v187, v187
    v_mfma_f32_16x16x32_bf16 v[144:147], a[64:67], a[0:3], 0
    v_cvt_pk_bf16_f32 v220, v184, v185
    v_mfma_f32_16x16x32_bf16 v[144:147], a[68:71], a[4:7], v[144:147]
    v_exp_f32 v188, v188
    v_mfma_f32_16x16x32_bf16 v[144:147], a[72:75], a[8:11], v[144:147]
    v_exp_f32 v189, v189
    v_mfma_f32_16x16x32_bf16 v[144:147], a[76:79], a[12:15], v[144:147]
    v_cvt_pk_bf16_f32 v221, v186, v187
    v_mfma_f32_16x16x32_bf16 v[148:151], a[92:95], a[12:15], 0
    v_exp_f32 v190, v190
    v_mfma_f32_16x16x32_bf16 v[148:151], a[88:91], a[8:11], v[148:151]
    v_exp_f32 v191, v191
    v_mfma_f32_16x16x32_bf16 v[148:151], a[84:87], a[4:7], v[148:151]
    v_cvt_pk_bf16_f32 v222, v188, v189
    v_mfma_f32_16x16x32_bf16 v[148:151], a[80:83], a[0:3], v[148:151]
    v_exp_f32 v192, v192
    v_mfma_f32_16x16x32_bf16 v[156:159], a[80:83], a[16:19], 0
    v_exp_f32 v193, v193
    v_mfma_f32_16x16x32_bf16 v[156:159], a[84:87], a[20:23], v[156:159]
    v_cvt_pk_bf16_f32 v223, v190, v191
    v_mfma_f32_16x16x32_bf16 v[156:159], a[88:91], a[24:27], v[156:159]
    v_exp_f32 v194, v194
    v_mfma_f32_16x16x32_bf16 v[156:159], a[92:95], a[28:31], v[156:159]
    v_exp_f32 v195, v195
    v_mfma_f32_16x16x32_bf16 v[152:155], a[76:79], a[28:31], 0
    v_cvt_pk_bf16_f32 v228, v192, v193
    v_mfma_f32_16x16x32_bf16 v[152:155], a[72:75], a[24:27], v[152:155]
    v_exp_f32 v196, v196
    v_mfma_f32_16x16x32_bf16 v[152:155], a[68:71], a[20:23], v[152:155]
    v_exp_f32 v197, v197
    v_mfma_f32_16x16x32_bf16 v[152:155], a[64:67], a[16:19], v[152:155]
    v_cvt_pk_bf16_f32 v229, v194, v195
    v_exp_f32 v198, v198
    v_exp_f32 v199, v199
    v_cvt_pk_bf16_f32 v230, v196, v197
    v_exp_f32 v200, v200
    v_exp_f32 v201, v201
    v_cvt_pk_bf16_f32 v231, v198, v199
    v_exp_f32 v202, v202
    v_exp_f32 v203, v203
    v_cvt_pk_bf16_f32 v236, v200, v201
    v_exp_f32 v204, v204
    v_exp_f32 v205, v205
    v_cvt_pk_bf16_f32 v237, v202, v203
    v_exp_f32 v206, v206
    v_exp_f32 v207, v207
    v_cvt_pk_bf16_f32 v238, v204, v205
    v_cvt_pk_bf16_f32 v239, v206, v207
    s_waitcnt vmcnt(9) lgkmcnt(0)
    s_barrier
    v_mfma_f32_16x16x32_bf16 a[128:131], a[144:147], v[208:211], 0
    v_exp_f32 v160, v160
    v_mfma_f32_16x16x32_bf16 a[128:131], a[144:147], v[212:215], a[128:131]
    s_add_u32 m0, s29, 33280
    s_add_u32 s31, s31, 8192
    v_mfma_f32_16x16x32_bf16 a[132:135], a[144:147], v[220:223], 0
    v_exp_f32 v161, v161
    v_mfma_f32_16x16x32_bf16 a[132:135], a[144:147], v[216:219], a[132:135]
    ds_read_b128 a[64:67], v3 offset:16640
    ds_read_b128 a[68:71], v3 offset:16704
    v_mfma_f32_16x16x32_bf16 v[20:23], a[180:183], v[216:219], 0
    v_exp_f32 v162, v162
    v_mfma_f32_16x16x32_bf16 v[20:23], a[96:99], v[220:223], v[20:23]
    ds_read_b128 a[72:75], v3 offset:16768
    ds_read_b128 a[76:79], v3 offset:16832
    v_mfma_f32_16x16x32_bf16 v[16:19], a[96:99], v[212:215], 0
    v_exp_f32 v163, v163
    v_mfma_f32_16x16x32_bf16 v[16:19], a[180:183], v[208:211], v[16:19]
    ds_read_b128 a[80:83], v3 offset:17152
    ds_read_b128 a[84:87], v3 offset:17216
    v_mfma_f32_16x16x32_bf16 v[32:35], a[184:187], v[208:211], 0
    v_and_b32 v14, 2, v0
    v_exp_f32 v164, v164
    v_mfma_f32_16x16x32_bf16 v[32:35], a[100:103], v[212:215], v[32:35]
    ds_read_b128 a[88:91], v3 offset:17280
    ds_read_b128 a[92:95], v3 offset:17344
    v_mfma_f32_16x16x32_bf16 v[36:39], a[100:103], v[220:223], 0
    v_exp_f32 v165, v165
    v_mfma_f32_16x16x32_bf16 v[36:39], a[184:187], v[216:219], v[36:39]
    buffer_load_dwordx4 v6, s[8:11], s31 offen nt lds
    v_cmp_eq_u32 vcc, 0, v14
    v_mfma_f32_16x16x32_bf16 v[52:55], a[188:191], v[216:219], 0
    v_exp_f32 v166, v166
    v_mfma_f32_16x16x32_bf16 v[52:55], a[104:107], v[220:223], v[52:55]
    v_cvt_pk_bf16_f32 v224, v160, v161
    v_cvt_pk_bf16_f32 v225, v162, v163
    v_mfma_f32_16x16x32_bf16 v[48:51], a[104:107], v[212:215], 0
    v_exp_f32 v167, v167
    v_mfma_f32_16x16x32_bf16 v[48:51], a[188:191], v[208:211], v[48:51]
    v_mov_b32 v14, 0x3f803f80
    buffer_load_dwordx4 v7, s[8:11], s31 offen offset:1056 nt lds
    v_mfma_f32_16x16x32_bf16 v[64:67], a[192:195], v[208:211], 0
    v_exp_f32 v168, v168
    v_mfma_f32_16x16x32_bf16 v[64:67], a[108:111], v[212:215], v[64:67]
    v_cvt_pk_bf16_f32 v226, v164, v165
    v_cvt_pk_bf16_f32 v227, v166, v167
    v_mfma_f32_16x16x32_bf16 v[68:71], a[108:111], v[220:223], 0
    v_exp_f32 v169, v169
    s_nop 0
    v_mfma_f32_16x16x32_bf16 v[68:71], a[192:195], v[216:219], v[68:71]
    buffer_load_dwordx4 v8, s[12:15], s31 offen offset:2080 nt lds
    v_mfma_f32_16x16x32_bf16 v[84:87], a[196:199], v[216:219], 0
    v_exp_f32 v170, v170
    v_mfma_f32_16x16x32_bf16 v[84:87], a[112:115], v[220:223], v[84:87]
    v_cvt_pk_bf16_f32 v232, v168, v169
    v_mfma_f32_16x16x32_bf16 v[80:83], a[112:115], v[212:215], 0
    v_exp_f32 v171, v171
    v_cndmask_b32 v14, 0, v14, vcc
    v_mfma_f32_16x16x32_bf16 v[80:83], a[196:199], v[208:211], v[80:83]
    buffer_load_dwordx4 v9, s[12:15], s31 offen offset:3136 nt lds
    v_mfma_f32_16x16x32_bf16 v[96:99], a[200:203], v[208:211], 0
    v_exp_f32 v172, v172
    v_mfma_f32_16x16x32_bf16 v[96:99], a[116:119], v[212:215], v[96:99]
    v_cvt_pk_bf16_f32 v233, v170, v171
    v_mfma_f32_16x16x32_bf16 v[100:103], a[116:119], v[220:223], 0
    v_exp_f32 v173, v173
    v_accvgpr_write_b32 a252, v14
    v_mfma_f32_16x16x32_bf16 v[100:103], a[200:203], v[216:219], v[100:103]
    s_lshl_b32 s5, s93, 10
    v_mfma_f32_16x16x32_bf16 v[116:119], a[204:207], v[216:219], 0
    v_exp_f32 v174, v174
    v_mfma_f32_16x16x32_bf16 v[116:119], a[120:123], v[220:223], v[116:119]
    buffer_load_dword v247, v250, s[24:27], s5 offen
    v_mfma_f32_16x16x32_bf16 v[112:115], a[120:123], v[212:215], 0
    v_exp_f32 v175, v175
    v_accvgpr_write_b32 a253, v14
    v_mfma_f32_16x16x32_bf16 v[112:115], a[204:207], v[208:211], v[112:115]
    v_cvt_pk_bf16_f32 v234, v172, v173
    v_cvt_pk_bf16_f32 v235, v174, v175
    v_mfma_f32_16x16x32_bf16 v[128:131], a[208:211], v[208:211], 0
    v_exp_f32 v144, v144
    v_mfma_f32_16x16x32_bf16 v[128:131], a[124:127], v[212:215], v[128:131]
    v_mfma_f32_16x16x32_bf16 v[132:135], a[124:127], v[220:223], 0
    v_exp_f32 v145, v145
    v_accvgpr_write_b32 a254, v14
    v_mfma_f32_16x16x32_bf16 v[132:135], a[208:211], v[216:219], v[132:135]
    s_waitcnt lgkmcnt(0)
    v_mfma_f32_16x16x32_bf16 v[176:179], a[64:67], a[0:3], 0
    v_exp_f32 v146, v146
    v_mfma_f32_16x16x32_bf16 v[176:179], a[68:71], a[4:7], v[176:179]
    ds_read_b64_tr_b16 a[180:181], v4 offset:16640
    ds_read_b64_tr_b16 a[182:183], v4 offset:17152
    v_mfma_f32_16x16x32_bf16 v[176:179], a[72:75], a[8:11], v[176:179]
    v_accvgpr_write_b32 a255, v14
    v_exp_f32 v147, v147
    v_mfma_f32_16x16x32_bf16 v[176:179], a[76:79], a[12:15], v[176:179]
    ds_read_b64_tr_b16 a[184:185], v4 offset:16672
    ds_read_b64_tr_b16 a[186:187], v4 offset:17184
    v_mfma_f32_16x16x32_bf16 v[180:183], a[92:95], a[12:15], 0
    v_exp_f32 v148, v148
    v_mfma_f32_16x16x32_bf16 v[180:183], a[88:91], a[8:11], v[180:183]
    ds_read_b64_tr_b16 a[188:189], v4 offset:16704
    v_and_b32 v14, 1, v0
    ds_read_b64_tr_b16 a[190:191], v4 offset:17216
    v_mfma_f32_16x16x32_bf16 v[180:183], a[84:87], a[4:7], v[180:183]
    v_exp_f32 v149, v149
    v_mfma_f32_16x16x32_bf16 v[180:183], a[80:83], a[0:3], v[180:183]
    ds_read_b64_tr_b16 a[192:193], v4 offset:16736
    ds_read_b64_tr_b16 a[194:195], v4 offset:17248
    v_mfma_f32_16x16x32_bf16 v[188:191], a[80:83], a[16:19], 0
    v_exp_f32 v150, v150
    v_mul_u32_u24 v15, 0xaaaa, v14
    v_mfma_f32_16x16x32_bf16 v[188:191], a[84:87], a[20:23], v[188:191]
    ds_read_b64_tr_b16 a[196:197], v4 offset:16768
    ds_read_b64_tr_b16 a[198:199], v4 offset:17280
    v_mfma_f32_16x16x32_bf16 v[188:191], a[88:91], a[24:27], v[188:191]
    v_exp_f32 v151, v151
    v_mfma_f32_16x16x32_bf16 v[188:191], a[92:95], a[28:31], v[188:191]
    ds_read_b64_tr_b16 a[200:201], v4 offset:16800
    ds_read_b64_tr_b16 a[202:203], v4 offset:17312
    v_add_u32 v15, 0x4444, v15
    v_mfma_f32_16x16x32_bf16 v[184:187], a[76:79], a[28:31], 0
    v_exp_f32 v152, v152
    v_mfma_f32_16x16x32_bf16 v[184:187], a[72:75], a[24:27], v[184:187]
    ds_read_b64_tr_b16 a[204:205], v4 offset:16832
    ds_read_b64_tr_b16 a[206:207], v4 offset:17344
    v_mfma_f32_16x16x32_bf16 v[184:187], a[68:71], a[20:23], v[184:187]
    v_exp_f32 v153, v153
    v_mfma_f32_16x16x32_bf16 v[184:187], a[64:67], a[16:19], v[184:187]
    v_lshl_or_b32 v15, v15, 16, v15
    ds_read_b64_tr_b16 a[208:209], v4 offset:16864
    ds_read_b64_tr_b16 a[210:211], v4 offset:17376
    v_mfma_f32_16x16x32_bf16 v[192:195], a[64:67], a[32:35], 0
    v_exp_f32 v154, v154
    v_mfma_f32_16x16x32_bf16 v[192:195], a[68:71], a[36:39], v[192:195]
    v_cvt_pk_bf16_f32 v208, v144, v145
    v_cvt_pk_bf16_f32 v209, v146, v147
    v_mfma_f32_16x16x32_bf16 v[192:195], a[72:75], a[40:43], v[192:195]
    v_exp_f32 v155, v155
    v_mfma_f32_16x16x32_bf16 v[192:195], a[76:79], a[44:47], v[192:195]
    v_cvt_pk_bf16_f32 v210, v148, v149
    v_cvt_pk_bf16_f32 v211, v150, v151
    v_mfma_f32_16x16x32_bf16 v[196:199], a[92:95], a[44:47], 0
    v_exp_f32 v156, v156
    v_mfma_f32_16x16x32_bf16 v[196:199], a[88:91], a[40:43], v[196:199]
    v_cvt_pk_bf16_f32 v216, v152, v153
    v_cvt_pk_bf16_f32 v217, v154, v155
    v_mfma_f32_16x16x32_bf16 v[196:199], a[84:87], a[36:39], v[196:199]
    v_exp_f32 v157, v157
    v_mfma_f32_16x16x32_bf16 v[196:199], a[80:83], a[32:35], v[196:199]
    v_cvt_pk_bf16_f32 v218, v156, v157
    v_mfma_f32_16x16x32_bf16 v[204:207], a[80:83], a[48:51], 0
    v_exp_f32 v158, v158
    v_mfma_f32_16x16x32_bf16 v[204:207], a[84:87], a[52:55], v[204:207]
    v_mfma_f32_16x16x32_bf16 v[204:207], a[88:91], a[56:59], v[204:207]
    v_exp_f32 v159, v159
    v_mfma_f32_16x16x32_bf16 v[204:207], a[92:95], a[60:63], v[204:207]
    v_cvt_pk_bf16_f32 v219, v158, v159
    v_mfma_f32_16x16x32_bf16 v[200:203], a[76:79], a[60:63], 0
    v_mfma_f32_16x16x32_bf16 v[200:203], a[72:75], a[56:59], v[200:203]
    v_mfma_f32_16x16x32_bf16 v[200:203], a[68:71], a[52:55], v[200:203]
    v_mfma_f32_16x16x32_bf16 v[200:203], a[64:67], a[48:51], v[200:203]
    v_smfmac_f32_16x16x64_bf16 a[136:139], a[252:255], v[224:231], v15
    v_smfmac_f32_16x16x64_bf16 a[140:143], a[252:255], v[232:239], v15
    s_mov_b32 s93, 0
attn_loop:
    s_waitcnt lgkmcnt(0)
    v_mfma_f32_16x16x32_bf16 v[24:27], a[96:99], v[228:231], v[24:27]
    v_exp_f32 v176, v176
    v_mfma_f32_16x16x32_bf16 v[24:27], a[180:183], v[224:227], v[24:27]
    s_add_u32 m0, s29, 49920
    s_add_u32 s31, s31, 8192
    v_mfma_f32_16x16x32_bf16 v[28:31], a[180:183], v[232:235], v[28:31]
    v_exp_f32 v177, v177
    v_mfma_f32_16x16x32_bf16 v[28:31], a[96:99], v[236:239], v[28:31]
    ds_read_b128 a[64:67], v3 offset:33280
    ds_read_b128 a[68:71], v3 offset:33344
    v_mfma_f32_16x16x32_bf16 v[44:47], a[100:103], v[236:239], v[44:47]
    v_exp_f32 v178, v178
    v_mfma_f32_16x16x32_bf16 v[44:47], a[184:187], v[232:235], v[44:47]
    ds_read_b128 a[72:75], v3 offset:33408
    ds_read_b128 a[76:79], v3 offset:33472
    v_mfma_f32_16x16x32_bf16 v[40:43], a[184:187], v[224:227], v[40:43]
    v_exp_f32 v179, v179
    v_mfma_f32_16x16x32_bf16 v[40:43], a[100:103], v[228:231], v[40:43]
    ds_read_b128 a[80:83], v3 offset:33792
    ds_read_b128 a[84:87], v3 offset:33856
    v_mfma_f32_16x16x32_bf16 v[56:59], a[104:107], v[228:231], v[56:59]
    v_exp_f32 v180, v180
    v_mfma_f32_16x16x32_bf16 v[56:59], a[188:191], v[224:227], v[56:59]
    ds_read_b128 a[88:91], v3 offset:33920
    ds_read_b128 a[92:95], v3 offset:33984
    v_mfma_f32_16x16x32_bf16 v[60:63], a[188:191], v[232:235], v[60:63]
    v_exp_f32 v181, v181
    v_mfma_f32_16x16x32_bf16 v[60:63], a[104:107], v[236:239], v[60:63]
    buffer_load_dwordx4 v6, s[8:11], s31 offen nt lds
    v_mfma_f32_16x16x32_bf16 v[76:79], a[108:111], v[236:239], v[76:79]
    v_exp_f32 v182, v182
    v_mfma_f32_16x16x32_bf16 v[76:79], a[192:195], v[232:235], v[76:79]
    v_cvt_pk_bf16_f32 v212, v176, v177
    v_cvt_pk_bf16_f32 v213, v178, v179
    v_mfma_f32_16x16x32_bf16 v[72:75], a[192:195], v[224:227], v[72:75]
    v_exp_f32 v183, v183
    v_mfma_f32_16x16x32_bf16 v[72:75], a[108:111], v[228:231], v[72:75]
    buffer_load_dwordx4 v7, s[8:11], s31 offen offset:1056 nt lds
    v_mfma_f32_16x16x32_bf16 v[88:91], a[112:115], v[228:231], v[88:91]
    v_exp_f32 v184, v184
    v_mfma_f32_16x16x32_bf16 v[88:91], a[196:199], v[224:227], v[88:91]
    v_cvt_pk_bf16_f32 v214, v180, v181
    v_cvt_pk_bf16_f32 v215, v182, v183
    v_mfma_f32_16x16x32_bf16 v[92:95], a[196:199], v[232:235], v[92:95]
    v_exp_f32 v185, v185
    v_mfma_f32_16x16x32_bf16 v[92:95], a[112:115], v[236:239], v[92:95]
    buffer_load_dwordx4 v8, s[12:15], s31 offen offset:2080 nt lds
    v_mfma_f32_16x16x32_bf16 v[108:111], a[116:119], v[236:239], v[108:111]
    v_exp_f32 v186, v186
    v_mfma_f32_16x16x32_bf16 v[108:111], a[200:203], v[232:235], v[108:111]
    v_cvt_pk_bf16_f32 v220, v184, v185
    v_mfma_f32_16x16x32_bf16 v[104:107], a[200:203], v[224:227], v[104:107]
    v_exp_f32 v187, v187
    v_mfma_f32_16x16x32_bf16 v[104:107], a[116:119], v[228:231], v[104:107]
    buffer_load_dwordx4 v9, s[12:15], s31 offen offset:3136 nt lds
    v_mfma_f32_16x16x32_bf16 v[120:123], a[120:123], v[228:231], v[120:123]
    v_exp_f32 v188, v188
    v_mfma_f32_16x16x32_bf16 v[120:123], a[204:207], v[224:227], v[120:123]
    v_cvt_pk_bf16_f32 v221, v186, v187
    s_add_u32 m0, s74, 1024
    v_mfma_f32_16x16x32_bf16 v[124:127], a[204:207], v[232:235], v[124:127]
    v_exp_f32 v189, v189
    v_mfma_f32_16x16x32_bf16 v[124:127], a[120:123], v[236:239], v[124:127]
    s_mul_i32 s5, s93, 229376
    s_add_u32 s5, s5, s76
    v_mfma_f32_16x16x32_bf16 v[140:143], a[124:127], v[236:239], v[140:143]
    v_exp_f32 v190, v190
    v_mfma_f32_16x16x32_bf16 v[140:143], a[208:211], v[232:235], v[140:143]
    buffer_load_dwordx4 v245, s[44:47], s5 offen nt lds
    v_mfma_f32_16x16x32_bf16 v[136:139], a[208:211], v[224:227], v[136:139]
    v_exp_f32 v191, v191
    v_mfma_f32_16x16x32_bf16 v[136:139], a[124:127], v[228:231], v[136:139]
    s_waitcnt lgkmcnt(0)
    v_cvt_pk_bf16_f32 v222, v188, v189
    v_mfma_f32_16x16x32_bf16 v[160:163], a[64:67], a[32:35], 0
    v_exp_f32 v192, v192
    v_mfma_f32_16x16x32_bf16 v[160:163], a[68:71], a[36:39], v[160:163]
    ds_read_b64_tr_b16 a[96:97], v4 offset:33280
    ds_read_b64_tr_b16 a[98:99], v4 offset:33792
    v_mfma_f32_16x16x32_bf16 v[160:163], a[72:75], a[40:43], v[160:163]
    v_exp_f32 v193, v193
    v_mfma_f32_16x16x32_bf16 v[160:163], a[76:79], a[44:47], v[160:163]
    ds_read_b64_tr_b16 a[100:101], v4 offset:33312
    ds_read_b64_tr_b16 a[102:103], v4 offset:33824
    v_mfma_f32_16x16x32_bf16 v[164:167], a[92:95], a[44:47], 0
    v_exp_f32 v194, v194
    v_mfma_f32_16x16x32_bf16 v[164:167], a[88:91], a[40:43], v[164:167]
    ds_read_b64_tr_b16 a[104:105], v4 offset:33344
    ds_read_b64_tr_b16 a[106:107], v4 offset:33856
    v_mfma_f32_16x16x32_bf16 v[164:167], a[84:87], a[36:39], v[164:167]
    v_exp_f32 v195, v195
    v_mfma_f32_16x16x32_bf16 v[164:167], a[80:83], a[32:35], v[164:167]
    ds_read_b64_tr_b16 a[108:109], v4 offset:33376
    ds_read_b64_tr_b16 a[110:111], v4 offset:33888
    v_mfma_f32_16x16x32_bf16 v[172:175], a[80:83], a[48:51], 0
    v_exp_f32 v196, v196
    v_mfma_f32_16x16x32_bf16 v[172:175], a[84:87], a[52:55], v[172:175]
    ds_read_b64_tr_b16 a[112:113], v4 offset:33408
    ds_read_b64_tr_b16 a[114:115], v4 offset:33920
    v_mfma_f32_16x16x32_bf16 v[172:175], a[88:91], a[56:59], v[172:175]
    v_exp_f32 v197, v197
    v_mfma_f32_16x16x32_bf16 v[172:175], a[92:95], a[60:63], v[172:175]
    ds_read_b64_tr_b16 a[116:117], v4 offset:33440
    ds_read_b64_tr_b16 a[118:119], v4 offset:33952
    v_mfma_f32_16x16x32_bf16 v[168:171], a[76:79], a[60:63], 0
    v_exp_f32 v198, v198
    v_mfma_f32_16x16x32_bf16 v[168:171], a[72:75], a[56:59], v[168:171]
    ds_read_b64_tr_b16 a[120:121], v4 offset:33472
    ds_read_b64_tr_b16 a[122:123], v4 offset:33984
    v_mfma_f32_16x16x32_bf16 v[168:171], a[68:71], a[52:55], v[168:171]
    v_exp_f32 v199, v199
    v_mfma_f32_16x16x32_bf16 v[168:171], a[64:67], a[48:51], v[168:171]
    ds_read_b64_tr_b16 a[124:125], v4 offset:33504
    ds_read_b64_tr_b16 a[126:127], v4 offset:34016
    v_mfma_f32_16x16x32_bf16 v[144:147], a[64:67], a[0:3], 0
    v_exp_f32 v200, v200
    v_mfma_f32_16x16x32_bf16 v[144:147], a[68:71], a[4:7], v[144:147]
    v_cvt_pk_bf16_f32 v223, v190, v191
    v_cvt_pk_bf16_f32 v228, v192, v193
    v_mfma_f32_16x16x32_bf16 v[144:147], a[72:75], a[8:11], v[144:147]
    v_exp_f32 v201, v201
    v_mfma_f32_16x16x32_bf16 v[144:147], a[76:79], a[12:15], v[144:147]
    v_cvt_pk_bf16_f32 v229, v194, v195
    v_cvt_pk_bf16_f32 v230, v196, v197
    v_mfma_f32_16x16x32_bf16 v[148:151], a[92:95], a[12:15], 0
    v_exp_f32 v202, v202
    v_mfma_f32_16x16x32_bf16 v[148:151], a[88:91], a[8:11], v[148:151]
    v_cvt_pk_bf16_f32 v231, v198, v199
    v_cvt_pk_bf16_f32 v236, v200, v201
    v_mfma_f32_16x16x32_bf16 v[148:151], a[84:87], a[4:7], v[148:151]
    v_exp_f32 v203, v203
    v_mfma_f32_16x16x32_bf16 v[148:151], a[80:83], a[0:3], v[148:151]
    v_cvt_pk_bf16_f32 v237, v202, v203
    v_mfma_f32_16x16x32_bf16 v[156:159], a[80:83], a[16:19], 0
    v_exp_f32 v204, v204
    v_mfma_f32_16x16x32_bf16 v[156:159], a[84:87], a[20:23], v[156:159]
    v_mfma_f32_16x16x32_bf16 v[156:159], a[88:91], a[24:27], v[156:159]
    v_exp_f32 v205, v205
    v_mfma_f32_16x16x32_bf16 v[156:159], a[92:95], a[28:31], v[156:159]
    v_cvt_pk_bf16_f32 v238, v204, v205
    v_mfma_f32_16x16x32_bf16 v[152:155], a[76:79], a[28:31], 0
    v_exp_f32 v206, v206
    v_mfma_f32_16x16x32_bf16 v[152:155], a[72:75], a[24:27], v[152:155]
    v_mfma_f32_16x16x32_bf16 v[152:155], a[68:71], a[20:23], v[152:155]
    v_exp_f32 v207, v207
    v_mfma_f32_16x16x32_bf16 v[152:155], a[64:67], a[16:19], v[152:155]
    v_cvt_pk_bf16_f32 v239, v206, v207
    v_smfmac_f32_16x16x64_bf16 a[128:131], a[252:255], v[208:215], v15
    s_waitcnt vmcnt(11) lgkmcnt(0)
    v_smfmac_f32_16x16x64_bf16 a[132:135], a[252:255], v[216:223], v15
    s_barrier
    v_mfma_f32_16x16x32_bf16 v[16:19], a[180:183], v[208:211], v[16:19]
    v_exp_f32 v160, v160
    v_mfma_f32_16x16x32_bf16 v[16:19], a[96:99], v[212:215], v[16:19]
    s_add_u32 m0, s29, 66560
    s_add_u32 s31, s31, 8192
    v_mfma_f32_16x16x32_bf16 v[20:23], a[96:99], v[220:223], v[20:23]
    v_exp_f32 v161, v161
    v_mfma_f32_16x16x32_bf16 v[20:23], a[180:183], v[216:219], v[20:23]
    ds_read_b128 a[64:67], v1 offset:0
    ds_read_b128 a[68:71], v1 offset:64
    v_mfma_f32_16x16x32_bf16 v[36:39], a[184:187], v[216:219], v[36:39]
    v_exp_f32 v162, v162
    v_mfma_f32_16x16x32_bf16 v[36:39], a[100:103], v[220:223], v[36:39]
    ds_read_b128 a[72:75], v1 offset:128
    ds_read_b128 a[76:79], v1 offset:192
    v_mfma_f32_16x16x32_bf16 v[32:35], a[100:103], v[212:215], v[32:35]
    v_exp_f32 v163, v163
    v_mfma_f32_16x16x32_bf16 v[32:35], a[184:187], v[208:211], v[32:35]
    ds_read_b128 a[80:83], v1 offset:512
    ds_read_b128 a[84:87], v1 offset:576
    v_mfma_f32_16x16x32_bf16 v[48:51], a[188:191], v[208:211], v[48:51]
    v_exp_f32 v164, v164
    v_mfma_f32_16x16x32_bf16 v[48:51], a[104:107], v[212:215], v[48:51]
    ds_read_b128 a[88:91], v1 offset:640
    ds_read_b128 a[92:95], v1 offset:704
    v_mfma_f32_16x16x32_bf16 v[52:55], a[104:107], v[220:223], v[52:55]
    v_exp_f32 v165, v165
    v_mfma_f32_16x16x32_bf16 v[52:55], a[188:191], v[216:219], v[52:55]
    buffer_load_dwordx4 v6, s[8:11], s31 offen nt lds
    v_mfma_f32_16x16x32_bf16 v[68:71], a[192:195], v[216:219], v[68:71]
    v_exp_f32 v166, v166
    v_mfma_f32_16x16x32_bf16 v[68:71], a[108:111], v[220:223], v[68:71]
    v_cvt_pk_bf16_f32 v224, v160, v161
    v_cvt_pk_bf16_f32 v225, v162, v163
    v_mfma_f32_16x16x32_bf16 v[64:67], a[108:111], v[212:215], v[64:67]
    v_exp_f32 v167, v167
    v_mfma_f32_16x16x32_bf16 v[64:67], a[192:195], v[208:211], v[64:67]
    buffer_load_dwordx4 v7, s[8:11], s31 offen offset:1056 nt lds
    v_mfma_f32_16x16x32_bf16 v[80:83], a[196:199], v[208:211], v[80:83]
    v_exp_f32 v168, v168
    v_mfma_f32_16x16x32_bf16 v[80:83], a[112:115], v[212:215], v[80:83]
    v_cvt_pk_bf16_f32 v226, v164, v165
    v_cvt_pk_bf16_f32 v227, v166, v167
    v_mfma_f32_16x16x32_bf16 v[84:87], a[112:115], v[220:223], v[84:87]
    v_exp_f32 v169, v169
    v_mfma_f32_16x16x32_bf16 v[84:87], a[196:199], v[216:219], v[84:87]
    buffer_load_dwordx4 v8, s[12:15], s31 offen offset:2080 nt lds
    v_mfma_f32_16x16x32_bf16 v[100:103], a[200:203], v[216:219], v[100:103]
    v_exp_f32 v170, v170
    v_mfma_f32_16x16x32_bf16 v[100:103], a[116:119], v[220:223], v[100:103]
    v_cvt_pk_bf16_f32 v232, v168, v169
    v_mfma_f32_16x16x32_bf16 v[96:99], a[116:119], v[212:215], v[96:99]
    v_exp_f32 v171, v171
    v_mfma_f32_16x16x32_bf16 v[96:99], a[200:203], v[208:211], v[96:99]
    buffer_load_dwordx4 v9, s[12:15], s31 offen offset:3136 nt lds
    v_mfma_f32_16x16x32_bf16 v[112:115], a[204:207], v[208:211], v[112:115]
    v_exp_f32 v172, v172
    v_mfma_f32_16x16x32_bf16 v[112:115], a[120:123], v[212:215], v[112:115]
    v_cvt_pk_bf16_f32 v233, v170, v171
    s_mov_b32 m0, s74
    v_mfma_f32_16x16x32_bf16 v[116:119], a[120:123], v[220:223], v[116:119]
    v_exp_f32 v173, v173
    v_mfma_f32_16x16x32_bf16 v[116:119], a[204:207], v[216:219], v[116:119]
    s_mul_i32 s5, s93, 98304
    s_add_u32 s5, s5, s75
    v_mfma_f32_16x16x32_bf16 v[132:135], a[208:211], v[216:219], v[132:135]
    v_exp_f32 v174, v174
    v_mfma_f32_16x16x32_bf16 v[132:135], a[124:127], v[220:223], v[132:135]
    buffer_load_dwordx4 v244, s[60:63], s5 offen nt lds
    v_mfma_f32_16x16x32_bf16 v[128:131], a[124:127], v[212:215], v[128:131]
    v_exp_f32 v175, v175
    v_mfma_f32_16x16x32_bf16 v[128:131], a[208:211], v[208:211], v[128:131]
    s_waitcnt lgkmcnt(0)
    v_cvt_pk_bf16_f32 v234, v172, v173
    v_mfma_f32_16x16x32_bf16 v[176:179], a[64:67], a[0:3], 0
    v_exp_f32 v144, v144
    v_mfma_f32_16x16x32_bf16 v[176:179], a[68:71], a[4:7], v[176:179]
    ds_read_b64_tr_b16 a[180:181], v2 offset:0
    ds_read_b64_tr_b16 a[182:183], v2 offset:512
    v_mfma_f32_16x16x32_bf16 v[176:179], a[72:75], a[8:11], v[176:179]
    v_exp_f32 v145, v145
    v_mfma_f32_16x16x32_bf16 v[176:179], a[76:79], a[12:15], v[176:179]
    ds_read_b64_tr_b16 a[184:185], v2 offset:32
    ds_read_b64_tr_b16 a[186:187], v2 offset:544
    v_mfma_f32_16x16x32_bf16 v[180:183], a[92:95], a[12:15], 0
    v_exp_f32 v146, v146
    v_mfma_f32_16x16x32_bf16 v[180:183], a[88:91], a[8:11], v[180:183]
    ds_read_b64_tr_b16 a[188:189], v2 offset:64
    ds_read_b64_tr_b16 a[190:191], v2 offset:576
    v_mfma_f32_16x16x32_bf16 v[180:183], a[84:87], a[4:7], v[180:183]
    v_exp_f32 v147, v147
    v_mfma_f32_16x16x32_bf16 v[180:183], a[80:83], a[0:3], v[180:183]
    ds_read_b64_tr_b16 a[192:193], v2 offset:96
    ds_read_b64_tr_b16 a[194:195], v2 offset:608
    v_mfma_f32_16x16x32_bf16 v[188:191], a[80:83], a[16:19], 0
    v_exp_f32 v148, v148
    v_mfma_f32_16x16x32_bf16 v[188:191], a[84:87], a[20:23], v[188:191]
    ds_read_b64_tr_b16 a[196:197], v2 offset:128
    ds_read_b64_tr_b16 a[198:199], v2 offset:640
    v_mfma_f32_16x16x32_bf16 v[188:191], a[88:91], a[24:27], v[188:191]
    v_exp_f32 v149, v149
    v_mfma_f32_16x16x32_bf16 v[188:191], a[92:95], a[28:31], v[188:191]
    ds_read_b64_tr_b16 a[200:201], v2 offset:160
    ds_read_b64_tr_b16 a[202:203], v2 offset:672
    v_mfma_f32_16x16x32_bf16 v[184:187], a[76:79], a[28:31], 0
    v_exp_f32 v150, v150
    v_mfma_f32_16x16x32_bf16 v[184:187], a[72:75], a[24:27], v[184:187]
    ds_read_b64_tr_b16 a[204:205], v2 offset:192
    ds_read_b64_tr_b16 a[206:207], v2 offset:704
    v_mfma_f32_16x16x32_bf16 v[184:187], a[68:71], a[20:23], v[184:187]
    v_exp_f32 v151, v151
    v_mfma_f32_16x16x32_bf16 v[184:187], a[64:67], a[16:19], v[184:187]
    ds_read_b64_tr_b16 a[208:209], v2 offset:224
    ds_read_b64_tr_b16 a[210:211], v2 offset:736
    v_mfma_f32_16x16x32_bf16 v[192:195], a[64:67], a[32:35], 0
    v_exp_f32 v152, v152
    v_mfma_f32_16x16x32_bf16 v[192:195], a[68:71], a[36:39], v[192:195]
    v_cvt_pk_bf16_f32 v235, v174, v175
    v_cvt_pk_bf16_f32 v208, v144, v145
    v_mfma_f32_16x16x32_bf16 v[192:195], a[72:75], a[40:43], v[192:195]
    v_exp_f32 v153, v153
    v_mfma_f32_16x16x32_bf16 v[192:195], a[76:79], a[44:47], v[192:195]
    v_cvt_pk_bf16_f32 v209, v146, v147
    v_cvt_pk_bf16_f32 v210, v148, v149
    v_mfma_f32_16x16x32_bf16 v[196:199], a[92:95], a[44:47], 0
    v_exp_f32 v154, v154
    v_mfma_f32_16x16x32_bf16 v[196:199], a[88:91], a[40:43], v[196:199]
    v_cvt_pk_bf16_f32 v211, v150, v151
    v_cvt_pk_bf16_f32 v216, v152, v153
    v_mfma_f32_16x16x32_bf16 v[196:199], a[84:87], a[36:39], v[196:199]
    v_exp_f32 v155, v155
    v_mfma_f32_16x16x32_bf16 v[196:199], a[80:83], a[32:35], v[196:199]
    v_cvt_pk_bf16_f32 v217, v154, v155
    v_mfma_f32_16x16x32_bf16 v[204:207], a[80:83], a[48:51], 0
    v_exp_f32 v156, v156
    v_mfma_f32_16x16x32_bf16 v[204:207], a[84:87], a[52:55], v[204:207]
    s_lshl_b32 s5, s93, 13
    v_mfma_f32_16x16x32_bf16 v[204:207], a[88:91], a[56:59], v[204:207]
    v_exp_f32 v157, v157
    v_mfma_f32_16x16x32_bf16 v[204:207], a[92:95], a[60:63], v[204:207]
    v_cvt_pk_bf16_f32 v218, v156, v157
    v_mfma_f32_16x16x32_bf16 v[200:203], a[76:79], a[60:63], 0
    v_exp_f32 v158, v158
    v_mfma_f32_16x16x32_bf16 v[200:203], a[72:75], a[56:59], v[200:203]
    buffer_load_dword v247, v251, s[40:43], s5 offen
    v_mfma_f32_16x16x32_bf16 v[200:203], a[68:71], a[52:55], v[200:203]
    v_exp_f32 v159, v159
    v_mfma_f32_16x16x32_bf16 v[200:203], a[64:67], a[48:51], v[200:203]
    v_cvt_pk_bf16_f32 v219, v158, v159
    v_smfmac_f32_16x16x64_bf16 a[136:139], a[252:255], v[224:231], v15
    v_smfmac_f32_16x16x64_bf16 a[140:143], a[252:255], v[232:239], v15
    s_waitcnt lgkmcnt(0)
    v_mfma_f32_16x16x32_bf16 v[24:27], a[96:99], v[228:231], v[24:27]
    v_exp_f32 v176, v176
    v_mfma_f32_16x16x32_bf16 v[24:27], a[180:183], v[224:227], v[24:27]
    s_add_u32 m0, s29, 83200
    s_add_u32 s31, s31, 8192
    v_mfma_f32_16x16x32_bf16 v[28:31], a[180:183], v[232:235], v[28:31]
    v_exp_f32 v177, v177
    v_mfma_f32_16x16x32_bf16 v[28:31], a[96:99], v[236:239], v[28:31]
    ds_read_b128 a[64:67], v1 offset:16640
    ds_read_b128 a[68:71], v1 offset:16704
    v_mfma_f32_16x16x32_bf16 v[44:47], a[100:103], v[236:239], v[44:47]
    v_exp_f32 v178, v178
    v_mfma_f32_16x16x32_bf16 v[44:47], a[184:187], v[232:235], v[44:47]
    ds_read_b128 a[72:75], v1 offset:16768
    ds_read_b128 a[76:79], v1 offset:16832
    v_mfma_f32_16x16x32_bf16 v[40:43], a[184:187], v[224:227], v[40:43]
    v_exp_f32 v179, v179
    v_mfma_f32_16x16x32_bf16 v[40:43], a[100:103], v[228:231], v[40:43]
    ds_read_b128 a[80:83], v1 offset:17152
    ds_read_b128 a[84:87], v1 offset:17216
    v_mfma_f32_16x16x32_bf16 v[56:59], a[104:107], v[228:231], v[56:59]
    v_exp_f32 v180, v180
    v_mfma_f32_16x16x32_bf16 v[56:59], a[188:191], v[224:227], v[56:59]
    ds_read_b128 a[88:91], v1 offset:17280
    ds_read_b128 a[92:95], v1 offset:17344
    v_mfma_f32_16x16x32_bf16 v[60:63], a[188:191], v[232:235], v[60:63]
    v_exp_f32 v181, v181
    v_mfma_f32_16x16x32_bf16 v[60:63], a[104:107], v[236:239], v[60:63]
    buffer_load_dwordx4 v6, s[8:11], s31 offen nt lds
    v_mfma_f32_16x16x32_bf16 v[76:79], a[108:111], v[236:239], v[76:79]
    v_exp_f32 v182, v182
    v_mfma_f32_16x16x32_bf16 v[76:79], a[192:195], v[232:235], v[76:79]
    v_cvt_pk_bf16_f32 v212, v176, v177
    v_cvt_pk_bf16_f32 v213, v178, v179
    v_mfma_f32_16x16x32_bf16 v[72:75], a[192:195], v[224:227], v[72:75]
    v_exp_f32 v183, v183
    v_mfma_f32_16x16x32_bf16 v[72:75], a[108:111], v[228:231], v[72:75]
    buffer_load_dwordx4 v7, s[8:11], s31 offen offset:1056 nt lds
    v_mfma_f32_16x16x32_bf16 v[88:91], a[112:115], v[228:231], v[88:91]
    v_exp_f32 v184, v184
    v_mfma_f32_16x16x32_bf16 v[88:91], a[196:199], v[224:227], v[88:91]
    v_cvt_pk_bf16_f32 v214, v180, v181
    v_cvt_pk_bf16_f32 v215, v182, v183
    v_mfma_f32_16x16x32_bf16 v[92:95], a[196:199], v[232:235], v[92:95]
    v_exp_f32 v185, v185
    v_mfma_f32_16x16x32_bf16 v[92:95], a[112:115], v[236:239], v[92:95]
    buffer_load_dwordx4 v8, s[12:15], s31 offen offset:2080 nt lds
    v_mfma_f32_16x16x32_bf16 v[108:111], a[116:119], v[236:239], v[108:111]
    v_exp_f32 v186, v186
    v_mfma_f32_16x16x32_bf16 v[108:111], a[200:203], v[232:235], v[108:111]
    v_cvt_pk_bf16_f32 v220, v184, v185
    v_mfma_f32_16x16x32_bf16 v[104:107], a[200:203], v[224:227], v[104:107]
    v_exp_f32 v187, v187
    v_mfma_f32_16x16x32_bf16 v[104:107], a[116:119], v[228:231], v[104:107]
    buffer_load_dwordx4 v9, s[12:15], s31 offen offset:3136 nt lds
    v_mfma_f32_16x16x32_bf16 v[120:123], a[120:123], v[228:231], v[120:123]
    v_exp_f32 v188, v188
    v_mfma_f32_16x16x32_bf16 v[120:123], a[204:207], v[224:227], v[120:123]
    v_cvt_pk_bf16_f32 v221, v186, v187
    s_add_u32 m0, s74, 2048
    v_mfma_f32_16x16x32_bf16 v[124:127], a[204:207], v[232:235], v[124:127]
    v_exp_f32 v189, v189
    v_mfma_f32_16x16x32_bf16 v[124:127], a[120:123], v[236:239], v[124:127]
    s_mul_i32 s5, s93, 229376
    s_add_u32 s5, s5, s76
    v_mfma_f32_16x16x32_bf16 v[140:143], a[124:127], v[236:239], v[140:143]
    v_exp_f32 v190, v190
    v_mfma_f32_16x16x32_bf16 v[140:143], a[208:211], v[232:235], v[140:143]
    buffer_load_dwordx4 v245, s[56:59], s5 offen nt lds
    v_mfma_f32_16x16x32_bf16 v[136:139], a[208:211], v[224:227], v[136:139]
    v_exp_f32 v191, v191
    v_mfma_f32_16x16x32_bf16 v[136:139], a[124:127], v[228:231], v[136:139]
    s_waitcnt lgkmcnt(0)
    v_cvt_pk_bf16_f32 v222, v188, v189
    v_mfma_f32_16x16x32_bf16 v[160:163], a[64:67], a[32:35], 0
    v_exp_f32 v192, v192
    v_mfma_f32_16x16x32_bf16 v[160:163], a[68:71], a[36:39], v[160:163]
    ds_read_b64_tr_b16 a[96:97], v2 offset:16640
    ds_read_b64_tr_b16 a[98:99], v2 offset:17152
    v_mfma_f32_16x16x32_bf16 v[160:163], a[72:75], a[40:43], v[160:163]
    v_exp_f32 v193, v193
    v_mfma_f32_16x16x32_bf16 v[160:163], a[76:79], a[44:47], v[160:163]
    ds_read_b64_tr_b16 a[100:101], v2 offset:16672
    ds_read_b64_tr_b16 a[102:103], v2 offset:17184
    v_mfma_f32_16x16x32_bf16 v[164:167], a[92:95], a[44:47], 0
    v_exp_f32 v194, v194
    v_mfma_f32_16x16x32_bf16 v[164:167], a[88:91], a[40:43], v[164:167]
    ds_read_b64_tr_b16 a[104:105], v2 offset:16704
    ds_read_b64_tr_b16 a[106:107], v2 offset:17216
    v_mfma_f32_16x16x32_bf16 v[164:167], a[84:87], a[36:39], v[164:167]
    v_exp_f32 v195, v195
    v_mfma_f32_16x16x32_bf16 v[164:167], a[80:83], a[32:35], v[164:167]
    ds_read_b64_tr_b16 a[108:109], v2 offset:16736
    ds_read_b64_tr_b16 a[110:111], v2 offset:17248
    v_mfma_f32_16x16x32_bf16 v[172:175], a[80:83], a[48:51], 0
    v_exp_f32 v196, v196
    v_mfma_f32_16x16x32_bf16 v[172:175], a[84:87], a[52:55], v[172:175]
    ds_read_b64_tr_b16 a[112:113], v2 offset:16768
    ds_read_b64_tr_b16 a[114:115], v2 offset:17280
    v_mfma_f32_16x16x32_bf16 v[172:175], a[88:91], a[56:59], v[172:175]
    v_exp_f32 v197, v197
    v_mfma_f32_16x16x32_bf16 v[172:175], a[92:95], a[60:63], v[172:175]
    ds_read_b64_tr_b16 a[116:117], v2 offset:16800
    ds_read_b64_tr_b16 a[118:119], v2 offset:17312
    v_mfma_f32_16x16x32_bf16 v[168:171], a[76:79], a[60:63], 0
    v_exp_f32 v198, v198
    v_mfma_f32_16x16x32_bf16 v[168:171], a[72:75], a[56:59], v[168:171]
    ds_read_b64_tr_b16 a[120:121], v2 offset:16832
    ds_read_b64_tr_b16 a[122:123], v2 offset:17344
    v_mfma_f32_16x16x32_bf16 v[168:171], a[68:71], a[52:55], v[168:171]
    v_exp_f32 v199, v199
    v_mfma_f32_16x16x32_bf16 v[168:171], a[64:67], a[48:51], v[168:171]
    ds_read_b64_tr_b16 a[124:125], v2 offset:16864
    ds_read_b64_tr_b16 a[126:127], v2 offset:17376
    v_mfma_f32_16x16x32_bf16 v[144:147], a[64:67], a[0:3], 0
    v_exp_f32 v200, v200
    v_mfma_f32_16x16x32_bf16 v[144:147], a[68:71], a[4:7], v[144:147]
    v_cvt_pk_bf16_f32 v223, v190, v191
    v_cvt_pk_bf16_f32 v228, v192, v193
    v_mfma_f32_16x16x32_bf16 v[144:147], a[72:75], a[8:11], v[144:147]
    v_exp_f32 v201, v201
    v_mfma_f32_16x16x32_bf16 v[144:147], a[76:79], a[12:15], v[144:147]
    v_cvt_pk_bf16_f32 v229, v194, v195
    v_cvt_pk_bf16_f32 v230, v196, v197
    v_mfma_f32_16x16x32_bf16 v[148:151], a[92:95], a[12:15], 0
    v_exp_f32 v202, v202
    v_mfma_f32_16x16x32_bf16 v[148:151], a[88:91], a[8:11], v[148:151]
    v_cvt_pk_bf16_f32 v231, v198, v199
    v_cvt_pk_bf16_f32 v236, v200, v201
    v_mfma_f32_16x16x32_bf16 v[148:151], a[84:87], a[4:7], v[148:151]
    v_exp_f32 v203, v203
    v_mfma_f32_16x16x32_bf16 v[148:151], a[80:83], a[0:3], v[148:151]
    v_cvt_pk_bf16_f32 v237, v202, v203
    v_mfma_f32_16x16x32_bf16 v[156:159], a[80:83], a[16:19], 0
    v_exp_f32 v204, v204
    v_mfma_f32_16x16x32_bf16 v[156:159], a[84:87], a[20:23], v[156:159]
    v_mfma_f32_16x16x32_bf16 v[156:159], a[88:91], a[24:27], v[156:159]
    v_exp_f32 v205, v205
    v_mfma_f32_16x16x32_bf16 v[156:159], a[92:95], a[28:31], v[156:159]
    v_cvt_pk_bf16_f32 v238, v204, v205
    v_mfma_f32_16x16x32_bf16 v[152:155], a[76:79], a[28:31], 0
    v_exp_f32 v206, v206
    v_mfma_f32_16x16x32_bf16 v[152:155], a[72:75], a[24:27], v[152:155]
    v_mfma_f32_16x16x32_bf16 v[152:155], a[68:71], a[20:23], v[152:155]
    v_exp_f32 v207, v207
    v_mfma_f32_16x16x32_bf16 v[152:155], a[64:67], a[16:19], v[152:155]
    v_cvt_pk_bf16_f32 v239, v206, v207
    v_smfmac_f32_16x16x64_bf16 a[128:131], a[252:255], v[208:215], v15
    s_waitcnt vmcnt(12) lgkmcnt(0)
    v_smfmac_f32_16x16x64_bf16 a[132:135], a[252:255], v[216:223], v15
    s_barrier
    v_mfma_f32_16x16x32_bf16 v[16:19], a[180:183], v[208:211], v[16:19]
    v_exp_f32 v160, v160
    v_mfma_f32_16x16x32_bf16 v[16:19], a[96:99], v[212:215], v[16:19]
    s_add_u32 m0, s29, 0
    s_add_u32 s31, s31, 8192
    v_mfma_f32_16x16x32_bf16 v[20:23], a[96:99], v[220:223], v[20:23]
    v_exp_f32 v161, v161
    v_mfma_f32_16x16x32_bf16 v[20:23], a[180:183], v[216:219], v[20:23]
    ds_read_b128 a[64:67], v1 offset:33280
    ds_read_b128 a[68:71], v1 offset:33344
    v_mfma_f32_16x16x32_bf16 v[36:39], a[184:187], v[216:219], v[36:39]
    v_exp_f32 v162, v162
    v_mfma_f32_16x16x32_bf16 v[36:39], a[100:103], v[220:223], v[36:39]
    ds_read_b128 a[72:75], v1 offset:33408
    ds_read_b128 a[76:79], v1 offset:33472
    v_mfma_f32_16x16x32_bf16 v[32:35], a[100:103], v[212:215], v[32:35]
    v_exp_f32 v163, v163
    v_mfma_f32_16x16x32_bf16 v[32:35], a[184:187], v[208:211], v[32:35]
    ds_read_b128 a[80:83], v1 offset:33792
    ds_read_b128 a[84:87], v1 offset:33856
    v_mfma_f32_16x16x32_bf16 v[48:51], a[188:191], v[208:211], v[48:51]
    v_exp_f32 v164, v164
    v_mfma_f32_16x16x32_bf16 v[48:51], a[104:107], v[212:215], v[48:51]
    ds_read_b128 a[88:91], v1 offset:33920
    ds_read_b128 a[92:95], v1 offset:33984
    v_mfma_f32_16x16x32_bf16 v[52:55], a[104:107], v[220:223], v[52:55]
    v_exp_f32 v165, v165
    v_mfma_f32_16x16x32_bf16 v[52:55], a[188:191], v[216:219], v[52:55]
    buffer_load_dwordx4 v6, s[8:11], s31 offen nt lds
    v_mfma_f32_16x16x32_bf16 v[68:71], a[192:195], v[216:219], v[68:71]
    v_exp_f32 v166, v166
    v_mfma_f32_16x16x32_bf16 v[68:71], a[108:111], v[220:223], v[68:71]
    v_cvt_pk_bf16_f32 v224, v160, v161
    v_cvt_pk_bf16_f32 v225, v162, v163
    v_mfma_f32_16x16x32_bf16 v[64:67], a[108:111], v[212:215], v[64:67]
    v_exp_f32 v167, v167
    v_mfma_f32_16x16x32_bf16 v[64:67], a[192:195], v[208:211], v[64:67]
    buffer_load_dwordx4 v7, s[8:11], s31 offen offset:1056 nt lds
    v_mfma_f32_16x16x32_bf16 v[80:83], a[196:199], v[208:211], v[80:83]
    v_exp_f32 v168, v168
    v_mfma_f32_16x16x32_bf16 v[80:83], a[112:115], v[212:215], v[80:83]
    v_cvt_pk_bf16_f32 v226, v164, v165
    v_cvt_pk_bf16_f32 v227, v166, v167
    v_mfma_f32_16x16x32_bf16 v[84:87], a[112:115], v[220:223], v[84:87]
    v_exp_f32 v169, v169
    v_mfma_f32_16x16x32_bf16 v[84:87], a[196:199], v[216:219], v[84:87]
    buffer_load_dwordx4 v8, s[12:15], s31 offen offset:2080 nt lds
    v_mfma_f32_16x16x32_bf16 v[100:103], a[200:203], v[216:219], v[100:103]
    v_exp_f32 v170, v170
    v_mfma_f32_16x16x32_bf16 v[100:103], a[116:119], v[220:223], v[100:103]
    v_cvt_pk_bf16_f32 v232, v168, v169
    v_mfma_f32_16x16x32_bf16 v[96:99], a[116:119], v[212:215], v[96:99]
    v_exp_f32 v171, v171
    v_mfma_f32_16x16x32_bf16 v[96:99], a[200:203], v[208:211], v[96:99]
    buffer_load_dwordx4 v9, s[12:15], s31 offen offset:3136 nt lds
    v_mfma_f32_16x16x32_bf16 v[112:115], a[204:207], v[208:211], v[112:115]
    v_exp_f32 v172, v172
    v_mfma_f32_16x16x32_bf16 v[112:115], a[120:123], v[212:215], v[112:115]
    v_cvt_pk_bf16_f32 v233, v170, v171
    v_mfma_f32_16x16x32_bf16 v[116:119], a[120:123], v[220:223], v[116:119]
    v_exp_f32 v173, v173
    v_mfma_f32_16x16x32_bf16 v[116:119], a[204:207], v[216:219], v[116:119]
    s_cmp_le_u32 s34, 6
    s_cselect_b32 s5, s97, 0x10000000
    v_mfma_f32_16x16x32_bf16 v[132:135], a[208:211], v[216:219], v[132:135]
    v_exp_f32 v174, v174
    v_mfma_f32_16x16x32_bf16 v[132:135], a[124:127], v[220:223], v[132:135]
    buffer_store_dwordx4 v[240:243], v12, s[68:71], s5 offen sc1
    v_mfma_f32_16x16x32_bf16 v[128:131], a[124:127], v[212:215], v[128:131]
    v_exp_f32 v175, v175
    v_mfma_f32_16x16x32_bf16 v[128:131], a[208:211], v[208:211], v[128:131]
    s_waitcnt lgkmcnt(0)
    v_cvt_pk_bf16_f32 v234, v172, v173
    v_mfma_f32_16x16x32_bf16 v[176:179], a[64:67], a[0:3], 0
    v_exp_f32 v144, v144
    v_mfma_f32_16x16x32_bf16 v[176:179], a[68:71], a[4:7], v[176:179]
    ds_read_b64_tr_b16 a[180:181], v2 offset:33280
    ds_read_b64_tr_b16 a[182:183], v2 offset:33792
    v_mfma_f32_16x16x32_bf16 v[176:179], a[72:75], a[8:11], v[176:179]
    v_exp_f32 v145, v145
    v_mfma_f32_16x16x32_bf16 v[176:179], a[76:79], a[12:15], v[176:179]
    ds_read_b64_tr_b16 a[184:185], v2 offset:33312
    ds_read_b64_tr_b16 a[186:187], v2 offset:33824
    v_mfma_f32_16x16x32_bf16 v[180:183], a[92:95], a[12:15], 0
    v_exp_f32 v146, v146
    v_mfma_f32_16x16x32_bf16 v[180:183], a[88:91], a[8:11], v[180:183]
    ds_read_b64_tr_b16 a[188:189], v2 offset:33344
    ds_read_b64_tr_b16 a[190:191], v2 offset:33856
    v_mfma_f32_16x16x32_bf16 v[180:183], a[84:87], a[4:7], v[180:183]
    v_exp_f32 v147, v147
    v_mfma_f32_16x16x32_bf16 v[180:183], a[80:83], a[0:3], v[180:183]
    ds_read_b64_tr_b16 a[192:193], v2 offset:33376
    ds_read_b64_tr_b16 a[194:195], v2 offset:33888
    v_mfma_f32_16x16x32_bf16 v[188:191], a[80:83], a[16:19], 0
    v_exp_f32 v148, v148
    v_mfma_f32_16x16x32_bf16 v[188:191], a[84:87], a[20:23], v[188:191]
    ds_read_b64_tr_b16 a[196:197], v2 offset:33408
    ds_read_b64_tr_b16 a[198:199], v2 offset:33920
    v_mfma_f32_16x16x32_bf16 v[188:191], a[88:91], a[24:27], v[188:191]
    v_exp_f32 v149, v149
    v_mfma_f32_16x16x32_bf16 v[188:191], a[92:95], a[28:31], v[188:191]
    ds_read_b64_tr_b16 a[200:201], v2 offset:33440
    ds_read_b64_tr_b16 a[202:203], v2 offset:33952
    v_mfma_f32_16x16x32_bf16 v[184:187], a[76:79], a[28:31], 0
    v_exp_f32 v150, v150
    v_mfma_f32_16x16x32_bf16 v[184:187], a[72:75], a[24:27], v[184:187]
    ds_read_b64_tr_b16 a[204:205], v2 offset:33472
    ds_read_b64_tr_b16 a[206:207], v2 offset:33984
    v_mfma_f32_16x16x32_bf16 v[184:187], a[68:71], a[20:23], v[184:187]
    v_exp_f32 v151, v151
    v_mfma_f32_16x16x32_bf16 v[184:187], a[64:67], a[16:19], v[184:187]
    ds_read_b64_tr_b16 a[208:209], v2 offset:33504
    ds_read_b64_tr_b16 a[210:211], v2 offset:34016
    v_mfma_f32_16x16x32_bf16 v[192:195], a[64:67], a[32:35], 0
    v_exp_f32 v152, v152
    v_mfma_f32_16x16x32_bf16 v[192:195], a[68:71], a[36:39], v[192:195]
    v_cvt_pk_bf16_f32 v235, v174, v175
    v_cvt_pk_bf16_f32 v208, v144, v145
    v_mfma_f32_16x16x32_bf16 v[192:195], a[72:75], a[40:43], v[192:195]
    v_exp_f32 v153, v153
    v_mfma_f32_16x16x32_bf16 v[192:195], a[76:79], a[44:47], v[192:195]
    v_cvt_pk_bf16_f32 v209, v146, v147
    v_cvt_pk_bf16_f32 v210, v148, v149
    v_mfma_f32_16x16x32_bf16 v[196:199], a[92:95], a[44:47], 0
    v_exp_f32 v154, v154
    v_mfma_f32_16x16x32_bf16 v[196:199], a[88:91], a[40:43], v[196:199]
    v_cvt_pk_bf16_f32 v211, v150, v151
    v_cvt_pk_bf16_f32 v216, v152, v153
    v_mfma_f32_16x16x32_bf16 v[196:199], a[84:87], a[36:39], v[196:199]
    v_exp_f32 v155, v155
    v_mfma_f32_16x16x32_bf16 v[196:199], a[80:83], a[32:35], v[196:199]
    v_cvt_pk_bf16_f32 v217, v154, v155
    v_mfma_f32_16x16x32_bf16 v[204:207], a[80:83], a[48:51], 0
    v_exp_f32 v156, v156
    v_mfma_f32_16x16x32_bf16 v[204:207], a[84:87], a[52:55], v[204:207]
    v_mfma_f32_16x16x32_bf16 v[204:207], a[88:91], a[56:59], v[204:207]
    v_exp_f32 v157, v157
    v_mfma_f32_16x16x32_bf16 v[204:207], a[92:95], a[60:63], v[204:207]
    v_cvt_pk_bf16_f32 v218, v156, v157
    v_mfma_f32_16x16x32_bf16 v[200:203], a[76:79], a[60:63], 0
    v_exp_f32 v158, v158
    v_mfma_f32_16x16x32_bf16 v[200:203], a[72:75], a[56:59], v[200:203]
    v_mfma_f32_16x16x32_bf16 v[200:203], a[68:71], a[52:55], v[200:203]
    v_exp_f32 v159, v159
    v_mfma_f32_16x16x32_bf16 v[200:203], a[64:67], a[48:51], v[200:203]
    v_cvt_pk_bf16_f32 v219, v158, v159
    s_add_u32 s97, s97, 1024
    v_smfmac_f32_16x16x64_bf16 a[136:139], a[252:255], v[224:231], v15
    v_smfmac_f32_16x16x64_bf16 a[140:143], a[252:255], v[232:239], v15
    s_waitcnt lgkmcnt(0)
    v_mfma_f32_16x16x32_bf16 v[24:27], a[96:99], v[228:231], v[24:27]
    v_exp_f32 v176, v176
    v_mfma_f32_16x16x32_bf16 v[24:27], a[180:183], v[224:227], v[24:27]
    s_add_u32 m0, s29, 16640
    s_add_u32 s31, s31, 8192
    v_mfma_f32_16x16x32_bf16 v[28:31], a[180:183], v[232:235], v[28:31]
    v_exp_f32 v177, v177
    v_mfma_f32_16x16x32_bf16 v[28:31], a[96:99], v[236:239], v[28:31]
    ds_read_b128 a[64:67], v3 offset:0
    ds_read_b128 a[68:71], v3 offset:64
    v_mfma_f32_16x16x32_bf16 v[44:47], a[100:103], v[236:239], v[44:47]
    v_exp_f32 v178, v178
    v_mfma_f32_16x16x32_bf16 v[44:47], a[184:187], v[232:235], v[44:47]
    ds_read_b128 a[72:75], v3 offset:128
    ds_read_b128 a[76:79], v3 offset:192
    v_mfma_f32_16x16x32_bf16 v[40:43], a[184:187], v[224:227], v[40:43]
    v_exp_f32 v179, v179
    v_mfma_f32_16x16x32_bf16 v[40:43], a[100:103], v[228:231], v[40:43]
    ds_read_b128 a[80:83], v3 offset:512
    ds_read_b128 a[84:87], v3 offset:576
    v_mfma_f32_16x16x32_bf16 v[56:59], a[104:107], v[228:231], v[56:59]
    v_exp_f32 v180, v180
    v_mfma_f32_16x16x32_bf16 v[56:59], a[188:191], v[224:227], v[56:59]
    ds_read_b128 a[88:91], v3 offset:640
    ds_read_b128 a[92:95], v3 offset:704
    v_mfma_f32_16x16x32_bf16 v[60:63], a[188:191], v[232:235], v[60:63]
    v_exp_f32 v181, v181
    v_mfma_f32_16x16x32_bf16 v[60:63], a[104:107], v[236:239], v[60:63]
    buffer_load_dwordx4 v6, s[8:11], s31 offen nt lds
    v_mfma_f32_16x16x32_bf16 v[76:79], a[108:111], v[236:239], v[76:79]
    v_exp_f32 v182, v182
    v_mfma_f32_16x16x32_bf16 v[76:79], a[192:195], v[232:235], v[76:79]
    v_cvt_pk_bf16_f32 v212, v176, v177
    v_cvt_pk_bf16_f32 v213, v178, v179
    v_mfma_f32_16x16x32_bf16 v[72:75], a[192:195], v[224:227], v[72:75]
    v_exp_f32 v183, v183
    v_mfma_f32_16x16x32_bf16 v[72:75], a[108:111], v[228:231], v[72:75]
    buffer_load_dwordx4 v7, s[8:11], s31 offen offset:1056 nt lds
    v_mfma_f32_16x16x32_bf16 v[88:91], a[112:115], v[228:231], v[88:91]
    v_exp_f32 v184, v184
    v_mfma_f32_16x16x32_bf16 v[88:91], a[196:199], v[224:227], v[88:91]
    v_cvt_pk_bf16_f32 v214, v180, v181
    v_cvt_pk_bf16_f32 v215, v182, v183
    v_mfma_f32_16x16x32_bf16 v[92:95], a[196:199], v[232:235], v[92:95]
    v_exp_f32 v185, v185
    v_mfma_f32_16x16x32_bf16 v[92:95], a[112:115], v[236:239], v[92:95]
    buffer_load_dwordx4 v8, s[12:15], s31 offen offset:2080 nt lds
    v_mfma_f32_16x16x32_bf16 v[108:111], a[116:119], v[236:239], v[108:111]
    v_exp_f32 v186, v186
    v_mfma_f32_16x16x32_bf16 v[108:111], a[200:203], v[232:235], v[108:111]
    v_cvt_pk_bf16_f32 v220, v184, v185
    v_mfma_f32_16x16x32_bf16 v[104:107], a[200:203], v[224:227], v[104:107]
    v_exp_f32 v187, v187
    v_mfma_f32_16x16x32_bf16 v[104:107], a[116:119], v[228:231], v[104:107]
    buffer_load_dwordx4 v9, s[12:15], s31 offen offset:3136 nt lds
    v_mfma_f32_16x16x32_bf16 v[120:123], a[120:123], v[228:231], v[120:123]
    v_exp_f32 v188, v188
    v_mfma_f32_16x16x32_bf16 v[120:123], a[204:207], v[224:227], v[120:123]
    v_cvt_pk_bf16_f32 v221, v186, v187
    v_mfma_f32_16x16x32_bf16 v[124:127], a[204:207], v[232:235], v[124:127]
    v_exp_f32 v189, v189
    v_mfma_f32_16x16x32_bf16 v[124:127], a[120:123], v[236:239], v[124:127]
    s_and_b32 s5, s93, 0x2003
    s_mul_i32 s5, s5, s78
    v_mfma_f32_16x16x32_bf16 v[140:143], a[124:127], v[236:239], v[140:143]
    v_exp_f32 v190, v190
    v_mfma_f32_16x16x32_bf16 v[140:143], a[208:211], v[232:235], v[140:143]
    buffer_load_dword v247, v246, s[48:51], s5 offen
    v_mfma_f32_16x16x32_bf16 v[136:139], a[208:211], v[224:227], v[136:139]
    v_exp_f32 v191, v191
    v_mfma_f32_16x16x32_bf16 v[136:139], a[124:127], v[228:231], v[136:139]
    s_waitcnt lgkmcnt(0)
    v_cvt_pk_bf16_f32 v222, v188, v189
    v_mfma_f32_16x16x32_bf16 v[160:163], a[64:67], a[32:35], 0
    v_exp_f32 v192, v192
    v_mfma_f32_16x16x32_bf16 v[160:163], a[68:71], a[36:39], v[160:163]
    ds_read_b64_tr_b16 a[96:97], v4 offset:0
    ds_read_b64_tr_b16 a[98:99], v4 offset:512
    v_mfma_f32_16x16x32_bf16 v[160:163], a[72:75], a[40:43], v[160:163]
    v_exp_f32 v193, v193
    v_mfma_f32_16x16x32_bf16 v[160:163], a[76:79], a[44:47], v[160:163]
    ds_read_b64_tr_b16 a[100:101], v4 offset:32
    ds_read_b64_tr_b16 a[102:103], v4 offset:544
    v_mfma_f32_16x16x32_bf16 v[164:167], a[92:95], a[44:47], 0
    v_exp_f32 v194, v194
    v_mfma_f32_16x16x32_bf16 v[164:167], a[88:91], a[40:43], v[164:167]
    ds_read_b64_tr_b16 a[104:105], v4 offset:64
    ds_read_b64_tr_b16 a[106:107], v4 offset:576
    v_mfma_f32_16x16x32_bf16 v[164:167], a[84:87], a[36:39], v[164:167]
    v_exp_f32 v195, v195
    v_mfma_f32_16x16x32_bf16 v[164:167], a[80:83], a[32:35], v[164:167]
    ds_read_b64_tr_b16 a[108:109], v4 offset:96
    ds_read_b64_tr_b16 a[110:111], v4 offset:608
    v_mfma_f32_16x16x32_bf16 v[172:175], a[80:83], a[48:51], 0
    v_exp_f32 v196, v196
    v_mfma_f32_16x16x32_bf16 v[172:175], a[84:87], a[52:55], v[172:175]
    ds_read_b64_tr_b16 a[112:113], v4 offset:128
    ds_read_b64_tr_b16 a[114:115], v4 offset:640
    v_mfma_f32_16x16x32_bf16 v[172:175], a[88:91], a[56:59], v[172:175]
    v_exp_f32 v197, v197
    v_mfma_f32_16x16x32_bf16 v[172:175], a[92:95], a[60:63], v[172:175]
    ds_read_b64_tr_b16 a[116:117], v4 offset:160
    ds_read_b64_tr_b16 a[118:119], v4 offset:672
    v_mfma_f32_16x16x32_bf16 v[168:171], a[76:79], a[60:63], 0
    v_exp_f32 v198, v198
    v_mfma_f32_16x16x32_bf16 v[168:171], a[72:75], a[56:59], v[168:171]
    ds_read_b64_tr_b16 a[120:121], v4 offset:192
    ds_read_b64_tr_b16 a[122:123], v4 offset:704
    v_mfma_f32_16x16x32_bf16 v[168:171], a[68:71], a[52:55], v[168:171]
    v_exp_f32 v199, v199
    v_mfma_f32_16x16x32_bf16 v[168:171], a[64:67], a[48:51], v[168:171]
    ds_read_b64_tr_b16 a[124:125], v4 offset:224
    ds_read_b64_tr_b16 a[126:127], v4 offset:736
    v_mfma_f32_16x16x32_bf16 v[144:147], a[64:67], a[0:3], 0
    v_exp_f32 v200, v200
    v_mfma_f32_16x16x32_bf16 v[144:147], a[68:71], a[4:7], v[144:147]
    v_cvt_pk_bf16_f32 v223, v190, v191
    v_cvt_pk_bf16_f32 v228, v192, v193
    v_mfma_f32_16x16x32_bf16 v[144:147], a[72:75], a[8:11], v[144:147]
    v_exp_f32 v201, v201
    v_mfma_f32_16x16x32_bf16 v[144:147], a[76:79], a[12:15], v[144:147]
    v_cvt_pk_bf16_f32 v229, v194, v195
    v_cvt_pk_bf16_f32 v230, v196, v197
    v_mfma_f32_16x16x32_bf16 v[148:151], a[92:95], a[12:15], 0
    v_exp_f32 v202, v202
    v_mfma_f32_16x16x32_bf16 v[148:151], a[88:91], a[8:11], v[148:151]
    v_cvt_pk_bf16_f32 v231, v198, v199
    v_cvt_pk_bf16_f32 v236, v200, v201
    v_mfma_f32_16x16x32_bf16 v[148:151], a[84:87], a[4:7], v[148:151]
    v_exp_f32 v203, v203
    v_mfma_f32_16x16x32_bf16 v[148:151], a[80:83], a[0:3], v[148:151]
    v_cvt_pk_bf16_f32 v237, v202, v203
    v_mfma_f32_16x16x32_bf16 v[156:159], a[80:83], a[16:19], 0
    v_exp_f32 v204, v204
    v_mfma_f32_16x16x32_bf16 v[156:159], a[84:87], a[20:23], v[156:159]
    s_bitcmp1_b32 494, s34
    s_cselect_b32 s7, 0, 0x2000
    v_mfma_f32_16x16x32_bf16 v[156:159], a[88:91], a[24:27], v[156:159]
    v_exp_f32 v205, v205
    v_mfma_f32_16x16x32_bf16 v[156:159], a[92:95], a[28:31], v[156:159]
    v_cvt_pk_bf16_f32 v238, v204, v205
    s_addc_u32 s73, s73, 0
    v_mfma_f32_16x16x32_bf16 v[152:155], a[76:79], a[28:31], 0
    v_exp_f32 v206, v206
    v_mfma_f32_16x16x32_bf16 v[152:155], a[72:75], a[24:27], v[152:155]
    s_and_b32 s6, s73, 3
    s_mul_i32 s6, s6, 3072
    v_mfma_f32_16x16x32_bf16 v[152:155], a[68:71], a[20:23], v[152:155]
    v_exp_f32 v207, v207
    v_mfma_f32_16x16x32_bf16 v[152:155], a[64:67], a[16:19], v[152:155]
    v_cvt_pk_bf16_f32 v239, v206, v207
    s_add_u32 s6, s6, s92
    v_smfmac_f32_16x16x64_bf16 a[128:131], a[252:255], v[208:215], v15
    s_waitcnt vmcnt(11) lgkmcnt(0)
    v_smfmac_f32_16x16x64_bf16 a[132:135], a[252:255], v[216:223], v15
    s_barrier
    v_mfma_f32_16x16x32_bf16 v[16:19], a[180:183], v[208:211], v[16:19]
    v_exp_f32 v160, v160
    v_mfma_f32_16x16x32_bf16 v[16:19], a[96:99], v[212:215], v[16:19]
    s_add_u32 m0, s29, 33280
    s_add_u32 s31, s31, 8192
    v_mfma_f32_16x16x32_bf16 v[20:23], a[96:99], v[220:223], v[20:23]
    v_exp_f32 v161, v161
    v_mfma_f32_16x16x32_bf16 v[20:23], a[180:183], v[216:219], v[20:23]
    ds_read_b128 a[64:67], v3 offset:16640
    ds_read_b128 a[68:71], v3 offset:16704
    v_mfma_f32_16x16x32_bf16 v[36:39], a[184:187], v[216:219], v[36:39]
    v_exp_f32 v162, v162
    v_mfma_f32_16x16x32_bf16 v[36:39], a[100:103], v[220:223], v[36:39]
    ds_read_b128 a[72:75], v3 offset:16768
    ds_read_b128 a[76:79], v3 offset:16832
    v_mfma_f32_16x16x32_bf16 v[32:35], a[100:103], v[212:215], v[32:35]
    v_exp_f32 v163, v163
    v_mfma_f32_16x16x32_bf16 v[32:35], a[184:187], v[208:211], v[32:35]
    ds_read_b128 a[80:83], v3 offset:17152
    ds_read_b128 a[84:87], v3 offset:17216
    v_mfma_f32_16x16x32_bf16 v[48:51], a[188:191], v[208:211], v[48:51]
    v_exp_f32 v164, v164
    v_mfma_f32_16x16x32_bf16 v[48:51], a[104:107], v[212:215], v[48:51]
    ds_read_b128 a[88:91], v3 offset:17280
    ds_read_b128 a[92:95], v3 offset:17344
    v_mfma_f32_16x16x32_bf16 v[52:55], a[104:107], v[220:223], v[52:55]
    v_exp_f32 v165, v165
    v_mfma_f32_16x16x32_bf16 v[52:55], a[188:191], v[216:219], v[52:55]
    buffer_load_dwordx4 v6, s[8:11], s31 offen nt lds
    v_mfma_f32_16x16x32_bf16 v[68:71], a[192:195], v[216:219], v[68:71]
    v_exp_f32 v166, v166
    v_mfma_f32_16x16x32_bf16 v[68:71], a[108:111], v[220:223], v[68:71]
    v_cvt_pk_bf16_f32 v224, v160, v161
    v_cvt_pk_bf16_f32 v225, v162, v163
    v_mfma_f32_16x16x32_bf16 v[64:67], a[108:111], v[212:215], v[64:67]
    v_exp_f32 v167, v167
    v_mfma_f32_16x16x32_bf16 v[64:67], a[192:195], v[208:211], v[64:67]
    buffer_load_dwordx4 v7, s[8:11], s31 offen offset:1056 nt lds
    v_mfma_f32_16x16x32_bf16 v[80:83], a[196:199], v[208:211], v[80:83]
    v_exp_f32 v168, v168
    v_mfma_f32_16x16x32_bf16 v[80:83], a[112:115], v[212:215], v[80:83]
    v_cvt_pk_bf16_f32 v226, v164, v165
    v_cvt_pk_bf16_f32 v227, v166, v167
    v_mfma_f32_16x16x32_bf16 v[84:87], a[112:115], v[220:223], v[84:87]
    v_exp_f32 v169, v169
    v_mfma_f32_16x16x32_bf16 v[84:87], a[196:199], v[216:219], v[84:87]
    buffer_load_dwordx4 v8, s[12:15], s31 offen offset:2080 nt lds
    v_mfma_f32_16x16x32_bf16 v[100:103], a[200:203], v[216:219], v[100:103]
    v_exp_f32 v170, v170
    v_mfma_f32_16x16x32_bf16 v[100:103], a[116:119], v[220:223], v[100:103]
    v_cvt_pk_bf16_f32 v232, v168, v169
    v_mfma_f32_16x16x32_bf16 v[96:99], a[116:119], v[212:215], v[96:99]
    v_exp_f32 v171, v171
    v_mfma_f32_16x16x32_bf16 v[96:99], a[200:203], v[208:211], v[96:99]
    buffer_load_dwordx4 v9, s[12:15], s31 offen offset:3136 nt lds
    v_mfma_f32_16x16x32_bf16 v[112:115], a[204:207], v[208:211], v[112:115]
    v_exp_f32 v172, v172
    v_mfma_f32_16x16x32_bf16 v[112:115], a[120:123], v[212:215], v[112:115]
    v_cvt_pk_bf16_f32 v233, v170, v171
    v_mfma_f32_16x16x32_bf16 v[116:119], a[120:123], v[220:223], v[116:119]
    v_exp_f32 v173, v173
    v_mfma_f32_16x16x32_bf16 v[116:119], a[204:207], v[216:219], v[116:119]
    s_lshl_b32 s5, s93, 10
    v_mfma_f32_16x16x32_bf16 v[132:135], a[208:211], v[216:219], v[132:135]
    v_exp_f32 v174, v174
    v_mfma_f32_16x16x32_bf16 v[132:135], a[124:127], v[220:223], v[132:135]
    buffer_load_dword v247, v250, s[24:27], s5 offen
    v_mfma_f32_16x16x32_bf16 v[128:131], a[124:127], v[212:215], v[128:131]
    v_exp_f32 v175, v175
    v_mfma_f32_16x16x32_bf16 v[128:131], a[208:211], v[208:211], v[128:131]
    s_waitcnt lgkmcnt(0)
    v_cvt_pk_bf16_f32 v234, v172, v173
    v_mfma_f32_16x16x32_bf16 v[176:179], a[64:67], a[0:3], 0
    v_exp_f32 v144, v144
    v_mfma_f32_16x16x32_bf16 v[176:179], a[68:71], a[4:7], v[176:179]
    ds_read_b64_tr_b16 a[180:181], v4 offset:16640
    ds_read_b64_tr_b16 a[182:183], v4 offset:17152
    v_mfma_f32_16x16x32_bf16 v[176:179], a[72:75], a[8:11], v[176:179]
    v_exp_f32 v145, v145
    v_mfma_f32_16x16x32_bf16 v[176:179], a[76:79], a[12:15], v[176:179]
    ds_read_b64_tr_b16 a[184:185], v4 offset:16672
    ds_read_b64_tr_b16 a[186:187], v4 offset:17184
    v_mfma_f32_16x16x32_bf16 v[180:183], a[92:95], a[12:15], 0
    v_exp_f32 v146, v146
    v_mfma_f32_16x16x32_bf16 v[180:183], a[88:91], a[8:11], v[180:183]
    ds_read_b64_tr_b16 a[188:189], v4 offset:16704
    ds_read_b64_tr_b16 a[190:191], v4 offset:17216
    v_mfma_f32_16x16x32_bf16 v[180:183], a[84:87], a[4:7], v[180:183]
    v_exp_f32 v147, v147
    v_mfma_f32_16x16x32_bf16 v[180:183], a[80:83], a[0:3], v[180:183]
    ds_read_b64_tr_b16 a[192:193], v4 offset:16736
    ds_read_b64_tr_b16 a[194:195], v4 offset:17248
    v_mfma_f32_16x16x32_bf16 v[188:191], a[80:83], a[16:19], 0
    v_exp_f32 v148, v148
    v_mfma_f32_16x16x32_bf16 v[188:191], a[84:87], a[20:23], v[188:191]
    ds_read_b64_tr_b16 a[196:197], v4 offset:16768
    ds_read_b64_tr_b16 a[198:199], v4 offset:17280
    v_mfma_f32_16x16x32_bf16 v[188:191], a[88:91], a[24:27], v[188:191]
    v_exp_f32 v149, v149
    v_mfma_f32_16x16x32_bf16 v[188:191], a[92:95], a[28:31], v[188:191]
    ds_read_b64_tr_b16 a[200:201], v4 offset:16800
    ds_read_b64_tr_b16 a[202:203], v4 offset:17312
    v_mfma_f32_16x16x32_bf16 v[184:187], a[76:79], a[28:31], 0
    v_exp_f32 v150, v150
    v_mfma_f32_16x16x32_bf16 v[184:187], a[72:75], a[24:27], v[184:187]
    ds_read_b64_tr_b16 a[204:205], v4 offset:16832
    ds_read_b64_tr_b16 a[206:207], v4 offset:17344
    v_mfma_f32_16x16x32_bf16 v[184:187], a[68:71], a[20:23], v[184:187]
    v_exp_f32 v151, v151
    v_mfma_f32_16x16x32_bf16 v[184:187], a[64:67], a[16:19], v[184:187]
    ds_read_b64_tr_b16 a[208:209], v4 offset:16864
    ds_read_b64_tr_b16 a[210:211], v4 offset:17376
    v_mfma_f32_16x16x32_bf16 v[192:195], a[64:67], a[32:35], 0
    v_exp_f32 v152, v152
    v_mfma_f32_16x16x32_bf16 v[192:195], a[68:71], a[36:39], v[192:195]
    v_cvt_pk_bf16_f32 v235, v174, v175
    v_cvt_pk_bf16_f32 v208, v144, v145
    v_mfma_f32_16x16x32_bf16 v[192:195], a[72:75], a[40:43], v[192:195]
    v_exp_f32 v153, v153
    v_mfma_f32_16x16x32_bf16 v[192:195], a[76:79], a[44:47], v[192:195]
    v_cvt_pk_bf16_f32 v209, v146, v147
    v_cvt_pk_bf16_f32 v210, v148, v149
    v_mfma_f32_16x16x32_bf16 v[196:199], a[92:95], a[44:47], 0
    v_exp_f32 v154, v154
    v_mfma_f32_16x16x32_bf16 v[196:199], a[88:91], a[40:43], v[196:199]
    v_cvt_pk_bf16_f32 v211, v150, v151
    v_cvt_pk_bf16_f32 v216, v152, v153
    v_mfma_f32_16x16x32_bf16 v[196:199], a[84:87], a[36:39], v[196:199]
    v_exp_f32 v155, v155
    v_mfma_f32_16x16x32_bf16 v[196:199], a[80:83], a[32:35], v[196:199]
    v_cvt_pk_bf16_f32 v217, v154, v155
    v_mfma_f32_16x16x32_bf16 v[204:207], a[80:83], a[48:51], 0
    v_exp_f32 v156, v156
    v_mfma_f32_16x16x32_bf16 v[204:207], a[84:87], a[52:55], v[204:207]
    s_cmp_eq_u32 s7, 0
    s_cselect_b32 s74, s6, 99840
    v_mfma_f32_16x16x32_bf16 v[204:207], a[88:91], a[56:59], v[204:207]
    v_exp_f32 v157, v157
    v_mfma_f32_16x16x32_bf16 v[204:207], a[92:95], a[60:63], v[204:207]
    v_cvt_pk_bf16_f32 v218, v156, v157
    s_or_b32 s93, s73, s7
    v_mfma_f32_16x16x32_bf16 v[200:203], a[76:79], a[60:63], 0
    v_exp_f32 v158, v158
    v_mfma_f32_16x16x32_bf16 v[200:203], a[72:75], a[56:59], v[200:203]
    v_mfma_f32_16x16x32_bf16 v[200:203], a[68:71], a[52:55], v[200:203]
    v_exp_f32 v159, v159
    v_mfma_f32_16x16x32_bf16 v[200:203], a[64:67], a[48:51], v[200:203]
    v_cvt_pk_bf16_f32 v219, v158, v159
    v_smfmac_f32_16x16x64_bf16 a[136:139], a[252:255], v[224:231], v15
    s_add_u32 s34, s34, 1
    s_cmp_lt_u32 s34, s72
    v_smfmac_f32_16x16x64_bf16 a[140:143], a[252:255], v[232:239], v15
    s_cbranch_scc1 attn_loop
    s_cmp_eq_u32 s72, 11
    s_cbranch_scc1 attn_exit
    s_cmp_lg_u32 s86, 29491200
    s_cbranch_scc1 attn_nt
    s_mov_b32 s5, 29458432
    v_mov_b32 v15, s85
    buffer_store_dword v15, off, s[68:71], s5 sc1
attn_nt:
    s_waitcnt lgkmcnt(0)
    s_mul_i32 s5, s28, 12288
    s_add_u32 s5, s5, 114688
    v_lshl_add_u32 v13, v0, 3, s5
    v_lshrrev_b32 v14, 4, v0
    v_mul_u32_u24 v14, 3072, v14
    v_bfe_u32 v15, v0, 2, 2
    v_lshl_add_u32 v14, v15, 7, v14
    v_and_b32 v15, 3, v0
    v_lshl_add_u32 v14, v15, 3, v14
    v_add_u32 v14, s5, v14
    ds_read_b64_tr_b16 a[212:213], v14 offset:0
    ds_read_b64_tr_b16 a[214:215], v14 offset:512
    ds_read_b64_tr_b16 a[216:217], v14 offset:32
    ds_read_b64_tr_b16 a[218:219], v14 offset:544
    ds_read_b64_tr_b16 a[220:221], v14 offset:64
    ds_read_b64_tr_b16 a[222:223], v14 offset:576
    ds_read_b64_tr_b16 a[224:225], v14 offset:96
    ds_read_b64_tr_b16 a[226:227], v14 offset:608
    ds_read_b64_tr_b16 a[148:149], v13 offset:1024
    ds_read_b64_tr_b16 a[150:151], v13 offset:1536
    ds_read_b64_tr_b16 a[152:153], v13 offset:2048
    ds_read_b64_tr_b16 a[154:155], v13 offset:2560
    s_waitcnt lgkmcnt(2)
    ds_read_b64_tr_b16 a[156:157], v13 offset:4096
    ds_read_b64_tr_b16 a[158:159], v13 offset:4608
    ds_read_b64_tr_b16 a[160:161], v13 offset:5120
    ds_read_b64_tr_b16 a[162:163], v13 offset:5632
    ds_read_b64_tr_b16 a[164:165], v13 offset:7168
    ds_read_b64_tr_b16 a[166:167], v13 offset:7680
    ds_read_b64_tr_b16 a[168:169], v13 offset:8192
    ds_read_b64_tr_b16 a[170:171], v13 offset:8704
    ds_read_b64_tr_b16 a[172:173], v13 offset:10240
    ds_read_b64_tr_b16 a[174:175], v13 offset:10752
    ds_read_b64_tr_b16 a[176:177], v13 offset:11264
    ds_read_b64_tr_b16 a[178:179], v13 offset:11776
    v_lshl_add_u32 v15, s28, 6, v0
    s_getpc_b64 s[38:39]
    s_add_u32 s38, s38, attn_exit-.
    s_addc_u32 s39, s39, 0
    v_min_u32 v15, ((attn_slow-attn_exit)>>7)-1, v15
    v_lshlrev_b32 v15, 7, v15
    global_load_dword v247, v15, s[38:39]
    s_lshr_b32 s5, s2, 3
    s_lshl_b32 s5, s5, 2
    s_add_u32 s5, s5, s28
    s_lshr_b32 s6, s5, 6
    s_lshl_b32 s6, s6, 21
    s_and_b32 s5, s5, 63
    s_mul_i32 s5, s5, 4096
    s_add_u32 s5, s5, s6
    s_and_b32 s6, s17, 1
    s_lshl_b32 s6, s6, 22
    s_add_u32 s5, s5, s6
    v_min_u32 v13, 31, v0
    v_lshl_add_u32 v246, v13, 7, s5
    s_mov_b32 s78, 262144
    v_and_b32 v14, 1, v0
    v_mul_u32_u24 v15, 0xaaaa, v14
    v_add_u32 v15, 0x4444, v15
    v_lshl_or_b32 v15, v15, 16, v15
    s_mov_b32 s72, 11
    s_branch attn_loop
attn_exit:
    s_waitcnt vmcnt(0) lgkmcnt(0)
    s_barrier
    v_mfma_f32_16x16x32_bf16 v[24:27], a[96:99], v[228:231], v[24:27]
    ds_read_b64_tr_b16 a[64:65], v4 offset:33280
    ds_read_b64_tr_b16 a[66:67], v4 offset:33792
    v_mfma_f32_16x16x32_bf16 v[24:27], a[180:183], v[224:227], v[24:27]
    ds_read_b64_tr_b16 a[68:69], v4 offset:33312
    ds_read_b64_tr_b16 a[70:71], v4 offset:33824
    v_mfma_f32_16x16x32_bf16 v[28:31], a[180:183], v[232:235], v[28:31]
    ds_read_b64_tr_b16 a[72:73], v4 offset:33344
    ds_read_b64_tr_b16 a[74:75], v4 offset:33856
    v_mfma_f32_16x16x32_bf16 v[28:31], a[96:99], v[236:239], v[28:31]
    ds_read_b64_tr_b16 a[76:77], v4 offset:33376
    ds_read_b64_tr_b16 a[78:79], v4 offset:33888
    v_mfma_f32_16x16x32_bf16 v[44:47], a[100:103], v[236:239], v[44:47]
    ds_read_b64_tr_b16 a[80:81], v4 offset:33408
    ds_read_b64_tr_b16 a[82:83], v4 offset:33920
    v_mfma_f32_16x16x32_bf16 v[44:47], a[184:187], v[232:235], v[44:47]
    ds_read_b64_tr_b16 a[84:85], v4 offset:33440
    ds_read_b64_tr_b16 a[86:87], v4 offset:33952
    v_mfma_f32_16x16x32_bf16 v[40:43], a[184:187], v[224:227], v[40:43]
    ds_read_b64_tr_b16 a[88:89], v4 offset:33472
    ds_read_b64_tr_b16 a[90:91], v4 offset:33984
    v_mfma_f32_16x16x32_bf16 v[40:43], a[100:103], v[228:231], v[40:43]
    ds_read_b64_tr_b16 a[92:93], v4 offset:33504
    ds_read_b64_tr_b16 a[94:95], v4 offset:34016
    v_mfma_f32_16x16x32_bf16 v[56:59], a[104:107], v[228:231], v[56:59]
    v_exp_f32 v176, v176
    v_mfma_f32_16x16x32_bf16 v[56:59], a[188:191], v[224:227], v[56:59]
    v_exp_f32 v177, v177
    v_mfma_f32_16x16x32_bf16 v[60:63], a[188:191], v[232:235], v[60:63]
    v_exp_f32 v178, v178
    v_mfma_f32_16x16x32_bf16 v[60:63], a[104:107], v[236:239], v[60:63]
    v_exp_f32 v179, v179
    v_mfma_f32_16x16x32_bf16 v[76:79], a[108:111], v[236:239], v[76:79]
    v_cvt_pk_bf16_f32 v212, v176, v177
    v_mov_b32 v6, v252
    v_mfma_f32_16x16x32_bf16 v[76:79], a[192:195], v[232:235], v[76:79]
    v_exp_f32 v180, v180
    v_mfma_f32_16x16x32_bf16 v[72:75], a[192:195], v[224:227], v[72:75]
    v_exp_f32 v181, v181
    v_mfma_f32_16x16x32_bf16 v[72:75], a[108:111], v[228:231], v[72:75]
    v_cvt_pk_bf16_f32 v213, v178, v179
    v_add_u32 v7, 992, v252
    v_mfma_f32_16x16x32_bf16 v[88:91], a[112:115], v[228:231], v[88:91]
    v_exp_f32 v182, v182
    v_mfma_f32_16x16x32_bf16 v[88:91], a[196:199], v[224:227], v[88:91]
    v_exp_f32 v183, v183
    v_mfma_f32_16x16x32_bf16 v[92:95], a[196:199], v[232:235], v[92:95]
    v_cvt_pk_bf16_f32 v214, v180, v181
    v_add_u32 v8, 1984, v252
    v_mfma_f32_16x16x32_bf16 v[92:95], a[112:115], v[236:239], v[92:95]
    v_exp_f32 v184, v184
    v_mfma_f32_16x16x32_bf16 v[108:111], a[116:119], v[236:239], v[108:111]
    v_exp_f32 v185, v185
    v_mfma_f32_16x16x32_bf16 v[108:111], a[200:203], v[232:235], v[108:111]
    v_cvt_pk_bf16_f32 v215, v182, v183
    v_add_u32 v9, 2976, v252
    v_mfma_f32_16x16x32_bf16 v[104:107], a[200:203], v[224:227], v[104:107]
    v_exp_f32 v186, v186
    v_mfma_f32_16x16x32_bf16 v[104:107], a[116:119], v[228:231], v[104:107]
    v_exp_f32 v187, v187
    v_mfma_f32_16x16x32_bf16 v[120:123], a[120:123], v[228:231], v[120:123]
    v_cvt_pk_bf16_f32 v220, v184, v185
    s_add_u32 m0, s30, 16896
    v_mfma_f32_16x16x32_bf16 v[120:123], a[204:207], v[224:227], v[120:123]
    v_exp_f32 v188, v188
    v_mfma_f32_16x16x32_bf16 v[124:127], a[204:207], v[232:235], v[124:127]
    v_exp_f32 v189, v189
    v_mfma_f32_16x16x32_bf16 v[124:127], a[120:123], v[236:239], v[124:127]
    v_cvt_pk_bf16_f32 v221, v186, v187
    s_add_u32 s32, s32, 65536
    v_mfma_f32_16x16x32_bf16 v[140:143], a[124:127], v[236:239], v[140:143]
    v_exp_f32 v190, v190
    v_mfma_f32_16x16x32_bf16 v[140:143], a[208:211], v[232:235], v[140:143]
    v_exp_f32 v191, v191
    v_mfma_f32_16x16x32_bf16 v[136:139], a[208:211], v[224:227], v[136:139]
    v_cvt_pk_bf16_f32 v222, v188, v189
    v_cvt_pk_bf16_f32 v223, v190, v191
    v_mfma_f32_16x16x32_bf16 v[136:139], a[124:127], v[228:231], v[136:139]
    buffer_load_dwordx4 v6, s[48:51], s32 offen offset:0 lds
    buffer_load_dwordx4 v7, s[48:51], s32 offen offset:1056 lds
    buffer_load_dwordx4 v8, s[48:51], s32 offen offset:2112 lds
    buffer_load_dwordx4 v9, s[48:51], s32 offen offset:3168 lds
    s_add_u32 m0, s30, 33792
    s_add_u32 s32, s32, 65536
    buffer_load_dwordx4 v6, s[48:51], s32 offen offset:0 lds
    buffer_load_dwordx4 v7, s[48:51], s32 offen offset:1056 lds
    buffer_load_dwordx4 v8, s[48:51], s32 offen offset:2112 lds
    buffer_load_dwordx4 v9, s[48:51], s32 offen offset:3168 lds
    s_add_u32 m0, s30, 50688
    s_add_u32 s32, s32, 65536
    buffer_load_dwordx4 v6, s[48:51], s32 offen offset:0 lds
    buffer_load_dwordx4 v7, s[48:51], s32 offen offset:1056 lds
    buffer_load_dwordx4 v8, s[48:51], s32 offen offset:2112 lds
    buffer_load_dwordx4 v9, s[48:51], s32 offen offset:3168 lds
    s_waitcnt lgkmcnt(0)
    s_barrier
    v_smfmac_f32_16x16x64_bf16 a[128:131], a[252:255], v[208:215], v15
    v_exp_f32 v192, v192
    v_smfmac_f32_16x16x64_bf16 a[132:135], a[252:255], v[216:223], v15
    v_exp_f32 v193, v193
    v_mfma_f32_16x16x32_bf16 v[20:23], a[180:183], v[216:219], v[20:23]
    v_exp_f32 v194, v194
    v_mfma_f32_16x16x32_bf16 v[20:23], a[64:67], v[220:223], v[20:23]
    v_exp_f32 v195, v195
    v_mfma_f32_16x16x32_bf16 v[16:19], a[64:67], v[212:215], v[16:19]
    v_cvt_pk_bf16_f32 v228, v192, v193
    s_add_u32 m0, s30, 67584
    v_mfma_f32_16x16x32_bf16 v[16:19], a[180:183], v[208:211], v[16:19]
    v_exp_f32 v196, v196
    v_mfma_f32_16x16x32_bf16 v[32:35], a[184:187], v[208:211], v[32:35]
    v_exp_f32 v197, v197
    v_mfma_f32_16x16x32_bf16 v[32:35], a[68:71], v[212:215], v[32:35]
    v_cvt_pk_bf16_f32 v229, v194, v195
    s_add_u32 s32, s32, 65536
    v_mfma_f32_16x16x32_bf16 v[36:39], a[68:71], v[220:223], v[36:39]
    v_exp_f32 v198, v198
    v_mfma_f32_16x16x32_bf16 v[36:39], a[184:187], v[216:219], v[36:39]
    v_exp_f32 v199, v199
    v_mfma_f32_16x16x32_bf16 v[52:55], a[188:191], v[216:219], v[52:55]
    v_cvt_pk_bf16_f32 v230, v196, v197
    buffer_load_dwordx4 v6, s[48:51], s32 offen offset:0 lds
    v_mfma_f32_16x16x32_bf16 v[52:55], a[72:75], v[220:223], v[52:55]
    v_exp_f32 v200, v200
    v_mfma_f32_16x16x32_bf16 v[48:51], a[72:75], v[212:215], v[48:51]
    v_exp_f32 v201, v201
    v_mfma_f32_16x16x32_bf16 v[48:51], a[188:191], v[208:211], v[48:51]
    v_cvt_pk_bf16_f32 v231, v198, v199
    buffer_load_dwordx4 v7, s[48:51], s32 offen offset:1056 lds
    v_mfma_f32_16x16x32_bf16 v[64:67], a[192:195], v[208:211], v[64:67]
    v_exp_f32 v202, v202
    v_mfma_f32_16x16x32_bf16 v[64:67], a[76:79], v[212:215], v[64:67]
    v_exp_f32 v203, v203
    v_mfma_f32_16x16x32_bf16 v[68:71], a[76:79], v[220:223], v[68:71]
    v_cvt_pk_bf16_f32 v236, v200, v201
    buffer_load_dwordx4 v8, s[48:51], s32 offen offset:2112 lds
    v_mfma_f32_16x16x32_bf16 v[68:71], a[192:195], v[216:219], v[68:71]
    v_exp_f32 v204, v204
    v_mfma_f32_16x16x32_bf16 v[84:87], a[196:199], v[216:219], v[84:87]
    v_exp_f32 v205, v205
    v_mfma_f32_16x16x32_bf16 v[84:87], a[80:83], v[220:223], v[84:87]
    v_cvt_pk_bf16_f32 v237, v202, v203
    buffer_load_dwordx4 v9, s[48:51], s32 offen offset:3168 lds
    v_mfma_f32_16x16x32_bf16 v[80:83], a[80:83], v[212:215], v[80:83]
    v_exp_f32 v206, v206
    v_mfma_f32_16x16x32_bf16 v[80:83], a[196:199], v[208:211], v[80:83]
    v_exp_f32 v207, v207
    v_mfma_f32_16x16x32_bf16 v[96:99], a[200:203], v[208:211], v[96:99]
    v_cvt_pk_bf16_f32 v238, v204, v205
    v_cvt_pk_bf16_f32 v239, v206, v207
    v_mfma_f32_16x16x32_bf16 v[96:99], a[84:87], v[212:215], v[96:99]
    s_add_u32 m0, s30, 84480
    s_add_u32 s32, s32, 65536
    v_mfma_f32_16x16x32_bf16 v[100:103], a[84:87], v[220:223], v[100:103]
    buffer_load_dwordx4 v6, s[48:51], s32 offen offset:0 lds
    buffer_load_dwordx4 v7, s[48:51], s32 offen offset:1056 lds
    v_mfma_f32_16x16x32_bf16 v[100:103], a[200:203], v[216:219], v[100:103]
    buffer_load_dwordx4 v8, s[48:51], s32 offen offset:2112 lds
    buffer_load_dwordx4 v9, s[48:51], s32 offen offset:3168 lds
    v_mfma_f32_16x16x32_bf16 v[116:119], a[204:207], v[216:219], v[116:119]
    buffer_load_dwordx4 a[244:247], v5, s[80:83], s23 offen offset:0
    buffer_load_dwordx4 a[248:251], v5, s[80:83], s23 offen offset:64
    v_mfma_f32_16x16x32_bf16 v[116:119], a[88:91], v[220:223], v[116:119]
    v_accvgpr_read_b32 v250, a128
    v_accvgpr_read_b32 v13, a129
    v_mfma_f32_16x16x32_bf16 v[112:115], a[88:91], v[212:215], v[112:115]
    v_add_f32 v250, v250, v13
    v_accvgpr_read_b32 v251, a132
    v_mfma_f32_16x16x32_bf16 v[112:115], a[204:207], v[208:211], v[112:115]
    v_accvgpr_read_b32 v13, a133
    v_add_f32 v251, v251, v13
    v_mfma_f32_16x16x32_bf16 v[128:131], a[208:211], v[208:211], v[128:131]
    v_rcp_f32 v250, v250
    v_mfma_f32_16x16x32_bf16 v[128:131], a[92:95], v[212:215], v[128:131]
    v_rcp_f32 v251, v251
    v_mfma_f32_16x16x32_bf16 v[132:135], a[92:95], v[220:223], v[132:135]
    v_mul_f32 v16, v16, v250
    v_mul_f32 v17, v17, v250
    v_mfma_f32_16x16x32_bf16 v[132:135], a[208:211], v[216:219], v[132:135]
    v_mul_f32 v18, v18, v250
    v_mul_f32 v19, v19, v250
    v_mfma_f32_16x16x32_bf16 a[136:139], a[144:147], v[228:231], a[136:139]
    v_mul_f32 v32, v32, v250
    v_mul_f32 v33, v33, v250
    v_mfma_f32_16x16x32_bf16 a[140:143], a[144:147], v[236:239], a[140:143]
    v_mul_f32 v34, v34, v250
    v_mul_f32 v35, v35, v250
    v_mfma_f32_16x16x32_bf16 v[28:31], a[64:67], v[236:239], v[28:31]
    v_cvt_pk_bf16_f32 v144, v16, v17
    v_cvt_pk_bf16_f32 v145, v18, v19
    v_mfma_f32_16x16x32_bf16 v[24:27], a[64:67], v[228:231], v[24:27]
    v_cvt_pk_bf16_f32 v146, v32, v33
    v_cvt_pk_bf16_f32 v147, v34, v35
    v_mfma_f32_16x16x32_bf16 v[40:43], a[68:71], v[228:231], v[40:43]
    s_add_u32 s7, s21, 0
    buffer_store_dwordx4 v[144:147], v10, s[68:71], s7 offen sc1
    v_mfma_f32_16x16x32_bf16 v[44:47], a[68:71], v[236:239], v[44:47]
    v_mul_f32 v20, v20, v251
    v_mul_f32 v21, v21, v251
    v_mfma_f32_16x16x32_bf16 v[60:63], a[72:75], v[236:239], v[60:63]
    v_mul_f32 v22, v22, v251
    v_mul_f32 v23, v23, v251
    v_mfma_f32_16x16x32_bf16 v[56:59], a[72:75], v[228:231], v[56:59]
    v_mul_f32 v36, v36, v251
    v_mul_f32 v37, v37, v251
    v_mfma_f32_16x16x32_bf16 v[72:75], a[76:79], v[228:231], v[72:75]
    v_mul_f32 v38, v38, v251
    v_mul_f32 v39, v39, v251
    v_mfma_f32_16x16x32_bf16 v[76:79], a[76:79], v[236:239], v[76:79]
    v_cvt_pk_bf16_f32 v148, v20, v21
    v_cvt_pk_bf16_f32 v149, v22, v23
    v_mfma_f32_16x16x32_bf16 v[92:95], a[80:83], v[236:239], v[92:95]
    v_cvt_pk_bf16_f32 v150, v36, v37
    v_cvt_pk_bf16_f32 v151, v38, v39
    v_mfma_f32_16x16x32_bf16 v[88:91], a[80:83], v[228:231], v[88:91]
    s_add_u32 s7, s21, 0
    buffer_store_dwordx4 v[148:151], v11, s[68:71], s7 offen sc1
    v_mfma_f32_16x16x32_bf16 v[104:107], a[84:87], v[228:231], v[104:107]
    v_mul_f32 v48, v48, v250
    v_mul_f32 v49, v49, v250
    v_mfma_f32_16x16x32_bf16 v[108:111], a[84:87], v[236:239], v[108:111]
    v_mul_f32 v50, v50, v250
    v_mul_f32 v51, v51, v250
    v_mfma_f32_16x16x32_bf16 v[124:127], a[88:91], v[236:239], v[124:127]
    v_mul_f32 v64, v64, v250
    v_mul_f32 v65, v65, v250
    v_mfma_f32_16x16x32_bf16 v[120:123], a[88:91], v[228:231], v[120:123]
    v_mul_f32 v66, v66, v250
    v_mul_f32 v67, v67, v250
    v_mfma_f32_16x16x32_bf16 v[136:139], a[92:95], v[228:231], v[136:139]
    v_cvt_pk_bf16_f32 v160, v48, v49
    v_cvt_pk_bf16_f32 v161, v50, v51
    v_mfma_f32_16x16x32_bf16 v[140:143], a[92:95], v[236:239], v[140:143]
    v_cvt_pk_bf16_f32 v162, v64, v65
    v_cvt_pk_bf16_f32 v163, v66, v67
    s_add_u32 s7, s21, 163840
    buffer_store_dwordx4 v[160:163], v10, s[68:71], s7 offen sc1
    v_mul_f32 v52, v52, v251
    v_mul_f32 v53, v53, v251
    v_mul_f32 v54, v54, v251
    v_mul_f32 v55, v55, v251
    v_mul_f32 v68, v68, v251
    v_mul_f32 v69, v69, v251
    v_mul_f32 v70, v70, v251
    v_mul_f32 v71, v71, v251
    v_cvt_pk_bf16_f32 v164, v52, v53
    v_cvt_pk_bf16_f32 v165, v54, v55
    v_cvt_pk_bf16_f32 v166, v68, v69
    v_cvt_pk_bf16_f32 v167, v70, v71
    s_add_u32 s7, s21, 163840
    buffer_store_dwordx4 v[164:167], v11, s[68:71], s7 offen sc1
    v_accvgpr_read_b32 v240, a128
    v_accvgpr_read_b32 v241, a132
    v_accvgpr_read_b32 v242, a136
    v_accvgpr_read_b32 v243, a140
    v_accvgpr_read_b32 v244, a129
    v_accvgpr_read_b32 v245, a133
    v_accvgpr_read_b32 v246, a137
    v_accvgpr_read_b32 v247, a141
    v_add_f32 v240, v240, v244
    v_add_f32 v241, v241, v245
    v_add_f32 v242, v242, v246
    v_add_f32 v243, v243, v247
    v_min_f32 v13, v240, v241
    v_min3_f32 v13, v13, v242, v243
    v_add_f32 v14, v240, v241
    v_add_f32 v15, v242, v243
    v_add_f32 v14, v14, v15
    v_cmp_nle_f32 vcc, 813694976, v13
    s_mov_b64 s[36:37], vcc
    v_cmp_nge_f32 vcc, 1317011456, v14
    s_mov_b32 s6, 0
    v_rcp_f32 v240, v240
    v_rcp_f32 v241, v241
    v_rcp_f32 v242, v242
    v_rcp_f32 v243, v243
    s_or_b64 s[36:37], s[36:37], vcc
    s_cbranch_scc1 attn_slow
attn_ret:
    v_pk_mul_f32 v[24:25], v[24:25], v[242:243] op_sel:[0,0] op_sel_hi:[1,0]
    v_pk_mul_f32 v[26:27], v[26:27], v[242:243] op_sel:[0,0] op_sel_hi:[1,0]
    v_pk_mul_f32 v[40:41], v[40:41], v[242:243] op_sel:[0,0] op_sel_hi:[1,0]
    v_pk_mul_f32 v[42:43], v[42:43], v[242:243] op_sel:[0,0] op_sel_hi:[1,0]
    v_cvt_pk_bf16_f32 v152, v24, v25
    v_cvt_pk_bf16_f32 v153, v26, v27
    v_cvt_pk_bf16_f32 v154, v40, v41
    v_cvt_pk_bf16_f32 v155, v42, v43
    s_add_u32 s36, s21, 0
    buffer_store_dwordx4 v[152:155], v248, s[68:71], s36 offen sc1
    v_pk_mul_f32 v[28:29], v[28:29], v[242:243] op_sel:[0,1] op_sel_hi:[1,1]
    v_pk_mul_f32 v[30:31], v[30:31], v[242:243] op_sel:[0,1] op_sel_hi:[1,1]
    v_pk_mul_f32 v[44:45], v[44:45], v[242:243] op_sel:[0,1] op_sel_hi:[1,1]
    v_pk_mul_f32 v[46:47], v[46:47], v[242:243] op_sel:[0,1] op_sel_hi:[1,1]
    v_cvt_pk_bf16_f32 v156, v28, v29
    v_cvt_pk_bf16_f32 v157, v30, v31
    v_cvt_pk_bf16_f32 v158, v44, v45
    v_cvt_pk_bf16_f32 v159, v46, v47
    buffer_store_dwordx4 v[156:159], v249, s[68:71], s36 offen sc1
    v_pk_mul_f32 v[56:57], v[56:57], v[242:243] op_sel:[0,0] op_sel_hi:[1,0]
    v_pk_mul_f32 v[58:59], v[58:59], v[242:243] op_sel:[0,0] op_sel_hi:[1,0]
    v_pk_mul_f32 v[72:73], v[72:73], v[242:243] op_sel:[0,0] op_sel_hi:[1,0]
    v_pk_mul_f32 v[74:75], v[74:75], v[242:243] op_sel:[0,0] op_sel_hi:[1,0]
    v_cvt_pk_bf16_f32 v168, v56, v57
    v_cvt_pk_bf16_f32 v169, v58, v59
    v_cvt_pk_bf16_f32 v170, v72, v73
    v_cvt_pk_bf16_f32 v171, v74, v75
    s_add_u32 s36, s21, 163840
    buffer_store_dwordx4 v[168:171], v248, s[68:71], s36 offen sc1
    v_pk_mul_f32 v[60:61], v[60:61], v[242:243] op_sel:[0,1] op_sel_hi:[1,1]
    v_pk_mul_f32 v[62:63], v[62:63], v[242:243] op_sel:[0,1] op_sel_hi:[1,1]
    v_pk_mul_f32 v[76:77], v[76:77], v[242:243] op_sel:[0,1] op_sel_hi:[1,1]
    v_pk_mul_f32 v[78:79], v[78:79], v[242:243] op_sel:[0,1] op_sel_hi:[1,1]
    v_cvt_pk_bf16_f32 v172, v60, v61
    v_cvt_pk_bf16_f32 v173, v62, v63
    v_cvt_pk_bf16_f32 v174, v76, v77
    v_cvt_pk_bf16_f32 v175, v78, v79
    buffer_store_dwordx4 v[172:175], v249, s[68:71], s36 offen sc1
    v_pk_mul_f32 v[80:81], v[80:81], v[240:241] op_sel:[0,0] op_sel_hi:[1,0]
    v_pk_mul_f32 v[82:83], v[82:83], v[240:241] op_sel:[0,0] op_sel_hi:[1,0]
    v_pk_mul_f32 v[96:97], v[96:97], v[240:241] op_sel:[0,0] op_sel_hi:[1,0]
    v_pk_mul_f32 v[98:99], v[98:99], v[240:241] op_sel:[0,0] op_sel_hi:[1,0]
    v_cvt_pk_bf16_f32 v176, v80, v81
    v_cvt_pk_bf16_f32 v177, v82, v83
    v_cvt_pk_bf16_f32 v178, v96, v97
    v_cvt_pk_bf16_f32 v179, v98, v99
    s_add_u32 s36, s21, 327680
    buffer_store_dwordx4 v[176:179], v10, s[68:71], s36 offen sc1
    v_pk_mul_f32 v[84:85], v[84:85], v[240:241] op_sel:[0,1] op_sel_hi:[1,1]
    v_pk_mul_f32 v[86:87], v[86:87], v[240:241] op_sel:[0,1] op_sel_hi:[1,1]
    v_pk_mul_f32 v[100:101], v[100:101], v[240:241] op_sel:[0,1] op_sel_hi:[1,1]
    v_pk_mul_f32 v[102:103], v[102:103], v[240:241] op_sel:[0,1] op_sel_hi:[1,1]
    v_cvt_pk_bf16_f32 v180, v84, v85
    v_cvt_pk_bf16_f32 v181, v86, v87
    v_cvt_pk_bf16_f32 v182, v100, v101
    v_cvt_pk_bf16_f32 v183, v102, v103
    buffer_store_dwordx4 v[180:183], v11, s[68:71], s36 offen sc1
    v_pk_mul_f32 v[88:89], v[88:89], v[242:243] op_sel:[0,0] op_sel_hi:[1,0]
    v_pk_mul_f32 v[90:91], v[90:91], v[242:243] op_sel:[0,0] op_sel_hi:[1,0]
    v_pk_mul_f32 v[104:105], v[104:105], v[242:243] op_sel:[0,0] op_sel_hi:[1,0]
    v_pk_mul_f32 v[106:107], v[106:107], v[242:243] op_sel:[0,0] op_sel_hi:[1,0]
    v_cvt_pk_bf16_f32 v184, v88, v89
    v_cvt_pk_bf16_f32 v185, v90, v91
    v_cvt_pk_bf16_f32 v186, v104, v105
    v_cvt_pk_bf16_f32 v187, v106, v107
    buffer_store_dwordx4 v[184:187], v248, s[68:71], s36 offen sc1
    v_pk_mul_f32 v[92:93], v[92:93], v[242:243] op_sel:[0,1] op_sel_hi:[1,1]
    v_pk_mul_f32 v[94:95], v[94:95], v[242:243] op_sel:[0,1] op_sel_hi:[1,1]
    v_pk_mul_f32 v[108:109], v[108:109], v[242:243] op_sel:[0,1] op_sel_hi:[1,1]
    v_pk_mul_f32 v[110:111], v[110:111], v[242:243] op_sel:[0,1] op_sel_hi:[1,1]
    v_cvt_pk_bf16_f32 v188, v92, v93
    v_cvt_pk_bf16_f32 v189, v94, v95
    v_cvt_pk_bf16_f32 v190, v108, v109
    v_cvt_pk_bf16_f32 v191, v110, v111
    buffer_store_dwordx4 v[188:191], v249, s[68:71], s36 offen sc1
    v_pk_mul_f32 v[112:113], v[112:113], v[240:241] op_sel:[0,0] op_sel_hi:[1,0]
    v_pk_mul_f32 v[114:115], v[114:115], v[240:241] op_sel:[0,0] op_sel_hi:[1,0]
    v_pk_mul_f32 v[128:129], v[128:129], v[240:241] op_sel:[0,0] op_sel_hi:[1,0]
    v_pk_mul_f32 v[130:131], v[130:131], v[240:241] op_sel:[0,0] op_sel_hi:[1,0]
    v_cvt_pk_bf16_f32 v192, v112, v113
    v_cvt_pk_bf16_f32 v193, v114, v115
    v_cvt_pk_bf16_f32 v194, v128, v129
    v_cvt_pk_bf16_f32 v195, v130, v131
    s_add_u32 s36, s21, 491520
    buffer_store_dwordx4 v[192:195], v10, s[68:71], s36 offen sc1
    v_pk_mul_f32 v[116:117], v[116:117], v[240:241] op_sel:[0,1] op_sel_hi:[1,1]
    v_pk_mul_f32 v[118:119], v[118:119], v[240:241] op_sel:[0,1] op_sel_hi:[1,1]
    v_pk_mul_f32 v[132:133], v[132:133], v[240:241] op_sel:[0,1] op_sel_hi:[1,1]
    v_pk_mul_f32 v[134:135], v[134:135], v[240:241] op_sel:[0,1] op_sel_hi:[1,1]
    v_cvt_pk_bf16_f32 v196, v116, v117
    v_cvt_pk_bf16_f32 v197, v118, v119
    v_cvt_pk_bf16_f32 v198, v132, v133
    v_cvt_pk_bf16_f32 v199, v134, v135
    buffer_store_dwordx4 v[196:199], v11, s[68:71], s36 offen sc1
    v_pk_mul_f32 v[120:121], v[120:121], v[242:243] op_sel:[0,0] op_sel_hi:[1,0]
    v_pk_mul_f32 v[122:123], v[122:123], v[242:243] op_sel:[0,0] op_sel_hi:[1,0]
    v_pk_mul_f32 v[136:137], v[136:137], v[242:243] op_sel:[0,0] op_sel_hi:[1,0]
    v_pk_mul_f32 v[138:139], v[138:139], v[242:243] op_sel:[0,0] op_sel_hi:[1,0]
    v_cvt_pk_bf16_f32 v200, v120, v121
    v_cvt_pk_bf16_f32 v201, v122, v123
    v_cvt_pk_bf16_f32 v202, v136, v137
    v_cvt_pk_bf16_f32 v203, v138, v139
    buffer_store_dwordx4 v[200:203], v248, s[68:71], s36 offen sc1
    v_pk_mul_f32 v[124:125], v[124:125], v[242:243] op_sel:[0,1] op_sel_hi:[1,1]
    v_pk_mul_f32 v[126:127], v[126:127], v[242:243] op_sel:[0,1] op_sel_hi:[1,1]
    v_pk_mul_f32 v[140:141], v[140:141], v[242:243] op_sel:[0,1] op_sel_hi:[1,1]
    v_pk_mul_f32 v[142:143], v[142:143], v[242:243] op_sel:[0,1] op_sel_hi:[1,1]
    v_cvt_pk_bf16_f32 v204, v124, v125
    v_cvt_pk_bf16_f32 v205, v126, v127
    v_cvt_pk_bf16_f32 v206, v140, v141
    v_cvt_pk_bf16_f32 v207, v142, v143
    buffer_store_dwordx4 v[204:207], v249, s[68:71], s36 offen sc1
    v_mov_b32 v15, s85
    v_and_b32 v14, 31, v0
    v_lshlrev_b32 v14, 2, v14
    s_waitcnt vmcnt(0)
    buffer_store_dword v15, v14, s[68:71], s87 offen sc1
    s_cmp_lg_u32 s6, 0
    s_cbranch_scc1 attn_nostg
    s_mul_i32 s5, s28, 12288
    s_add_u32 s5, s5, 114688
    v_lshl_add_u32 v13, v0, 3, s5
    v_lshrrev_b32 v14, 4, v0
    v_mul_u32_u24 v14, 3072, v14
    v_bfe_u32 v15, v0, 2, 2
    v_lshl_add_u32 v14, v15, 7, v14
    v_and_b32 v15, 3, v0
    v_lshl_add_u32 v14, v15, 3, v14
    v_add_u32 v14, s5, v14
    ds_read_b64_tr_b16 a[228:229], v14 offset:0
    ds_read_b64_tr_b16 a[230:231], v14 offset:512
    ds_read_b64_tr_b16 a[232:233], v14 offset:32
    ds_read_b64_tr_b16 a[234:235], v14 offset:544
    ds_read_b64_tr_b16 a[236:237], v14 offset:64
    ds_read_b64_tr_b16 a[238:239], v14 offset:576
    ds_read_b64_tr_b16 a[240:241], v14 offset:96
    ds_read_b64_tr_b16 a[242:243], v14 offset:608
    ds_read_b64_tr_b16 a[180:181], v13 offset:1024
    ds_read_b64_tr_b16 a[182:183], v13 offset:1536
    ds_read_b64_tr_b16 a[184:185], v13 offset:2048
    ds_read_b64_tr_b16 a[186:187], v13 offset:2560
    s_waitcnt lgkmcnt(2)
    ds_read_b64_tr_b16 a[188:189], v13 offset:4096
    ds_read_b64_tr_b16 a[190:191], v13 offset:4608
    ds_read_b64_tr_b16 a[192:193], v13 offset:5120
    ds_read_b64_tr_b16 a[194:195], v13 offset:5632
    ds_read_b64_tr_b16 a[196:197], v13 offset:7168
    ds_read_b64_tr_b16 a[198:199], v13 offset:7680
    ds_read_b64_tr_b16 a[200:201], v13 offset:8192
    ds_read_b64_tr_b16 a[202:203], v13 offset:8704
    ds_read_b64_tr_b16 a[204:205], v13 offset:10240
    ds_read_b64_tr_b16 a[206:207], v13 offset:10752
    ds_read_b64_tr_b16 a[208:209], v13 offset:11264
    ds_read_b64_tr_b16 a[210:211], v13 offset:11776
attn_nostg:
    s_and_b32 s36, s2, 7
    s_mul_i32 s36, s36, 28
    s_lshr_b32 s37, s2, 3
    s_add_u32 s36, s36, s37
    s_lshl_b32 s36, s36, 15
    s_lshl_b32 s37, s28, 9
    s_add_u32 s36, s36, s37
    s_cmp_ge_u32 s2, 224
    s_cselect_b32 s36, 0x10000000, s36
    v_lshrrev_b32 v13, 5, v0
    v_lshlrev_b32 v13, 11, v13
    v_and_b32 v14, 31, v0
    v_lshl_add_u32 v13, v14, 4, v13
    v_lshrrev_b32 v14, 2, v0
    v_lshlrev_b32 v14, 9, v14
    v_and_b32 v15, 3, v0
    v_lshl_add_u32 v14, v15, 3, v14
    v_add_u32 v14, s5, v14
    s_waitcnt lgkmcnt(0)
    v_mov_b32 v15, 0
    s_mov_b64 exec, 0xf
    buffer_atomic_or v15, v253, s[68:71], s20 offen sc0 sc1
    s_mov_b64 exec, -1
    s_add_u32 m0, s5, 0
    s_add_u32 s37, s36, 0
    buffer_load_dwordx4 v13, s[24:27], s37 offen lds
    s_add_u32 m0, s5, 1024
    s_add_u32 s37, s36, 4096
    buffer_load_dwordx4 v13, s[24:27], s37 offen lds
    s_add_u32 m0, s5, 2048
    s_add_u32 s37, s36, 8192
    buffer_load_dwordx4 v13, s[24:27], s37 offen lds
    s_add_u32 m0, s5, 3072
    s_add_u32 s37, s36, 12288
    buffer_load_dwordx4 v13, s[24:27], s37 offen lds
    s_add_u32 m0, s5, 4096
    s_add_u32 s37, s36, 16384
    buffer_load_dwordx4 v13, s[24:27], s37 offen lds
    s_add_u32 m0, s5, 5120
    s_add_u32 s37, s36, 20480
    buffer_load_dwordx4 v13, s[24:27], s37 offen lds
    s_add_u32 m0, s5, 6144
    s_add_u32 s37, s36, 24576
    buffer_load_dwordx4 v13, s[24:27], s37 offen lds
    s_add_u32 m0, s5, 7168
    s_add_u32 s37, s36, 28672
    buffer_load_dwordx4 v13, s[24:27], s37 offen lds
    v_mov_b32 v1, v254
    v_add_u32 v2, s88, v254
    v_add_u32 v3, 67584, v1
    v_add_u32 v4, 67584, v2
    s_cmp_lg_u32 s89, 0
    s_cselect_b64 vcc, -1, 0
    v_cndmask_b32 v252, v248, v10, vcc
    v_cndmask_b32 v254, v249, v11, vcc
    v_cndmask_b32 v10, v10, v248, vcc
    v_cndmask_b32 v11, v11, v249, vcc
    v_accvgpr_read_b32 v16, a244
    v_accvgpr_read_b32 v17, a245
    v_accvgpr_read_b32 v18, a246
    v_accvgpr_read_b32 v19, a247
    v_accvgpr_read_b32 v20, a248
    v_accvgpr_read_b32 v21, a249
    v_accvgpr_read_b32 v22, a250
    v_accvgpr_read_b32 v23, a251
    v_lshlrev_b32 v24, 16, v16
    v_and_b32 v25, 0xffff0000, v16
    v_lshlrev_b32 v26, 16, v17
    v_and_b32 v27, 0xffff0000, v17
    v_lshlrev_b32 v28, 16, v18
    v_and_b32 v29, 0xffff0000, v18
    v_lshlrev_b32 v30, 16, v19
    v_and_b32 v31, 0xffff0000, v19
    v_lshlrev_b32 v32, 16, v20
    v_and_b32 v33, 0xffff0000, v20
    v_lshlrev_b32 v34, 16, v21
    v_and_b32 v35, 0xffff0000, v21
    v_lshlrev_b32 v36, 16, v22
    v_and_b32 v37, 0xffff0000, v22
    v_lshlrev_b32 v38, 16, v23
    v_and_b32 v39, 0xffff0000, v23
    v_mul_f32 v40, 3216550459, v24
    v_mul_f32 v41, 3216550459, v25
    v_mul_f32 v42, 3216550459, v26
    v_mul_f32 v43, 3216550459, v27
    v_mul_f32 v44, 3216550459, v28
    v_mul_f32 v45, 3216550459, v29
    v_mul_f32 v46, 3216550459, v30
    v_mul_f32 v47, 3216550459, v31
    v_mul_f32 v48, 3216550459, v32
    v_mul_f32 v49, 3216550459, v33
    v_mul_f32 v50, 3216550459, v34
    v_mul_f32 v51, 3216550459, v35
    v_mul_f32 v52, 3216550459, v36
    v_mul_f32 v53, 3216550459, v37
    v_mul_f32 v54, 3216550459, v38
    v_mul_f32 v55, 3216550459, v39
    v_exp_f32 v40, v40
    v_exp_f32 v41, v41
    v_exp_f32 v42, v42
    v_exp_f32 v43, v43
    v_exp_f32 v44, v44
    v_exp_f32 v45, v45
    v_exp_f32 v46, v46
    v_exp_f32 v47, v47
    v_exp_f32 v48, v48
    v_exp_f32 v49, v49
    v_exp_f32 v50, v50
    v_exp_f32 v51, v51
    v_exp_f32 v52, v52
    v_exp_f32 v53, v53
    v_exp_f32 v54, v54
    v_exp_f32 v55, v55
    v_add_f32 v40, 1.0, v40
    v_add_f32 v41, 1.0, v41
    v_add_f32 v42, 1.0, v42
    v_add_f32 v43, 1.0, v43
    v_add_f32 v44, 1.0, v44
    v_add_f32 v45, 1.0, v45
    v_add_f32 v46, 1.0, v46
    v_add_f32 v47, 1.0, v47
    v_add_f32 v48, 1.0, v48
    v_add_f32 v49, 1.0, v49
    v_add_f32 v50, 1.0, v50
    v_add_f32 v51, 1.0, v51
    v_add_f32 v52, 1.0, v52
    v_add_f32 v53, 1.0, v53
    v_add_f32 v54, 1.0, v54
    v_add_f32 v55, 1.0, v55
    v_rcp_f32 v40, v40
    v_rcp_f32 v41, v41
    v_rcp_f32 v42, v42
    v_rcp_f32 v43, v43
    v_rcp_f32 v44, v44
    v_rcp_f32 v45, v45
    v_rcp_f32 v46, v46
    v_rcp_f32 v47, v47
    v_rcp_f32 v48, v48
    v_rcp_f32 v49, v49
    v_rcp_f32 v50, v50
    v_rcp_f32 v51, v51
    v_rcp_f32 v52, v52
    v_rcp_f32 v53, v53
    v_rcp_f32 v54, v54
    v_rcp_f32 v55, v55
    v_mul_f32 v24, v24, v40
    v_mul_f32 v25, v25, v41
    v_mul_f32 v26, v26, v42
    v_mul_f32 v27, v27, v43
    v_mul_f32 v28, v28, v44
    v_mul_f32 v29, v29, v45
    v_mul_f32 v30, v30, v46
    v_mul_f32 v31, v31, v47
    v_mul_f32 v32, v32, v48
    v_mul_f32 v33, v33, v49
    v_mul_f32 v34, v34, v50
    v_mul_f32 v35, v35, v51
    v_mul_f32 v36, v36, v52
    v_mul_f32 v37, v37, v53
    v_mul_f32 v38, v38, v54
    v_mul_f32 v39, v39, v55
    v_cvt_pk_bf16_f32 v16, v24, v25
    v_cvt_pk_bf16_f32 v17, v26, v27
    v_cvt_pk_bf16_f32 v18, v28, v29
    v_cvt_pk_bf16_f32 v19, v30, v31
    v_cvt_pk_bf16_f32 v20, v32, v33
    v_cvt_pk_bf16_f32 v21, v34, v35
    v_cvt_pk_bf16_f32 v22, v36, v37
    v_cvt_pk_bf16_f32 v23, v38, v39
    s_nop 0
    v_mfma_f32_16x16x32_bf16 v[232:235], a[212:215], v[16:19], 0
    v_mfma_f32_16x16x32_bf16 v[236:239], a[216:219], v[16:19], 0
    v_mfma_f32_16x16x32_bf16 v[240:243], a[220:223], v[16:19], 0
    v_mfma_f32_16x16x32_bf16 v[244:247], a[224:227], v[16:19], 0
    v_mfma_f32_16x16x32_bf16 v[232:235], a[228:231], v[20:23], v[232:235]
    v_mfma_f32_16x16x32_bf16 v[236:239], a[232:235], v[20:23], v[236:239]
    v_mfma_f32_16x16x32_bf16 v[240:243], a[236:239], v[20:23], v[240:243]
    v_mfma_f32_16x16x32_bf16 v[244:247], a[240:243], v[20:23], v[244:247]
    s_waitcnt vmcnt(8)
    v_cmp_ne_u32 vcc, s85, v15
    s_and_b64 vcc, vcc, 0xf
    s_mov_b32 s4, 0
    s_nop 0
    s_cbranch_vccnz attn_p3_r
attn_p3_k:
    s_add_u32 s33, s33, 163840
    buffer_load_dwordx4 a[0:3], v10, s[68:71], s33 offen sc1
    buffer_load_dwordx4 a[4:7], v11, s[68:71], s33 offen sc1
    buffer_load_dwordx4 a[8:11], v252, s[68:71], s33 offen sc1
    buffer_load_dwordx4 a[12:15], v254, s[68:71], s33 offen sc1
    s_add_u32 s33, s33, 163840
    buffer_load_dwordx4 a[16:19], v10, s[68:71], s33 offen sc1
    buffer_load_dwordx4 a[20:23], v11, s[68:71], s33 offen sc1
    buffer_load_dwordx4 a[24:27], v252, s[68:71], s33 offen sc1
    buffer_load_dwordx4 a[28:31], v254, s[68:71], s33 offen sc1
    s_add_u32 s33, s33, 163840
    buffer_load_dwordx4 a[32:35], v10, s[68:71], s33 offen sc1
    buffer_load_dwordx4 a[36:39], v11, s[68:71], s33 offen sc1
    buffer_load_dwordx4 a[40:43], v252, s[68:71], s33 offen sc1
    buffer_load_dwordx4 a[44:47], v254, s[68:71], s33 offen sc1
    s_add_u32 s33, s33, 163840
    buffer_load_dwordx4 a[48:51], v10, s[68:71], s33 offen sc1
    buffer_load_dwordx4 a[52:55], v11, s[68:71], s33 offen sc1
    buffer_load_dwordx4 a[56:59], v252, s[68:71], s33 offen sc1
    buffer_load_dwordx4 a[60:63], v254, s[68:71], s33 offen sc1
    s_waitcnt vmcnt(16)
    ds_read_b64_tr_b16 a[212:213], v14 offset:0
    ds_read_b64_tr_b16 a[216:217], v14 offset:32
    ds_read_b64_tr_b16 a[214:215], v14 offset:64
    ds_read_b64_tr_b16 a[218:219], v14 offset:96
    ds_read_b64_tr_b16 a[220:221], v14 offset:128
    ds_read_b64_tr_b16 a[224:225], v14 offset:160
    ds_read_b64_tr_b16 a[222:223], v14 offset:192
    ds_read_b64_tr_b16 a[226:227], v14 offset:224
    ds_read_b64_tr_b16 a[228:229], v14 offset:256
    ds_read_b64_tr_b16 a[232:233], v14 offset:288
    ds_read_b64_tr_b16 a[230:231], v14 offset:320
    ds_read_b64_tr_b16 a[234:235], v14 offset:352
    s_waitcnt lgkmcnt(4)
    ds_read_b64_tr_b16 a[236:237], v14 offset:384
    ds_read_b64_tr_b16 a[240:241], v14 offset:416
    ds_read_b64_tr_b16 a[238:239], v14 offset:448
    ds_read_b64_tr_b16 a[242:243], v14 offset:480
    s_waitcnt lgkmcnt(0)
    s_barrier
    ds_read_b64_tr_b16 v[144:145], v1 offset:16896
    ds_read_b64_tr_b16 v[146:147], v1 offset:17408
    ds_read_b64_tr_b16 v[148:149], v1 offset:33792
    ds_read_b64_tr_b16 v[150:151], v1 offset:34304
    ds_read_b64_tr_b16 v[152:153], v1 offset:16904
    ds_read_b64_tr_b16 v[154:155], v1 offset:17416
    ds_read_b64_tr_b16 v[156:157], v1 offset:33800
    ds_read_b64_tr_b16 v[158:159], v1 offset:34312
    ds_read_b64_tr_b16 v[160:161], v1 offset:16960
    ds_read_b64_tr_b16 v[162:163], v1 offset:17472
    ds_read_b64_tr_b16 v[164:165], v1 offset:33856
    ds_read_b64_tr_b16 v[166:167], v1 offset:34368
    ds_read_b64_tr_b16 v[168:169], v1 offset:16968
    ds_read_b64_tr_b16 v[170:171], v1 offset:17480
    ds_read_b64_tr_b16 v[172:173], v1 offset:33864
    ds_read_b64_tr_b16 v[174:175], v1 offset:34376
    s_add_u32 m0, s30, 101376
    s_add_u32 s32, s32, 65536
    buffer_load_dwordx4 v6, s[48:51], s32 offen offset:0 lds
    buffer_load_dwordx4 v7, s[48:51], s32 offen offset:1056 lds
    buffer_load_dwordx4 v8, s[48:51], s32 offen offset:2112 lds
    buffer_load_dwordx4 v9, s[48:51], s32 offen offset:3168 lds
attn_o:
    s_waitcnt vmcnt(12) lgkmcnt(0)
    v_mfma_f32_16x16x32_bf16 v[16:19], v[144:147], a[0:3], 0
    s_add_u32 m0, s30, 118272
    s_add_u32 s32, s32, 65536
    v_mfma_f32_16x16x32_bf16 v[16:19], v[148:151], a[16:19], v[16:19]
    s_add_u32 s33, s33, 163840
    buffer_load_dwordx4 a[64:67], v10, s[68:71], s33 offen sc1
    v_mfma_f32_16x16x32_bf16 v[48:51], v[148:151], a[20:23], 0
    ds_read_b64_tr_b16 v[176:177], v2 offset:16896
    ds_read_b64_tr_b16 v[178:179], v2 offset:17408
    v_mfma_f32_16x16x32_bf16 v[48:51], v[144:147], a[4:7], v[48:51]
    buffer_load_dwordx4 a[68:71], v11, s[68:71], s33 offen sc1
    v_mfma_f32_16x16x32_bf16 v[80:83], v[144:147], a[8:11], 0
    ds_read_b64_tr_b16 v[180:181], v2 offset:33792
    ds_read_b64_tr_b16 v[182:183], v2 offset:34304
    v_mfma_f32_16x16x32_bf16 v[80:83], v[148:151], a[24:27], v[80:83]
    buffer_load_dwordx4 a[72:75], v252, s[68:71], s33 offen sc1
    v_mfma_f32_16x16x32_bf16 v[112:115], v[148:151], a[28:31], 0
    ds_read_b64_tr_b16 v[184:185], v2 offset:16904
    ds_read_b64_tr_b16 v[186:187], v2 offset:17416
    v_mfma_f32_16x16x32_bf16 v[112:115], v[144:147], a[12:15], v[112:115]
    buffer_load_dwordx4 a[76:79], v254, s[68:71], s33 offen sc1
    v_mfma_f32_16x16x32_bf16 v[116:119], v[152:155], a[12:15], 0
    ds_read_b64_tr_b16 v[188:189], v2 offset:33800
    ds_read_b64_tr_b16 v[190:191], v2 offset:34312
    v_mfma_f32_16x16x32_bf16 v[116:119], v[156:159], a[28:31], v[116:119]
    s_add_u32 s33, s33, 163840
    buffer_load_dwordx4 a[80:83], v10, s[68:71], s33 offen sc1
    v_mfma_f32_16x16x32_bf16 v[84:87], v[156:159], a[24:27], 0
    ds_read_b64_tr_b16 v[192:193], v2 offset:16960
    ds_read_b64_tr_b16 v[194:195], v2 offset:17472
    v_mfma_f32_16x16x32_bf16 v[84:87], v[152:155], a[8:11], v[84:87]
    buffer_load_dwordx4 a[84:87], v11, s[68:71], s33 offen sc1
    v_mfma_f32_16x16x32_bf16 v[52:55], v[152:155], a[4:7], 0
    ds_read_b64_tr_b16 v[196:197], v2 offset:33856
    ds_read_b64_tr_b16 v[198:199], v2 offset:34368
    v_mfma_f32_16x16x32_bf16 v[52:55], v[156:159], a[20:23], v[52:55]
    buffer_load_dwordx4 a[88:91], v252, s[68:71], s33 offen sc1
    v_mfma_f32_16x16x32_bf16 v[20:23], v[156:159], a[16:19], 0
    ds_read_b64_tr_b16 v[200:201], v2 offset:16968
    ds_read_b64_tr_b16 v[202:203], v2 offset:17480
    v_mfma_f32_16x16x32_bf16 v[20:23], v[152:155], a[0:3], v[20:23]
    buffer_load_dwordx4 a[92:95], v254, s[68:71], s33 offen sc1
    v_mfma_f32_16x16x32_bf16 v[24:27], v[160:163], a[0:3], 0
    ds_read_b64_tr_b16 v[204:205], v2 offset:33864
    ds_read_b64_tr_b16 v[206:207], v2 offset:34376
    v_mfma_f32_16x16x32_bf16 v[24:27], v[164:167], a[16:19], v[24:27]
    v_mfma_f32_16x16x32_bf16 v[56:59], v[164:167], a[20:23], 0
    v_mfma_f32_16x16x32_bf16 v[56:59], v[160:163], a[4:7], v[56:59]
    buffer_load_dwordx4 v6, s[48:51], s32 offen offset:0 lds
    v_mfma_f32_16x16x32_bf16 v[88:91], v[160:163], a[8:11], 0
    v_mfma_f32_16x16x32_bf16 v[88:91], v[164:167], a[24:27], v[88:91]
    v_mfma_f32_16x16x32_bf16 v[120:123], v[164:167], a[28:31], 0
    buffer_load_dwordx4 v7, s[48:51], s32 offen offset:1056 lds
    v_mfma_f32_16x16x32_bf16 v[120:123], v[160:163], a[12:15], v[120:123]
    v_mfma_f32_16x16x32_bf16 v[124:127], v[168:171], a[12:15], 0
    v_mfma_f32_16x16x32_bf16 v[124:127], v[172:175], a[28:31], v[124:127]
    buffer_load_dwordx4 v8, s[48:51], s32 offen offset:2112 lds
    v_mfma_f32_16x16x32_bf16 v[92:95], v[172:175], a[24:27], 0
    v_mfma_f32_16x16x32_bf16 v[92:95], v[168:171], a[8:11], v[92:95]
    v_mfma_f32_16x16x32_bf16 v[60:63], v[168:171], a[4:7], 0
    buffer_load_dwordx4 v9, s[48:51], s32 offen offset:3168 lds
    v_mfma_f32_16x16x32_bf16 v[60:63], v[172:175], a[20:23], v[60:63]
    v_mfma_f32_16x16x32_bf16 v[28:31], v[172:175], a[16:19], 0
    v_mfma_f32_16x16x32_bf16 v[28:31], v[168:171], a[0:3], v[28:31]
    s_waitcnt vmcnt(24) lgkmcnt(0)
    s_barrier
    v_mfma_f32_16x16x32_bf16 v[32:35], v[176:179], a[0:3], 0
    s_add_u32 m0, s30, 0
    s_add_u32 s32, s32, 65536
    v_mfma_f32_16x16x32_bf16 v[32:35], v[180:183], a[16:19], v[32:35]
    s_add_u32 s33, s33, 163840
    v_mfma_f32_16x16x32_bf16 v[64:67], v[180:183], a[20:23], 0
    ds_read_b64_tr_b16 v[144:145], v1 offset:50688
    ds_read_b64_tr_b16 v[146:147], v1 offset:51200
    v_mfma_f32_16x16x32_bf16 v[64:67], v[176:179], a[4:7], v[64:67]
    buffer_load_dwordx4 a[96:99], v10, s[68:71], s33 offen sc1
    v_mfma_f32_16x16x32_bf16 v[96:99], v[176:179], a[8:11], 0
    ds_read_b64_tr_b16 v[148:149], v3 offset:0
    ds_read_b64_tr_b16 v[150:151], v3 offset:512
    v_mfma_f32_16x16x32_bf16 v[96:99], v[180:183], a[24:27], v[96:99]
    v_mfma_f32_16x16x32_bf16 v[128:131], v[180:183], a[28:31], 0
    ds_read_b64_tr_b16 v[152:153], v1 offset:50696
    ds_read_b64_tr_b16 v[154:155], v1 offset:51208
    v_mfma_f32_16x16x32_bf16 v[128:131], v[176:179], a[12:15], v[128:131]
    buffer_load_dwordx4 a[100:103], v11, s[68:71], s33 offen sc1
    v_mfma_f32_16x16x32_bf16 v[132:135], v[184:187], a[12:15], 0
    ds_read_b64_tr_b16 v[156:157], v3 offset:8
    ds_read_b64_tr_b16 v[158:159], v3 offset:520
    v_mfma_f32_16x16x32_bf16 v[132:135], v[188:191], a[28:31], v[132:135]
    v_mfma_f32_16x16x32_bf16 v[100:103], v[188:191], a[24:27], 0
    ds_read_b64_tr_b16 v[160:161], v1 offset:50752
    ds_read_b64_tr_b16 v[162:163], v1 offset:51264
    v_mfma_f32_16x16x32_bf16 v[100:103], v[184:187], a[8:11], v[100:103]
    buffer_load_dwordx4 a[104:107], v252, s[68:71], s33 offen sc1
    v_mfma_f32_16x16x32_bf16 v[68:71], v[184:187], a[4:7], 0
    ds_read_b64_tr_b16 v[164:165], v3 offset:64
    ds_read_b64_tr_b16 v[166:167], v3 offset:576
    v_mfma_f32_16x16x32_bf16 v[68:71], v[188:191], a[20:23], v[68:71]
    v_mfma_f32_16x16x32_bf16 v[36:39], v[188:191], a[16:19], 0
    ds_read_b64_tr_b16 v[168:169], v1 offset:50760
    ds_read_b64_tr_b16 v[170:171], v1 offset:51272
    v_mfma_f32_16x16x32_bf16 v[36:39], v[184:187], a[0:3], v[36:39]
    buffer_load_dwordx4 a[108:111], v254, s[68:71], s33 offen sc1
    v_mfma_f32_16x16x32_bf16 v[40:43], v[192:195], a[0:3], 0
    ds_read_b64_tr_b16 v[172:173], v3 offset:72
    ds_read_b64_tr_b16 v[174:175], v3 offset:584
    v_mfma_f32_16x16x32_bf16 v[40:43], v[196:199], a[16:19], v[40:43]
    v_mfma_f32_16x16x32_bf16 v[72:75], v[196:199], a[20:23], 0
    v_mfma_f32_16x16x32_bf16 v[72:75], v[192:195], a[4:7], v[72:75]
    buffer_load_dwordx4 v6, s[48:51], s32 offen offset:0 lds
    v_mfma_f32_16x16x32_bf16 v[104:107], v[192:195], a[8:11], 0
    v_mfma_f32_16x16x32_bf16 v[104:107], v[196:199], a[24:27], v[104:107]
    v_mfma_f32_16x16x32_bf16 v[136:139], v[196:199], a[28:31], 0
    buffer_load_dwordx4 v7, s[48:51], s32 offen offset:1056 lds
    v_mfma_f32_16x16x32_bf16 v[136:139], v[192:195], a[12:15], v[136:139]
    v_mfma_f32_16x16x32_bf16 v[140:143], v[200:203], a[12:15], 0
    v_mfma_f32_16x16x32_bf16 v[140:143], v[204:207], a[28:31], v[140:143]
    buffer_load_dwordx4 v8, s[48:51], s32 offen offset:2112 lds
    v_mfma_f32_16x16x32_bf16 v[108:111], v[204:207], a[24:27], 0
    v_mfma_f32_16x16x32_bf16 v[108:111], v[200:203], a[8:11], v[108:111]
    v_mfma_f32_16x16x32_bf16 v[76:79], v[200:203], a[4:7], 0
    buffer_load_dwordx4 v9, s[48:51], s32 offen offset:3168 lds
    v_mfma_f32_16x16x32_bf16 v[76:79], v[204:207], a[20:23], v[76:79]
    v_mfma_f32_16x16x32_bf16 v[44:47], v[204:207], a[16:19], 0
    v_mfma_f32_16x16x32_bf16 v[44:47], v[200:203], a[0:3], v[44:47]
    s_waitcnt vmcnt(24) lgkmcnt(0)
    v_mfma_f32_16x16x32_bf16 v[16:19], v[144:147], a[32:35], v[16:19]
    s_add_u32 m0, s30, 16896
    s_add_u32 s32, s32, 65536
    v_mfma_f32_16x16x32_bf16 v[16:19], v[148:151], a[48:51], v[16:19]
    s_add_u32 s33, s33, 163840
    v_mfma_f32_16x16x32_bf16 v[48:51], v[148:151], a[52:55], v[48:51]
    ds_read_b64_tr_b16 v[176:177], v2 offset:50688
    ds_read_b64_tr_b16 v[178:179], v2 offset:51200
    v_mfma_f32_16x16x32_bf16 v[48:51], v[144:147], a[36:39], v[48:51]
    buffer_load_dwordx4 a[112:115], v10, s[68:71], s33 offen sc1
    v_mfma_f32_16x16x32_bf16 v[80:83], v[144:147], a[40:43], v[80:83]
    ds_read_b64_tr_b16 v[180:181], v4 offset:0
    ds_read_b64_tr_b16 v[182:183], v4 offset:512
    v_mfma_f32_16x16x32_bf16 v[80:83], v[148:151], a[56:59], v[80:83]
    v_mfma_f32_16x16x32_bf16 v[112:115], v[148:151], a[60:63], v[112:115]
    ds_read_b64_tr_b16 v[184:185], v2 offset:50696
    ds_read_b64_tr_b16 v[186:187], v2 offset:51208
    v_mfma_f32_16x16x32_bf16 v[112:115], v[144:147], a[44:47], v[112:115]
    buffer_load_dwordx4 a[116:119], v11, s[68:71], s33 offen sc1
    v_mfma_f32_16x16x32_bf16 v[116:119], v[152:155], a[44:47], v[116:119]
    ds_read_b64_tr_b16 v[188:189], v4 offset:8
    ds_read_b64_tr_b16 v[190:191], v4 offset:520
    v_mfma_f32_16x16x32_bf16 v[116:119], v[156:159], a[60:63], v[116:119]
    v_mfma_f32_16x16x32_bf16 v[84:87], v[156:159], a[56:59], v[84:87]
    ds_read_b64_tr_b16 v[192:193], v2 offset:50752
    ds_read_b64_tr_b16 v[194:195], v2 offset:51264
    v_mfma_f32_16x16x32_bf16 v[84:87], v[152:155], a[40:43], v[84:87]
    buffer_load_dwordx4 a[120:123], v252, s[68:71], s33 offen sc1
    v_mfma_f32_16x16x32_bf16 v[52:55], v[152:155], a[36:39], v[52:55]
    ds_read_b64_tr_b16 v[196:197], v4 offset:64
    ds_read_b64_tr_b16 v[198:199], v4 offset:576
    v_mfma_f32_16x16x32_bf16 v[52:55], v[156:159], a[52:55], v[52:55]
    v_mfma_f32_16x16x32_bf16 v[20:23], v[156:159], a[48:51], v[20:23]
    ds_read_b64_tr_b16 v[200:201], v2 offset:50760
    ds_read_b64_tr_b16 v[202:203], v2 offset:51272
    v_mfma_f32_16x16x32_bf16 v[20:23], v[152:155], a[32:35], v[20:23]
    buffer_load_dwordx4 a[124:127], v254, s[68:71], s33 offen sc1
    v_mfma_f32_16x16x32_bf16 v[24:27], v[160:163], a[32:35], v[24:27]
    ds_read_b64_tr_b16 v[204:205], v4 offset:72
    ds_read_b64_tr_b16 v[206:207], v4 offset:584
    v_mfma_f32_16x16x32_bf16 v[24:27], v[164:167], a[48:51], v[24:27]
    v_lshrrev_b32 v251, 2, v0
    v_min_u32 v251, 1, v251
    v_mfma_f32_16x16x32_bf16 v[56:59], v[164:167], a[52:55], v[56:59]
    v_lshl_add_u32 v251, v251, 28, v253
    s_mov_b32 s79, s20
    v_mfma_f32_16x16x32_bf16 v[56:59], v[160:163], a[36:39], v[56:59]
    buffer_load_dwordx4 v6, s[48:51], s32 offen offset:0 lds
    v_mfma_f32_16x16x32_bf16 v[88:91], v[160:163], a[40:43], v[88:91]
    v_mfma_f32_16x16x32_bf16 v[88:91], v[164:167], a[56:59], v[88:91]
    v_mfma_f32_16x16x32_bf16 v[120:123], v[164:167], a[60:63], v[120:123]
    buffer_load_dwordx4 v7, s[48:51], s32 offen offset:1056 lds
    v_mfma_f32_16x16x32_bf16 v[120:123], v[160:163], a[44:47], v[120:123]
    v_mfma_f32_16x16x32_bf16 v[124:127], v[168:171], a[44:47], v[124:127]
    v_mfma_f32_16x16x32_bf16 v[124:127], v[172:175], a[60:63], v[124:127]
    buffer_load_dwordx4 v8, s[48:51], s32 offen offset:2112 lds
    v_mfma_f32_16x16x32_bf16 v[92:95], v[172:175], a[56:59], v[92:95]
    v_mfma_f32_16x16x32_bf16 v[92:95], v[168:171], a[40:43], v[92:95]
    v_mfma_f32_16x16x32_bf16 v[60:63], v[168:171], a[36:39], v[60:63]
    buffer_load_dwordx4 v9, s[48:51], s32 offen offset:3168 lds
    v_mfma_f32_16x16x32_bf16 v[60:63], v[172:175], a[52:55], v[60:63]
    v_mfma_f32_16x16x32_bf16 v[28:31], v[172:175], a[48:51], v[28:31]
    v_mfma_f32_16x16x32_bf16 v[28:31], v[168:171], a[32:35], v[28:31]
    s_waitcnt vmcnt(28) lgkmcnt(0)
    s_barrier
    v_mfma_f32_16x16x32_bf16 v[32:35], v[176:179], a[32:35], v[32:35]
    s_add_u32 m0, s30, 33792
    s_add_u32 s32, s32, 65536
    v_mfma_f32_16x16x32_bf16 v[32:35], v[180:183], a[48:51], v[32:35]
    s_add_u32 s33, s33, 163840
    v_mfma_f32_16x16x32_bf16 v[64:67], v[180:183], a[52:55], v[64:67]
    ds_read_b64_tr_b16 v[144:145], v3 offset:16896
    ds_read_b64_tr_b16 v[146:147], v3 offset:17408
    v_mfma_f32_16x16x32_bf16 v[64:67], v[176:179], a[36:39], v[64:67]
    buffer_load_dwordx4 a[0:3], v10, s[68:71], s33 offen sc1
    v_mfma_f32_16x16x32_bf16 v[96:99], v[176:179], a[40:43], v[96:99]
    ds_read_b64_tr_b16 v[148:149], v3 offset:33792
    ds_read_b64_tr_b16 v[150:151], v3 offset:34304
    v_mfma_f32_16x16x32_bf16 v[96:99], v[180:183], a[56:59], v[96:99]
    v_mfma_f32_16x16x32_bf16 v[128:131], v[180:183], a[60:63], v[128:131]
    ds_read_b64_tr_b16 v[152:153], v3 offset:16904
    ds_read_b64_tr_b16 v[154:155], v3 offset:17416
    v_mfma_f32_16x16x32_bf16 v[128:131], v[176:179], a[44:47], v[128:131]
    buffer_load_dwordx4 a[4:7], v11, s[68:71], s33 offen sc1
    v_mfma_f32_16x16x32_bf16 v[132:135], v[184:187], a[44:47], v[132:135]
    ds_read_b64_tr_b16 v[156:157], v3 offset:33800
    ds_read_b64_tr_b16 v[158:159], v3 offset:34312
    v_mfma_f32_16x16x32_bf16 v[132:135], v[188:191], a[60:63], v[132:135]
    v_mfma_f32_16x16x32_bf16 v[100:103], v[188:191], a[56:59], v[100:103]
    ds_read_b64_tr_b16 v[160:161], v3 offset:16960
    ds_read_b64_tr_b16 v[162:163], v3 offset:17472
    v_mfma_f32_16x16x32_bf16 v[100:103], v[184:187], a[40:43], v[100:103]
    buffer_load_dwordx4 a[8:11], v252, s[68:71], s33 offen sc1
    v_mfma_f32_16x16x32_bf16 v[68:71], v[184:187], a[36:39], v[68:71]
    ds_read_b64_tr_b16 v[164:165], v3 offset:33856
    ds_read_b64_tr_b16 v[166:167], v3 offset:34368
    v_mfma_f32_16x16x32_bf16 v[68:71], v[188:191], a[52:55], v[68:71]
    v_mfma_f32_16x16x32_bf16 v[36:39], v[188:191], a[48:51], v[36:39]
    ds_read_b64_tr_b16 v[168:169], v3 offset:16968
    ds_read_b64_tr_b16 v[170:171], v3 offset:17480
    v_mfma_f32_16x16x32_bf16 v[36:39], v[184:187], a[32:35], v[36:39]
    buffer_load_dwordx4 a[12:15], v254, s[68:71], s33 offen sc1
    v_mfma_f32_16x16x32_bf16 v[40:43], v[192:195], a[32:35], v[40:43]
    ds_read_b64_tr_b16 v[172:173], v3 offset:33864
    ds_read_b64_tr_b16 v[174:175], v3 offset:34376
    v_mfma_f32_16x16x32_bf16 v[40:43], v[196:199], a[48:51], v[40:43]
    v_and_b32 v13, 15, v0
    v_lshl_add_u32 v13, v13, 26, v5
    v_mfma_f32_16x16x32_bf16 v[72:75], v[196:199], a[52:55], v[72:75]
    v_mfma_f32_16x16x32_bf16 v[72:75], v[192:195], a[36:39], v[72:75]
    buffer_load_dwordx4 v6, s[48:51], s32 offen offset:0 lds
    v_mfma_f32_16x16x32_bf16 v[104:107], v[192:195], a[40:43], v[104:107]
    v_mfma_f32_16x16x32_bf16 v[104:107], v[196:199], a[56:59], v[104:107]
    v_mfma_f32_16x16x32_bf16 v[136:139], v[196:199], a[60:63], v[136:139]
    buffer_load_dwordx4 v7, s[48:51], s32 offen offset:1056 lds
    v_mfma_f32_16x16x32_bf16 v[136:139], v[192:195], a[44:47], v[136:139]
    v_mfma_f32_16x16x32_bf16 v[140:143], v[200:203], a[44:47], v[140:143]
    v_mfma_f32_16x16x32_bf16 v[140:143], v[204:207], a[60:63], v[140:143]
    buffer_load_dwordx4 v8, s[48:51], s32 offen offset:2112 lds
    v_mfma_f32_16x16x32_bf16 v[108:111], v[204:207], a[56:59], v[108:111]
    v_mfma_f32_16x16x32_bf16 v[108:111], v[200:203], a[40:43], v[108:111]
    v_mfma_f32_16x16x32_bf16 v[76:79], v[200:203], a[36:39], v[76:79]
    buffer_load_dwordx4 v9, s[48:51], s32 offen offset:3168 lds
    v_mfma_f32_16x16x32_bf16 v[76:79], v[204:207], a[52:55], v[76:79]
    v_mfma_f32_16x16x32_bf16 v[44:47], v[204:207], a[48:51], v[44:47]
    v_mfma_f32_16x16x32_bf16 v[44:47], v[200:203], a[32:35], v[44:47]
    s_waitcnt vmcnt(28) lgkmcnt(0)
    v_mfma_f32_16x16x32_bf16 v[16:19], v[144:147], a[64:67], v[16:19]
    s_add_u32 m0, s30, 50688
    s_add_u32 s32, s32, 65536
    v_mfma_f32_16x16x32_bf16 v[16:19], v[148:151], a[80:83], v[16:19]
    s_add_u32 s33, s33, 163840
    v_mfma_f32_16x16x32_bf16 v[48:51], v[148:151], a[84:87], v[48:51]
    ds_read_b64_tr_b16 v[176:177], v4 offset:16896
    ds_read_b64_tr_b16 v[178:179], v4 offset:17408
    v_mfma_f32_16x16x32_bf16 v[48:51], v[144:147], a[68:71], v[48:51]
    buffer_load_dwordx4 a[16:19], v10, s[68:71], s33 offen sc1
    v_mfma_f32_16x16x32_bf16 v[80:83], v[144:147], a[72:75], v[80:83]
    ds_read_b64_tr_b16 v[180:181], v4 offset:33792
    ds_read_b64_tr_b16 v[182:183], v4 offset:34304
    v_mfma_f32_16x16x32_bf16 v[80:83], v[148:151], a[88:91], v[80:83]
    v_mfma_f32_16x16x32_bf16 v[112:115], v[148:151], a[92:95], v[112:115]
    ds_read_b64_tr_b16 v[184:185], v4 offset:16904
    ds_read_b64_tr_b16 v[186:187], v4 offset:17416
    v_mfma_f32_16x16x32_bf16 v[112:115], v[144:147], a[76:79], v[112:115]
    buffer_load_dwordx4 a[20:23], v11, s[68:71], s33 offen sc1
    v_mfma_f32_16x16x32_bf16 v[116:119], v[152:155], a[76:79], v[116:119]
    ds_read_b64_tr_b16 v[188:189], v4 offset:33800
    ds_read_b64_tr_b16 v[190:191], v4 offset:34312
    v_mfma_f32_16x16x32_bf16 v[116:119], v[156:159], a[92:95], v[116:119]
    v_mfma_f32_16x16x32_bf16 v[84:87], v[156:159], a[88:91], v[84:87]
    ds_read_b64_tr_b16 v[192:193], v4 offset:16960
    ds_read_b64_tr_b16 v[194:195], v4 offset:17472
    v_mfma_f32_16x16x32_bf16 v[84:87], v[152:155], a[72:75], v[84:87]
    buffer_load_dwordx4 a[24:27], v252, s[68:71], s33 offen sc1
    v_mfma_f32_16x16x32_bf16 v[52:55], v[152:155], a[68:71], v[52:55]
    ds_read_b64_tr_b16 v[196:197], v4 offset:33856
    ds_read_b64_tr_b16 v[198:199], v4 offset:34368
    v_mfma_f32_16x16x32_bf16 v[52:55], v[156:159], a[84:87], v[52:55]
    v_mfma_f32_16x16x32_bf16 v[20:23], v[156:159], a[80:83], v[20:23]
    ds_read_b64_tr_b16 v[200:201], v4 offset:16968
    ds_read_b64_tr_b16 v[202:203], v4 offset:17480
    v_mfma_f32_16x16x32_bf16 v[20:23], v[152:155], a[64:67], v[20:23]
    buffer_load_dwordx4 a[28:31], v254, s[68:71], s33 offen sc1
    v_mfma_f32_16x16x32_bf16 v[24:27], v[160:163], a[64:67], v[24:27]
    ds_read_b64_tr_b16 v[204:205], v4 offset:33864
    ds_read_b64_tr_b16 v[206:207], v4 offset:34376
    v_mfma_f32_16x16x32_bf16 v[24:27], v[164:167], a[80:83], v[24:27]
    v_mfma_f32_16x16x32_bf16 v[56:59], v[164:167], a[84:87], v[56:59]
    v_mfma_f32_16x16x32_bf16 v[56:59], v[160:163], a[68:71], v[56:59]
    buffer_load_dwordx4 v6, s[48:51], s32 offen offset:0 lds
    v_mfma_f32_16x16x32_bf16 v[88:91], v[160:163], a[72:75], v[88:91]
    v_mfma_f32_16x16x32_bf16 v[88:91], v[164:167], a[88:91], v[88:91]
    v_mfma_f32_16x16x32_bf16 v[120:123], v[164:167], a[92:95], v[120:123]
    buffer_load_dwordx4 v7, s[48:51], s32 offen offset:1056 lds
    v_mfma_f32_16x16x32_bf16 v[120:123], v[160:163], a[76:79], v[120:123]
    v_mfma_f32_16x16x32_bf16 v[124:127], v[168:171], a[76:79], v[124:127]
    v_mfma_f32_16x16x32_bf16 v[124:127], v[172:175], a[92:95], v[124:127]
    buffer_load_dwordx4 v8, s[48:51], s32 offen offset:2112 lds
    v_mfma_f32_16x16x32_bf16 v[92:95], v[172:175], a[88:91], v[92:95]
    v_mfma_f32_16x16x32_bf16 v[92:95], v[168:171], a[72:75], v[92:95]
    v_mfma_f32_16x16x32_bf16 v[60:63], v[168:171], a[68:71], v[60:63]
    buffer_load_dwordx4 v9, s[48:51], s32 offen offset:3168 lds
    v_mfma_f32_16x16x32_bf16 v[60:63], v[172:175], a[84:87], v[60:63]
    buffer_store_dwordx4 v[232:235], v13, s[68:71], s22 offen offset:0 sc1
    v_mfma_f32_16x16x32_bf16 v[28:31], v[172:175], a[80:83], v[28:31]
    v_mfma_f32_16x16x32_bf16 v[28:31], v[168:171], a[64:67], v[28:31]
    buffer_store_dwordx4 v[236:239], v13, s[68:71], s22 offen offset:64 sc1
    s_waitcnt vmcnt(26) lgkmcnt(0)
    s_barrier
    v_mfma_f32_16x16x32_bf16 v[32:35], v[176:179], a[64:67], v[32:35]
    s_add_u32 m0, s30, 67584
    s_add_u32 s32, s32, 65536
    v_mfma_f32_16x16x32_bf16 v[32:35], v[180:183], a[80:83], v[32:35]
    s_add_u32 s33, s33, 163840
    v_mfma_f32_16x16x32_bf16 v[64:67], v[180:183], a[84:87], v[64:67]
    ds_read_b64_tr_b16 v[144:145], v3 offset:50688
    ds_read_b64_tr_b16 v[146:147], v3 offset:51200
    v_mfma_f32_16x16x32_bf16 v[64:67], v[176:179], a[68:71], v[64:67]
    buffer_load_dwordx4 a[32:35], v10, s[68:71], s33 offen sc1
    v_mfma_f32_16x16x32_bf16 v[96:99], v[176:179], a[72:75], v[96:99]
    ds_read_b64_tr_b16 v[148:149], v1 offset:0
    ds_read_b64_tr_b16 v[150:151], v1 offset:512
    v_mfma_f32_16x16x32_bf16 v[96:99], v[180:183], a[88:91], v[96:99]
    v_mfma_f32_16x16x32_bf16 v[128:131], v[180:183], a[92:95], v[128:131]
    ds_read_b64_tr_b16 v[152:153], v3 offset:50696
    ds_read_b64_tr_b16 v[154:155], v3 offset:51208
    v_mfma_f32_16x16x32_bf16 v[128:131], v[176:179], a[76:79], v[128:131]
    buffer_load_dwordx4 a[36:39], v11, s[68:71], s33 offen sc1
    v_mfma_f32_16x16x32_bf16 v[132:135], v[184:187], a[76:79], v[132:135]
    ds_read_b64_tr_b16 v[156:157], v1 offset:8
    ds_read_b64_tr_b16 v[158:159], v1 offset:520
    v_mfma_f32_16x16x32_bf16 v[132:135], v[188:191], a[92:95], v[132:135]
    v_mfma_f32_16x16x32_bf16 v[100:103], v[188:191], a[88:91], v[100:103]
    ds_read_b64_tr_b16 v[160:161], v3 offset:50752
    ds_read_b64_tr_b16 v[162:163], v3 offset:51264
    v_mfma_f32_16x16x32_bf16 v[100:103], v[184:187], a[72:75], v[100:103]
    buffer_load_dwordx4 a[40:43], v252, s[68:71], s33 offen sc1
    v_mfma_f32_16x16x32_bf16 v[68:71], v[184:187], a[68:71], v[68:71]
    ds_read_b64_tr_b16 v[164:165], v1 offset:64
    ds_read_b64_tr_b16 v[166:167], v1 offset:576
    v_mfma_f32_16x16x32_bf16 v[68:71], v[188:191], a[84:87], v[68:71]
    v_mfma_f32_16x16x32_bf16 v[36:39], v[188:191], a[80:83], v[36:39]
    ds_read_b64_tr_b16 v[168:169], v3 offset:50760
    ds_read_b64_tr_b16 v[170:171], v3 offset:51272
    v_mfma_f32_16x16x32_bf16 v[36:39], v[184:187], a[64:67], v[36:39]
    buffer_load_dwordx4 a[44:47], v254, s[68:71], s33 offen sc1
    v_mfma_f32_16x16x32_bf16 v[40:43], v[192:195], a[64:67], v[40:43]
    ds_read_b64_tr_b16 v[172:173], v1 offset:72
    ds_read_b64_tr_b16 v[174:175], v1 offset:584
    v_mfma_f32_16x16x32_bf16 v[40:43], v[196:199], a[80:83], v[40:43]
    v_mfma_f32_16x16x32_bf16 v[72:75], v[196:199], a[84:87], v[72:75]
    v_mfma_f32_16x16x32_bf16 v[72:75], v[192:195], a[68:71], v[72:75]
    buffer_load_dwordx4 v6, s[48:51], s32 offen offset:0 lds
    v_mfma_f32_16x16x32_bf16 v[104:107], v[192:195], a[72:75], v[104:107]
    v_mfma_f32_16x16x32_bf16 v[104:107], v[196:199], a[88:91], v[104:107]
    v_mfma_f32_16x16x32_bf16 v[136:139], v[196:199], a[92:95], v[136:139]
    buffer_load_dwordx4 v7, s[48:51], s32 offen offset:1056 lds
    v_mfma_f32_16x16x32_bf16 v[136:139], v[192:195], a[76:79], v[136:139]
    v_mfma_f32_16x16x32_bf16 v[140:143], v[200:203], a[76:79], v[140:143]
    v_mfma_f32_16x16x32_bf16 v[140:143], v[204:207], a[92:95], v[140:143]
    buffer_load_dwordx4 v8, s[48:51], s32 offen offset:2112 lds
    v_mfma_f32_16x16x32_bf16 v[108:111], v[204:207], a[88:91], v[108:111]
    v_mfma_f32_16x16x32_bf16 v[108:111], v[200:203], a[72:75], v[108:111]
    v_mfma_f32_16x16x32_bf16 v[76:79], v[200:203], a[68:71], v[76:79]
    buffer_load_dwordx4 v9, s[48:51], s32 offen offset:3168 lds
    v_mfma_f32_16x16x32_bf16 v[76:79], v[204:207], a[84:87], v[76:79]
    buffer_store_dwordx4 v[240:243], v13, s[68:71], s22 offen offset:128 sc1
    v_mfma_f32_16x16x32_bf16 v[44:47], v[204:207], a[80:83], v[44:47]
    v_mfma_f32_16x16x32_bf16 v[44:47], v[200:203], a[64:67], v[44:47]
    buffer_store_dwordx4 v[244:247], v13, s[68:71], s22 offen offset:192 sc1
    s_waitcnt vmcnt(32) lgkmcnt(0)
    v_mfma_f32_16x16x32_bf16 v[16:19], v[144:147], a[96:99], v[16:19]
    s_add_u32 m0, s30, 84480
    s_add_u32 s32, s32, 65536
    v_mfma_f32_16x16x32_bf16 v[16:19], v[148:151], a[112:115], v[16:19]
    s_add_u32 s33, s33, 163840
    v_mfma_f32_16x16x32_bf16 v[48:51], v[148:151], a[116:119], v[48:51]
    ds_read_b64_tr_b16 v[176:177], v4 offset:50688
    ds_read_b64_tr_b16 v[178:179], v4 offset:51200
    v_mfma_f32_16x16x32_bf16 v[48:51], v[144:147], a[100:103], v[48:51]
    buffer_load_dwordx4 a[48:51], v10, s[68:71], s33 offen sc1
    v_mfma_f32_16x16x32_bf16 v[80:83], v[144:147], a[104:107], v[80:83]
    ds_read_b64_tr_b16 v[180:181], v2 offset:0
    ds_read_b64_tr_b16 v[182:183], v2 offset:512
    v_mfma_f32_16x16x32_bf16 v[80:83], v[148:151], a[120:123], v[80:83]
    v_mfma_f32_16x16x32_bf16 v[112:115], v[148:151], a[124:127], v[112:115]
    ds_read_b64_tr_b16 v[184:185], v4 offset:50696
    ds_read_b64_tr_b16 v[186:187], v4 offset:51208
    v_mfma_f32_16x16x32_bf16 v[112:115], v[144:147], a[108:111], v[112:115]
    buffer_load_dwordx4 a[52:55], v11, s[68:71], s33 offen sc1
    v_mfma_f32_16x16x32_bf16 v[116:119], v[152:155], a[108:111], v[116:119]
    ds_read_b64_tr_b16 v[188:189], v2 offset:8
    ds_read_b64_tr_b16 v[190:191], v2 offset:520
    v_mfma_f32_16x16x32_bf16 v[116:119], v[156:159], a[124:127], v[116:119]
    v_mfma_f32_16x16x32_bf16 v[84:87], v[156:159], a[120:123], v[84:87]
    ds_read_b64_tr_b16 v[192:193], v4 offset:50752
    ds_read_b64_tr_b16 v[194:195], v4 offset:51264
    v_mfma_f32_16x16x32_bf16 v[84:87], v[152:155], a[104:107], v[84:87]
    buffer_load_dwordx4 a[56:59], v252, s[68:71], s33 offen sc1
    v_mfma_f32_16x16x32_bf16 v[52:55], v[152:155], a[100:103], v[52:55]
    ds_read_b64_tr_b16 v[196:197], v2 offset:64
    ds_read_b64_tr_b16 v[198:199], v2 offset:576
    v_mfma_f32_16x16x32_bf16 v[52:55], v[156:159], a[116:119], v[52:55]
    v_mfma_f32_16x16x32_bf16 v[20:23], v[156:159], a[112:115], v[20:23]
    ds_read_b64_tr_b16 v[200:201], v4 offset:50760
    ds_read_b64_tr_b16 v[202:203], v4 offset:51272
    v_mfma_f32_16x16x32_bf16 v[20:23], v[152:155], a[96:99], v[20:23]
    buffer_load_dwordx4 a[60:63], v254, s[68:71], s33 offen sc1
    v_mfma_f32_16x16x32_bf16 v[24:27], v[160:163], a[96:99], v[24:27]
    ds_read_b64_tr_b16 v[204:205], v2 offset:72
    ds_read_b64_tr_b16 v[206:207], v2 offset:584
    v_mfma_f32_16x16x32_bf16 v[24:27], v[164:167], a[112:115], v[24:27]
    v_mfma_f32_16x16x32_bf16 v[56:59], v[164:167], a[116:119], v[56:59]
    v_mfma_f32_16x16x32_bf16 v[56:59], v[160:163], a[100:103], v[56:59]
    buffer_load_dwordx4 v6, s[48:51], s32 offen offset:0 lds
    v_mfma_f32_16x16x32_bf16 v[88:91], v[160:163], a[104:107], v[88:91]
    v_mfma_f32_16x16x32_bf16 v[88:91], v[164:167], a[120:123], v[88:91]
    v_mfma_f32_16x16x32_bf16 v[120:123], v[164:167], a[124:127], v[120:123]
    buffer_load_dwordx4 v7, s[48:51], s32 offen offset:1056 lds
    v_mfma_f32_16x16x32_bf16 v[120:123], v[160:163], a[108:111], v[120:123]
    v_mfma_f32_16x16x32_bf16 v[124:127], v[168:171], a[108:111], v[124:127]
    v_mfma_f32_16x16x32_bf16 v[124:127], v[172:175], a[124:127], v[124:127]
    buffer_load_dwordx4 v8, s[48:51], s32 offen offset:2112 lds
    v_mfma_f32_16x16x32_bf16 v[92:95], v[172:175], a[120:123], v[92:95]
    v_mfma_f32_16x16x32_bf16 v[92:95], v[168:171], a[104:107], v[92:95]
    v_mfma_f32_16x16x32_bf16 v[60:63], v[168:171], a[100:103], v[60:63]
    buffer_load_dwordx4 v9, s[48:51], s32 offen offset:3168 lds
    v_mfma_f32_16x16x32_bf16 v[60:63], v[172:175], a[116:119], v[60:63]
    v_mfma_f32_16x16x32_bf16 v[28:31], v[172:175], a[112:115], v[28:31]
    v_mfma_f32_16x16x32_bf16 v[28:31], v[168:171], a[96:99], v[28:31]
    s_waitcnt vmcnt(28) lgkmcnt(0)
    s_barrier
    v_mfma_f32_16x16x32_bf16 v[32:35], v[176:179], a[96:99], v[32:35]
    s_add_u32 m0, s30, 101376
    s_add_u32 s32, s32, 65536
    v_mfma_f32_16x16x32_bf16 v[32:35], v[180:183], a[112:115], v[32:35]
    s_add_u32 s33, s33, 163840
    v_mfma_f32_16x16x32_bf16 v[64:67], v[180:183], a[116:119], v[64:67]
    ds_read_b64_tr_b16 v[144:145], v1 offset:16896
    ds_read_b64_tr_b16 v[146:147], v1 offset:17408
    v_mfma_f32_16x16x32_bf16 v[64:67], v[176:179], a[100:103], v[64:67]
    buffer_load_dwordx4 a[64:67], v10, s[68:71], s33 offen sc1
    v_mfma_f32_16x16x32_bf16 v[96:99], v[176:179], a[104:107], v[96:99]
    ds_read_b64_tr_b16 v[148:149], v1 offset:33792
    ds_read_b64_tr_b16 v[150:151], v1 offset:34304
    v_mfma_f32_16x16x32_bf16 v[96:99], v[180:183], a[120:123], v[96:99]
    v_mfma_f32_16x16x32_bf16 v[128:131], v[180:183], a[124:127], v[128:131]
    ds_read_b64_tr_b16 v[152:153], v1 offset:16904
    ds_read_b64_tr_b16 v[154:155], v1 offset:17416
    v_mfma_f32_16x16x32_bf16 v[128:131], v[176:179], a[108:111], v[128:131]
    buffer_load_dwordx4 a[68:71], v11, s[68:71], s33 offen sc1
    v_mfma_f32_16x16x32_bf16 v[132:135], v[184:187], a[108:111], v[132:135]
    ds_read_b64_tr_b16 v[156:157], v1 offset:33800
    ds_read_b64_tr_b16 v[158:159], v1 offset:34312
    v_mfma_f32_16x16x32_bf16 v[132:135], v[188:191], a[124:127], v[132:135]
    v_mfma_f32_16x16x32_bf16 v[100:103], v[188:191], a[120:123], v[100:103]
    ds_read_b64_tr_b16 v[160:161], v1 offset:16960
    ds_read_b64_tr_b16 v[162:163], v1 offset:17472
    v_mfma_f32_16x16x32_bf16 v[100:103], v[184:187], a[104:107], v[100:103]
    buffer_load_dwordx4 a[72:75], v252, s[68:71], s33 offen sc1
    v_mfma_f32_16x16x32_bf16 v[68:71], v[184:187], a[100:103], v[68:71]
    ds_read_b64_tr_b16 v[164:165], v1 offset:33856
    ds_read_b64_tr_b16 v[166:167], v1 offset:34368
    v_mfma_f32_16x16x32_bf16 v[68:71], v[188:191], a[116:119], v[68:71]
    v_mfma_f32_16x16x32_bf16 v[36:39], v[188:191], a[112:115], v[36:39]
    ds_read_b64_tr_b16 v[168:169], v1 offset:16968
    ds_read_b64_tr_b16 v[170:171], v1 offset:17480
    v_mfma_f32_16x16x32_bf16 v[36:39], v[184:187], a[96:99], v[36:39]
    buffer_load_dwordx4 a[76:79], v254, s[68:71], s33 offen sc1
    v_mfma_f32_16x16x32_bf16 v[40:43], v[192:195], a[96:99], v[40:43]
    ds_read_b64_tr_b16 v[172:173], v1 offset:33864
    ds_read_b64_tr_b16 v[174:175], v1 offset:34376
    v_mfma_f32_16x16x32_bf16 v[40:43], v[196:199], a[112:115], v[40:43]
    v_mfma_f32_16x16x32_bf16 v[72:75], v[196:199], a[116:119], v[72:75]
    v_mfma_f32_16x16x32_bf16 v[72:75], v[192:195], a[100:103], v[72:75]
    buffer_load_dwordx4 v6, s[48:51], s32 offen offset:0 lds
    v_mfma_f32_16x16x32_bf16 v[104:107], v[192:195], a[104:107], v[104:107]
    v_mfma_f32_16x16x32_bf16 v[104:107], v[196:199], a[120:123], v[104:107]
    v_mfma_f32_16x16x32_bf16 v[136:139], v[196:199], a[124:127], v[136:139]
    buffer_load_dwordx4 v7, s[48:51], s32 offen offset:1056 lds
    v_mfma_f32_16x16x32_bf16 v[136:139], v[192:195], a[108:111], v[136:139]
    v_mfma_f32_16x16x32_bf16 v[140:143], v[200:203], a[108:111], v[140:143]
    v_mfma_f32_16x16x32_bf16 v[140:143], v[204:207], a[124:127], v[140:143]
    buffer_load_dwordx4 v8, s[48:51], s32 offen offset:2112 lds
    v_mfma_f32_16x16x32_bf16 v[108:111], v[204:207], a[120:123], v[108:111]
    v_mfma_f32_16x16x32_bf16 v[108:111], v[200:203], a[104:107], v[108:111]
    v_mov_b32 v250, 0
    v_mfma_f32_16x16x32_bf16 v[76:79], v[200:203], a[100:103], v[76:79]
    buffer_load_dwordx4 v9, s[48:51], s32 offen offset:3168 lds
    v_mfma_f32_16x16x32_bf16 v[76:79], v[204:207], a[116:119], v[76:79]
    v_mfma_f32_16x16x32_bf16 v[44:47], v[204:207], a[112:115], v[44:47]
    v_mfma_f32_16x16x32_bf16 v[44:47], v[200:203], a[96:99], v[44:47]
    buffer_atomic_or v250, v251, s[68:71], s79 offen offset:512 sc0 sc1
    s_waitcnt vmcnt(33) lgkmcnt(0)
    v_mfma_f32_16x16x32_bf16 v[16:19], v[144:147], a[0:3], v[16:19]
    s_add_u32 m0, s30, 118272
    s_add_u32 s32, s32, 65536
    v_mfma_f32_16x16x32_bf16 v[16:19], v[148:151], a[16:19], v[16:19]
    s_add_u32 s33, s33, 163840
    v_mfma_f32_16x16x32_bf16 v[48:51], v[148:151], a[20:23], v[48:51]
    ds_read_b64_tr_b16 v[176:177], v2 offset:16896
    ds_read_b64_tr_b16 v[178:179], v2 offset:17408
    v_mfma_f32_16x16x32_bf16 v[48:51], v[144:147], a[4:7], v[48:51]
    buffer_load_dwordx4 a[80:83], v10, s[68:71], s33 offen sc1
    v_mfma_f32_16x16x32_bf16 v[80:83], v[144:147], a[8:11], v[80:83]
    ds_read_b64_tr_b16 v[180:181], v2 offset:33792
    ds_read_b64_tr_b16 v[182:183], v2 offset:34304
    v_mfma_f32_16x16x32_bf16 v[80:83], v[148:151], a[24:27], v[80:83]
    v_mfma_f32_16x16x32_bf16 v[112:115], v[148:151], a[28:31], v[112:115]
    ds_read_b64_tr_b16 v[184:185], v2 offset:16904
    ds_read_b64_tr_b16 v[186:187], v2 offset:17416
    v_mfma_f32_16x16x32_bf16 v[112:115], v[144:147], a[12:15], v[112:115]
    buffer_load_dwordx4 a[84:87], v11, s[68:71], s33 offen sc1
    v_mfma_f32_16x16x32_bf16 v[116:119], v[152:155], a[12:15], v[116:119]
    ds_read_b64_tr_b16 v[188:189], v2 offset:33800
    ds_read_b64_tr_b16 v[190:191], v2 offset:34312
    v_mfma_f32_16x16x32_bf16 v[116:119], v[156:159], a[28:31], v[116:119]
    v_mfma_f32_16x16x32_bf16 v[84:87], v[156:159], a[24:27], v[84:87]
    ds_read_b64_tr_b16 v[192:193], v2 offset:16960
    ds_read_b64_tr_b16 v[194:195], v2 offset:17472
    v_mfma_f32_16x16x32_bf16 v[84:87], v[152:155], a[8:11], v[84:87]
    buffer_load_dwordx4 a[88:91], v252, s[68:71], s33 offen sc1
    v_mfma_f32_16x16x32_bf16 v[52:55], v[152:155], a[4:7], v[52:55]
    ds_read_b64_tr_b16 v[196:197], v2 offset:33856
    ds_read_b64_tr_b16 v[198:199], v2 offset:34368
    v_mfma_f32_16x16x32_bf16 v[52:55], v[156:159], a[20:23], v[52:55]
    v_mfma_f32_16x16x32_bf16 v[20:23], v[156:159], a[16:19], v[20:23]
    ds_read_b64_tr_b16 v[200:201], v2 offset:16968
    ds_read_b64_tr_b16 v[202:203], v2 offset:17480
    v_mfma_f32_16x16x32_bf16 v[20:23], v[152:155], a[0:3], v[20:23]
    buffer_load_dwordx4 a[92:95], v254, s[68:71], s33 offen sc1
    v_mfma_f32_16x16x32_bf16 v[24:27], v[160:163], a[0:3], v[24:27]
    ds_read_b64_tr_b16 v[204:205], v2 offset:33864
    ds_read_b64_tr_b16 v[206:207], v2 offset:34376
    v_mfma_f32_16x16x32_bf16 v[24:27], v[164:167], a[16:19], v[24:27]
    v_mfma_f32_16x16x32_bf16 v[56:59], v[164:167], a[20:23], v[56:59]
    v_mfma_f32_16x16x32_bf16 v[56:59], v[160:163], a[4:7], v[56:59]
    buffer_load_dwordx4 v6, s[48:51], s32 offen offset:0 lds
    v_mfma_f32_16x16x32_bf16 v[88:91], v[160:163], a[8:11], v[88:91]
    v_mfma_f32_16x16x32_bf16 v[88:91], v[164:167], a[24:27], v[88:91]
    v_mfma_f32_16x16x32_bf16 v[120:123], v[164:167], a[28:31], v[120:123]
    buffer_load_dwordx4 v7, s[48:51], s32 offen offset:1056 lds
    v_mfma_f32_16x16x32_bf16 v[120:123], v[160:163], a[12:15], v[120:123]
    v_mfma_f32_16x16x32_bf16 v[124:127], v[168:171], a[12:15], v[124:127]
    v_mfma_f32_16x16x32_bf16 v[124:127], v[172:175], a[28:31], v[124:127]
    buffer_load_dwordx4 v8, s[48:51], s32 offen offset:2112 lds
    v_mfma_f32_16x16x32_bf16 v[92:95], v[172:175], a[24:27], v[92:95]
    v_mfma_f32_16x16x32_bf16 v[92:95], v[168:171], a[8:11], v[92:95]
    v_mfma_f32_16x16x32_bf16 v[60:63], v[168:171], a[4:7], v[60:63]
    buffer_load_dwordx4 v9, s[48:51], s32 offen offset:3168 lds
    v_mfma_f32_16x16x32_bf16 v[60:63], v[172:175], a[20:23], v[60:63]
    v_mfma_f32_16x16x32_bf16 v[28:31], v[172:175], a[16:19], v[28:31]
    v_mfma_f32_16x16x32_bf16 v[28:31], v[168:171], a[0:3], v[28:31]
    s_waitcnt vmcnt(27) lgkmcnt(0)
    s_barrier
    v_mfma_f32_16x16x32_bf16 v[32:35], v[176:179], a[0:3], v[32:35]
    s_add_u32 m0, s30, 0
    s_add_u32 s32, s32, 65536
    v_mfma_f32_16x16x32_bf16 v[32:35], v[180:183], a[16:19], v[32:35]
    s_add_u32 s33, s33, 163840
    v_mfma_f32_16x16x32_bf16 v[64:67], v[180:183], a[20:23], v[64:67]
    ds_read_b64_tr_b16 v[144:145], v1 offset:50688
    ds_read_b64_tr_b16 v[146:147], v1 offset:51200
    v_mfma_f32_16x16x32_bf16 v[64:67], v[176:179], a[4:7], v[64:67]
    buffer_load_dwordx4 a[96:99], v10, s[68:71], s33 offen sc1
    v_mfma_f32_16x16x32_bf16 v[96:99], v[176:179], a[8:11], v[96:99]
    ds_read_b64_tr_b16 v[148:149], v3 offset:0
    ds_read_b64_tr_b16 v[150:151], v3 offset:512
    v_mfma_f32_16x16x32_bf16 v[96:99], v[180:183], a[24:27], v[96:99]
    v_and_b32 v15, 15, v0
    v_lshl_add_u32 v13, v15, 11, v5
    v_mfma_f32_16x16x32_bf16 v[128:131], v[180:183], a[28:31], v[128:131]
    ds_read_b64_tr_b16 v[152:153], v1 offset:50696
    ds_read_b64_tr_b16 v[154:155], v1 offset:51208
    v_mfma_f32_16x16x32_bf16 v[128:131], v[176:179], a[12:15], v[128:131]
    buffer_load_dwordx4 a[100:103], v11, s[68:71], s33 offen sc1
    v_mfma_f32_16x16x32_bf16 v[132:135], v[184:187], a[12:15], v[132:135]
    ds_read_b64_tr_b16 v[156:157], v3 offset:8
    ds_read_b64_tr_b16 v[158:159], v3 offset:520
    v_mfma_f32_16x16x32_bf16 v[132:135], v[188:191], a[28:31], v[132:135]
    v_mul_u32_u24 v14, 1040, v5
    v_lshl_add_u32 v14, v15, 4, v14
    v_mfma_f32_16x16x32_bf16 v[100:103], v[188:191], a[24:27], v[100:103]
    ds_read_b64_tr_b16 v[160:161], v1 offset:50752
    ds_read_b64_tr_b16 v[162:163], v1 offset:51264
    v_mfma_f32_16x16x32_bf16 v[100:103], v[184:187], a[8:11], v[100:103]
    buffer_load_dwordx4 a[104:107], v252, s[68:71], s33 offen sc1
    v_mfma_f32_16x16x32_bf16 v[68:71], v[184:187], a[4:7], v[68:71]
    ds_read_b64_tr_b16 v[164:165], v3 offset:64
    ds_read_b64_tr_b16 v[166:167], v3 offset:576
    v_mfma_f32_16x16x32_bf16 v[68:71], v[188:191], a[20:23], v[68:71]
    s_lshl_b32 s20, s18, 16
    s_lshl_b32 s22, s17, 7
    v_mfma_f32_16x16x32_bf16 v[36:39], v[188:191], a[16:19], v[36:39]
    ds_read_b64_tr_b16 v[168:169], v1 offset:50760
    ds_read_b64_tr_b16 v[170:171], v1 offset:51272
    v_mfma_f32_16x16x32_bf16 v[36:39], v[184:187], a[0:3], v[36:39]
    buffer_load_dwordx4 a[108:111], v254, s[68:71], s33 offen sc1
    v_mfma_f32_16x16x32_bf16 v[40:43], v[192:195], a[0:3], v[40:43]
    ds_read_b64_tr_b16 v[172:173], v3 offset:72
    ds_read_b64_tr_b16 v[174:175], v3 offset:584
    v_mfma_f32_16x16x32_bf16 v[40:43], v[196:199], a[16:19], v[40:43]
    s_add_u32 s20, s20, s22
    s_add_u32 s21, s20, 32768
    v_mfma_f32_16x16x32_bf16 v[72:75], v[196:199], a[20:23], v[72:75]
    s_lshl_b32 s23, s28, 12
    s_lshl_b32 s36, s17, 8
    v_mfma_f32_16x16x32_bf16 v[72:75], v[192:195], a[4:7], v[72:75]
    buffer_load_dwordx4 v6, s[48:51], s32 offen offset:0 lds
    v_mfma_f32_16x16x32_bf16 v[104:107], v[192:195], a[8:11], v[104:107]
    s_add_u32 s23, s23, s36
    s_add_u32 s36, s23, 29622272
    v_mfma_f32_16x16x32_bf16 v[104:107], v[196:199], a[24:27], v[104:107]
    s_add_u32 s37, s23, 29688832
    s_add_u32 s38, s23, 29755392
    v_mfma_f32_16x16x32_bf16 v[136:139], v[196:199], a[28:31], v[136:139]
    buffer_load_dwordx4 v7, s[48:51], s32 offen offset:1056 lds
    v_mfma_f32_16x16x32_bf16 v[136:139], v[192:195], a[12:15], v[136:139]
    s_add_u32 s39, s23, 29821952
    s_xor_b32 s23, s87, 512
    v_mfma_f32_16x16x32_bf16 v[140:143], v[200:203], a[12:15], v[140:143]
    s_xor_b32 s78, s79, 2048
    s_add_u32 s78, s78, 12800
    v_mfma_f32_16x16x32_bf16 v[140:143], v[204:207], a[28:31], v[140:143]
    buffer_load_dwordx4 v8, s[48:51], s32 offen offset:2112 lds
    v_mfma_f32_16x16x32_bf16 v[108:111], v[204:207], a[24:27], v[108:111]
    v_lshlrev_b32 v229, 3, v15
    v_mfma_f32_16x16x32_bf16 v[108:111], v[200:203], a[8:11], v[108:111]
    v_mfma_f32_16x16x32_bf16 v[76:79], v[200:203], a[4:7], v[76:79]
    buffer_load_dwordx4 v9, s[48:51], s32 offen offset:3168 lds
    v_mfma_f32_16x16x32_bf16 v[76:79], v[204:207], a[20:23], v[76:79]
    v_mfma_f32_16x16x32_bf16 v[44:47], v[204:207], a[16:19], v[44:47]
    v_mfma_f32_16x16x32_bf16 v[44:47], v[200:203], a[0:3], v[44:47]
    s_waitcnt vmcnt(29) lgkmcnt(0)
    v_mfma_f32_16x16x32_bf16 v[16:19], v[144:147], a[32:35], v[16:19]
    s_add_u32 m0, s30, 16896
    s_add_u32 s32, s32, 65536
    v_mfma_f32_16x16x32_bf16 v[16:19], v[148:151], a[48:51], v[16:19]
    s_add_u32 s33, s33, 163840
    v_mfma_f32_16x16x32_bf16 v[48:51], v[148:151], a[52:55], v[48:51]
    ds_read_b64_tr_b16 v[176:177], v2 offset:50688
    ds_read_b64_tr_b16 v[178:179], v2 offset:51200
    v_mfma_f32_16x16x32_bf16 v[48:51], v[144:147], a[36:39], v[48:51]
    buffer_load_dwordx4 a[112:115], v10, s[68:71], s33 offen sc1
    v_mfma_f32_16x16x32_bf16 v[80:83], v[144:147], a[40:43], v[80:83]
    ds_read_b64_tr_b16 v[180:181], v4 offset:0
    ds_read_b64_tr_b16 v[182:183], v4 offset:512
    v_mfma_f32_16x16x32_bf16 v[80:83], v[148:151], a[56:59], v[80:83]
    v_mfma_f32_16x16x32_bf16 v[112:115], v[148:151], a[60:63], v[112:115]
    ds_read_b64_tr_b16 v[184:185], v2 offset:50696
    ds_read_b64_tr_b16 v[186:187], v2 offset:51208
    v_mfma_f32_16x16x32_bf16 v[112:115], v[144:147], a[44:47], v[112:115]
    buffer_load_dwordx4 a[116:119], v11, s[68:71], s33 offen sc1
    v_mfma_f32_16x16x32_bf16 v[116:119], v[152:155], a[44:47], v[116:119]
    ds_read_b64_tr_b16 v[188:189], v4 offset:8
    ds_read_b64_tr_b16 v[190:191], v4 offset:520
    v_mfma_f32_16x16x32_bf16 v[116:119], v[156:159], a[60:63], v[116:119]
    v_mfma_f32_16x16x32_bf16 v[84:87], v[156:159], a[56:59], v[84:87]
    ds_read_b64_tr_b16 v[192:193], v2 offset:50752
    ds_read_b64_tr_b16 v[194:195], v2 offset:51264
    v_mfma_f32_16x16x32_bf16 v[84:87], v[152:155], a[40:43], v[84:87]
    buffer_load_dwordx4 a[120:123], v252, s[68:71], s33 offen sc1
    v_mfma_f32_16x16x32_bf16 v[52:55], v[152:155], a[36:39], v[52:55]
    ds_read_b64_tr_b16 v[196:197], v4 offset:64
    ds_read_b64_tr_b16 v[198:199], v4 offset:576
    v_mfma_f32_16x16x32_bf16 v[52:55], v[156:159], a[52:55], v[52:55]
    v_mfma_f32_16x16x32_bf16 v[20:23], v[156:159], a[48:51], v[20:23]
    ds_read_b64_tr_b16 v[200:201], v2 offset:50760
    ds_read_b64_tr_b16 v[202:203], v2 offset:51272
    v_mfma_f32_16x16x32_bf16 v[20:23], v[152:155], a[32:35], v[20:23]
    buffer_load_dwordx4 a[124:127], v254, s[68:71], s33 offen sc1
    v_mfma_f32_16x16x32_bf16 v[24:27], v[160:163], a[32:35], v[24:27]
    ds_read_b64_tr_b16 v[204:205], v4 offset:72
    ds_read_b64_tr_b16 v[206:207], v4 offset:584
    v_mfma_f32_16x16x32_bf16 v[24:27], v[164:167], a[48:51], v[24:27]
    v_mfma_f32_16x16x32_bf16 v[56:59], v[164:167], a[52:55], v[56:59]
    v_mfma_f32_16x16x32_bf16 v[56:59], v[160:163], a[36:39], v[56:59]
    buffer_load_dwordx4 v6, s[48:51], s32 offen offset:0 lds
    v_mfma_f32_16x16x32_bf16 v[88:91], v[160:163], a[40:43], v[88:91]
    v_mfma_f32_16x16x32_bf16 v[88:91], v[164:167], a[56:59], v[88:91]
    v_mfma_f32_16x16x32_bf16 v[120:123], v[164:167], a[60:63], v[120:123]
    buffer_load_dwordx4 v7, s[48:51], s32 offen offset:1056 lds
    v_mfma_f32_16x16x32_bf16 v[120:123], v[160:163], a[44:47], v[120:123]
    v_mfma_f32_16x16x32_bf16 v[124:127], v[168:171], a[44:47], v[124:127]
    v_mfma_f32_16x16x32_bf16 v[124:127], v[172:175], a[60:63], v[124:127]
    buffer_load_dwordx4 v8, s[48:51], s32 offen offset:2112 lds
    v_mfma_f32_16x16x32_bf16 v[92:95], v[172:175], a[56:59], v[92:95]
    v_mfma_f32_16x16x32_bf16 v[92:95], v[168:171], a[40:43], v[92:95]
    v_mfma_f32_16x16x32_bf16 v[60:63], v[168:171], a[36:39], v[60:63]
    buffer_load_dwordx4 v9, s[48:51], s32 offen offset:3168 lds
    v_mfma_f32_16x16x32_bf16 v[60:63], v[172:175], a[52:55], v[60:63]
    v_mfma_f32_16x16x32_bf16 v[28:31], v[172:175], a[48:51], v[28:31]
    v_mfma_f32_16x16x32_bf16 v[28:31], v[168:171], a[32:35], v[28:31]
    s_waitcnt vmcnt(24)
    v_cmp_ne_u32 vcc, s85, v250
    s_and_b64 vcc, vcc, 15
    s_mov_b32 s4, 0
    s_nop 0
    s_cbranch_vccnz attn_p4_r
attn_p4_k:
    s_waitcnt vmcnt(25) lgkmcnt(0)
    s_barrier
    v_mfma_f32_16x16x32_bf16 v[32:35], v[176:179], a[32:35], v[32:35]
    s_add_u32 m0, s30, 33792
    s_add_u32 s32, s32, 65536
    v_mfma_f32_16x16x32_bf16 v[32:35], v[180:183], a[48:51], v[32:35]
    s_add_u32 s33, s33, 163840
    v_mfma_f32_16x16x32_bf16 v[64:67], v[180:183], a[52:55], v[64:67]
    ds_read_b64_tr_b16 v[144:145], v3 offset:16896
    ds_read_b64_tr_b16 v[146:147], v3 offset:17408
    v_mfma_f32_16x16x32_bf16 v[64:67], v[176:179], a[36:39], v[64:67]
    buffer_load_dwordx4 a[0:3], v10, s[68:71], s33 offen sc1
    v_mfma_f32_16x16x32_bf16 v[96:99], v[176:179], a[40:43], v[96:99]
    ds_read_b64_tr_b16 v[148:149], v3 offset:33792
    ds_read_b64_tr_b16 v[150:151], v3 offset:34304
    v_mfma_f32_16x16x32_bf16 v[96:99], v[180:183], a[56:59], v[96:99]
    v_mfma_f32_16x16x32_bf16 v[128:131], v[180:183], a[60:63], v[128:131]
    ds_read_b64_tr_b16 v[152:153], v3 offset:16904
    ds_read_b64_tr_b16 v[154:155], v3 offset:17416
    v_mfma_f32_16x16x32_bf16 v[128:131], v[176:179], a[44:47], v[128:131]
    buffer_load_dwordx4 a[4:7], v11, s[68:71], s33 offen sc1
    v_mfma_f32_16x16x32_bf16 v[132:135], v[184:187], a[44:47], v[132:135]
    ds_read_b64_tr_b16 v[156:157], v3 offset:33800
    ds_read_b64_tr_b16 v[158:159], v3 offset:34312
    v_mfma_f32_16x16x32_bf16 v[132:135], v[188:191], a[60:63], v[132:135]
    v_mfma_f32_16x16x32_bf16 v[100:103], v[188:191], a[56:59], v[100:103]
    ds_read_b64_tr_b16 v[160:161], v3 offset:16960
    ds_read_b64_tr_b16 v[162:163], v3 offset:17472
    v_mfma_f32_16x16x32_bf16 v[100:103], v[184:187], a[40:43], v[100:103]
    buffer_load_dwordx4 a[8:11], v252, s[68:71], s33 offen sc1
    v_mfma_f32_16x16x32_bf16 v[68:71], v[184:187], a[36:39], v[68:71]
    ds_read_b64_tr_b16 v[164:165], v3 offset:33856
    ds_read_b64_tr_b16 v[166:167], v3 offset:34368
    v_mfma_f32_16x16x32_bf16 v[68:71], v[188:191], a[52:55], v[68:71]
    v_mfma_f32_16x16x32_bf16 v[36:39], v[188:191], a[48:51], v[36:39]
    ds_read_b64_tr_b16 v[168:169], v3 offset:16968
    ds_read_b64_tr_b16 v[170:171], v3 offset:17480
    v_mfma_f32_16x16x32_bf16 v[36:39], v[184:187], a[32:35], v[36:39]
    buffer_load_dwordx4 a[12:15], v254, s[68:71], s33 offen sc1
    v_mfma_f32_16x16x32_bf16 v[40:43], v[192:195], a[32:35], v[40:43]
    ds_read_b64_tr_b16 v[172:173], v3 offset:33864
    ds_read_b64_tr_b16 v[174:175], v3 offset:34376
    v_mfma_f32_16x16x32_bf16 v[40:43], v[196:199], a[48:51], v[40:43]
    v_mfma_f32_16x16x32_bf16 v[72:75], v[196:199], a[52:55], v[72:75]
    v_mfma_f32_16x16x32_bf16 v[72:75], v[192:195], a[36:39], v[72:75]
    buffer_load_dwordx4 v6, s[48:51], s32 offen offset:0 lds
    v_mfma_f32_16x16x32_bf16 v[104:107], v[192:195], a[40:43], v[104:107]
    v_mfma_f32_16x16x32_bf16 v[104:107], v[196:199], a[56:59], v[104:107]
    v_mfma_f32_16x16x32_bf16 v[136:139], v[196:199], a[60:63], v[136:139]
    buffer_load_dwordx4 v7, s[48:51], s32 offen offset:1056 lds
    v_mfma_f32_16x16x32_bf16 v[136:139], v[192:195], a[44:47], v[136:139]
    v_mfma_f32_16x16x32_bf16 v[140:143], v[200:203], a[44:47], v[140:143]
    v_mfma_f32_16x16x32_bf16 v[140:143], v[204:207], a[60:63], v[140:143]
    buffer_load_dwordx4 v8, s[48:51], s32 offen offset:2112 lds
    v_mfma_f32_16x16x32_bf16 v[108:111], v[204:207], a[56:59], v[108:111]
    v_mfma_f32_16x16x32_bf16 v[108:111], v[200:203], a[40:43], v[108:111]
    v_mfma_f32_16x16x32_bf16 v[76:79], v[200:203], a[36:39], v[76:79]
    buffer_load_dwordx4 v9, s[48:51], s32 offen offset:3168 lds
    v_mfma_f32_16x16x32_bf16 v[76:79], v[204:207], a[52:55], v[76:79]
    v_mfma_f32_16x16x32_bf16 v[44:47], v[204:207], a[48:51], v[44:47]
    v_mfma_f32_16x16x32_bf16 v[44:47], v[200:203], a[32:35], v[44:47]
    s_waitcnt vmcnt(28) lgkmcnt(0)
    v_mfma_f32_16x16x32_bf16 v[16:19], v[144:147], a[64:67], v[16:19]
    s_add_u32 m0, s30, 50688
    s_add_u32 s32, s32, 65536
    v_mfma_f32_16x16x32_bf16 v[16:19], v[148:151], a[80:83], v[16:19]
    s_add_u32 s33, s33, 163840
    v_mfma_f32_16x16x32_bf16 v[48:51], v[148:151], a[84:87], v[48:51]
    ds_read_b64_tr_b16 v[176:177], v4 offset:16896
    ds_read_b64_tr_b16 v[178:179], v4 offset:17408
    v_mfma_f32_16x16x32_bf16 v[48:51], v[144:147], a[68:71], v[48:51]
    buffer_load_dwordx4 a[16:19], v10, s[68:71], s33 offen sc1
    v_mfma_f32_16x16x32_bf16 v[80:83], v[144:147], a[72:75], v[80:83]
    ds_read_b64_tr_b16 v[180:181], v4 offset:33792
    ds_read_b64_tr_b16 v[182:183], v4 offset:34304
    v_mfma_f32_16x16x32_bf16 v[80:83], v[148:151], a[88:91], v[80:83]
    v_mfma_f32_16x16x32_bf16 v[112:115], v[148:151], a[92:95], v[112:115]
    ds_read_b64_tr_b16 v[184:185], v4 offset:16904
    ds_read_b64_tr_b16 v[186:187], v4 offset:17416
    v_mfma_f32_16x16x32_bf16 v[112:115], v[144:147], a[76:79], v[112:115]
    buffer_load_dwordx4 a[20:23], v11, s[68:71], s33 offen sc1
    v_mfma_f32_16x16x32_bf16 v[116:119], v[152:155], a[76:79], v[116:119]
    ds_read_b64_tr_b16 v[188:189], v4 offset:33800
    ds_read_b64_tr_b16 v[190:191], v4 offset:34312
    v_mfma_f32_16x16x32_bf16 v[116:119], v[156:159], a[92:95], v[116:119]
    v_mfma_f32_16x16x32_bf16 v[84:87], v[156:159], a[88:91], v[84:87]
    ds_read_b64_tr_b16 v[192:193], v4 offset:16960
    ds_read_b64_tr_b16 v[194:195], v4 offset:17472
    v_mfma_f32_16x16x32_bf16 v[84:87], v[152:155], a[72:75], v[84:87]
    buffer_load_dwordx4 a[24:27], v252, s[68:71], s33 offen sc1
    v_mfma_f32_16x16x32_bf16 v[52:55], v[152:155], a[68:71], v[52:55]
    ds_read_b64_tr_b16 v[196:197], v4 offset:33856
    ds_read_b64_tr_b16 v[198:199], v4 offset:34368
    v_mfma_f32_16x16x32_bf16 v[52:55], v[156:159], a[84:87], v[52:55]
    v_mfma_f32_16x16x32_bf16 v[20:23], v[156:159], a[80:83], v[20:23]
    ds_read_b64_tr_b16 v[200:201], v4 offset:16968
    ds_read_b64_tr_b16 v[202:203], v4 offset:17480
    v_mfma_f32_16x16x32_bf16 v[20:23], v[152:155], a[64:67], v[20:23]
    buffer_load_dwordx4 a[28:31], v254, s[68:71], s33 offen sc1
    v_mfma_f32_16x16x32_bf16 v[24:27], v[160:163], a[64:67], v[24:27]
    ds_read_b64_tr_b16 v[204:205], v4 offset:33864
    ds_read_b64_tr_b16 v[206:207], v4 offset:34376
    v_mfma_f32_16x16x32_bf16 v[24:27], v[164:167], a[80:83], v[24:27]
    v_mfma_f32_16x16x32_bf16 v[56:59], v[164:167], a[84:87], v[56:59]
    v_mfma_f32_16x16x32_bf16 v[56:59], v[160:163], a[68:71], v[56:59]
    buffer_load_dwordx4 v6, s[48:51], s32 offen offset:0 lds
    v_mfma_f32_16x16x32_bf16 v[88:91], v[160:163], a[72:75], v[88:91]
    v_mfma_f32_16x16x32_bf16 v[88:91], v[164:167], a[88:91], v[88:91]
    v_mfma_f32_16x16x32_bf16 v[120:123], v[164:167], a[92:95], v[120:123]
    buffer_load_dwordx4 v7, s[48:51], s32 offen offset:1056 lds
    v_mfma_f32_16x16x32_bf16 v[120:123], v[160:163], a[76:79], v[120:123]
    v_mfma_f32_16x16x32_bf16 v[124:127], v[168:171], a[76:79], v[124:127]
    v_mfma_f32_16x16x32_bf16 v[124:127], v[172:175], a[92:95], v[124:127]
    buffer_load_dwordx4 v8, s[48:51], s32 offen offset:2112 lds
    v_mfma_f32_16x16x32_bf16 v[92:95], v[172:175], a[88:91], v[92:95]
    v_mfma_f32_16x16x32_bf16 v[92:95], v[168:171], a[72:75], v[92:95]
    v_mfma_f32_16x16x32_bf16 v[60:63], v[168:171], a[68:71], v[60:63]
    buffer_load_dwordx4 v9, s[48:51], s32 offen offset:3168 lds
    v_mfma_f32_16x16x32_bf16 v[60:63], v[172:175], a[84:87], v[60:63]
    v_mfma_f32_16x16x32_bf16 v[28:31], v[172:175], a[80:83], v[28:31]
    v_mfma_f32_16x16x32_bf16 v[28:31], v[168:171], a[64:67], v[28:31]
    s_waitcnt vmcnt(24) lgkmcnt(0)
    s_barrier
    v_mfma_f32_16x16x32_bf16 v[32:35], v[176:179], a[64:67], v[32:35]
    s_add_u32 m0, s30, 67584
    s_add_u32 s32, s32, 65536
    v_mfma_f32_16x16x32_bf16 v[32:35], v[180:183], a[80:83], v[32:35]
    s_add_u32 s33, s33, 163840
    v_mfma_f32_16x16x32_bf16 v[64:67], v[180:183], a[84:87], v[64:67]
    ds_read_b64_tr_b16 v[144:145], v3 offset:50688
    ds_read_b64_tr_b16 v[146:147], v3 offset:51200
    v_mfma_f32_16x16x32_bf16 v[64:67], v[176:179], a[68:71], v[64:67]
    buffer_load_dwordx4 a[32:35], v10, s[68:71], s33 offen sc1
    v_mfma_f32_16x16x32_bf16 v[96:99], v[176:179], a[72:75], v[96:99]
    ds_read_b64_tr_b16 v[148:149], v1 offset:0
    ds_read_b64_tr_b16 v[150:151], v1 offset:512
    v_mfma_f32_16x16x32_bf16 v[96:99], v[180:183], a[88:91], v[96:99]
    v_mfma_f32_16x16x32_bf16 v[128:131], v[180:183], a[92:95], v[128:131]
    ds_read_b64_tr_b16 v[152:153], v3 offset:50696
    ds_read_b64_tr_b16 v[154:155], v3 offset:51208
    v_mfma_f32_16x16x32_bf16 v[128:131], v[176:179], a[76:79], v[128:131]
    buffer_load_dwordx4 a[36:39], v11, s[68:71], s33 offen sc1
    v_mfma_f32_16x16x32_bf16 v[132:135], v[184:187], a[76:79], v[132:135]
    ds_read_b64_tr_b16 v[156:157], v1 offset:8
    ds_read_b64_tr_b16 v[158:159], v1 offset:520
    v_mfma_f32_16x16x32_bf16 v[132:135], v[188:191], a[92:95], v[132:135]
    v_mfma_f32_16x16x32_bf16 v[100:103], v[188:191], a[88:91], v[100:103]
    ds_read_b64_tr_b16 v[160:161], v3 offset:50752
    ds_read_b64_tr_b16 v[162:163], v3 offset:51264
    v_mfma_f32_16x16x32_bf16 v[100:103], v[184:187], a[72:75], v[100:103]
    buffer_load_dwordx4 a[40:43], v252, s[68:71], s33 offen sc1
    v_mfma_f32_16x16x32_bf16 v[68:71], v[184:187], a[68:71], v[68:71]
    ds_read_b64_tr_b16 v[164:165], v1 offset:64
    ds_read_b64_tr_b16 v[166:167], v1 offset:576
    v_mfma_f32_16x16x32_bf16 v[68:71], v[188:191], a[84:87], v[68:71]
    v_mfma_f32_16x16x32_bf16 v[36:39], v[188:191], a[80:83], v[36:39]
    ds_read_b64_tr_b16 v[168:169], v3 offset:50760
    ds_read_b64_tr_b16 v[170:171], v3 offset:51272
    v_mfma_f32_16x16x32_bf16 v[36:39], v[184:187], a[64:67], v[36:39]
    buffer_load_dwordx4 a[44:47], v254, s[68:71], s33 offen sc1
    v_mfma_f32_16x16x32_bf16 v[40:43], v[192:195], a[64:67], v[40:43]
    ds_read_b64_tr_b16 v[172:173], v1 offset:72
    ds_read_b64_tr_b16 v[174:175], v1 offset:584
    v_mfma_f32_16x16x32_bf16 v[40:43], v[196:199], a[80:83], v[40:43]
    v_mfma_f32_16x16x32_bf16 v[72:75], v[196:199], a[84:87], v[72:75]
    v_mfma_f32_16x16x32_bf16 v[72:75], v[192:195], a[68:71], v[72:75]
    buffer_load_dwordx4 v6, s[48:51], s32 offen offset:0 lds
    v_mfma_f32_16x16x32_bf16 v[104:107], v[192:195], a[72:75], v[104:107]
    v_mfma_f32_16x16x32_bf16 v[104:107], v[196:199], a[88:91], v[104:107]
    v_mfma_f32_16x16x32_bf16 v[136:139], v[196:199], a[92:95], v[136:139]
    buffer_load_dwordx4 v7, s[48:51], s32 offen offset:1056 lds
    v_mfma_f32_16x16x32_bf16 v[136:139], v[192:195], a[76:79], v[136:139]
    v_mfma_f32_16x16x32_bf16 v[140:143], v[200:203], a[76:79], v[140:143]
    v_mfma_f32_16x16x32_bf16 v[140:143], v[204:207], a[92:95], v[140:143]
    buffer_load_dwordx4 v8, s[48:51], s32 offen offset:2112 lds
    v_mfma_f32_16x16x32_bf16 v[108:111], v[204:207], a[88:91], v[108:111]
    v_mfma_f32_16x16x32_bf16 v[108:111], v[200:203], a[72:75], v[108:111]
    v_mfma_f32_16x16x32_bf16 v[76:79], v[200:203], a[68:71], v[76:79]
    buffer_load_dwordx4 v9, s[48:51], s32 offen offset:3168 lds
    v_mfma_f32_16x16x32_bf16 v[76:79], v[204:207], a[84:87], v[76:79]
    v_mfma_f32_16x16x32_bf16 v[44:47], v[204:207], a[80:83], v[44:47]
    v_mfma_f32_16x16x32_bf16 v[44:47], v[200:203], a[64:67], v[44:47]
    s_waitcnt vmcnt(28) lgkmcnt(0)
    v_mfma_f32_16x16x32_bf16 v[16:19], v[144:147], a[96:99], v[16:19]
    s_add_u32 m0, s30, 84480
    s_add_u32 s32, s32, 65536
    v_mfma_f32_16x16x32_bf16 v[16:19], v[148:151], a[112:115], v[16:19]
    s_add_u32 s33, s33, 163840
    v_mfma_f32_16x16x32_bf16 v[48:51], v[148:151], a[116:119], v[48:51]
    ds_read_b64_tr_b16 v[176:177], v4 offset:50688
    ds_read_b64_tr_b16 v[178:179], v4 offset:51200
    v_mfma_f32_16x16x32_bf16 v[48:51], v[144:147], a[100:103], v[48:51]
    buffer_load_dwordx4 a[48:51], v10, s[68:71], s33 offen sc1
    v_mfma_f32_16x16x32_bf16 v[80:83], v[144:147], a[104:107], v[80:83]
    ds_read_b64_tr_b16 v[180:181], v2 offset:0
    ds_read_b64_tr_b16 v[182:183], v2 offset:512
    v_mfma_f32_16x16x32_bf16 v[80:83], v[148:151], a[120:123], v[80:83]
    v_mfma_f32_16x16x32_bf16 v[112:115], v[148:151], a[124:127], v[112:115]
    ds_read_b64_tr_b16 v[184:185], v4 offset:50696
    ds_read_b64_tr_b16 v[186:187], v4 offset:51208
    v_mfma_f32_16x16x32_bf16 v[112:115], v[144:147], a[108:111], v[112:115]
    buffer_load_dwordx4 a[52:55], v11, s[68:71], s33 offen sc1
    v_mfma_f32_16x16x32_bf16 v[116:119], v[152:155], a[108:111], v[116:119]
    ds_read_b64_tr_b16 v[188:189], v2 offset:8
    ds_read_b64_tr_b16 v[190:191], v2 offset:520
    v_mfma_f32_16x16x32_bf16 v[116:119], v[156:159], a[124:127], v[116:119]
    v_mfma_f32_16x16x32_bf16 v[84:87], v[156:159], a[120:123], v[84:87]
    ds_read_b64_tr_b16 v[192:193], v4 offset:50752
    ds_read_b64_tr_b16 v[194:195], v4 offset:51264
    v_mfma_f32_16x16x32_bf16 v[84:87], v[152:155], a[104:107], v[84:87]
    buffer_load_dwordx4 a[56:59], v252, s[68:71], s33 offen sc1
    v_mfma_f32_16x16x32_bf16 v[52:55], v[152:155], a[100:103], v[52:55]
    ds_read_b64_tr_b16 v[196:197], v2 offset:64
    ds_read_b64_tr_b16 v[198:199], v2 offset:576
    v_mfma_f32_16x16x32_bf16 v[52:55], v[156:159], a[116:119], v[52:55]
    v_mfma_f32_16x16x32_bf16 v[20:23], v[156:159], a[112:115], v[20:23]
    ds_read_b64_tr_b16 v[200:201], v4 offset:50760
    ds_read_b64_tr_b16 v[202:203], v4 offset:51272
    v_mfma_f32_16x16x32_bf16 v[20:23], v[152:155], a[96:99], v[20:23]
    buffer_load_dwordx4 a[60:63], v254, s[68:71], s33 offen sc1
    v_mfma_f32_16x16x32_bf16 v[24:27], v[160:163], a[96:99], v[24:27]
    ds_read_b64_tr_b16 v[204:205], v2 offset:72
    ds_read_b64_tr_b16 v[206:207], v2 offset:584
    v_mfma_f32_16x16x32_bf16 v[24:27], v[164:167], a[112:115], v[24:27]
    v_mfma_f32_16x16x32_bf16 v[56:59], v[164:167], a[116:119], v[56:59]
    v_mfma_f32_16x16x32_bf16 v[56:59], v[160:163], a[100:103], v[56:59]
    buffer_load_dwordx4 v6, s[48:51], s32 offen offset:0 lds
    v_mfma_f32_16x16x32_bf16 v[88:91], v[160:163], a[104:107], v[88:91]
    v_mfma_f32_16x16x32_bf16 v[88:91], v[164:167], a[120:123], v[88:91]
    v_mfma_f32_16x16x32_bf16 v[120:123], v[164:167], a[124:127], v[120:123]
    buffer_load_dwordx4 v7, s[48:51], s32 offen offset:1056 lds
    v_mfma_f32_16x16x32_bf16 v[120:123], v[160:163], a[108:111], v[120:123]
    v_mfma_f32_16x16x32_bf16 v[124:127], v[168:171], a[108:111], v[124:127]
    v_mfma_f32_16x16x32_bf16 v[124:127], v[172:175], a[124:127], v[124:127]
    buffer_load_dwordx4 v8, s[48:51], s32 offen offset:2112 lds
    v_mfma_f32_16x16x32_bf16 v[92:95], v[172:175], a[120:123], v[92:95]
    v_mfma_f32_16x16x32_bf16 v[92:95], v[168:171], a[104:107], v[92:95]
    v_mfma_f32_16x16x32_bf16 v[60:63], v[168:171], a[100:103], v[60:63]
    buffer_load_dwordx4 v9, s[48:51], s32 offen offset:3168 lds
    v_mfma_f32_16x16x32_bf16 v[60:63], v[172:175], a[116:119], v[60:63]
    v_mfma_f32_16x16x32_bf16 v[28:31], v[172:175], a[112:115], v[28:31]
    v_mfma_f32_16x16x32_bf16 v[28:31], v[168:171], a[96:99], v[28:31]
    s_waitcnt vmcnt(24) lgkmcnt(0)
    s_barrier
    v_mfma_f32_16x16x32_bf16 v[32:35], v[176:179], a[96:99], v[32:35]
    s_add_u32 m0, s30, 101376
    s_add_u32 s32, s32, 65536
    v_mfma_f32_16x16x32_bf16 v[32:35], v[180:183], a[112:115], v[32:35]
    s_add_u32 s33, s33, 163840
    v_mfma_f32_16x16x32_bf16 v[64:67], v[180:183], a[116:119], v[64:67]
    ds_read_b64_tr_b16 v[144:145], v1 offset:16896
    ds_read_b64_tr_b16 v[146:147], v1 offset:17408
    v_mfma_f32_16x16x32_bf16 v[64:67], v[176:179], a[100:103], v[64:67]
    buffer_load_dwordx4 a[64:67], v10, s[68:71], s33 offen sc1
    v_mfma_f32_16x16x32_bf16 v[96:99], v[176:179], a[104:107], v[96:99]
    ds_read_b64_tr_b16 v[148:149], v1 offset:33792
    ds_read_b64_tr_b16 v[150:151], v1 offset:34304
    v_mfma_f32_16x16x32_bf16 v[96:99], v[180:183], a[120:123], v[96:99]
    v_mfma_f32_16x16x32_bf16 v[128:131], v[180:183], a[124:127], v[128:131]
    ds_read_b64_tr_b16 v[152:153], v1 offset:16904
    ds_read_b64_tr_b16 v[154:155], v1 offset:17416
    v_mfma_f32_16x16x32_bf16 v[128:131], v[176:179], a[108:111], v[128:131]
    buffer_load_dwordx4 a[68:71], v11, s[68:71], s33 offen sc1
    v_mfma_f32_16x16x32_bf16 v[132:135], v[184:187], a[108:111], v[132:135]
    ds_read_b64_tr_b16 v[156:157], v1 offset:33800
    ds_read_b64_tr_b16 v[158:159], v1 offset:34312
    v_mfma_f32_16x16x32_bf16 v[132:135], v[188:191], a[124:127], v[132:135]
    v_mfma_f32_16x16x32_bf16 v[100:103], v[188:191], a[120:123], v[100:103]
    ds_read_b64_tr_b16 v[160:161], v1 offset:16960
    ds_read_b64_tr_b16 v[162:163], v1 offset:17472
    v_mfma_f32_16x16x32_bf16 v[100:103], v[184:187], a[104:107], v[100:103]
    buffer_load_dwordx4 a[72:75], v252, s[68:71], s33 offen sc1
    v_mfma_f32_16x16x32_bf16 v[68:71], v[184:187], a[100:103], v[68:71]
    ds_read_b64_tr_b16 v[164:165], v1 offset:33856
    ds_read_b64_tr_b16 v[166:167], v1 offset:34368
    v_mfma_f32_16x16x32_bf16 v[68:71], v[188:191], a[116:119], v[68:71]
    v_mfma_f32_16x16x32_bf16 v[36:39], v[188:191], a[112:115], v[36:39]
    ds_read_b64_tr_b16 v[168:169], v1 offset:16968
    ds_read_b64_tr_b16 v[170:171], v1 offset:17480
    v_mfma_f32_16x16x32_bf16 v[36:39], v[184:187], a[96:99], v[36:39]
    buffer_load_dwordx4 a[76:79], v254, s[68:71], s33 offen sc1
    v_mfma_f32_16x16x32_bf16 v[40:43], v[192:195], a[96:99], v[40:43]
    ds_read_b64_tr_b16 v[172:173], v1 offset:33864
    ds_read_b64_tr_b16 v[174:175], v1 offset:34376
    v_mfma_f32_16x16x32_bf16 v[40:43], v[196:199], a[112:115], v[40:43]
    v_mfma_f32_16x16x32_bf16 v[72:75], v[196:199], a[116:119], v[72:75]
    v_mfma_f32_16x16x32_bf16 v[72:75], v[192:195], a[100:103], v[72:75]
    buffer_load_dwordx4 v6, s[48:51], s32 offen offset:0 lds
    v_mfma_f32_16x16x32_bf16 v[104:107], v[192:195], a[104:107], v[104:107]
    v_mfma_f32_16x16x32_bf16 v[104:107], v[196:199], a[120:123], v[104:107]
    v_mfma_f32_16x16x32_bf16 v[136:139], v[196:199], a[124:127], v[136:139]
    buffer_load_dwordx4 v7, s[48:51], s32 offen offset:1056 lds
    v_mfma_f32_16x16x32_bf16 v[136:139], v[192:195], a[108:111], v[136:139]
    v_mfma_f32_16x16x32_bf16 v[140:143], v[200:203], a[108:111], v[140:143]
    v_mfma_f32_16x16x32_bf16 v[140:143], v[204:207], a[124:127], v[140:143]
    buffer_load_dwordx4 v8, s[48:51], s32 offen offset:2112 lds
    v_mfma_f32_16x16x32_bf16 v[108:111], v[204:207], a[120:123], v[108:111]
    v_mfma_f32_16x16x32_bf16 v[108:111], v[200:203], a[104:107], v[108:111]
    v_mfma_f32_16x16x32_bf16 v[76:79], v[200:203], a[100:103], v[76:79]
    buffer_load_dwordx4 v9, s[48:51], s32 offen offset:3168 lds
    v_mfma_f32_16x16x32_bf16 v[76:79], v[204:207], a[116:119], v[76:79]
    v_mfma_f32_16x16x32_bf16 v[44:47], v[204:207], a[112:115], v[44:47]
    v_mfma_f32_16x16x32_bf16 v[44:47], v[200:203], a[96:99], v[44:47]
    s_waitcnt vmcnt(28) lgkmcnt(0)
    v_mfma_f32_16x16x32_bf16 v[16:19], v[144:147], a[0:3], v[16:19]
    s_add_u32 m0, s30, 118272
    s_add_u32 s32, s32, 65536
    v_mfma_f32_16x16x32_bf16 v[16:19], v[148:151], a[16:19], v[16:19]
    s_add_u32 s33, s33, 163840
    v_mfma_f32_16x16x32_bf16 v[48:51], v[148:151], a[20:23], v[48:51]
    ds_read_b64_tr_b16 v[176:177], v2 offset:16896
    ds_read_b64_tr_b16 v[178:179], v2 offset:17408
    v_mfma_f32_16x16x32_bf16 v[48:51], v[144:147], a[4:7], v[48:51]
    buffer_load_dwordx4 a[80:83], v10, s[68:71], s33 offen sc1
    v_mfma_f32_16x16x32_bf16 v[80:83], v[144:147], a[8:11], v[80:83]
    ds_read_b64_tr_b16 v[180:181], v2 offset:33792
    ds_read_b64_tr_b16 v[182:183], v2 offset:34304
    v_mfma_f32_16x16x32_bf16 v[80:83], v[148:151], a[24:27], v[80:83]
    v_mfma_f32_16x16x32_bf16 v[112:115], v[148:151], a[28:31], v[112:115]
    ds_read_b64_tr_b16 v[184:185], v2 offset:16904
    ds_read_b64_tr_b16 v[186:187], v2 offset:17416
    v_mfma_f32_16x16x32_bf16 v[112:115], v[144:147], a[12:15], v[112:115]
    buffer_load_dwordx4 a[84:87], v11, s[68:71], s33 offen sc1
    v_mfma_f32_16x16x32_bf16 v[116:119], v[152:155], a[12:15], v[116:119]
    ds_read_b64_tr_b16 v[188:189], v2 offset:33800
    ds_read_b64_tr_b16 v[190:191], v2 offset:34312
    v_mfma_f32_16x16x32_bf16 v[116:119], v[156:159], a[28:31], v[116:119]
    v_mfma_f32_16x16x32_bf16 v[84:87], v[156:159], a[24:27], v[84:87]
    ds_read_b64_tr_b16 v[192:193], v2 offset:16960
    ds_read_b64_tr_b16 v[194:195], v2 offset:17472
    v_mfma_f32_16x16x32_bf16 v[84:87], v[152:155], a[8:11], v[84:87]
    buffer_load_dwordx4 a[88:91], v252, s[68:71], s33 offen sc1
    v_mfma_f32_16x16x32_bf16 v[52:55], v[152:155], a[4:7], v[52:55]
    ds_read_b64_tr_b16 v[196:197], v2 offset:33856
    ds_read_b64_tr_b16 v[198:199], v2 offset:34368
    v_mfma_f32_16x16x32_bf16 v[52:55], v[156:159], a[20:23], v[52:55]
    v_mfma_f32_16x16x32_bf16 v[20:23], v[156:159], a[16:19], v[20:23]
    ds_read_b64_tr_b16 v[200:201], v2 offset:16968
    ds_read_b64_tr_b16 v[202:203], v2 offset:17480
    v_mfma_f32_16x16x32_bf16 v[20:23], v[152:155], a[0:3], v[20:23]
    buffer_load_dwordx4 a[92:95], v254, s[68:71], s33 offen sc1
    v_mfma_f32_16x16x32_bf16 v[24:27], v[160:163], a[0:3], v[24:27]
    ds_read_b64_tr_b16 v[204:205], v2 offset:33864
    ds_read_b64_tr_b16 v[206:207], v2 offset:34376
    v_mfma_f32_16x16x32_bf16 v[24:27], v[164:167], a[16:19], v[24:27]
    v_mfma_f32_16x16x32_bf16 v[56:59], v[164:167], a[20:23], v[56:59]
    v_mfma_f32_16x16x32_bf16 v[56:59], v[160:163], a[4:7], v[56:59]
    buffer_load_dwordx4 v6, s[48:51], s32 offen offset:0 lds
    v_mfma_f32_16x16x32_bf16 v[88:91], v[160:163], a[8:11], v[88:91]
    v_mfma_f32_16x16x32_bf16 v[88:91], v[164:167], a[24:27], v[88:91]
    v_mfma_f32_16x16x32_bf16 v[120:123], v[164:167], a[28:31], v[120:123]
    buffer_load_dwordx4 v7, s[48:51], s32 offen offset:1056 lds
    v_mfma_f32_16x16x32_bf16 v[120:123], v[160:163], a[12:15], v[120:123]
    v_mfma_f32_16x16x32_bf16 v[124:127], v[168:171], a[12:15], v[124:127]
    v_mfma_f32_16x16x32_bf16 v[124:127], v[172:175], a[28:31], v[124:127]
    buffer_load_dwordx4 v8, s[48:51], s32 offen offset:2112 lds
    v_mfma_f32_16x16x32_bf16 v[92:95], v[172:175], a[24:27], v[92:95]
    v_mfma_f32_16x16x32_bf16 v[92:95], v[168:171], a[8:11], v[92:95]
    v_mfma_f32_16x16x32_bf16 v[60:63], v[168:171], a[4:7], v[60:63]
    buffer_load_dwordx4 v9, s[48:51], s32 offen offset:3168 lds
    v_mfma_f32_16x16x32_bf16 v[60:63], v[172:175], a[20:23], v[60:63]
    buffer_load_dwordx2 v[224:225], v229, s[52:55], s22 offen
    v_mfma_f32_16x16x32_bf16 v[28:31], v[172:175], a[16:19], v[28:31]
    v_mfma_f32_16x16x32_bf16 v[28:31], v[168:171], a[0:3], v[28:31]
    buffer_load_dwordx4 v[232:235], v14, s[68:71], s36 offen sc1
    s_waitcnt vmcnt(26) lgkmcnt(0)
    s_barrier
    v_mfma_f32_16x16x32_bf16 v[32:35], v[176:179], a[0:3], v[32:35]
    s_add_u32 m0, s30, 0
    s_add_u32 s32, s32, 65536
    v_mfma_f32_16x16x32_bf16 v[32:35], v[180:183], a[16:19], v[32:35]
    s_add_u32 s33, s33, 163840
    v_mfma_f32_16x16x32_bf16 v[64:67], v[180:183], a[20:23], v[64:67]
    ds_read_b64_tr_b16 v[144:145], v1 offset:50688
    ds_read_b64_tr_b16 v[146:147], v1 offset:51200
    v_mfma_f32_16x16x32_bf16 v[64:67], v[176:179], a[4:7], v[64:67]
    buffer_load_dwordx4 a[96:99], v10, s[68:71], s33 offen sc1
    v_mfma_f32_16x16x32_bf16 v[96:99], v[176:179], a[8:11], v[96:99]
    ds_read_b64_tr_b16 v[148:149], v3 offset:0
    ds_read_b64_tr_b16 v[150:151], v3 offset:512
    v_mfma_f32_16x16x32_bf16 v[96:99], v[180:183], a[24:27], v[96:99]
    v_mfma_f32_16x16x32_bf16 v[128:131], v[180:183], a[28:31], v[128:131]
    ds_read_b64_tr_b16 v[152:153], v1 offset:50696
    ds_read_b64_tr_b16 v[154:155], v1 offset:51208
    v_mfma_f32_16x16x32_bf16 v[128:131], v[176:179], a[12:15], v[128:131]
    buffer_load_dwordx4 a[100:103], v11, s[68:71], s33 offen sc1
    v_mfma_f32_16x16x32_bf16 v[132:135], v[184:187], a[12:15], v[132:135]
    ds_read_b64_tr_b16 v[156:157], v3 offset:8
    ds_read_b64_tr_b16 v[158:159], v3 offset:520
    v_mfma_f32_16x16x32_bf16 v[132:135], v[188:191], a[28:31], v[132:135]
    v_mfma_f32_16x16x32_bf16 v[100:103], v[188:191], a[24:27], v[100:103]
    ds_read_b64_tr_b16 v[160:161], v1 offset:50752
    ds_read_b64_tr_b16 v[162:163], v1 offset:51264
    v_mfma_f32_16x16x32_bf16 v[100:103], v[184:187], a[8:11], v[100:103]
    buffer_load_dwordx4 a[104:107], v252, s[68:71], s33 offen sc1
    v_mfma_f32_16x16x32_bf16 v[68:71], v[184:187], a[4:7], v[68:71]
    ds_read_b64_tr_b16 v[164:165], v3 offset:64
    ds_read_b64_tr_b16 v[166:167], v3 offset:576
    v_mfma_f32_16x16x32_bf16 v[68:71], v[188:191], a[20:23], v[68:71]
    v_mfma_f32_16x16x32_bf16 v[36:39], v[188:191], a[16:19], v[36:39]
    ds_read_b64_tr_b16 v[168:169], v1 offset:50760
    ds_read_b64_tr_b16 v[170:171], v1 offset:51272
    v_mfma_f32_16x16x32_bf16 v[36:39], v[184:187], a[0:3], v[36:39]
    buffer_load_dwordx4 a[108:111], v254, s[68:71], s33 offen sc1
    v_mfma_f32_16x16x32_bf16 v[40:43], v[192:195], a[0:3], v[40:43]
    ds_read_b64_tr_b16 v[172:173], v3 offset:72
    ds_read_b64_tr_b16 v[174:175], v3 offset:584
    v_mfma_f32_16x16x32_bf16 v[40:43], v[196:199], a[16:19], v[40:43]
    v_mfma_f32_16x16x32_bf16 v[72:75], v[196:199], a[20:23], v[72:75]
    v_mfma_f32_16x16x32_bf16 v[72:75], v[192:195], a[4:7], v[72:75]
    buffer_load_dwordx4 v6, s[48:51], s32 offen offset:0 lds
    v_mfma_f32_16x16x32_bf16 v[104:107], v[192:195], a[8:11], v[104:107]
    v_mfma_f32_16x16x32_bf16 v[104:107], v[196:199], a[24:27], v[104:107]
    v_mfma_f32_16x16x32_bf16 v[136:139], v[196:199], a[28:31], v[136:139]
    buffer_load_dwordx4 v7, s[48:51], s32 offen offset:1056 lds
    v_mfma_f32_16x16x32_bf16 v[136:139], v[192:195], a[12:15], v[136:139]
    v_mfma_f32_16x16x32_bf16 v[140:143], v[200:203], a[12:15], v[140:143]
    v_mfma_f32_16x16x32_bf16 v[140:143], v[204:207], a[28:31], v[140:143]
    buffer_load_dwordx4 v8, s[48:51], s32 offen offset:2112 lds
    v_mfma_f32_16x16x32_bf16 v[108:111], v[204:207], a[24:27], v[108:111]
    v_mfma_f32_16x16x32_bf16 v[108:111], v[200:203], a[8:11], v[108:111]
    v_mfma_f32_16x16x32_bf16 v[76:79], v[200:203], a[4:7], v[76:79]
    buffer_load_dwordx4 v9, s[48:51], s32 offen offset:3168 lds
    v_mfma_f32_16x16x32_bf16 v[76:79], v[204:207], a[20:23], v[76:79]
    buffer_load_dwordx4 v[236:239], v14, s[68:71], s37 offen sc1
    v_mfma_f32_16x16x32_bf16 v[44:47], v[204:207], a[16:19], v[44:47]
    v_mfma_f32_16x16x32_bf16 v[44:47], v[200:203], a[0:3], v[44:47]
    buffer_load_dwordx4 v[240:243], v14, s[68:71], s38 offen sc1
    s_waitcnt vmcnt(32) lgkmcnt(0)
    v_mfma_f32_16x16x32_bf16 v[16:19], v[144:147], a[32:35], v[16:19]
    s_add_u32 m0, s30, 16896
    s_add_u32 s32, s32, 65536
    v_mfma_f32_16x16x32_bf16 v[16:19], v[148:151], a[48:51], v[16:19]
    s_add_u32 s33, s33, 163840
    v_mfma_f32_16x16x32_bf16 v[48:51], v[148:151], a[52:55], v[48:51]
    ds_read_b64_tr_b16 v[176:177], v2 offset:50688
    ds_read_b64_tr_b16 v[178:179], v2 offset:51200
    v_mfma_f32_16x16x32_bf16 v[48:51], v[144:147], a[36:39], v[48:51]
    buffer_load_dwordx4 a[112:115], v10, s[68:71], s33 offen sc1
    v_mfma_f32_16x16x32_bf16 v[80:83], v[144:147], a[40:43], v[80:83]
    ds_read_b64_tr_b16 v[180:181], v4 offset:0
    ds_read_b64_tr_b16 v[182:183], v4 offset:512
    v_mfma_f32_16x16x32_bf16 v[80:83], v[148:151], a[56:59], v[80:83]
    v_mfma_f32_16x16x32_bf16 v[112:115], v[148:151], a[60:63], v[112:115]
    ds_read_b64_tr_b16 v[184:185], v2 offset:50696
    ds_read_b64_tr_b16 v[186:187], v2 offset:51208
    v_mfma_f32_16x16x32_bf16 v[112:115], v[144:147], a[44:47], v[112:115]
    buffer_load_dwordx4 a[116:119], v11, s[68:71], s33 offen sc1
    v_mfma_f32_16x16x32_bf16 v[116:119], v[152:155], a[44:47], v[116:119]
    ds_read_b64_tr_b16 v[188:189], v4 offset:8
    ds_read_b64_tr_b16 v[190:191], v4 offset:520
    v_mfma_f32_16x16x32_bf16 v[116:119], v[156:159], a[60:63], v[116:119]
    v_mfma_f32_16x16x32_bf16 v[84:87], v[156:159], a[56:59], v[84:87]
    ds_read_b64_tr_b16 v[192:193], v2 offset:50752
    ds_read_b64_tr_b16 v[194:195], v2 offset:51264
    v_mfma_f32_16x16x32_bf16 v[84:87], v[152:155], a[40:43], v[84:87]
    buffer_load_dwordx4 a[120:123], v252, s[68:71], s33 offen sc1
    v_mfma_f32_16x16x32_bf16 v[52:55], v[152:155], a[36:39], v[52:55]
    ds_read_b64_tr_b16 v[196:197], v4 offset:64
    ds_read_b64_tr_b16 v[198:199], v4 offset:576
    v_mfma_f32_16x16x32_bf16 v[52:55], v[156:159], a[52:55], v[52:55]
    v_mfma_f32_16x16x32_bf16 v[20:23], v[156:159], a[48:51], v[20:23]
    ds_read_b64_tr_b16 v[200:201], v2 offset:50760
    ds_read_b64_tr_b16 v[202:203], v2 offset:51272
    v_mfma_f32_16x16x32_bf16 v[20:23], v[152:155], a[32:35], v[20:23]
    buffer_load_dwordx4 a[124:127], v254, s[68:71], s33 offen sc1
    v_mfma_f32_16x16x32_bf16 v[24:27], v[160:163], a[32:35], v[24:27]
    ds_read_b64_tr_b16 v[204:205], v4 offset:72
    ds_read_b64_tr_b16 v[206:207], v4 offset:584
    v_mfma_f32_16x16x32_bf16 v[24:27], v[164:167], a[48:51], v[24:27]
    v_mfma_f32_16x16x32_bf16 v[56:59], v[164:167], a[52:55], v[56:59]
    v_mfma_f32_16x16x32_bf16 v[56:59], v[160:163], a[36:39], v[56:59]
    buffer_load_dwordx4 v6, s[48:51], s32 offen offset:0 lds
    v_mfma_f32_16x16x32_bf16 v[88:91], v[160:163], a[40:43], v[88:91]
    v_mfma_f32_16x16x32_bf16 v[88:91], v[164:167], a[56:59], v[88:91]
    v_mfma_f32_16x16x32_bf16 v[120:123], v[164:167], a[60:63], v[120:123]
    buffer_load_dwordx4 v7, s[48:51], s32 offen offset:1056 lds
    v_mfma_f32_16x16x32_bf16 v[120:123], v[160:163], a[44:47], v[120:123]
    v_mfma_f32_16x16x32_bf16 v[124:127], v[168:171], a[44:47], v[124:127]
    v_mfma_f32_16x16x32_bf16 v[124:127], v[172:175], a[60:63], v[124:127]
    buffer_load_dwordx4 v8, s[48:51], s32 offen offset:2112 lds
    v_mfma_f32_16x16x32_bf16 v[92:95], v[172:175], a[56:59], v[92:95]
    v_mfma_f32_16x16x32_bf16 v[92:95], v[168:171], a[40:43], v[92:95]
    v_mfma_f32_16x16x32_bf16 v[60:63], v[168:171], a[36:39], v[60:63]
    buffer_load_dwordx4 v9, s[48:51], s32 offen offset:3168 lds
    v_mfma_f32_16x16x32_bf16 v[60:63], v[172:175], a[52:55], v[60:63]
    buffer_load_dwordx4 v[244:247], v14, s[68:71], s39 offen sc1
    v_mfma_f32_16x16x32_bf16 v[28:31], v[172:175], a[48:51], v[28:31]
    buffer_load_dword v249, off, s[68:71], s78 sc1
    v_mfma_f32_16x16x32_bf16 v[28:31], v[168:171], a[32:35], v[28:31]
    buffer_load_dword v248, off, s[68:71], s23 sc1
    s_waitcnt vmcnt(31) lgkmcnt(0)
    s_barrier
    v_mfma_f32_16x16x32_bf16 v[32:35], v[176:179], a[32:35], v[32:35]
    s_add_u32 m0, s30, 33792
    s_add_u32 s32, s32, 65536
    v_mfma_f32_16x16x32_bf16 v[32:35], v[180:183], a[48:51], v[32:35]
    s_add_u32 s33, s33, 163840
    v_mfma_f32_16x16x32_bf16 v[64:67], v[180:183], a[52:55], v[64:67]
    ds_read_b64_tr_b16 v[144:145], v3 offset:16896
    ds_read_b64_tr_b16 v[146:147], v3 offset:17408
    v_mfma_f32_16x16x32_bf16 v[64:67], v[176:179], a[36:39], v[64:67]
    buffer_load_dwordx4 a[0:3], v10, s[68:71], s33 offen sc1
    v_mfma_f32_16x16x32_bf16 v[96:99], v[176:179], a[40:43], v[96:99]
    ds_read_b64_tr_b16 v[148:149], v3 offset:33792
    ds_read_b64_tr_b16 v[150:151], v3 offset:34304
    v_mfma_f32_16x16x32_bf16 v[96:99], v[180:183], a[56:59], v[96:99]
    v_mfma_f32_16x16x32_bf16 v[128:131], v[180:183], a[60:63], v[128:131]
    ds_read_b64_tr_b16 v[152:153], v3 offset:16904
    ds_read_b64_tr_b16 v[154:155], v3 offset:17416
    v_mfma_f32_16x16x32_bf16 v[128:131], v[176:179], a[44:47], v[128:131]
    buffer_load_dwordx4 a[4:7], v11, s[68:71], s33 offen sc1
    v_mfma_f32_16x16x32_bf16 v[132:135], v[184:187], a[44:47], v[132:135]
    ds_read_b64_tr_b16 v[156:157], v3 offset:33800
    ds_read_b64_tr_b16 v[158:159], v3 offset:34312
    v_mfma_f32_16x16x32_bf16 v[132:135], v[188:191], a[60:63], v[132:135]
    v_mfma_f32_16x16x32_bf16 v[100:103], v[188:191], a[56:59], v[100:103]
    ds_read_b64_tr_b16 v[160:161], v3 offset:16960
    ds_read_b64_tr_b16 v[162:163], v3 offset:17472
    v_mfma_f32_16x16x32_bf16 v[100:103], v[184:187], a[40:43], v[100:103]
    buffer_load_dwordx4 a[8:11], v252, s[68:71], s33 offen sc1
    v_mfma_f32_16x16x32_bf16 v[68:71], v[184:187], a[36:39], v[68:71]
    ds_read_b64_tr_b16 v[164:165], v3 offset:33856
    ds_read_b64_tr_b16 v[166:167], v3 offset:34368
    v_mfma_f32_16x16x32_bf16 v[68:71], v[188:191], a[52:55], v[68:71]
    v_mfma_f32_16x16x32_bf16 v[36:39], v[188:191], a[48:51], v[36:39]
    ds_read_b64_tr_b16 v[168:169], v3 offset:16968
    ds_read_b64_tr_b16 v[170:171], v3 offset:17480
    v_mfma_f32_16x16x32_bf16 v[36:39], v[184:187], a[32:35], v[36:39]
    buffer_load_dwordx4 a[12:15], v254, s[68:71], s33 offen sc1
    v_mfma_f32_16x16x32_bf16 v[40:43], v[192:195], a[32:35], v[40:43]
    ds_read_b64_tr_b16 v[172:173], v3 offset:33864
    ds_read_b64_tr_b16 v[174:175], v3 offset:34376
    v_mfma_f32_16x16x32_bf16 v[40:43], v[196:199], a[48:51], v[40:43]
    v_mfma_f32_16x16x32_bf16 v[72:75], v[196:199], a[52:55], v[72:75]
    v_mfma_f32_16x16x32_bf16 v[72:75], v[192:195], a[36:39], v[72:75]
    buffer_load_dwordx4 v6, s[48:51], s32 offen offset:0 lds
    v_mfma_f32_16x16x32_bf16 v[104:107], v[192:195], a[40:43], v[104:107]
    v_mfma_f32_16x16x32_bf16 v[104:107], v[196:199], a[56:59], v[104:107]
    v_mfma_f32_16x16x32_bf16 v[136:139], v[196:199], a[60:63], v[136:139]
    buffer_load_dwordx4 v7, s[48:51], s32 offen offset:1056 lds
    v_mfma_f32_16x16x32_bf16 v[136:139], v[192:195], a[44:47], v[136:139]
    v_mfma_f32_16x16x32_bf16 v[140:143], v[200:203], a[44:47], v[140:143]
    v_mfma_f32_16x16x32_bf16 v[140:143], v[204:207], a[60:63], v[140:143]
    buffer_load_dwordx4 v8, s[48:51], s32 offen offset:2112 lds
    v_mfma_f32_16x16x32_bf16 v[108:111], v[204:207], a[56:59], v[108:111]
    v_mfma_f32_16x16x32_bf16 v[108:111], v[200:203], a[40:43], v[108:111]
    v_mfma_f32_16x16x32_bf16 v[76:79], v[200:203], a[36:39], v[76:79]
    buffer_load_dwordx4 v9, s[48:51], s32 offen offset:3168 lds
    v_mfma_f32_16x16x32_bf16 v[76:79], v[204:207], a[52:55], v[76:79]
    v_mfma_f32_16x16x32_bf16 v[44:47], v[204:207], a[48:51], v[44:47]
    v_mfma_f32_16x16x32_bf16 v[44:47], v[200:203], a[32:35], v[44:47]
    s_bitcmp1_b32 s2, 0
    s_cbranch_scc0 attn_tk
    s_waitcnt vmcnt(35) lgkmcnt(0)
    v_mfma_f32_16x16x32_bf16 v[16:19], v[144:147], a[64:67], v[16:19]
    s_add_u32 m0, s30, 50688
    s_add_u32 s32, s32, 65536
    v_mfma_f32_16x16x32_bf16 v[16:19], v[148:151], a[80:83], v[16:19]
    s_add_u32 s33, s33, 163840
    v_mfma_f32_16x16x32_bf16 v[48:51], v[148:151], a[84:87], v[48:51]
    ds_read_b64_tr_b16 v[176:177], v4 offset:16896
    ds_read_b64_tr_b16 v[178:179], v4 offset:17408
    v_mfma_f32_16x16x32_bf16 v[48:51], v[144:147], a[68:71], v[48:51]
    buffer_load_dwordx4 a[16:19], v10, s[68:71], s33 offen sc1
    v_mfma_f32_16x16x32_bf16 v[80:83], v[144:147], a[72:75], v[80:83]
    ds_read_b64_tr_b16 v[180:181], v4 offset:33792
    ds_read_b64_tr_b16 v[182:183], v4 offset:34304
    v_mfma_f32_16x16x32_bf16 v[80:83], v[148:151], a[88:91], v[80:83]
    v_mfma_f32_16x16x32_bf16 v[112:115], v[148:151], a[92:95], v[112:115]
    ds_read_b64_tr_b16 v[184:185], v4 offset:16904
    ds_read_b64_tr_b16 v[186:187], v4 offset:17416
    v_mfma_f32_16x16x32_bf16 v[112:115], v[144:147], a[76:79], v[112:115]
    buffer_load_dwordx4 a[20:23], v11, s[68:71], s33 offen sc1
    v_mfma_f32_16x16x32_bf16 v[116:119], v[152:155], a[76:79], v[116:119]
    ds_read_b64_tr_b16 v[188:189], v4 offset:33800
    ds_read_b64_tr_b16 v[190:191], v4 offset:34312
    v_mfma_f32_16x16x32_bf16 v[116:119], v[156:159], a[92:95], v[116:119]
    v_mfma_f32_16x16x32_bf16 v[84:87], v[156:159], a[88:91], v[84:87]
    ds_read_b64_tr_b16 v[192:193], v4 offset:16960
    ds_read_b64_tr_b16 v[194:195], v4 offset:17472
    v_mfma_f32_16x16x32_bf16 v[84:87], v[152:155], a[72:75], v[84:87]
    buffer_load_dwordx4 a[24:27], v252, s[68:71], s33 offen sc1
    v_mfma_f32_16x16x32_bf16 v[52:55], v[152:155], a[68:71], v[52:55]
    ds_read_b64_tr_b16 v[196:197], v4 offset:33856
    ds_read_b64_tr_b16 v[198:199], v4 offset:34368
    v_mfma_f32_16x16x32_bf16 v[52:55], v[156:159], a[84:87], v[52:55]
    v_mfma_f32_16x16x32_bf16 v[20:23], v[156:159], a[80:83], v[20:23]
    ds_read_b64_tr_b16 v[200:201], v4 offset:16968
    ds_read_b64_tr_b16 v[202:203], v4 offset:17480
    v_mfma_f32_16x16x32_bf16 v[20:23], v[152:155], a[64:67], v[20:23]
    buffer_load_dwordx4 a[28:31], v254, s[68:71], s33 offen sc1
    v_mfma_f32_16x16x32_bf16 v[24:27], v[160:163], a[64:67], v[24:27]
    ds_read_b64_tr_b16 v[204:205], v4 offset:33864
    ds_read_b64_tr_b16 v[206:207], v4 offset:34376
    v_mfma_f32_16x16x32_bf16 v[24:27], v[164:167], a[80:83], v[24:27]
    v_mfma_f32_16x16x32_bf16 v[56:59], v[164:167], a[84:87], v[56:59]
    v_mfma_f32_16x16x32_bf16 v[56:59], v[160:163], a[68:71], v[56:59]
    buffer_load_dwordx4 v6, s[48:51], s32 offen offset:0 lds
    v_mfma_f32_16x16x32_bf16 v[88:91], v[160:163], a[72:75], v[88:91]
    v_mfma_f32_16x16x32_bf16 v[88:91], v[164:167], a[88:91], v[88:91]
    v_mfma_f32_16x16x32_bf16 v[120:123], v[164:167], a[92:95], v[120:123]
    buffer_load_dwordx4 v7, s[48:51], s32 offen offset:1056 lds
    v_mfma_f32_16x16x32_bf16 v[120:123], v[160:163], a[76:79], v[120:123]
    v_mfma_f32_16x16x32_bf16 v[124:127], v[168:171], a[76:79], v[124:127]
    v_mfma_f32_16x16x32_bf16 v[124:127], v[172:175], a[92:95], v[124:127]
    buffer_load_dwordx4 v8, s[48:51], s32 offen offset:2112 lds
    v_mfma_f32_16x16x32_bf16 v[92:95], v[172:175], a[88:91], v[92:95]
    v_mfma_f32_16x16x32_bf16 v[92:95], v[168:171], a[72:75], v[92:95]
    v_mfma_f32_16x16x32_bf16 v[60:63], v[168:171], a[68:71], v[60:63]
    buffer_load_dwordx4 v9, s[48:51], s32 offen offset:3168 lds
    v_mfma_f32_16x16x32_bf16 v[60:63], v[172:175], a[84:87], v[60:63]
    v_mfma_f32_16x16x32_bf16 v[28:31], v[172:175], a[80:83], v[28:31]
    v_mfma_f32_16x16x32_bf16 v[28:31], v[168:171], a[64:67], v[28:31]
    s_waitcnt vmcnt(16)
    v_xor_b32 v248, s85, v248
    v_xor_b32 v249, s85, v249
    v_or_b32 v248, v248, v249
    v_cmp_ne_u32 vcc, 0, v248
    v_mov_b32 v249, 0
    s_nop 0
    v_cndmask_b32 v248, 0, -1, vcc
    v_max_u32 v250, v232, v233
    v_max_u32 v251, v234, v235
    v_max3_u32 v250, v250, v236, v237
    v_max3_u32 v251, v251, v238, v239
    v_max3_u32 v250, v250, v240, v241
    v_max3_u32 v251, v251, v242, v243
    v_max3_u32 v250, v250, v244, v245
    v_max3_u32 v251, v251, v246, v247
    v_max3_u32 v250, v250, v248, v249
    v_max_u32 v250, v250, v251
    v_cmp_eq_u32 vcc, -1, v250
    s_mov_b32 s4, 0
    s_nop 0
    s_cbranch_vccnz attn_p6_r
attn_p6_k:
    s_waitcnt vmcnt(29) lgkmcnt(0)
    s_barrier
    v_mfma_f32_16x16x32_bf16 v[32:35], v[176:179], a[64:67], v[32:35]
    s_add_u32 m0, s30, 67584
    s_add_u32 s32, s32, 65536
    v_mfma_f32_16x16x32_bf16 v[32:35], v[180:183], a[80:83], v[32:35]
    s_add_u32 s33, s33, 163840
    v_mfma_f32_16x16x32_bf16 v[64:67], v[180:183], a[84:87], v[64:67]
    ds_read_b64_tr_b16 v[144:145], v3 offset:50688
    ds_read_b64_tr_b16 v[146:147], v3 offset:51200
    v_mfma_f32_16x16x32_bf16 v[64:67], v[176:179], a[68:71], v[64:67]
    buffer_load_dwordx4 a[32:35], v10, s[68:71], s33 offen sc1
    v_mfma_f32_16x16x32_bf16 v[96:99], v[176:179], a[72:75], v[96:99]
    ds_read_b64_tr_b16 v[148:149], v1 offset:0
    ds_read_b64_tr_b16 v[150:151], v1 offset:512
    v_mfma_f32_16x16x32_bf16 v[96:99], v[180:183], a[88:91], v[96:99]
    v_add_f32 v232, v232, v236
    v_add_f32 v233, v233, v237
    v_mfma_f32_16x16x32_bf16 v[128:131], v[180:183], a[92:95], v[128:131]
    ds_read_b64_tr_b16 v[152:153], v3 offset:50696
    ds_read_b64_tr_b16 v[154:155], v3 offset:51208
    v_mfma_f32_16x16x32_bf16 v[128:131], v[176:179], a[76:79], v[128:131]
    buffer_load_dwordx4 a[36:39], v11, s[68:71], s33 offen sc1
    v_mfma_f32_16x16x32_bf16 v[132:135], v[184:187], a[76:79], v[132:135]
    ds_read_b64_tr_b16 v[156:157], v1 offset:8
    ds_read_b64_tr_b16 v[158:159], v1 offset:520
    v_mfma_f32_16x16x32_bf16 v[132:135], v[188:191], a[92:95], v[132:135]
    v_add_f32 v234, v234, v238
    v_add_f32 v235, v235, v239
    v_mfma_f32_16x16x32_bf16 v[100:103], v[188:191], a[88:91], v[100:103]
    ds_read_b64_tr_b16 v[160:161], v3 offset:50752
    ds_read_b64_tr_b16 v[162:163], v3 offset:51264
    v_mfma_f32_16x16x32_bf16 v[100:103], v[184:187], a[72:75], v[100:103]
    buffer_load_dwordx4 a[40:43], v252, s[68:71], s33 offen sc1
    v_mfma_f32_16x16x32_bf16 v[68:71], v[184:187], a[68:71], v[68:71]
    ds_read_b64_tr_b16 v[164:165], v1 offset:64
    ds_read_b64_tr_b16 v[166:167], v1 offset:576
    v_mfma_f32_16x16x32_bf16 v[68:71], v[188:191], a[84:87], v[68:71]
    v_add_f32 v240, v240, v244
    v_add_f32 v241, v241, v245
    v_mfma_f32_16x16x32_bf16 v[36:39], v[188:191], a[80:83], v[36:39]
    ds_read_b64_tr_b16 v[168:169], v3 offset:50760
    ds_read_b64_tr_b16 v[170:171], v3 offset:51272
    v_mfma_f32_16x16x32_bf16 v[36:39], v[184:187], a[64:67], v[36:39]
    buffer_load_dwordx4 a[44:47], v254, s[68:71], s33 offen sc1
    v_mfma_f32_16x16x32_bf16 v[40:43], v[192:195], a[64:67], v[40:43]
    ds_read_b64_tr_b16 v[172:173], v1 offset:72
    ds_read_b64_tr_b16 v[174:175], v1 offset:584
    v_mfma_f32_16x16x32_bf16 v[40:43], v[196:199], a[80:83], v[40:43]
    v_add_f32 v242, v242, v246
    v_add_f32 v243, v243, v247
    v_mfma_f32_16x16x32_bf16 v[72:75], v[196:199], a[84:87], v[72:75]
    v_add_f32 v232, v232, v240
    v_add_f32 v233, v233, v241
    v_mfma_f32_16x16x32_bf16 v[72:75], v[192:195], a[68:71], v[72:75]
    buffer_load_dwordx4 v6, s[48:51], s32 offen offset:0 lds
    v_mfma_f32_16x16x32_bf16 v[104:107], v[192:195], a[72:75], v[104:107]
    v_add_f32 v234, v234, v242
    v_add_f32 v235, v235, v243
    v_mfma_f32_16x16x32_bf16 v[104:107], v[196:199], a[88:91], v[104:107]
    v_mov_b32 v236, v232
    v_mov_b32 v237, v233
    v_mfma_f32_16x16x32_bf16 v[136:139], v[196:199], a[92:95], v[136:139]
    buffer_load_dwordx4 v7, s[48:51], s32 offen offset:1056 lds
    v_mfma_f32_16x16x32_bf16 v[136:139], v[192:195], a[76:79], v[136:139]
    v_mov_b32 v238, v234
    v_mov_b32 v239, v235
    v_mfma_f32_16x16x32_bf16 v[140:143], v[200:203], a[76:79], v[140:143]
    v_permlane16_swap_b32 v232, v236
    v_permlane16_swap_b32 v233, v237
    v_mfma_f32_16x16x32_bf16 v[140:143], v[204:207], a[92:95], v[140:143]
    buffer_load_dwordx4 v8, s[48:51], s32 offen offset:2112 lds
    v_mfma_f32_16x16x32_bf16 v[108:111], v[204:207], a[88:91], v[108:111]
    v_permlane16_swap_b32 v234, v238
    v_permlane16_swap_b32 v235, v239
    v_mfma_f32_16x16x32_bf16 v[108:111], v[200:203], a[72:75], v[108:111]
    v_add_f32 v232, v232, v236
    v_add_f32 v233, v233, v237
    v_mfma_f32_16x16x32_bf16 v[76:79], v[200:203], a[68:71], v[76:79]
    buffer_load_dwordx4 v9, s[48:51], s32 offen offset:3168 lds
    v_mfma_f32_16x16x32_bf16 v[76:79], v[204:207], a[84:87], v[76:79]
    v_add_f32 v234, v234, v238
    v_add_f32 v235, v235, v239
    v_mfma_f32_16x16x32_bf16 v[44:47], v[204:207], a[80:83], v[44:47]
    v_mov_b32 v236, v232
    v_mov_b32 v237, v233
    v_mfma_f32_16x16x32_bf16 v[44:47], v[200:203], a[64:67], v[44:47]
    v_mov_b32 v238, v234
    v_mov_b32 v239, v235
    s_waitcnt vmcnt(31) lgkmcnt(0)
    v_mfma_f32_16x16x32_bf16 v[16:19], v[144:147], a[96:99], v[16:19]
    s_add_u32 m0, s30, 84480
    s_add_u32 s32, s32, 65536
    v_mfma_f32_16x16x32_bf16 v[16:19], v[148:151], a[112:115], v[16:19]
    s_add_u32 s33, s33, 163840
    v_mfma_f32_16x16x32_bf16 v[48:51], v[148:151], a[116:119], v[48:51]
    ds_read_b64_tr_b16 v[176:177], v4 offset:50688
    ds_read_b64_tr_b16 v[178:179], v4 offset:51200
    v_mfma_f32_16x16x32_bf16 v[48:51], v[144:147], a[100:103], v[48:51]
    buffer_load_dwordx4 a[48:51], v10, s[68:71], s33 offen sc1
    v_mfma_f32_16x16x32_bf16 v[80:83], v[144:147], a[104:107], v[80:83]
    ds_read_b64_tr_b16 v[180:181], v2 offset:0
    ds_read_b64_tr_b16 v[182:183], v2 offset:512
    v_mfma_f32_16x16x32_bf16 v[80:83], v[148:151], a[120:123], v[80:83]
    v_permlane32_swap_b32 v232, v236
    v_permlane32_swap_b32 v233, v237
    v_mfma_f32_16x16x32_bf16 v[112:115], v[148:151], a[124:127], v[112:115]
    ds_read_b64_tr_b16 v[184:185], v4 offset:50696
    ds_read_b64_tr_b16 v[186:187], v4 offset:51208
    v_mfma_f32_16x16x32_bf16 v[112:115], v[144:147], a[108:111], v[112:115]
    buffer_load_dwordx4 a[52:55], v11, s[68:71], s33 offen sc1
    v_mfma_f32_16x16x32_bf16 v[116:119], v[152:155], a[108:111], v[116:119]
    ds_read_b64_tr_b16 v[188:189], v2 offset:8
    ds_read_b64_tr_b16 v[190:191], v2 offset:520
    v_mfma_f32_16x16x32_bf16 v[116:119], v[156:159], a[124:127], v[116:119]
    v_permlane32_swap_b32 v234, v238
    v_permlane32_swap_b32 v235, v239
    v_mfma_f32_16x16x32_bf16 v[84:87], v[156:159], a[120:123], v[84:87]
    ds_read_b64_tr_b16 v[192:193], v4 offset:50752
    ds_read_b64_tr_b16 v[194:195], v4 offset:51264
    v_mfma_f32_16x16x32_bf16 v[84:87], v[152:155], a[104:107], v[84:87]
    buffer_load_dwordx4 a[56:59], v252, s[68:71], s33 offen sc1
    v_mfma_f32_16x16x32_bf16 v[52:55], v[152:155], a[100:103], v[52:55]
    ds_read_b64_tr_b16 v[196:197], v2 offset:64
    ds_read_b64_tr_b16 v[198:199], v2 offset:576
    v_mfma_f32_16x16x32_bf16 v[52:55], v[156:159], a[116:119], v[52:55]
    v_add_f32 v232, v232, v236
    v_add_f32 v233, v233, v237
    v_mfma_f32_16x16x32_bf16 v[20:23], v[156:159], a[112:115], v[20:23]
    ds_read_b64_tr_b16 v[200:201], v4 offset:50760
    ds_read_b64_tr_b16 v[202:203], v4 offset:51272
    v_mfma_f32_16x16x32_bf16 v[20:23], v[152:155], a[96:99], v[20:23]
    buffer_load_dwordx4 a[60:63], v254, s[68:71], s33 offen sc1
    v_mfma_f32_16x16x32_bf16 v[24:27], v[160:163], a[96:99], v[24:27]
    ds_read_b64_tr_b16 v[204:205], v2 offset:72
    ds_read_b64_tr_b16 v[206:207], v2 offset:584
    v_mfma_f32_16x16x32_bf16 v[24:27], v[164:167], a[112:115], v[24:27]
    v_add_f32 v234, v234, v238
    v_add_f32 v235, v235, v239
    v_mfma_f32_16x16x32_bf16 v[56:59], v[164:167], a[116:119], v[56:59]
    v_cvt_pk_bf16_f32 v236, v232, v233
    v_cvt_pk_bf16_f32 v237, v234, v235
    v_mfma_f32_16x16x32_bf16 v[56:59], v[160:163], a[100:103], v[56:59]
    buffer_load_dwordx4 v6, s[48:51], s32 offen offset:0 lds
    v_mfma_f32_16x16x32_bf16 v[88:91], v[160:163], a[104:107], v[88:91]
    v_lshlrev_b32 v232, 16, v236
    v_and_b32 v233, 0xffff0000, v236
    v_mfma_f32_16x16x32_bf16 v[88:91], v[164:167], a[120:123], v[88:91]
    v_lshlrev_b32 v234, 16, v237
    v_and_b32 v235, 0xffff0000, v237
    v_mfma_f32_16x16x32_bf16 v[120:123], v[164:167], a[124:127], v[120:123]
    buffer_load_dwordx4 v7, s[48:51], s32 offen offset:1056 lds
    v_mfma_f32_16x16x32_bf16 v[120:123], v[160:163], a[108:111], v[120:123]
    s_cmp_eq_u32 s28, 2
    s_cselect_b32 s36, 1.0, 0
    v_mfma_f32_16x16x32_bf16 v[124:127], v[168:171], a[108:111], v[124:127]
    v_add_f32 v232, s36, v232
    v_add_f32 v233, s36, v233
    v_mfma_f32_16x16x32_bf16 v[124:127], v[172:175], a[124:127], v[124:127]
    buffer_load_dwordx4 v8, s[48:51], s32 offen offset:2112 lds
    v_mfma_f32_16x16x32_bf16 v[92:95], v[172:175], a[120:123], v[92:95]
    v_add_f32 v234, s36, v234
    v_add_f32 v235, s36, v235
    v_mfma_f32_16x16x32_bf16 v[92:95], v[168:171], a[104:107], v[92:95]
    v_cvt_pk_bf16_f32 v236, v232, v233
    v_cvt_pk_bf16_f32 v237, v234, v235
    v_mfma_f32_16x16x32_bf16 v[60:63], v[168:171], a[100:103], v[60:63]
    buffer_load_dwordx4 v9, s[48:51], s32 offen offset:3168 lds
    v_mfma_f32_16x16x32_bf16 v[60:63], v[172:175], a[116:119], v[60:63]
    v_lshlrev_b32 v232, 16, v236
    v_and_b32 v233, 0xffff0000, v236
    v_mfma_f32_16x16x32_bf16 v[28:31], v[172:175], a[112:115], v[28:31]
    v_lshlrev_b32 v234, 16, v237
    v_and_b32 v235, 0xffff0000, v237
    v_mfma_f32_16x16x32_bf16 v[28:31], v[168:171], a[96:99], v[28:31]
    s_lshl_b32 s36, s28, 8
    s_add_u32 s36, s36, 135168
    s_waitcnt vmcnt(24) lgkmcnt(0)
    s_barrier
    v_mfma_f32_16x16x32_bf16 v[32:35], v[176:179], a[96:99], v[32:35]
    s_add_u32 m0, s30, 101376
    s_add_u32 s32, s32, 65536
    v_mfma_f32_16x16x32_bf16 v[32:35], v[180:183], a[112:115], v[32:35]
    s_add_u32 s33, s33, 163840
    v_mfma_f32_16x16x32_bf16 v[64:67], v[180:183], a[116:119], v[64:67]
    ds_read_b64_tr_b16 v[144:145], v2 offset:16896
    ds_read_b64_tr_b16 v[146:147], v2 offset:17408
    v_mfma_f32_16x16x32_bf16 v[64:67], v[176:179], a[100:103], v[64:67]
    buffer_load_dwordx4 a[64:67], v10, s[68:71], s33 offen sc1
    v_mfma_f32_16x16x32_bf16 v[96:99], v[176:179], a[104:107], v[96:99]
    ds_read_b64_tr_b16 v[148:149], v2 offset:33792
    ds_read_b64_tr_b16 v[150:151], v2 offset:34304
    v_mfma_f32_16x16x32_bf16 v[96:99], v[180:183], a[120:123], v[96:99]
    v_lshl_add_u32 v230, v15, 4, s36
    ds_write_b128 v230, v[232:235]
    v_mfma_f32_16x16x32_bf16 v[128:131], v[180:183], a[124:127], v[128:131]
    ds_read_b64_tr_b16 v[152:153], v2 offset:16904
    ds_read_b64_tr_b16 v[154:155], v2 offset:17416
    v_mfma_f32_16x16x32_bf16 v[128:131], v[176:179], a[108:111], v[128:131]
    buffer_load_dwordx4 a[68:71], v11, s[68:71], s33 offen sc1
    v_mfma_f32_16x16x32_bf16 v[132:135], v[184:187], a[108:111], v[132:135]
    ds_read_b64_tr_b16 v[156:157], v2 offset:33800
    ds_read_b64_tr_b16 v[158:159], v2 offset:34312
    v_mfma_f32_16x16x32_bf16 v[132:135], v[188:191], a[124:127], v[132:135]
    v_lshlrev_b32 v236, 16, v224
    v_and_b32 v237, 0xffff0000, v224
    v_mfma_f32_16x16x32_bf16 v[100:103], v[188:191], a[120:123], v[100:103]
    ds_read_b64_tr_b16 v[160:161], v2 offset:16960
    ds_read_b64_tr_b16 v[162:163], v2 offset:17472
    v_mfma_f32_16x16x32_bf16 v[100:103], v[184:187], a[104:107], v[100:103]
    buffer_load_dwordx4 a[72:75], v252, s[68:71], s33 offen sc1
    v_mfma_f32_16x16x32_bf16 v[68:71], v[184:187], a[100:103], v[68:71]
    ds_read_b64_tr_b16 v[164:165], v2 offset:33856
    ds_read_b64_tr_b16 v[166:167], v2 offset:34368
    v_mfma_f32_16x16x32_bf16 v[68:71], v[188:191], a[116:119], v[68:71]
    v_lshlrev_b32 v238, 16, v225
    v_and_b32 v239, 0xffff0000, v225
    v_mfma_f32_16x16x32_bf16 v[36:39], v[188:191], a[112:115], v[36:39]
    ds_read_b64_tr_b16 v[168:169], v2 offset:16968
    ds_read_b64_tr_b16 v[170:171], v2 offset:17480
    v_mfma_f32_16x16x32_bf16 v[36:39], v[184:187], a[96:99], v[36:39]
    buffer_load_dwordx4 a[76:79], v254, s[68:71], s33 offen sc1
    v_mfma_f32_16x16x32_bf16 v[40:43], v[192:195], a[96:99], v[40:43]
    ds_read_b64_tr_b16 v[172:173], v2 offset:33864
    ds_read_b64_tr_b16 v[174:175], v2 offset:34376
    v_mfma_f32_16x16x32_bf16 v[40:43], v[196:199], a[112:115], v[40:43]
    v_mul_f32 v236, v232, v236
    v_mul_f32 v237, v233, v237
    v_mfma_f32_16x16x32_bf16 v[72:75], v[196:199], a[116:119], v[72:75]
    v_mul_f32 v238, v234, v238
    v_mul_f32 v239, v235, v239
    v_mfma_f32_16x16x32_bf16 v[72:75], v[192:195], a[100:103], v[72:75]
    buffer_load_dwordx4 v6, s[48:51], s32 offen offset:0 lds
    v_mfma_f32_16x16x32_bf16 v[104:107], v[192:195], a[104:107], v[104:107]
    ds_write_b128 v230, v[236:239] offset:1024
    v_add_f32 v240, v236, v237
    v_mfma_f32_16x16x32_bf16 v[104:107], v[196:199], a[120:123], v[104:107]
    v_add_f32 v241, v238, v239
    v_add_f32 v240, v240, v241
    v_mfma_f32_16x16x32_bf16 v[136:139], v[196:199], a[124:127], v[136:139]
    buffer_load_dwordx4 v7, s[48:51], s32 offen offset:1056 lds
    v_mfma_f32_16x16x32_bf16 v[136:139], v[192:195], a[108:111], v[136:139]
    s_nop 1
    v_add_f32_dpp v240, v240, v240 row_ror:8 row_mask:0xf bank_mask:0xf
    v_mfma_f32_16x16x32_bf16 v[140:143], v[200:203], a[108:111], v[140:143]
    s_nop 1
    v_add_f32_dpp v240, v240, v240 row_ror:4 row_mask:0xf bank_mask:0xf
    v_mfma_f32_16x16x32_bf16 v[140:143], v[204:207], a[124:127], v[140:143]
    buffer_load_dwordx4 v8, s[48:51], s32 offen offset:2112 lds
    v_mfma_f32_16x16x32_bf16 v[108:111], v[204:207], a[120:123], v[108:111]
    s_nop 1
    v_add_f32_dpp v240, v240, v240 row_ror:2 row_mask:0xf bank_mask:0xf
    v_mfma_f32_16x16x32_bf16 v[108:111], v[200:203], a[104:107], v[108:111]
    s_nop 1
    v_add_f32_dpp v240, v240, v240 row_ror:1 row_mask:0xf bank_mask:0xf
    v_mfma_f32_16x16x32_bf16 v[76:79], v[200:203], a[100:103], v[76:79]
    buffer_load_dwordx4 v9, s[48:51], s32 offen offset:3168 lds
    v_mfma_f32_16x16x32_bf16 v[76:79], v[204:207], a[116:119], v[76:79]
    v_mul_f32 v240, 1048576000, v240
    ds_write_b32 v230, v240 offset:2048
    v_mfma_f32_16x16x32_bf16 v[44:47], v[204:207], a[112:115], v[44:47]
    v_mfma_f32_16x16x32_bf16 v[44:47], v[200:203], a[96:99], v[44:47]
    s_waitcnt vmcnt(16) lgkmcnt(0)
    s_barrier
    v_mfma_f32_16x16x32_bf16 v[32:35], v[144:147], a[0:3], v[32:35]
    v_mfma_f32_16x16x32_bf16 v[32:35], v[148:151], a[16:19], v[32:35]
    s_add_u32 s33, s33, 163840
    v_mfma_f32_16x16x32_bf16 v[64:67], v[148:151], a[20:23], v[64:67]
    ds_read_b64_tr_b16 v[176:177], v2 offset:50688
    ds_read_b64_tr_b16 v[178:179], v2 offset:51200
    v_mfma_f32_16x16x32_bf16 v[64:67], v[144:147], a[4:7], v[64:67]
    buffer_load_dwordx4 a[80:83], v10, s[68:71], s33 offen sc1
    v_mfma_f32_16x16x32_bf16 v[96:99], v[144:147], a[8:11], v[96:99]
    ds_read_b64_tr_b16 v[180:181], v4 offset:0
    ds_read_b64_tr_b16 v[182:183], v4 offset:512
    v_mfma_f32_16x16x32_bf16 v[96:99], v[148:151], a[24:27], v[96:99]
    v_mfma_f32_16x16x32_bf16 v[128:131], v[148:151], a[28:31], v[128:131]
    ds_read_b64_tr_b16 v[184:185], v2 offset:50696
    ds_read_b64_tr_b16 v[186:187], v2 offset:51208
    v_mfma_f32_16x16x32_bf16 v[128:131], v[144:147], a[12:15], v[128:131]
    buffer_load_dwordx4 a[84:87], v11, s[68:71], s33 offen sc1
    v_mfma_f32_16x16x32_bf16 v[132:135], v[152:155], a[12:15], v[132:135]
    ds_read_b64_tr_b16 v[188:189], v4 offset:8
    ds_read_b64_tr_b16 v[190:191], v4 offset:520
    v_mfma_f32_16x16x32_bf16 v[132:135], v[156:159], a[28:31], v[132:135]
    v_mfma_f32_16x16x32_bf16 v[100:103], v[156:159], a[24:27], v[100:103]
    ds_read_b64_tr_b16 v[192:193], v2 offset:50752
    ds_read_b64_tr_b16 v[194:195], v2 offset:51264
    v_mfma_f32_16x16x32_bf16 v[100:103], v[152:155], a[8:11], v[100:103]
    buffer_load_dwordx4 a[88:91], v252, s[68:71], s33 offen sc1
    v_mfma_f32_16x16x32_bf16 v[68:71], v[152:155], a[4:7], v[68:71]
    ds_read_b64_tr_b16 v[196:197], v4 offset:64
    ds_read_b64_tr_b16 v[198:199], v4 offset:576
    v_mfma_f32_16x16x32_bf16 v[68:71], v[156:159], a[20:23], v[68:71]
    v_mfma_f32_16x16x32_bf16 v[36:39], v[156:159], a[16:19], v[36:39]
    ds_read_b64_tr_b16 v[200:201], v2 offset:50760
    ds_read_b64_tr_b16 v[202:203], v2 offset:51272
    v_mfma_f32_16x16x32_bf16 v[36:39], v[152:155], a[0:3], v[36:39]
    buffer_load_dwordx4 a[92:95], v254, s[68:71], s33 offen sc1
    v_mfma_f32_16x16x32_bf16 v[40:43], v[160:163], a[0:3], v[40:43]
    ds_read_b64_tr_b16 v[204:205], v4 offset:72
    ds_read_b64_tr_b16 v[206:207], v4 offset:584
    v_mfma_f32_16x16x32_bf16 v[40:43], v[164:167], a[16:19], v[40:43]
    s_and_b32 s36, s28, 1
    s_lshl_b32 s36, s36, 13
    v_mfma_f32_16x16x32_bf16 v[72:75], v[164:167], a[20:23], v[72:75]
    s_cmp_ge_u32 s28, 2
    s_cselect_b32 s37, 4294849024, 0
    v_mfma_f32_16x16x32_bf16 v[72:75], v[160:163], a[4:7], v[72:75]
    s_add_u32 s37, s37, 118272
    s_sub_u32 s7, 118272, s37
    v_mfma_f32_16x16x32_bf16 v[104:107], v[160:163], a[8:11], v[104:107]
    v_add_u32 v8, s36, v12
    v_add_u32 v7, s37, v8
    v_mfma_f32_16x16x32_bf16 v[104:107], v[164:167], a[24:27], v[104:107]
    v_add_u32 v8, s7, v8
    s_xor_b32 s37, s77, 8192
    v_mfma_f32_16x16x32_bf16 v[136:139], v[164:167], a[28:31], v[136:139]
    v_lshlrev_b32 v9, 1, v5
    v_add_u32 v9, 135168, v9
    v_mfma_f32_16x16x32_bf16 v[136:139], v[160:163], a[12:15], v[136:139]
    v_mov_b32 v6, 137216
    s_lshl_b32 s60, s18, 7
    v_mfma_f32_16x16x32_bf16 v[140:143], v[168:171], a[12:15], v[140:143]
    s_add_u32 s60, s60, 30547968
    s_lshl_b32 s61, s17, 2
    v_mfma_f32_16x16x32_bf16 v[140:143], v[172:175], a[28:31], v[140:143]
    s_add_u32 s61, s61, s60
    v_and_b32 v226, 0, v0
    v_mfma_f32_16x16x32_bf16 v[108:111], v[172:175], a[24:27], v[108:111]
    v_lshlrev_b32 v226, 2, v226
    v_mov_b32 v228, s85
    v_mfma_f32_16x16x32_bf16 v[108:111], v[168:171], a[8:11], v[108:111]
    v_mfma_f32_16x16x32_bf16 v[76:79], v[168:171], a[4:7], v[76:79]
    v_mfma_f32_16x16x32_bf16 v[76:79], v[172:175], a[20:23], v[76:79]
    v_mfma_f32_16x16x32_bf16 v[44:47], v[172:175], a[16:19], v[44:47]
    v_mfma_f32_16x16x32_bf16 v[44:47], v[168:171], a[0:3], v[44:47]
    s_waitcnt vmcnt(4) lgkmcnt(0)
    s_barrier
    v_mfma_f32_16x16x32_bf16 v[32:35], v[176:179], a[32:35], v[32:35]
    v_mfma_f32_16x16x32_bf16 v[32:35], v[180:183], a[48:51], v[32:35]
    buffer_load_dwordx4 v[208:211], v13, s[40:43], s20 offen offset:0
    v_mfma_f32_16x16x32_bf16 v[64:67], v[180:183], a[52:55], v[64:67]
    ds_read_b64_tr_b16 v[144:145], v4 offset:16896
    ds_read_b64_tr_b16 v[146:147], v4 offset:17408
    v_mfma_f32_16x16x32_bf16 v[64:67], v[176:179], a[36:39], v[64:67]
    buffer_load_dwordx4 v[212:215], v13, s[40:43], s20 offen offset:64
    v_mfma_f32_16x16x32_bf16 v[96:99], v[176:179], a[40:43], v[96:99]
    ds_read_b64_tr_b16 v[148:149], v4 offset:33792
    ds_read_b64_tr_b16 v[150:151], v4 offset:34304
    v_mfma_f32_16x16x32_bf16 v[96:99], v[180:183], a[56:59], v[96:99]
    buffer_load_dwordx4 v[216:219], v13, s[40:43], s21 offen offset:0
    v_mfma_f32_16x16x32_bf16 v[128:131], v[180:183], a[60:63], v[128:131]
    ds_read_b64_tr_b16 v[152:153], v4 offset:16904
    ds_read_b64_tr_b16 v[154:155], v4 offset:17416
    v_mfma_f32_16x16x32_bf16 v[128:131], v[176:179], a[44:47], v[128:131]
    buffer_load_dwordx4 v[220:223], v13, s[40:43], s21 offen offset:64
    v_mfma_f32_16x16x32_bf16 v[132:135], v[184:187], a[44:47], v[132:135]
    ds_read_b64_tr_b16 v[156:157], v4 offset:33800
    ds_read_b64_tr_b16 v[158:159], v4 offset:34312
    v_mfma_f32_16x16x32_bf16 v[132:135], v[188:191], a[60:63], v[132:135]
    v_mfma_f32_16x16x32_bf16 v[100:103], v[188:191], a[56:59], v[100:103]
    ds_read_b64_tr_b16 v[160:161], v4 offset:16960
    ds_read_b64_tr_b16 v[162:163], v4 offset:17472
    v_mfma_f32_16x16x32_bf16 v[100:103], v[184:187], a[40:43], v[100:103]
    v_mfma_f32_16x16x32_bf16 v[68:71], v[184:187], a[36:39], v[68:71]
    ds_read_b64_tr_b16 v[164:165], v4 offset:33856
    ds_read_b64_tr_b16 v[166:167], v4 offset:34368
    v_mfma_f32_16x16x32_bf16 v[68:71], v[188:191], a[52:55], v[68:71]
    v_mfma_f32_16x16x32_bf16 v[36:39], v[188:191], a[48:51], v[36:39]
    ds_read_b64_tr_b16 v[168:169], v4 offset:16968
    ds_read_b64_tr_b16 v[170:171], v4 offset:17480
    v_mfma_f32_16x16x32_bf16 v[36:39], v[184:187], a[32:35], v[36:39]
    v_mfma_f32_16x16x32_bf16 v[40:43], v[192:195], a[32:35], v[40:43]
    ds_read_b64_tr_b16 v[172:173], v4 offset:33864
    ds_read_b64_tr_b16 v[174:175], v4 offset:34376
    v_mfma_f32_16x16x32_bf16 v[40:43], v[196:199], a[48:51], v[40:43]
    v_mfma_f32_16x16x32_bf16 v[72:75], v[196:199], a[52:55], v[72:75]
    v_mfma_f32_16x16x32_bf16 v[72:75], v[192:195], a[36:39], v[72:75]
    v_mfma_f32_16x16x32_bf16 v[104:107], v[192:195], a[40:43], v[104:107]
    v_mfma_f32_16x16x32_bf16 v[104:107], v[196:199], a[56:59], v[104:107]
    v_mfma_f32_16x16x32_bf16 v[136:139], v[196:199], a[60:63], v[136:139]
    v_mfma_f32_16x16x32_bf16 v[136:139], v[192:195], a[44:47], v[136:139]
    v_mfma_f32_16x16x32_bf16 v[140:143], v[200:203], a[44:47], v[140:143]
    v_mfma_f32_16x16x32_bf16 v[140:143], v[204:207], a[60:63], v[140:143]
    v_mfma_f32_16x16x32_bf16 v[108:111], v[204:207], a[56:59], v[108:111]
    v_mfma_f32_16x16x32_bf16 v[108:111], v[200:203], a[40:43], v[108:111]
    v_mfma_f32_16x16x32_bf16 v[76:79], v[200:203], a[36:39], v[76:79]
    v_mfma_f32_16x16x32_bf16 v[76:79], v[204:207], a[52:55], v[76:79]
    v_mfma_f32_16x16x32_bf16 v[44:47], v[204:207], a[48:51], v[44:47]
    v_mfma_f32_16x16x32_bf16 v[44:47], v[200:203], a[32:35], v[44:47]
    s_waitcnt vmcnt(4) lgkmcnt(0)
    v_mfma_f32_16x16x32_bf16 v[96:99], v[144:147], a[72:75], v[96:99]
    v_mfma_f32_16x16x32_bf16 v[96:99], v[148:151], a[88:91], v[96:99]
    v_mfma_f32_16x16x32_bf16 v[100:103], v[156:159], a[88:91], v[100:103]
    ds_read_b64_tr_b16 v[176:177], v1 offset:16896
    ds_read_b64_tr_b16 v[178:179], v1 offset:17408
    v_mfma_f32_16x16x32_bf16 v[100:103], v[152:155], a[72:75], v[100:103]
    v_mfma_f32_16x16x32_bf16 v[104:107], v[160:163], a[72:75], v[104:107]
    ds_read_b64_tr_b16 v[180:181], v1 offset:33792
    ds_read_b64_tr_b16 v[182:183], v1 offset:34304
    v_mfma_f32_16x16x32_bf16 v[104:107], v[164:167], a[88:91], v[104:107]
    v_mfma_f32_16x16x32_bf16 v[108:111], v[172:175], a[88:91], v[108:111]
    ds_read_b64_tr_b16 v[184:185], v1 offset:16904
    ds_read_b64_tr_b16 v[186:187], v1 offset:17416
    v_mfma_f32_16x16x32_bf16 v[108:111], v[168:171], a[72:75], v[108:111]
    v_mfma_f32_16x16x32_bf16 v[140:143], v[168:171], a[76:79], v[140:143]
    ds_read_b64_tr_b16 v[188:189], v1 offset:33800
    ds_read_b64_tr_b16 v[190:191], v1 offset:34312
    v_mfma_f32_16x16x32_bf16 v[140:143], v[172:175], a[92:95], v[140:143]
    v_mfma_f32_16x16x32_bf16 v[136:139], v[164:167], a[92:95], v[136:139]
    ds_read_b64_tr_b16 v[192:193], v1 offset:16960
    ds_read_b64_tr_b16 v[194:195], v1 offset:17472
    v_mfma_f32_16x16x32_bf16 v[136:139], v[160:163], a[76:79], v[136:139]
    v_mfma_f32_16x16x32_bf16 v[132:135], v[152:155], a[76:79], v[132:135]
    ds_read_b64_tr_b16 v[196:197], v1 offset:33856
    ds_read_b64_tr_b16 v[198:199], v1 offset:34368
    v_mfma_f32_16x16x32_bf16 v[132:135], v[156:159], a[92:95], v[132:135]
    v_mfma_f32_16x16x32_bf16 v[128:131], v[148:151], a[92:95], v[128:131]
    ds_read_b64_tr_b16 v[200:201], v1 offset:16968
    ds_read_b64_tr_b16 v[202:203], v1 offset:17480
    v_mfma_f32_16x16x32_bf16 v[128:131], v[144:147], a[76:79], v[128:131]
    v_mfma_f32_16x16x32_bf16 v[32:35], v[144:147], a[64:67], v[32:35]
    ds_read_b64_tr_b16 v[204:205], v1 offset:33864
    ds_read_b64_tr_b16 v[206:207], v1 offset:34376
    v_mfma_f32_16x16x32_bf16 v[32:35], v[148:151], a[80:83], v[32:35]
    v_mfma_f32_16x16x32_bf16 v[36:39], v[156:159], a[80:83], v[36:39]
    v_mfma_f32_16x16x32_bf16 v[36:39], v[152:155], a[64:67], v[36:39]
    ds_write_b128 v7, v[96:99] offset:0
    v_mfma_f32_16x16x32_bf16 v[40:43], v[160:163], a[64:67], v[40:43]
    ds_write_b128 v7, v[128:131] offset:4096
    v_mfma_f32_16x16x32_bf16 v[40:43], v[164:167], a[80:83], v[40:43]
    v_mfma_f32_16x16x32_bf16 v[44:47], v[172:175], a[80:83], v[44:47]
    ds_write_b128 v7, v[100:103] offset:1024
    v_mfma_f32_16x16x32_bf16 v[44:47], v[168:171], a[64:67], v[44:47]
    ds_write_b128 v7, v[132:135] offset:5120
    v_mfma_f32_16x16x32_bf16 v[76:79], v[168:171], a[68:71], v[76:79]
    v_mfma_f32_16x16x32_bf16 v[76:79], v[172:175], a[84:87], v[76:79]
    ds_write_b128 v7, v[104:107] offset:2048
    v_mfma_f32_16x16x32_bf16 v[72:75], v[164:167], a[84:87], v[72:75]
    ds_write_b128 v7, v[136:139] offset:6144
    v_mfma_f32_16x16x32_bf16 v[72:75], v[160:163], a[68:71], v[72:75]
    v_mfma_f32_16x16x32_bf16 v[68:71], v[152:155], a[68:71], v[68:71]
    ds_write_b128 v7, v[108:111] offset:3072
    v_mfma_f32_16x16x32_bf16 v[68:71], v[156:159], a[84:87], v[68:71]
    ds_write_b128 v7, v[140:143] offset:7168
    v_mfma_f32_16x16x32_bf16 v[64:67], v[148:151], a[84:87], v[64:67]
    v_mfma_f32_16x16x32_bf16 v[64:67], v[144:147], a[68:71], v[64:67]
    s_waitcnt vmcnt(24) lgkmcnt(0)
    s_barrier
    v_mfma_f32_16x16x32_bf16 v[16:19], v[176:179], a[0:3], v[16:19]
    ds_read_b128 v[96:99], v8 offset:0
    ds_read_b128 v[100:103], v8 offset:1024
    v_mfma_f32_16x16x32_bf16 v[16:19], v[180:183], a[16:19], v[16:19]
    ds_read_b128 v[104:107], v8 offset:2048
    ds_read_b128 v[108:111], v8 offset:3072
    v_mfma_f32_16x16x32_bf16 v[48:51], v[180:183], a[20:23], v[48:51]
    ds_read_b64_tr_b16 v[144:145], v1 offset:50688
    ds_read_b64_tr_b16 v[146:147], v1 offset:51200
    v_mfma_f32_16x16x32_bf16 v[48:51], v[176:179], a[4:7], v[48:51]
    ds_read_b128 v[128:131], v8 offset:4096
    ds_read_b128 v[132:135], v8 offset:5120
    v_mfma_f32_16x16x32_bf16 v[80:83], v[176:179], a[8:11], v[80:83]
    ds_read_b64_tr_b16 v[148:149], v3 offset:0
    ds_read_b64_tr_b16 v[150:151], v3 offset:512
    v_mfma_f32_16x16x32_bf16 v[80:83], v[180:183], a[24:27], v[80:83]
    ds_read_b128 v[136:139], v8 offset:6144
    ds_read_b128 v[140:143], v8 offset:7168
    v_mfma_f32_16x16x32_bf16 v[112:115], v[180:183], a[28:31], v[112:115]
    ds_read_b64_tr_b16 v[152:153], v1 offset:50696
    ds_read_b64_tr_b16 v[154:155], v1 offset:51208
    v_mfma_f32_16x16x32_bf16 v[112:115], v[176:179], a[12:15], v[112:115]
    v_mfma_f32_16x16x32_bf16 v[116:119], v[184:187], a[12:15], v[116:119]
    ds_read_b64_tr_b16 v[156:157], v3 offset:8
    ds_read_b64_tr_b16 v[158:159], v3 offset:520
    v_mfma_f32_16x16x32_bf16 v[116:119], v[188:191], a[28:31], v[116:119]
    s_waitcnt lgkmcnt(4)
    v_mfma_f32_16x16x32_bf16 v[84:87], v[188:191], a[24:27], v[84:87]
    ds_read_b64_tr_b16 v[160:161], v1 offset:50752
    ds_read_b64_tr_b16 v[162:163], v1 offset:51264
    v_mfma_f32_16x16x32_bf16 v[84:87], v[184:187], a[8:11], v[84:87]
    v_add_f32 v32, v32, v96
    v_add_f32 v33, v33, v97
    v_mfma_f32_16x16x32_bf16 v[52:55], v[184:187], a[4:7], v[52:55]
    ds_read_b64_tr_b16 v[164:165], v3 offset:64
    ds_read_b64_tr_b16 v[166:167], v3 offset:576
    v_mfma_f32_16x16x32_bf16 v[52:55], v[188:191], a[20:23], v[52:55]
    v_add_f32 v34, v34, v98
    v_add_f32 v35, v35, v99
    v_mfma_f32_16x16x32_bf16 v[20:23], v[188:191], a[16:19], v[20:23]
    ds_read_b64_tr_b16 v[168:169], v1 offset:50760
    ds_read_b64_tr_b16 v[170:171], v1 offset:51272
    v_mfma_f32_16x16x32_bf16 v[20:23], v[184:187], a[0:3], v[20:23]
    v_add_f32 v36, v36, v100
    v_add_f32 v37, v37, v101
    v_mfma_f32_16x16x32_bf16 v[24:27], v[192:195], a[0:3], v[24:27]
    ds_read_b64_tr_b16 v[172:173], v3 offset:72
    ds_read_b64_tr_b16 v[174:175], v3 offset:584
    v_mfma_f32_16x16x32_bf16 v[24:27], v[196:199], a[16:19], v[24:27]
    v_add_f32 v38, v38, v102
    v_add_f32 v39, v39, v103
    v_mfma_f32_16x16x32_bf16 v[56:59], v[196:199], a[20:23], v[56:59]
    v_add_f32 v40, v40, v104
    v_add_f32 v41, v41, v105
    v_mfma_f32_16x16x32_bf16 v[56:59], v[192:195], a[4:7], v[56:59]
    v_add_f32 v42, v42, v106
    v_add_f32 v43, v43, v107
    v_mfma_f32_16x16x32_bf16 v[88:91], v[192:195], a[8:11], v[88:91]
    v_add_f32 v44, v44, v108
    v_add_f32 v45, v45, v109
    v_mfma_f32_16x16x32_bf16 v[88:91], v[196:199], a[24:27], v[88:91]
    v_add_f32 v46, v46, v110
    v_add_f32 v47, v47, v111
    v_mfma_f32_16x16x32_bf16 v[120:123], v[196:199], a[28:31], v[120:123]
    v_cvt_pk_bf16_f32 v96, v32, v33
    v_cvt_pk_bf16_f32 v97, v34, v35
    v_mfma_f32_16x16x32_bf16 v[120:123], v[192:195], a[12:15], v[120:123]
    v_cvt_pk_bf16_f32 v98, v36, v37
    v_cvt_pk_bf16_f32 v99, v38, v39
    v_mfma_f32_16x16x32_bf16 v[124:127], v[200:203], a[12:15], v[124:127]
    v_cvt_pk_bf16_f32 v100, v40, v41
    v_cvt_pk_bf16_f32 v101, v42, v43
    v_mfma_f32_16x16x32_bf16 v[124:127], v[204:207], a[28:31], v[124:127]
    v_cvt_pk_bf16_f32 v102, v44, v45
    v_cvt_pk_bf16_f32 v103, v46, v47
    v_mfma_f32_16x16x32_bf16 v[92:95], v[204:207], a[24:27], v[92:95]
    buffer_store_dwordx4 v[96:99], v12, s[68:71], s37 offen offset:0 sc1
    buffer_store_dwordx4 v[100:103], v12, s[68:71], s37 offen offset:1024 sc1
    v_mfma_f32_16x16x32_bf16 v[92:95], v[200:203], a[8:11], v[92:95]
    v_add_f32 v64, v64, v128
    v_add_f32 v65, v65, v129
    v_mfma_f32_16x16x32_bf16 v[60:63], v[200:203], a[4:7], v[60:63]
    v_add_f32 v66, v66, v130
    v_add_f32 v67, v67, v131
    v_mfma_f32_16x16x32_bf16 v[60:63], v[204:207], a[20:23], v[60:63]
    v_add_f32 v68, v68, v132
    v_add_f32 v69, v69, v133
    v_mfma_f32_16x16x32_bf16 v[28:31], v[204:207], a[16:19], v[28:31]
    v_add_f32 v70, v70, v134
    v_add_f32 v71, v71, v135
    v_mfma_f32_16x16x32_bf16 v[28:31], v[200:203], a[0:3], v[28:31]
    v_add_f32 v72, v72, v136
    v_add_f32 v73, v73, v137
    s_waitcnt vmcnt(10) lgkmcnt(0)
    v_mfma_f32_16x16x32_bf16 v[16:19], v[144:147], a[32:35], v[16:19]
    v_add_f32 v74, v74, v138
    v_add_f32 v75, v75, v139
    v_mfma_f32_16x16x32_bf16 v[16:19], v[148:151], a[48:51], v[16:19]
    v_add_f32 v76, v76, v140
    v_add_f32 v77, v77, v141
    v_mfma_f32_16x16x32_bf16 v[48:51], v[148:151], a[52:55], v[48:51]
    ds_read_b64_tr_b16 v[176:177], v3 offset:16896
    ds_read_b64_tr_b16 v[178:179], v3 offset:17408
    v_mfma_f32_16x16x32_bf16 v[48:51], v[144:147], a[36:39], v[48:51]
    v_add_f32 v78, v78, v142
    v_add_f32 v79, v79, v143
    v_mfma_f32_16x16x32_bf16 v[80:83], v[144:147], a[40:43], v[80:83]
    ds_read_b64_tr_b16 v[180:181], v3 offset:33792
    ds_read_b64_tr_b16 v[182:183], v3 offset:34304
    v_mfma_f32_16x16x32_bf16 v[80:83], v[148:151], a[56:59], v[80:83]
    v_cvt_pk_bf16_f32 v128, v64, v65
    v_cvt_pk_bf16_f32 v129, v66, v67
    v_mfma_f32_16x16x32_bf16 v[112:115], v[148:151], a[60:63], v[112:115]
    ds_read_b64_tr_b16 v[184:185], v3 offset:16904
    ds_read_b64_tr_b16 v[186:187], v3 offset:17416
    v_mfma_f32_16x16x32_bf16 v[112:115], v[144:147], a[44:47], v[112:115]
    v_cvt_pk_bf16_f32 v130, v68, v69
    v_cvt_pk_bf16_f32 v131, v70, v71
    v_mfma_f32_16x16x32_bf16 v[116:119], v[152:155], a[44:47], v[116:119]
    ds_read_b64_tr_b16 v[188:189], v3 offset:33800
    ds_read_b64_tr_b16 v[190:191], v3 offset:34312
    v_mfma_f32_16x16x32_bf16 v[116:119], v[156:159], a[60:63], v[116:119]
    v_cvt_pk_bf16_f32 v132, v72, v73
    v_cvt_pk_bf16_f32 v133, v74, v75
    v_mfma_f32_16x16x32_bf16 v[84:87], v[156:159], a[56:59], v[84:87]
    ds_read_b64_tr_b16 v[192:193], v3 offset:16960
    ds_read_b64_tr_b16 v[194:195], v3 offset:17472
    v_mfma_f32_16x16x32_bf16 v[84:87], v[152:155], a[40:43], v[84:87]
    v_cvt_pk_bf16_f32 v134, v76, v77
    v_cvt_pk_bf16_f32 v135, v78, v79
    v_mfma_f32_16x16x32_bf16 v[52:55], v[152:155], a[36:39], v[52:55]
    ds_read_b64_tr_b16 v[196:197], v3 offset:33856
    ds_read_b64_tr_b16 v[198:199], v3 offset:34368
    v_mfma_f32_16x16x32_bf16 v[52:55], v[156:159], a[52:55], v[52:55]
    buffer_store_dwordx4 v[128:131], v12, s[68:71], s37 offen offset:2048 sc1
    buffer_store_dwordx4 v[132:135], v12, s[68:71], s37 offen offset:3072 sc1
    v_mfma_f32_16x16x32_bf16 v[20:23], v[156:159], a[48:51], v[20:23]
    ds_read_b64_tr_b16 v[200:201], v3 offset:16968
    ds_read_b64_tr_b16 v[202:203], v3 offset:17480
    v_mfma_f32_16x16x32_bf16 v[20:23], v[152:155], a[32:35], v[20:23]
    v_mfma_f32_16x16x32_bf16 v[24:27], v[160:163], a[32:35], v[24:27]
    ds_read_b64_tr_b16 v[204:205], v3 offset:33864
    ds_read_b64_tr_b16 v[206:207], v3 offset:34376
    v_mfma_f32_16x16x32_bf16 v[24:27], v[164:167], a[48:51], v[24:27]
    v_mfma_f32_16x16x32_bf16 v[56:59], v[164:167], a[52:55], v[56:59]
    v_mfma_f32_16x16x32_bf16 v[56:59], v[160:163], a[36:39], v[56:59]
    v_mfma_f32_16x16x32_bf16 v[88:91], v[160:163], a[40:43], v[88:91]
    v_mfma_f32_16x16x32_bf16 v[88:91], v[164:167], a[56:59], v[88:91]
    v_mfma_f32_16x16x32_bf16 v[120:123], v[164:167], a[60:63], v[120:123]
    v_mfma_f32_16x16x32_bf16 v[120:123], v[160:163], a[44:47], v[120:123]
    v_mfma_f32_16x16x32_bf16 v[124:127], v[168:171], a[44:47], v[124:127]
    v_mfma_f32_16x16x32_bf16 v[124:127], v[172:175], a[60:63], v[124:127]
    v_mfma_f32_16x16x32_bf16 v[92:95], v[172:175], a[56:59], v[92:95]
    v_mfma_f32_16x16x32_bf16 v[92:95], v[168:171], a[40:43], v[92:95]
    v_mfma_f32_16x16x32_bf16 v[60:63], v[168:171], a[36:39], v[60:63]
    v_mfma_f32_16x16x32_bf16 v[60:63], v[172:175], a[52:55], v[60:63]
    v_mfma_f32_16x16x32_bf16 v[28:31], v[172:175], a[48:51], v[28:31]
    v_mfma_f32_16x16x32_bf16 v[28:31], v[168:171], a[32:35], v[28:31]
    s_waitcnt vmcnt(4) lgkmcnt(0)
    s_barrier
    v_mfma_f32_16x16x32_bf16 v[80:83], v[176:179], a[72:75], v[80:83]
    ds_read_b128 v[144:147], v9 offset:0
    ds_read_b128 v[148:151], v9 offset:16
    v_mfma_f32_16x16x32_bf16 v[80:83], v[180:183], a[88:91], v[80:83]
    ds_read_b128 v[152:155], v9 offset:128
    ds_read_b128 v[156:159], v9 offset:144
    v_mfma_f32_16x16x32_bf16 v[84:87], v[188:191], a[88:91], v[84:87]
    ds_read_b128 v[160:163], v9 offset:1536
    ds_read_b128 v[164:167], v9 offset:1552
    v_mfma_f32_16x16x32_bf16 v[84:87], v[184:187], a[72:75], v[84:87]
    ds_read_b128 v[168:171], v9 offset:1664
    ds_read_b128 v[172:175], v9 offset:1680
    v_mfma_f32_16x16x32_bf16 v[88:91], v[192:195], a[72:75], v[88:91]
    v_lshlrev_b32 v64, 16, v208
    v_and_b32 v65, 0xffff0000, v208
    v_mfma_f32_16x16x32_bf16 v[88:91], v[196:199], a[88:91], v[88:91]
    v_lshlrev_b32 v66, 16, v209
    v_and_b32 v67, 0xffff0000, v209
    v_mfma_f32_16x16x32_bf16 v[92:95], v[204:207], a[88:91], v[92:95]
    v_lshlrev_b32 v68, 16, v210
    v_and_b32 v69, 0xffff0000, v210
    v_mfma_f32_16x16x32_bf16 v[92:95], v[200:203], a[72:75], v[92:95]
    v_lshlrev_b32 v70, 16, v211
    v_and_b32 v71, 0xffff0000, v211
    v_mfma_f32_16x16x32_bf16 v[124:127], v[200:203], a[76:79], v[124:127]
    v_lshlrev_b32 v72, 16, v212
    v_and_b32 v73, 0xffff0000, v212
    v_mfma_f32_16x16x32_bf16 v[124:127], v[204:207], a[92:95], v[124:127]
    v_lshlrev_b32 v74, 16, v213
    v_and_b32 v75, 0xffff0000, v213
    v_mfma_f32_16x16x32_bf16 v[120:123], v[196:199], a[92:95], v[120:123]
    v_lshlrev_b32 v76, 16, v214
    v_and_b32 v77, 0xffff0000, v214
    v_mfma_f32_16x16x32_bf16 v[120:123], v[192:195], a[76:79], v[120:123]
    v_lshlrev_b32 v78, 16, v215
    v_and_b32 v79, 0xffff0000, v215
    v_mfma_f32_16x16x32_bf16 v[116:119], v[184:187], a[76:79], v[116:119]
    v_lshlrev_b32 v96, 16, v216
    v_and_b32 v97, 0xffff0000, v216
    ds_write_b128 v7, v[80:83] offset:0
    v_mfma_f32_16x16x32_bf16 v[116:119], v[188:191], a[92:95], v[116:119]
    v_lshlrev_b32 v98, 16, v217
    v_and_b32 v99, 0xffff0000, v217
    ds_write_b128 v7, v[84:87] offset:1024
    v_mfma_f32_16x16x32_bf16 v[112:115], v[180:183], a[92:95], v[112:115]
    v_lshlrev_b32 v100, 16, v218
    v_and_b32 v101, 0xffff0000, v218
    ds_write_b128 v7, v[88:91] offset:2048
    v_mfma_f32_16x16x32_bf16 v[112:115], v[176:179], a[76:79], v[112:115]
    v_lshlrev_b32 v102, 16, v219
    v_and_b32 v103, 0xffff0000, v219
    ds_write_b128 v7, v[92:95] offset:3072
    v_mfma_f32_16x16x32_bf16 v[16:19], v[176:179], a[64:67], v[16:19]
    v_lshlrev_b32 v104, 16, v220
    v_and_b32 v105, 0xffff0000, v220
    v_mfma_f32_16x16x32_bf16 v[16:19], v[180:183], a[80:83], v[16:19]
    v_lshlrev_b32 v106, 16, v221
    v_and_b32 v107, 0xffff0000, v221
    v_mfma_f32_16x16x32_bf16 v[20:23], v[188:191], a[80:83], v[20:23]
    v_lshlrev_b32 v108, 16, v222
    v_and_b32 v109, 0xffff0000, v222
    v_mfma_f32_16x16x32_bf16 v[20:23], v[184:187], a[64:67], v[20:23]
    v_mfma_f32_16x16x32_bf16 v[24:27], v[192:195], a[64:67], v[24:27]
    v_mfma_f32_16x16x32_bf16 v[24:27], v[196:199], a[80:83], v[24:27]
    v_lshlrev_b32 v110, 16, v223
    v_and_b32 v111, 0xffff0000, v223
    ds_write_b128 v7, v[112:115] offset:4096
    v_mfma_f32_16x16x32_bf16 v[28:31], v[204:207], a[80:83], v[28:31]
    ds_write_b128 v7, v[116:119] offset:5120
    v_mfma_f32_16x16x32_bf16 v[28:31], v[200:203], a[64:67], v[28:31]
    ds_write_b128 v7, v[120:123] offset:6144
    v_mfma_f32_16x16x32_bf16 v[60:63], v[200:203], a[68:71], v[60:63]
    ds_read2st64_b32 v[224:225], v6 offset0:2 offset1:1
    ds_write_b128 v7, v[124:127] offset:7168
    v_mfma_f32_16x16x32_bf16 v[60:63], v[204:207], a[84:87], v[60:63]
    v_mfma_f32_16x16x32_bf16 v[56:59], v[196:199], a[84:87], v[56:59]
    v_mfma_f32_16x16x32_bf16 v[56:59], v[192:195], a[68:71], v[56:59]
    v_mfma_f32_16x16x32_bf16 v[52:55], v[184:187], a[68:71], v[52:55]
    s_waitcnt lgkmcnt(0)
    s_barrier
    v_mfma_f32_16x16x32_bf16 v[52:55], v[188:191], a[84:87], v[52:55]
    ds_read_b128 v[80:83], v8 offset:0
    ds_read_b128 v[84:87], v8 offset:1024
    v_mfma_f32_16x16x32_bf16 v[48:51], v[180:183], a[84:87], v[48:51]
    ds_read_b128 v[88:91], v8 offset:2048
    ds_read_b128 v[92:95], v8 offset:3072
    v_mfma_f32_16x16x32_bf16 v[48:51], v[176:179], a[68:71], v[48:51]
    ds_read_b128 v[112:115], v8 offset:4096
    ds_read_b128 v[116:119], v8 offset:5120
    buffer_load_dwordx4 v[232:235], v12, s[68:71], s77 offen offset:0 sc1
    buffer_load_dwordx4 v[236:239], v12, s[68:71], s77 offen offset:1024 sc1
    buffer_load_dwordx4 v[240:243], v12, s[68:71], s77 offen offset:2048 sc1
    buffer_load_dwordx4 v[244:247], v12, s[68:71], s77 offen offset:3072 sc1
attn_oj:
attn_t:
    ds_read_b128 v[120:123], v8 offset:6144
    ds_read_b128 v[124:127], v8 offset:7168
    s_lshl_b32 s36, s18, 13
    s_add_u32 s36, s36, 29892608
    s_add_u32 s37, s36, 4096
    s_lshl_b32 s38, s17, 9
    s_add_u32 s38, s38, s36
    v_lshlrev_b32 v7, 3, v0
    v_mov_b32 v211, v224
    v_mov_b32 v215, v225
    s_waitcnt lgkmcnt(4)
    v_pk_add_f32 v[16:17], v[16:17], v[80:81]
    v_pk_add_f32 v[18:19], v[18:19], v[82:83]
    v_pk_add_f32 v[20:21], v[20:21], v[84:85]
    v_pk_add_f32 v[22:23], v[22:23], v[86:87]
    v_pk_add_f32 v[24:25], v[24:25], v[88:89]
    v_pk_add_f32 v[26:27], v[26:27], v[90:91]
    v_pk_add_f32 v[28:29], v[28:29], v[92:93]
    v_pk_add_f32 v[30:31], v[30:31], v[94:95]
    v_pk_fma_f32 v[16:17], v[16:17], v[144:145], v[64:65]
    v_pk_fma_f32 v[18:19], v[18:19], v[146:147], v[66:67]
    v_pk_fma_f32 v[20:21], v[20:21], v[148:149], v[68:69]
    v_pk_fma_f32 v[22:23], v[22:23], v[150:151], v[70:71]
    v_pk_fma_f32 v[24:25], v[24:25], v[152:153], v[72:73]
    v_pk_fma_f32 v[26:27], v[26:27], v[154:155], v[74:75]
    v_pk_fma_f32 v[28:29], v[28:29], v[156:157], v[76:77]
    v_pk_fma_f32 v[30:31], v[30:31], v[158:159], v[78:79]
    s_waitcnt lgkmcnt(0)
    v_pk_add_f32 v[32:33], v[48:49], v[112:113]
    v_pk_add_f32 v[34:35], v[50:51], v[114:115]
    v_pk_add_f32 v[36:37], v[52:53], v[116:117]
    v_pk_add_f32 v[38:39], v[54:55], v[118:119]
    v_pk_add_f32 v[40:41], v[56:57], v[120:121]
    v_pk_add_f32 v[42:43], v[58:59], v[122:123]
    v_pk_add_f32 v[44:45], v[60:61], v[124:125]
    v_pk_add_f32 v[46:47], v[62:63], v[126:127]
    v_pk_fma_f32 v[32:33], v[32:33], v[144:145], v[96:97]
    v_pk_fma_f32 v[34:35], v[34:35], v[146:147], v[98:99]
    v_pk_fma_f32 v[36:37], v[36:37], v[148:149], v[100:101]
    v_pk_fma_f32 v[38:39], v[38:39], v[150:151], v[102:103]
    v_pk_fma_f32 v[40:41], v[40:41], v[152:153], v[104:105]
    v_pk_fma_f32 v[42:43], v[42:43], v[154:155], v[106:107]
    v_pk_fma_f32 v[44:45], v[44:45], v[156:157], v[108:109]
    v_pk_fma_f32 v[46:47], v[46:47], v[158:159], v[110:111]
    s_waitcnt vmcnt(0)
    v_max_u32 v8, v232, v233
    v_max_u32 v6, v234, v235
    v_max3_u32 v8, v8, v236, v237
    v_max3_u32 v6, v6, v238, v239
    v_max3_u32 v8, v8, v240, v241
    v_max3_u32 v6, v6, v242, v243
    v_max3_u32 v8, v8, v244, v245
    v_max3_u32 v6, v6, v246, v247
    v_max_u32 v8, v8, v6
    v_cmp_eq_u32 vcc, -1, v8
    s_mov_b32 s4, 0
    s_nop 0
    s_cbranch_vccnz attn_p7_r
attn_p7_k:
    buffer_store_dword v228, v226, s[68:71], s61 offen sc1
    v_lshlrev_b32 v112, 16, v232
    v_and_b32 v113, 0xffff0000, v232
    v_lshlrev_b32 v114, 16, v233
    v_and_b32 v115, 0xffff0000, v233
    v_lshlrev_b32 v116, 16, v234
    v_and_b32 v117, 0xffff0000, v234
    v_lshlrev_b32 v118, 16, v235
    v_and_b32 v119, 0xffff0000, v235
    v_lshlrev_b32 v120, 16, v236
    v_and_b32 v121, 0xffff0000, v236
    v_lshlrev_b32 v122, 16, v237
    v_and_b32 v123, 0xffff0000, v237
    v_lshlrev_b32 v124, 16, v238
    v_and_b32 v125, 0xffff0000, v238
    v_lshlrev_b32 v126, 16, v239
    v_and_b32 v127, 0xffff0000, v239
    v_lshlrev_b32 v128, 16, v240
    v_and_b32 v129, 0xffff0000, v240
    v_lshlrev_b32 v130, 16, v241
    v_and_b32 v131, 0xffff0000, v241
    v_lshlrev_b32 v132, 16, v242
    v_and_b32 v133, 0xffff0000, v242
    v_lshlrev_b32 v134, 16, v243
    v_and_b32 v135, 0xffff0000, v243
    v_lshlrev_b32 v136, 16, v244
    v_and_b32 v137, 0xffff0000, v244
    v_lshlrev_b32 v138, 16, v245
    v_and_b32 v139, 0xffff0000, v245
    v_lshlrev_b32 v140, 16, v246
    v_and_b32 v141, 0xffff0000, v246
    v_lshlrev_b32 v142, 16, v247
    v_and_b32 v143, 0xffff0000, v247
    v_pk_fma_f32 v[16:17], v[112:113], v[144:145], v[16:17]
    v_pk_fma_f32 v[18:19], v[114:115], v[146:147], v[18:19]
    v_pk_fma_f32 v[20:21], v[116:117], v[148:149], v[20:21]
    v_pk_fma_f32 v[22:23], v[118:119], v[150:151], v[22:23]
    v_pk_fma_f32 v[24:25], v[120:121], v[152:153], v[24:25]
    v_pk_fma_f32 v[26:27], v[122:123], v[154:155], v[26:27]
    v_pk_fma_f32 v[28:29], v[124:125], v[156:157], v[28:29]
    v_pk_fma_f32 v[30:31], v[126:127], v[158:159], v[30:31]
    v_pk_fma_f32 v[32:33], v[128:129], v[144:145], v[32:33]
    v_pk_fma_f32 v[34:35], v[130:131], v[146:147], v[34:35]
    v_pk_fma_f32 v[36:37], v[132:133], v[148:149], v[36:37]
    v_pk_fma_f32 v[38:39], v[134:135], v[150:151], v[38:39]
    v_pk_fma_f32 v[40:41], v[136:137], v[152:153], v[40:41]
    v_pk_fma_f32 v[42:43], v[138:139], v[154:155], v[42:43]
    v_pk_fma_f32 v[44:45], v[140:141], v[156:157], v[44:45]
    v_pk_fma_f32 v[46:47], v[142:143], v[158:159], v[46:47]
    v_pk_add_f32 v[112:113], v[16:17], v[18:19]
    v_pk_mul_f32 v[114:115], v[16:17], v[16:17]
    v_pk_mul_f32 v[116:117], v[16:17], v[160:161]
    v_pk_fma_f32 v[114:115], v[18:19], v[18:19], v[114:115]
    v_pk_fma_f32 v[116:117], v[18:19], v[162:163], v[116:117]
    v_pk_add_f32 v[112:113], v[112:113], v[20:21]
    v_pk_fma_f32 v[114:115], v[20:21], v[20:21], v[114:115]
    v_pk_fma_f32 v[116:117], v[20:21], v[164:165], v[116:117]
    v_pk_add_f32 v[112:113], v[112:113], v[22:23]
    v_pk_fma_f32 v[114:115], v[22:23], v[22:23], v[114:115]
    v_pk_fma_f32 v[116:117], v[22:23], v[166:167], v[116:117]
    v_pk_add_f32 v[112:113], v[112:113], v[24:25]
    v_pk_fma_f32 v[114:115], v[24:25], v[24:25], v[114:115]
    v_pk_fma_f32 v[116:117], v[24:25], v[168:169], v[116:117]
    v_pk_add_f32 v[112:113], v[112:113], v[26:27]
    v_pk_fma_f32 v[114:115], v[26:27], v[26:27], v[114:115]
    v_pk_fma_f32 v[116:117], v[26:27], v[170:171], v[116:117]
    v_pk_add_f32 v[112:113], v[112:113], v[28:29]
    v_pk_fma_f32 v[114:115], v[28:29], v[28:29], v[114:115]
    v_pk_fma_f32 v[116:117], v[28:29], v[172:173], v[116:117]
    v_pk_add_f32 v[112:113], v[112:113], v[30:31]
    v_pk_fma_f32 v[114:115], v[30:31], v[30:31], v[114:115]
    v_pk_fma_f32 v[116:117], v[30:31], v[174:175], v[116:117]
    v_add_f32 v208, v112, v113
    v_add_f32 v209, v114, v115
    v_add_f32 v210, v116, v117
    v_pk_add_f32 v[118:119], v[32:33], v[34:35]
    v_pk_mul_f32 v[120:121], v[32:33], v[32:33]
    v_pk_mul_f32 v[122:123], v[32:33], v[160:161]
    v_pk_fma_f32 v[120:121], v[34:35], v[34:35], v[120:121]
    v_pk_fma_f32 v[122:123], v[34:35], v[162:163], v[122:123]
    v_pk_add_f32 v[118:119], v[118:119], v[36:37]
    v_pk_fma_f32 v[120:121], v[36:37], v[36:37], v[120:121]
    v_pk_fma_f32 v[122:123], v[36:37], v[164:165], v[122:123]
    v_pk_add_f32 v[118:119], v[118:119], v[38:39]
    v_pk_fma_f32 v[120:121], v[38:39], v[38:39], v[120:121]
    v_pk_fma_f32 v[122:123], v[38:39], v[166:167], v[122:123]
    v_pk_add_f32 v[118:119], v[118:119], v[40:41]
    v_pk_fma_f32 v[120:121], v[40:41], v[40:41], v[120:121]
    v_pk_fma_f32 v[122:123], v[40:41], v[168:169], v[122:123]
    v_pk_add_f32 v[118:119], v[118:119], v[42:43]
    v_pk_fma_f32 v[120:121], v[42:43], v[42:43], v[120:121]
    v_pk_fma_f32 v[122:123], v[42:43], v[170:171], v[122:123]
    v_pk_add_f32 v[118:119], v[118:119], v[44:45]
    v_pk_fma_f32 v[120:121], v[44:45], v[44:45], v[120:121]
    v_pk_fma_f32 v[122:123], v[44:45], v[172:173], v[122:123]
    v_pk_add_f32 v[118:119], v[118:119], v[46:47]
    v_pk_fma_f32 v[120:121], v[46:47], v[46:47], v[120:121]
    v_pk_fma_f32 v[122:123], v[46:47], v[174:175], v[122:123]
    v_add_f32 v212, v118, v119
    v_add_f32 v213, v120, v121
    v_add_f32 v214, v122, v123
    s_nop 1
    v_permlane32_swap_b32 v208, v210
    v_permlane32_swap_b32 v209, v211
    v_permlane32_swap_b32 v212, v214
    v_permlane32_swap_b32 v213, v215
    v_add_f32 v208, v208, v210
    v_add_f32 v209, v209, v211
    v_add_f32 v212, v212, v214
    v_add_f32 v213, v213, v215
    s_nop 1
    v_permlane16_swap_b32 v208, v209
    v_permlane16_swap_b32 v212, v213
    v_add_f32 v208, v208, v209
    v_add_f32 v209, v212, v213
    buffer_store_dwordx2 v[208:209], v7, s[68:71], s38 offen sc1
    ds_read_b128 v[144:147], v9 offset:256
    ds_read_b128 v[148:151], v9 offset:272
    ds_read_b128 v[152:155], v9 offset:384
    ds_read_b128 v[156:159], v9 offset:400
    ds_read_b128 v[176:179], v9 offset:512
    ds_read_b128 v[180:183], v9 offset:528
    ds_read_b128 v[184:187], v9 offset:640
    ds_read_b128 v[188:191], v9 offset:656
    ds_read_b128 v[192:195], v9 offset:768
    ds_read_b128 v[196:199], v9 offset:784
    ds_read_b128 v[200:203], v9 offset:896
    ds_read_b128 v[204:207], v9 offset:912
    s_lshl_b32 s39, s18, 5
    s_sub_u32 s39, 2047, s39
    v_sub_u32 v10, s39, v15
    v_subrev_u32 v11, 16, v10
    v_lshlrev_b32 v6, 2, v15
    v_mov_b32 v8, 0
    s_mov_b64 exec, 0xffff
    buffer_atomic_or v8, v6, s[68:71], s60 offen sc0 sc1
    s_mov_b64 exec, -1
    s_waitcnt vmcnt(0)
    v_cmp_ne_u32 vcc, s85, v8
    s_and_b64 vcc, vcc, 0xffff
    s_mov_b32 s4, 0
    s_nop 0
    s_cbranch_vccnz attn_p8_r
attn_p8_k:
    s_waitcnt vmcnt(0)
    buffer_load_dwordx2 v[48:49], v7, s[68:71], s36 offen offset:0 sc1
    buffer_load_dwordx2 v[50:51], v7, s[68:71], s36 offen offset:512 sc1
    buffer_load_dwordx2 v[52:53], v7, s[68:71], s36 offen offset:1024 sc1
    buffer_load_dwordx2 v[54:55], v7, s[68:71], s36 offen offset:1536 sc1
    buffer_load_dwordx2 v[56:57], v7, s[68:71], s36 offen offset:2048 sc1
    buffer_load_dwordx2 v[58:59], v7, s[68:71], s36 offen offset:2560 sc1
    buffer_load_dwordx2 v[60:61], v7, s[68:71], s36 offen offset:3072 sc1
    buffer_load_dwordx2 v[62:63], v7, s[68:71], s36 offen offset:3584 sc1
    buffer_load_dwordx2 v[64:65], v7, s[68:71], s37 offen offset:0 sc1
    buffer_load_dwordx2 v[66:67], v7, s[68:71], s37 offen offset:512 sc1
    buffer_load_dwordx2 v[68:69], v7, s[68:71], s37 offen offset:1024 sc1
    buffer_load_dwordx2 v[70:71], v7, s[68:71], s37 offen offset:1536 sc1
    buffer_load_dwordx2 v[72:73], v7, s[68:71], s37 offen offset:2048 sc1
    buffer_load_dwordx2 v[74:75], v7, s[68:71], s37 offen offset:2560 sc1
    buffer_load_dwordx2 v[76:77], v7, s[68:71], s37 offen offset:3072 sc1
    buffer_load_dwordx2 v[78:79], v7, s[68:71], s37 offen offset:3584 sc1
    s_waitcnt vmcnt(0)
    v_max_u32 v8, v48, v49
    v_max_u32 v9, v50, v51
    v_max3_u32 v8, v8, v52, v53
    v_max3_u32 v9, v9, v54, v55
    v_max3_u32 v8, v8, v56, v57
    v_max3_u32 v9, v9, v58, v59
    v_max3_u32 v8, v8, v60, v61
    v_max3_u32 v9, v9, v62, v63
    v_max3_u32 v8, v8, v64, v65
    v_max3_u32 v9, v9, v66, v67
    v_max3_u32 v8, v8, v68, v69
    v_max3_u32 v9, v9, v70, v71
    v_max3_u32 v8, v8, v72, v73
    v_max3_u32 v9, v9, v74, v75
    v_max3_u32 v8, v8, v76, v77
    v_max3_u32 v9, v9, v78, v79
    v_max_u32 v8, v8, v9
    v_cmp_eq_u32 vcc, -1, v8
    s_mov_b32 s4, 0
    s_nop 0
    s_cbranch_vccnz attn_p9_r
attn_p9_k:
    v_pk_add_f32 v[48:49], v[48:49], v[64:65]
    v_pk_add_f32 v[50:51], v[50:51], v[66:67]
    v_pk_add_f32 v[52:53], v[52:53], v[68:69]
    v_pk_add_f32 v[54:55], v[54:55], v[70:71]
    v_pk_add_f32 v[56:57], v[56:57], v[72:73]
    v_pk_add_f32 v[58:59], v[58:59], v[74:75]
    v_pk_add_f32 v[60:61], v[60:61], v[76:77]
    v_pk_add_f32 v[62:63], v[62:63], v[78:79]
    v_pk_add_f32 v[48:49], v[48:49], v[56:57]
    v_pk_add_f32 v[50:51], v[50:51], v[58:59]
    v_pk_add_f32 v[52:53], v[52:53], v[60:61]
    v_pk_add_f32 v[54:55], v[54:55], v[62:63]
    v_pk_add_f32 v[48:49], v[48:49], v[52:53]
    v_pk_add_f32 v[50:51], v[50:51], v[54:55]
    v_pk_add_f32 v[48:49], v[48:49], v[50:51]
    v_mov_b64 v[52:53], v[48:49]
    s_nop 1
    v_permlane32_swap_b32 v48, v52
    v_permlane32_swap_b32 v49, v53
    v_mov_b64 v[50:51], v[48:49]
    v_mov_b64 v[54:55], v[52:53]
    s_nop 0
    v_permlane16_swap_b32 v48, v50
    v_permlane16_swap_b32 v49, v51
    v_permlane16_swap_b32 v52, v54
    v_permlane16_swap_b32 v53, v55
    v_mul_f32 v48, 981467136, v48
    v_mul_f32 v49, 981467136, v49
    v_mul_f32 v50, 981467136, v50
    v_mul_f32 v51, 981467136, v51
    v_fma_f32 v50, -v48, v48, v50
    v_fma_f32 v51, -v49, v49, v51
    v_max_f32 v50, 0, v50
    v_max_f32 v51, 0, v51
    v_cvt_pk_bf16_f32 v8, v48, v49
    v_lshlrev_b32 v48, 16, v8
    v_and_b32 v49, 0xffff0000, v8
    v_cvt_pk_bf16_f32 v8, v50, v51
    v_lshlrev_b32 v50, 16, v8
    v_and_b32 v51, 0xffff0000, v8
    v_add_f32 v50, 925353388, v50
    v_add_f32 v51, 925353388, v51
    v_cvt_pk_bf16_f32 v8, v50, v51
    v_lshlrev_b32 v50, 16, v8
    v_and_b32 v51, 0xffff0000, v8
    v_sqrt_f32 v50, v50
    v_sqrt_f32 v51, v51
    s_nop 0
    v_cvt_pk_bf16_f32 v8, v50, v51
    v_lshlrev_b32 v50, 16, v8
    v_and_b32 v51, 0xffff0000, v8
    v_rcp_f32 v50, v50
    v_rcp_f32 v51, v51
    s_nop 0
    v_fma_f32 v52, -v48, v54, v52
    v_fma_f32 v53, -v49, v54, v53
    v_fma_f32 v52, v52, v50, v55
    v_fma_f32 v53, v53, v51, v55
    v_ashrrev_i32 v8, 31, v52
    v_or_b32 v8, 0x80000000, v8
    v_xor_b32 v8, v52, v8
    v_and_b32 v8, 0xfffff800, v8
    v_or_b32 v10, v8, v10
    v_ashrrev_i32 v8, 31, v53
    v_or_b32 v8, 0x80000000, v8
    v_xor_b32 v8, v53, v8
    v_and_b32 v8, 0xfffff800, v8
    v_or_b32 v11, v8, v11
    v_max_u32 v248, v10, v11
    v_min_u32 v249, v10, v11
    s_nop 1
    v_mov_b32_dpp v250, v248 row_ror:8 row_mask:0xf bank_mask:0xf
    v_mov_b32_dpp v251, v249 row_ror:8 row_mask:0xf bank_mask:0xf
    v_max_u32 v249, v249, v251
    v_med3_u32 v249, v248, v250, v249
    v_max_u32 v248, v248, v250
    s_nop 1
    v_mov_b32_dpp v250, v248 row_ror:4 row_mask:0xf bank_mask:0xf
    v_mov_b32_dpp v251, v249 row_ror:4 row_mask:0xf bank_mask:0xf
    v_max_u32 v249, v249, v251
    v_med3_u32 v249, v248, v250, v249
    v_max_u32 v248, v248, v250
    s_nop 1
    v_mov_b32_dpp v250, v248 row_ror:2 row_mask:0xf bank_mask:0xf
    v_mov_b32_dpp v251, v249 row_ror:2 row_mask:0xf bank_mask:0xf
    v_max_u32 v249, v249, v251
    v_med3_u32 v249, v248, v250, v249
    v_max_u32 v248, v248, v250
    s_nop 1
    v_mov_b32_dpp v250, v248 row_ror:1 row_mask:0xf bank_mask:0xf
    v_mov_b32_dpp v251, v249 row_ror:1 row_mask:0xf bank_mask:0xf
    v_max_u32 v249, v249, v251
    v_med3_u32 v249, v248, v250, v249
    v_max_u32 v248, v248, v250
    s_and_b32 s36, s17, 3
    s_cmp_lg_u32 s36, 0
    s_cbranch_scc1 attn_nokey
    s_lshl_b32 s36, s18, 3
    s_add_u32 s36, s36, 30416896
    s_lshr_b32 s37, s17, 2
    s_mul_i32 s37, s37, 8192
    s_add_u32 s36, s36, s37
    v_and_b32 v8, 15, v0
    v_lshlrev_b32 v8, 9, v8
    buffer_store_dwordx2 v[248:249], v8, s[68:71], s36 offen sc1
attn_nokey:
    v_pk_mul_f32 v[48:49], v[48:49], v[50:51]
    s_waitcnt lgkmcnt(0)
    v_pk_fma_f32 v[64:65], v[16:17], v[50:51], v[48:49] op_sel:[0,0,0] op_sel_hi:[1,0,0] neg_lo:[0,0,1] neg_hi:[0,0,1]
    v_pk_fma_f32 v[66:67], v[18:19], v[50:51], v[48:49] op_sel:[0,0,0] op_sel_hi:[1,0,0] neg_lo:[0,0,1] neg_hi:[0,0,1]
    v_pk_fma_f32 v[68:69], v[20:21], v[50:51], v[48:49] op_sel:[0,0,0] op_sel_hi:[1,0,0] neg_lo:[0,0,1] neg_hi:[0,0,1]
    v_pk_fma_f32 v[70:71], v[22:23], v[50:51], v[48:49] op_sel:[0,0,0] op_sel_hi:[1,0,0] neg_lo:[0,0,1] neg_hi:[0,0,1]
    v_pk_fma_f32 v[72:73], v[24:25], v[50:51], v[48:49] op_sel:[0,0,0] op_sel_hi:[1,0,0] neg_lo:[0,0,1] neg_hi:[0,0,1]
    v_pk_fma_f32 v[74:75], v[26:27], v[50:51], v[48:49] op_sel:[0,0,0] op_sel_hi:[1,0,0] neg_lo:[0,0,1] neg_hi:[0,0,1]
    v_pk_fma_f32 v[76:77], v[28:29], v[50:51], v[48:49] op_sel:[0,0,0] op_sel_hi:[1,0,0] neg_lo:[0,0,1] neg_hi:[0,0,1]
    v_pk_fma_f32 v[78:79], v[30:31], v[50:51], v[48:49] op_sel:[0,0,0] op_sel_hi:[1,0,0] neg_lo:[0,0,1] neg_hi:[0,0,1]
    v_pk_fma_f32 v[64:65], v[64:65], v[176:177], v[144:145]
    v_pk_fma_f32 v[66:67], v[66:67], v[178:179], v[146:147]
    v_pk_fma_f32 v[68:69], v[68:69], v[180:181], v[148:149]
    v_pk_fma_f32 v[70:71], v[70:71], v[182:183], v[150:151]
    v_pk_fma_f32 v[72:73], v[72:73], v[184:185], v[152:153]
    v_pk_fma_f32 v[74:75], v[74:75], v[186:187], v[154:155]
    v_pk_fma_f32 v[76:77], v[76:77], v[188:189], v[156:157]
    v_pk_fma_f32 v[78:79], v[78:79], v[190:191], v[158:159]
    v_cvt_pk_bf16_f32 v96, v64, v65
    v_cvt_pk_bf16_f32 v97, v66, v67
    v_cvt_pk_bf16_f32 v98, v68, v69
    v_cvt_pk_bf16_f32 v99, v70, v71
    v_cvt_pk_bf16_f32 v100, v72, v73
    v_cvt_pk_bf16_f32 v101, v74, v75
    v_cvt_pk_bf16_f32 v102, v76, v77
    v_cvt_pk_bf16_f32 v103, v78, v79
    v_pk_fma_f32 v[80:81], v[32:33], v[50:51], v[48:49] op_sel:[0,1,1] op_sel_hi:[1,1,1] neg_lo:[0,0,1] neg_hi:[0,0,1]
    v_pk_fma_f32 v[82:83], v[34:35], v[50:51], v[48:49] op_sel:[0,1,1] op_sel_hi:[1,1,1] neg_lo:[0,0,1] neg_hi:[0,0,1]
    v_pk_fma_f32 v[84:85], v[36:37], v[50:51], v[48:49] op_sel:[0,1,1] op_sel_hi:[1,1,1] neg_lo:[0,0,1] neg_hi:[0,0,1]
    v_pk_fma_f32 v[86:87], v[38:39], v[50:51], v[48:49] op_sel:[0,1,1] op_sel_hi:[1,1,1] neg_lo:[0,0,1] neg_hi:[0,0,1]
    v_pk_fma_f32 v[88:89], v[40:41], v[50:51], v[48:49] op_sel:[0,1,1] op_sel_hi:[1,1,1] neg_lo:[0,0,1] neg_hi:[0,0,1]
    v_pk_fma_f32 v[90:91], v[42:43], v[50:51], v[48:49] op_sel:[0,1,1] op_sel_hi:[1,1,1] neg_lo:[0,0,1] neg_hi:[0,0,1]
    v_pk_fma_f32 v[92:93], v[44:45], v[50:51], v[48:49] op_sel:[0,1,1] op_sel_hi:[1,1,1] neg_lo:[0,0,1] neg_hi:[0,0,1]
    v_pk_fma_f32 v[94:95], v[46:47], v[50:51], v[48:49] op_sel:[0,1,1] op_sel_hi:[1,1,1] neg_lo:[0,0,1] neg_hi:[0,0,1]
    v_pk_fma_f32 v[80:81], v[80:81], v[176:177], v[144:145]
    v_pk_fma_f32 v[82:83], v[82:83], v[178:179], v[146:147]
    v_pk_fma_f32 v[84:85], v[84:85], v[180:181], v[148:149]
    v_pk_fma_f32 v[86:87], v[86:87], v[182:183], v[150:151]
    v_pk_fma_f32 v[88:89], v[88:89], v[184:185], v[152:153]
    v_pk_fma_f32 v[90:91], v[90:91], v[186:187], v[154:155]
    v_pk_fma_f32 v[92:93], v[92:93], v[188:189], v[156:157]
    v_pk_fma_f32 v[94:95], v[94:95], v[190:191], v[158:159]
    v_cvt_pk_bf16_f32 v104, v80, v81
    v_cvt_pk_bf16_f32 v105, v82, v83
    v_cvt_pk_bf16_f32 v106, v84, v85
    v_cvt_pk_bf16_f32 v107, v86, v87
    v_cvt_pk_bf16_f32 v108, v88, v89
    v_cvt_pk_bf16_f32 v109, v90, v91
    v_cvt_pk_bf16_f32 v110, v92, v93
    v_cvt_pk_bf16_f32 v111, v94, v95
    s_and_b32 s36, s17, 3
    s_lshl_b32 s36, s36, 8
    s_add_u32 s36, s36, s77
    s_add_u32 s36, s36, 5120
    v_add_u32 v9, 128, v5
    v_cmp_eq_u32 s[38:39], v10, v248
    v_cmp_eq_u32 vcc, v10, v249
    s_nop 1
    v_cndmask_b32 v8, v5, v9, vcc
    s_or_b64 exec, s[38:39], vcc
    s_cbranch_execz attn_nc0
    buffer_store_dwordx4 v[96:99], v8, s[68:71], s36 offen sc1
    buffer_store_dwordx4 v[100:103], v8, s[68:71], s36 offen offset:64 sc1
attn_nc0:
    s_mov_b64 exec, -1
    v_cmp_eq_u32 s[38:39], v11, v248
    v_cmp_eq_u32 vcc, v11, v249
    s_nop 1
    v_cndmask_b32 v8, v5, v9, vcc
    s_or_b64 exec, s[38:39], vcc
    s_cbranch_execz attn_nc1
    buffer_store_dwordx4 v[104:107], v8, s[68:71], s36 offen sc1
    buffer_store_dwordx4 v[108:111], v8, s[68:71], s36 offen offset:64 sc1
attn_nc1:
    s_mov_b64 exec, -1
    s_and_b32 s37, s2, 63
    s_lshl_b32 s37, s37, 9
    s_add_u32 s37, s37, 30416896
    v_lshlrev_b32 v7, 3, v0
    s_waitcnt lgkmcnt(0)
    v_pk_fma_f32 v[112:113], v[64:65], v[192:193], v[16:17]
    v_pk_fma_f32 v[114:115], v[66:67], v[194:195], v[18:19]
    v_pk_fma_f32 v[116:117], v[68:69], v[196:197], v[20:21]
    v_pk_fma_f32 v[118:119], v[70:71], v[198:199], v[22:23]
    v_pk_fma_f32 v[120:121], v[72:73], v[200:201], v[24:25]
    v_pk_fma_f32 v[122:123], v[74:75], v[202:203], v[26:27]
    v_pk_fma_f32 v[124:125], v[76:77], v[204:205], v[28:29]
    v_pk_fma_f32 v[126:127], v[78:79], v[206:207], v[30:31]
    v_pk_fma_f32 v[128:129], v[80:81], v[192:193], v[32:33]
    v_pk_fma_f32 v[130:131], v[82:83], v[194:195], v[34:35]
    v_pk_fma_f32 v[132:133], v[84:85], v[196:197], v[36:37]
    v_pk_fma_f32 v[134:135], v[86:87], v[198:199], v[38:39]
    v_pk_fma_f32 v[136:137], v[88:89], v[200:201], v[40:41]
    v_pk_fma_f32 v[138:139], v[90:91], v[202:203], v[42:43]
    v_pk_fma_f32 v[140:141], v[92:93], v[204:205], v[44:45]
    v_pk_fma_f32 v[142:143], v[94:95], v[206:207], v[46:47]
    v_cvt_pk_bf16_f32 v208, v112, v113
    v_cvt_pk_bf16_f32 v209, v114, v115
    v_cvt_pk_bf16_f32 v210, v116, v117
    v_cvt_pk_bf16_f32 v211, v118, v119
    v_cvt_pk_bf16_f32 v212, v120, v121
    v_cvt_pk_bf16_f32 v213, v122, v123
    v_cvt_pk_bf16_f32 v214, v124, v125
    v_cvt_pk_bf16_f32 v215, v126, v127
    v_cvt_pk_bf16_f32 v216, v128, v129
    v_cvt_pk_bf16_f32 v217, v130, v131
    v_cvt_pk_bf16_f32 v218, v132, v133
    v_cvt_pk_bf16_f32 v219, v134, v135
    v_cvt_pk_bf16_f32 v220, v136, v137
    v_cvt_pk_bf16_f32 v221, v138, v139
    v_cvt_pk_bf16_f32 v222, v140, v141
    v_cvt_pk_bf16_f32 v223, v142, v143
    s_lshl_b32 s60, s28, 15
    s_add_u32 s60, s60, 20976640
    s_add_u32 s61, s60, 8192
    s_add_u32 s62, s60, 16384
    s_add_u32 s63, s60, 24576
    s_lshl_b32 s5, s28, 11
    v_add_u32 v1, s5, v12
    v_and_b32 v4, 1, v0
    v_lshlrev_b32 v2, 4, v4
    v_bfe_u32 v3, v0, 2, 2
    v_add_u32 v2, v2, v3
    v_mul_u32_u24 v2, 229376, v2
    v_bfe_u32 v3, v0, 1, 1
    v_lshl_add_u32 v2, v3, 6, v2
    v_add_u32 v2, v2, v5
    v_lshl_add_u32 v3, v4, 7, v5
    s_mul_i32 s56, s28, 917504
    s_lshr_b32 s57, s2, 3
    s_lshl_b32 s57, s57, 13
    s_add_u32 s56, s56, s57
    s_and_b32 s57, s2, 7
    s_lshl_b32 s57, s57, 7
    s_add_u32 s56, s56, s57
    s_add_u32 s56, s56, 20975616
    s_mov_b32 s58, 0xaaaaaaaa
    s_mov_b32 s59, 0xaaaaaaaa
    s_mov_b32 s40, 0x30003
    s_mov_b32 s41, 0x30003
    s_mov_b32 s42, 0xc000c
    s_mov_b32 s43, 0xc000c
    s_mov_b32 s44, 0x300030
    s_mov_b32 s45, 0x300030
    s_mov_b32 s46, 0xc000c0
    s_mov_b32 s47, 0xc000c0
    s_mov_b32 s48, 0x3000300
    s_mov_b32 s49, 0x3000300
    s_mov_b32 s50, 0xc000c00
    s_mov_b32 s51, 0xc000c00
    s_mov_b32 s52, 0x30003000
    s_mov_b32 s53, 0x30003000
    s_mov_b32 s54, 0xc000c000
    s_mov_b32 s55, 0xc000c000
    v_mov_b32 v6, 138240
    s_cmp_lg_u32 s28, 0
    s_cbranch_scc1 attn_kw
    s_waitcnt vmcnt(0)
    v_mov_b64 v[248:249], 0
    buffer_atomic_or_x2 v[248:249], v7, s[68:71], s37 offen sc0 sc1
    s_waitcnt vmcnt(0)
    v_max3_u32 v8, v248, v249, v249
    v_cmp_eq_u32 vcc, -1, v8
    s_mov_b32 s4, 0
    s_nop 0
    s_cbranch_vccnz attn_p10_r
attn_p10_k:
    s_nop 1
    v_mov_b32_dpp v250, v248 row_ror:8 row_mask:0xf bank_mask:0xf
    v_mov_b32_dpp v251, v249 row_ror:8 row_mask:0xf bank_mask:0xf
    v_max_u32 v249, v249, v251
    v_med3_u32 v249, v248, v250, v249
    v_max_u32 v248, v248, v250
    s_nop 1
    v_mov_b32_dpp v250, v248 row_ror:4 row_mask:0xf bank_mask:0xf
    v_mov_b32_dpp v251, v249 row_ror:4 row_mask:0xf bank_mask:0xf
    v_max_u32 v249, v249, v251
    v_med3_u32 v249, v248, v250, v249
    v_max_u32 v248, v248, v250
    s_nop 1
    v_mov_b32_dpp v250, v248 row_ror:2 row_mask:0xf bank_mask:0xf
    v_mov_b32_dpp v251, v249 row_ror:2 row_mask:0xf bank_mask:0xf
    v_max_u32 v249, v249, v251
    v_med3_u32 v249, v248, v250, v249
    v_max_u32 v248, v248, v250
    s_nop 1
    v_mov_b32_dpp v250, v248 row_ror:1 row_mask:0xf bank_mask:0xf
    v_mov_b32_dpp v251, v249 row_ror:1 row_mask:0xf bank_mask:0xf
    v_max_u32 v249, v249, v251
    v_med3_u32 v249, v248, v250, v249
    v_max_u32 v248, v248, v250
    v_mov_b64 v[250:251], v[248:249]
    s_nop 1
    v_permlane16_swap_b32 v248, v250
    v_permlane16_swap_b32 v249, v251
    v_max_u32 v249, v249, v251
    v_med3_u32 v249, v248, v250, v249
    v_max_u32 v248, v248, v250
    v_mov_b64 v[250:251], v[248:249]
    s_nop 1
    v_permlane32_swap_b32 v248, v250
    v_permlane32_swap_b32 v249, v251
    v_max_u32 v249, v249, v251
    v_med3_u32 v249, v248, v250, v249
    v_max_u32 v248, v248, v250
    ds_write_b64 v6, v[248:249]
    s_waitcnt lgkmcnt(0)
    s_branch attn_kx
attn_kw:
    buffer_store_dwordx4 v[208:211], v13, s[64:67], s20 offen offset:0 sc1
    buffer_store_dwordx4 v[212:215], v13, s[64:67], s20 offen offset:64 sc1
    buffer_store_dwordx4 v[216:219], v13, s[64:67], s21 offen offset:0 sc1
    buffer_store_dwordx4 v[220:223], v13, s[64:67], s21 offen offset:64 sc1
    s_mov_b32 s20, 0x10000000
    s_mov_b32 s21, 0x10000000
attn_kx:
    s_barrier
    ds_read_b64 v[248:249], v6
    s_waitcnt lgkmcnt(0)
    s_cmp_ge_u32 s2, 224
    s_cbranch_scc1 attn_nomoe
    v_xor_b32 v8, v248, v249
    v_cndmask_b32 v6, v248, v249, s[58:59]
    v_and_b32 v8, 0x7e0, v8
    v_cmp_eq_u32 vcc, 0, v8
    v_not_b32 v6, v6
    v_bfe_u32 v6, v6, 5, 6
    v_cndmask_b32 v8, v5, v3, vcc
    v_lshl_add_u32 v6, v6, 17, v8
    buffer_load_dwordx4 v[112:115], v6, s[68:71], s60 offen offset:0 sc1
    buffer_load_dwordx4 v[116:119], v6, s[68:71], s60 offen offset:64 sc1
    buffer_load_dwordx4 v[120:123], v6, s[68:71], s61 offen offset:256 sc1
    buffer_load_dwordx4 v[124:127], v6, s[68:71], s61 offen offset:320 sc1
    buffer_load_dwordx4 v[128:131], v6, s[68:71], s62 offen offset:512 sc1
    buffer_load_dwordx4 v[132:135], v6, s[68:71], s62 offen offset:576 sc1
    buffer_load_dwordx4 v[136:139], v6, s[68:71], s63 offen offset:768 sc1
    buffer_load_dwordx4 v[140:143], v6, s[68:71], s63 offen offset:832 sc1
    v_readfirstlane_b32 s9, v249
    v_readfirstlane_b32 s8, v248
    s_andn2_b32 s11, 2047, s9
    s_andn2_b32 s10, 2047, s8
    s_waitcnt vmcnt(0)
    v_mfma_f32_16x16x32_bf16 v[224:227], a[148:151], v[112:115], 0
    v_max_u32 v8, v112, v113
    v_max_u32 v9, v114, v115
    v_mfma_f32_16x16x32_bf16 v[228:231], a[152:155], v[112:115], 0
    v_max3_u32 v8, v8, v116, v117
    v_max3_u32 v9, v9, v118, v119
    v_mfma_f32_16x16x32_bf16 v[224:227], a[156:159], v[116:119], v[224:227]
    v_max3_u32 v8, v8, v120, v121
    v_max3_u32 v9, v9, v122, v123
    v_mfma_f32_16x16x32_bf16 v[228:231], a[160:163], v[116:119], v[228:231]
    v_max3_u32 v8, v8, v124, v125
    v_max3_u32 v9, v9, v126, v127
    v_mfma_f32_16x16x32_bf16 v[224:227], a[164:167], v[120:123], v[224:227]
    v_max3_u32 v8, v8, v128, v129
    v_max3_u32 v9, v9, v130, v131
    v_mfma_f32_16x16x32_bf16 v[228:231], a[168:171], v[120:123], v[228:231]
    v_max3_u32 v8, v8, v132, v133
    v_max3_u32 v9, v9, v134, v135
    v_mfma_f32_16x16x32_bf16 v[224:227], a[172:175], v[124:127], v[224:227]
    v_max3_u32 v8, v8, v136, v137
    v_max3_u32 v9, v9, v138, v139
    v_mfma_f32_16x16x32_bf16 v[228:231], a[176:179], v[124:127], v[228:231]
    v_max3_u32 v8, v8, v140, v141
    v_max3_u32 v9, v9, v142, v143
    v_mfma_f32_16x16x32_bf16 v[224:227], a[180:183], v[128:131], v[224:227]
    v_max_u32 v8, v8, v9
    v_cmp_eq_u32 vcc, -1, v8
    v_mfma_f32_16x16x32_bf16 v[228:231], a[184:187], v[128:131], v[228:231]
    v_mfma_f32_16x16x32_bf16 v[224:227], a[188:191], v[132:135], v[224:227]
    v_mfma_f32_16x16x32_bf16 v[228:231], a[192:195], v[132:135], v[228:231]
    v_mfma_f32_16x16x32_bf16 v[224:227], a[196:199], v[136:139], v[224:227]
    v_mfma_f32_16x16x32_bf16 v[228:231], a[200:203], v[136:139], v[228:231]
    v_mfma_f32_16x16x32_bf16 v[224:227], a[204:207], v[140:143], v[224:227]
    v_mfma_f32_16x16x32_bf16 v[228:231], a[208:211], v[140:143], v[228:231]
    s_mov_b32 s4, 0
    s_nop 0
    s_cbranch_vccnz attn_p11_r
attn_p11_k:
    buffer_store_dwordx4 v[208:211], v13, s[64:67], s20 offen offset:0 sc1
    buffer_store_dwordx4 v[212:215], v13, s[64:67], s20 offen offset:64 sc1
    buffer_store_dwordx4 v[216:219], v13, s[64:67], s21 offen offset:0 sc1
    buffer_store_dwordx4 v[220:223], v13, s[64:67], s21 offen offset:64 sc1
    s_nop 0
    ds_write_b128 v1, v[224:227]
    ds_write_b128 v1, v[228:231] offset:1024
    s_waitcnt lgkmcnt(0)
    s_barrier
    ds_read_b128 v[112:115], v12 offset:0
    ds_read_b128 v[116:119], v12 offset:1024
    ds_read_b128 v[120:123], v12 offset:2048
    ds_read_b128 v[124:127], v12 offset:3072
    ds_read_b128 v[128:131], v12 offset:4096
    ds_read_b128 v[132:135], v12 offset:5120
    ds_read_b128 v[136:139], v12 offset:6144
    ds_read_b128 v[140:143], v12 offset:7168
    s_waitcnt lgkmcnt(4)
    v_pk_add_f32 v[112:113], v[112:113], v[120:121]
    v_pk_add_f32 v[114:115], v[114:115], v[122:123]
    v_pk_add_f32 v[116:117], v[116:117], v[124:125]
    v_pk_add_f32 v[118:119], v[118:119], v[126:127]
    s_waitcnt lgkmcnt(0)
    v_pk_add_f32 v[128:129], v[128:129], v[136:137]
    v_pk_add_f32 v[130:131], v[130:131], v[138:139]
    v_pk_add_f32 v[132:133], v[132:133], v[140:141]
    v_pk_add_f32 v[134:135], v[134:135], v[142:143]
    v_pk_add_f32 v[112:113], v[112:113], v[128:129]
    v_pk_add_f32 v[114:115], v[114:115], v[130:131]
    v_pk_add_f32 v[116:117], v[116:117], v[132:133]
    v_pk_add_f32 v[118:119], v[118:119], v[134:135]
    v_mul_f32 v120, 3216550459, v112
    v_mul_f32 v121, 3216550459, v113
    v_mul_f32 v122, 3216550459, v114
    v_mul_f32 v123, 3216550459, v115
    v_exp_f32 v120, v120
    v_exp_f32 v121, v121
    v_exp_f32 v122, v122
    v_exp_f32 v123, v123
    v_add_f32 v120, 1.0, v120
    v_add_f32 v121, 1.0, v121
    v_add_f32 v122, 1.0, v122
    v_add_f32 v123, 1.0, v123
    v_rcp_f32 v120, v120
    v_rcp_f32 v121, v121
    v_rcp_f32 v122, v122
    v_rcp_f32 v123, v123
    v_mul_f32 v112, v112, v120
    v_mul_f32 v113, v113, v121
    v_mul_f32 v114, v114, v122
    v_mul_f32 v115, v115, v123
    v_mul_f32 v112, v112, v116
    v_mul_f32 v113, v113, v117
    v_mul_f32 v114, v114, v118
    v_mul_f32 v115, v115, v119
    v_cvt_pk_bf16_f32 v120, v112, v113
    v_cvt_pk_bf16_f32 v121, v114, v115
    v_cndmask_b32 v124, 0, v120, s[40:41]
    v_cndmask_b32 v125, 0, v121, s[40:41]
    v_cndmask_b32 v126, 0, v120, s[42:43]
    v_cndmask_b32 v127, 0, v121, s[42:43]
    v_cndmask_b32 v128, 0, v120, s[44:45]
    v_cndmask_b32 v129, 0, v121, s[44:45]
    v_cndmask_b32 v130, 0, v120, s[46:47]
    v_cndmask_b32 v131, 0, v121, s[46:47]
    v_mfma_f32_16x16x32_bf16 v[224:227], a[212:215], v[124:127], 0
    v_cndmask_b32 v132, 0, v120, s[48:49]
    v_cndmask_b32 v133, 0, v121, s[48:49]
    v_mfma_f32_16x16x32_bf16 v[228:231], a[216:219], v[124:127], 0
    v_cndmask_b32 v134, 0, v120, s[50:51]
    v_cndmask_b32 v135, 0, v121, s[50:51]
    v_mfma_f32_16x16x32_bf16 v[224:227], a[220:223], v[128:131], v[224:227]
    v_cndmask_b32 v136, 0, v120, s[52:53]
    v_cndmask_b32 v137, 0, v121, s[52:53]
    v_mfma_f32_16x16x32_bf16 v[228:231], a[224:227], v[128:131], v[228:231]
    v_cndmask_b32 v138, 0, v120, s[54:55]
    v_cndmask_b32 v139, 0, v121, s[54:55]
    v_mfma_f32_16x16x32_bf16 v[224:227], a[228:231], v[132:135], v[224:227]
    v_mfma_f32_16x16x32_bf16 v[228:231], a[232:235], v[132:135], v[228:231]
    v_mfma_f32_16x16x32_bf16 v[224:227], a[236:239], v[136:139], v[224:227]
    v_mfma_f32_16x16x32_bf16 v[228:231], a[240:243], v[136:139], v[228:231]
    s_nop 6
    v_cvt_pk_bf16_f32 v112, v224, v225
    v_cvt_pk_bf16_f32 v113, v226, v227
    v_cvt_pk_bf16_f32 v114, v228, v229
    v_cvt_pk_bf16_f32 v115, v230, v231
    buffer_store_dwordx4 v[112:115], v2, s[68:71], s56 offen sc1
    s_branch attn_moed
attn_nomoe:
    v_readfirstlane_b32 s9, v249
    v_readfirstlane_b32 s8, v248
    s_andn2_b32 s11, 2047, s9
    s_andn2_b32 s10, 2047, s8
    buffer_store_dwordx4 v[208:211], v13, s[64:67], s20 offen offset:0 sc1
    buffer_store_dwordx4 v[212:215], v13, s[64:67], s20 offen offset:64 sc1
    buffer_store_dwordx4 v[216:219], v13, s[64:67], s21 offen offset:0 sc1
    buffer_store_dwordx4 v[220:223], v13, s[64:67], s21 offen offset:64 sc1
attn_moed:
    s_mov_b32 s14, 0
attn_sel:
    s_lshr_b32 s36, s10, 7
    s_cmp_lg_u32 s36, s16
    s_cbranch_scc1 attn_next
    s_lshl_b32 s15, s14, 4
    s_add_u32 s15, s15, s17
    s_lshl_b32 s15, s15, 2
    s_add_u32 s15, s15, s28
    s_mul_i32 s15, s15, 57344
    s_add_u32 s15, s15, 20975616
    s_lshl_b32 s12, s10, 11
    s_add_u32 s12, s12, s22
    s_and_b32 s37, s8, 0xfffff800
    s_ashr_i32 s38, s37, 31
    s_not_b32 s38, s38
    s_or_b32 s38, s38, 0x80000000
    s_xor_b32 s37, s37, s38
    v_mov_b32 v4, s37
    v_cvt_pk_bf16_f32 v4, v4, v4
    v_lshlrev_b32 v4, 16, v4
    v_mul_f32 v4, 3216550459, v4
    v_exp_f32 v4, v4
    s_lshl_b32 s37, s14, 11
    v_add_f32 v4, 1.0, v4
    v_rcp_f32 v4, v4
    s_add_u32 s37, s37, 16384
    v_cvt_pk_bf16_f32 v4, v4, v4
    v_lshlrev_b32 v4, 16, v4
    s_lshl_b32 s38, s28, 8
    s_add_u32 s38, s38, s37
    v_bfe_u32 v1, v0, 2, 1
    v_lshl_add_u32 v1, v1, 7, s38
    v_and_b32 v2, 3, v0
    v_lshl_add_u32 v1, v2, 4, v1
    v_bfe_u32 v2, v0, 4, 1
    v_lshl_add_u32 v1, v2, 6, v1
    v_lshl_add_u32 v2, v5, 1, s37
    v_lshl_add_u32 v3, v15, 4, s37
    v_lshlrev_b32 v6, 4, v15
    v_add_u32 v6, 135936, v6
    v_cmp_eq_u32 vcc, s8, v10
    s_and_b64 exec, exec, vcc
    s_cbranch_execz attn_no0
    ds_write_b128 v2, v[16:19] offset:1024
    ds_write_b128 v2, v[20:23] offset:1040
    ds_write_b128 v2, v[24:27] offset:1152
    ds_write_b128 v2, v[28:31] offset:1168
    ds_write_b128 v2, v[64:67] offset:1280
    ds_write_b128 v2, v[68:71] offset:1296
    ds_write_b128 v2, v[72:75] offset:1408
    ds_write_b128 v2, v[76:79] offset:1424
attn_no0:
    s_mov_b64 exec, -1
    v_cmp_eq_u32 vcc, s8, v11
    s_and_b64 exec, exec, vcc
    s_cbranch_execz attn_no1
    ds_write_b128 v2, v[32:35] offset:1024
    ds_write_b128 v2, v[36:39] offset:1040
    ds_write_b128 v2, v[40:43] offset:1152
    ds_write_b128 v2, v[44:47] offset:1168
    ds_write_b128 v2, v[80:83] offset:1280
    ds_write_b128 v2, v[84:87] offset:1296
    ds_write_b128 v2, v[88:91] offset:1408
    ds_write_b128 v2, v[92:95] offset:1424
attn_no1:
    s_mov_b64 exec, -1
    ds_read_b128 v[208:211], v6
    s_waitcnt vmcnt(0)
    s_mov_b32 s36, s15
    buffer_load_dwordx4 v[152:155], v12, s[68:71], s36 offen sc1
    s_add_u32 s36, s36, 8192
    buffer_load_dwordx4 v[156:159], v12, s[68:71], s36 offen sc1
    s_add_u32 s36, s36, 8192
    buffer_load_dwordx4 v[160:163], v12, s[68:71], s36 offen sc1
    s_add_u32 s36, s36, 8192
    buffer_load_dwordx4 v[164:167], v12, s[68:71], s36 offen sc1
    s_add_u32 s36, s36, 8192
    buffer_load_dwordx4 v[168:171], v12, s[68:71], s36 offen sc1
    s_add_u32 s36, s36, 8192
    buffer_load_dwordx4 v[172:175], v12, s[68:71], s36 offen sc1
    s_add_u32 s36, s36, 8192
    buffer_load_dwordx4 v[176:179], v12, s[68:71], s36 offen sc1
    s_add_u32 s36, s36, 8192
    v_and_b32 v8, 1, v0
    v_lshlrev_b32 v8, 4, v8
    v_mov_b32 v9, 0x3f80
    v_lshlrev_b32 v9, v8, v9
    v_bfe_u32 v8, v0, 1, 2
    v_cmp_eq_u32 vcc, 0, v8
    s_nop 1
    v_cndmask_b32 v180, 0, v9, vcc
    v_cmp_eq_u32 vcc, 1, v8
    s_nop 1
    v_cndmask_b32 v181, 0, v9, vcc
    v_cmp_eq_u32 vcc, 2, v8
    s_nop 1
    v_cndmask_b32 v182, 0, v9, vcc
    v_cmp_eq_u32 vcc, 3, v8
    s_nop 1
    v_cndmask_b32 v183, 0, v9, vcc
    s_nop 0
    s_waitcnt vmcnt(0)
    v_mfma_f32_16x16x32_bf16 v[96:99], v[180:183], v[152:155], 0
    v_max_u32 v8, v152, v153
    v_max_u32 v9, v154, v155
    v_mfma_f32_16x16x32_bf16 v[96:99], v[180:183], v[156:159], v[96:99]
    v_max3_u32 v8, v8, v156, v157
    v_max3_u32 v9, v9, v158, v159
    v_mfma_f32_16x16x32_bf16 v[96:99], v[180:183], v[160:163], v[96:99]
    v_max3_u32 v8, v8, v160, v161
    v_max3_u32 v9, v9, v162, v163
    v_mfma_f32_16x16x32_bf16 v[96:99], v[180:183], v[164:167], v[96:99]
    v_max3_u32 v8, v8, v164, v165
    v_max3_u32 v9, v9, v166, v167
    v_mfma_f32_16x16x32_bf16 v[96:99], v[180:183], v[168:171], v[96:99]
    v_max3_u32 v8, v8, v168, v169
    v_max3_u32 v9, v9, v170, v171
    v_mfma_f32_16x16x32_bf16 v[96:99], v[180:183], v[172:175], v[96:99]
    v_max3_u32 v8, v8, v172, v173
    v_max3_u32 v9, v9, v174, v175
    v_mfma_f32_16x16x32_bf16 v[96:99], v[180:183], v[176:179], v[96:99]
    v_max3_u32 v8, v8, v176, v177
    v_max3_u32 v9, v9, v178, v179
    v_max_u32 v8, v8, v9
    v_cmp_eq_u32 vcc, -1, v8
    s_mov_b32 s4, 0
    s_nop 0
    s_cbranch_vccnz attn_p12_r
attn_p12_k:
    s_nop 2
    v_add_f32_dpp v96, v96, v96 row_ror:8 row_mask:0xf bank_mask:0xf
    v_add_f32_dpp v97, v97, v97 row_ror:8 row_mask:0xf bank_mask:0xf
    v_add_f32_dpp v98, v98, v98 row_ror:8 row_mask:0xf bank_mask:0xf
    v_add_f32_dpp v99, v99, v99 row_ror:8 row_mask:0xf bank_mask:0xf
    ds_write_b128 v1, v[96:99]
    v_lshlrev_b32 v2, 3, v15
    s_waitcnt lgkmcnt(0)
    s_barrier
    s_cmp_lg_u32 s28, 0
    s_cbranch_scc1 attn_nown
    ds_read_b128 v[96:99], v3 offset:0
    ds_read_b128 v[100:103], v3 offset:256
    ds_read_b128 v[104:107], v3 offset:512
    ds_read_b128 v[108:111], v3 offset:768
    ds_read_b128 v[112:115], v3 offset:1024
    ds_read_b128 v[116:119], v3 offset:1280
    s_waitcnt lgkmcnt(2)
    v_pk_add_f32 v[96:97], v[96:97], v[100:101]
    v_pk_add_f32 v[98:99], v[98:99], v[102:103]
    v_pk_add_f32 v[104:105], v[104:105], v[108:109]
    v_pk_add_f32 v[106:107], v[106:107], v[110:111]
    v_pk_add_f32 v[96:97], v[96:97], v[104:105]
    v_pk_add_f32 v[98:99], v[98:99], v[106:107]
    v_pk_mul_f32 v[96:97], v[96:97], v[4:5] op_sel_hi:[1,0]
    v_pk_mul_f32 v[98:99], v[98:99], v[4:5] op_sel_hi:[1,0]
    s_waitcnt lgkmcnt(0)
    v_pk_add_f32 v[96:97], v[96:97], v[116:117]
    v_pk_add_f32 v[98:99], v[98:99], v[118:119]
    v_pk_mul_f32 v[96:97], v[96:97], v[208:209]
    v_pk_mul_f32 v[98:99], v[98:99], v[210:211]
    v_pk_add_f32 v[96:97], v[96:97], v[112:113]
    v_pk_add_f32 v[98:99], v[98:99], v[114:115]
    v_cvt_pk_bf16_f32 v100, v96, v97
    v_cvt_pk_bf16_f32 v101, v98, v99
    buffer_store_dwordx2 v[100:101], v2, s[64:67], s12 offen sc1
attn_nown:
attn_next:
    s_mov_b32 s8, s9
    s_mov_b32 s10, s11
    s_add_u32 s14, s14, 1
    s_cmp_lt_u32 s14, 2
    s_cbranch_scc1 attn_sel
attn_end:
    s_endpgm
attn_p1_r:
    s_add_u32 s36, s20, 0
    buffer_load_dword v96, v85, s[68:71], s36 offen sc1
    s_add_u32 s36, s20, 8448
    buffer_load_dword v97, v85, s[68:71], s36 offen sc1
    s_add_u32 s36, s20, 16896
    buffer_load_dword v98, v85, s[68:71], s36 offen sc1
    s_add_u32 s36, s20, 25344
    buffer_load_dword v99, v85, s[68:71], s36 offen sc1
    s_add_u32 s36, s20, 33792
    buffer_load_dword v100, v85, s[68:71], s36 offen sc1
    s_add_u32 s36, s20, 42240
    buffer_load_dword v101, v85, s[68:71], s36 offen sc1
    s_add_u32 s36, s20, 50688
    buffer_load_dword v102, v85, s[68:71], s36 offen sc1
    s_add_u32 s36, s20, 59136
    buffer_load_dword v103, v85, s[68:71], s36 offen sc1
    buffer_load_dwordx2 v[104:105], v86, s[68:71], s21 offen offset:0 sc1
    buffer_load_dwordx2 v[106:107], v86, s[68:71], s21 offen offset:1024 sc1
    buffer_load_dwordx2 v[108:109], v86, s[68:71], s21 offen offset:2048 sc1
    buffer_load_dwordx2 v[110:111], v86, s[68:71], s21 offen offset:3072 sc1
    s_waitcnt vmcnt(0)
    v_xor_b32 v96, s84, v96
    v_xor_b32 v97, s84, v97
    v_xor_b32 v98, s84, v98
    v_xor_b32 v99, s84, v99
    v_xor_b32 v100, s84, v100
    v_xor_b32 v101, s84, v101
    v_xor_b32 v102, s84, v102
    v_xor_b32 v103, s84, v103
    v_xor_b32 v105, s85, v105
    v_xor_b32 v107, s85, v107
    v_xor_b32 v109, s85, v109
    v_xor_b32 v111, s85, v111
    v_or_b32 v80, v96, v97
    v_or_b32 v81, v98, v99
    v_or3_b32 v80, v80, v100, v101
    v_or3_b32 v81, v81, v102, v103
    v_or3_b32 v89, v105, v107, v109
    v_or_b32 v80, v80, v81
    v_and_b32 v80, 255, v80
    v_or3_b32 v80, v80, v89, v111
    v_cmp_ne_u32 vcc, 0, v80
    s_add_u32 s4, s4, 1
    s_cmp_ge_u32 s4, 400000
    s_cbranch_scc1 attn_p1_k
    s_cbranch_vccnz attn_p1_r
    s_branch attn_p1_k
attn_p2_r:
    buffer_load_dword v14, v230, s[68:71], s23 offen sc1
    s_waitcnt vmcnt(0)
    v_cmp_ne_u32 vcc, s85, v14
    s_add_u32 s4, s4, 1
    s_cmp_ge_u32 s4, 400000
    s_cbranch_scc1 attn_p2_k
    s_cbranch_vccnz attn_p2_r
    s_branch attn_p2_k
attn_p3_r:
    v_mov_b32 v15, 0
    s_mov_b64 exec, 0xf
    buffer_atomic_or v15, v253, s[68:71], s20 offen sc0 sc1
    s_mov_b64 exec, -1
    s_waitcnt vmcnt(0)
    v_cmp_ne_u32 vcc, s85, v15
    s_and_b64 vcc, vcc, 0xf
    s_add_u32 s4, s4, 1
    s_cmp_ge_u32 s4, 400000
    s_cbranch_scc1 attn_p3_k
    s_cbranch_vccnz attn_p3_r
    s_branch attn_p3_k
attn_p4_r:
    v_mov_b32 v250, 0
    buffer_atomic_or v250, v251, s[68:71], s79 offen offset:512 sc0 sc1
    s_waitcnt vmcnt(0)
    v_cmp_ne_u32 vcc, s85, v250
    s_and_b64 vcc, vcc, 15
    s_add_u32 s4, s4, 1
    s_cmp_ge_u32 s4, 400000
    s_cbranch_scc1 attn_p4_k
    s_cbranch_vccnz attn_p4_r
    s_branch attn_p4_k
attn_p5_r:
    buffer_load_dwordx4 v[232:235], v14, s[68:71], s36 offen sc1
    buffer_load_dwordx4 v[236:239], v14, s[68:71], s37 offen sc1
    buffer_load_dwordx4 v[240:243], v14, s[68:71], s38 offen sc1
    buffer_load_dwordx4 v[244:247], v14, s[68:71], s39 offen sc1
    buffer_load_dword v248, off, s[68:71], s23 sc1
    buffer_load_dword v249, off, s[68:71], s78 sc1
    s_waitcnt vmcnt(0)
    v_xor_b32 v248, s85, v248
    v_xor_b32 v249, s85, v249
    v_or_b32 v248, v248, v249
    v_cmp_ne_u32 vcc, 0, v248
    v_mov_b32 v249, 0
    s_nop 0
    v_cndmask_b32 v248, 0, -1, vcc
    v_max_u32 v250, v232, v233
    v_max_u32 v251, v234, v235
    v_max3_u32 v250, v250, v236, v237
    v_max3_u32 v251, v251, v238, v239
    v_max3_u32 v250, v250, v240, v241
    v_max3_u32 v251, v251, v242, v243
    v_max3_u32 v250, v250, v244, v245
    v_max3_u32 v251, v251, v246, v247
    v_max3_u32 v250, v250, v248, v249
    v_max_u32 v250, v250, v251
    v_cmp_eq_u32 vcc, -1, v250
    s_add_u32 s4, s4, 1
    s_cmp_ge_u32 s4, 400000
    s_cbranch_scc1 attn_p5_k
    s_cbranch_vccnz attn_p5_r
    s_branch attn_p5_k
attn_p6_r:
    buffer_load_dwordx4 v[232:235], v14, s[68:71], s36 offen sc1
    buffer_load_dwordx4 v[236:239], v14, s[68:71], s37 offen sc1
    buffer_load_dwordx4 v[240:243], v14, s[68:71], s38 offen sc1
    buffer_load_dwordx4 v[244:247], v14, s[68:71], s39 offen sc1
    buffer_load_dword v248, off, s[68:71], s23 sc1
    buffer_load_dword v249, off, s[68:71], s78 sc1
    s_waitcnt vmcnt(0)
    v_xor_b32 v248, s85, v248
    v_xor_b32 v249, s85, v249
    v_or_b32 v248, v248, v249
    v_cmp_ne_u32 vcc, 0, v248
    v_mov_b32 v249, 0
    s_nop 0
    v_cndmask_b32 v248, 0, -1, vcc
    v_max_u32 v250, v232, v233
    v_max_u32 v251, v234, v235
    v_max3_u32 v250, v250, v236, v237
    v_max3_u32 v251, v251, v238, v239
    v_max3_u32 v250, v250, v240, v241
    v_max3_u32 v251, v251, v242, v243
    v_max3_u32 v250, v250, v244, v245
    v_max3_u32 v251, v251, v246, v247
    v_max3_u32 v250, v250, v248, v249
    v_max_u32 v250, v250, v251
    v_cmp_eq_u32 vcc, -1, v250
    s_add_u32 s4, s4, 1
    s_cmp_ge_u32 s4, 400000
    s_cbranch_scc1 attn_p6_k
    s_cbranch_vccnz attn_p6_r
    s_branch attn_p6_k
attn_tk:
    s_waitcnt vmcnt(35) lgkmcnt(0)
    v_mfma_f32_16x16x32_bf16 v[16:19], v[144:147], a[64:67], v[16:19]
    s_add_u32 m0, s30, 50688
    s_add_u32 s32, s32, 65536
    v_mfma_f32_16x16x32_bf16 v[16:19], v[148:151], a[80:83], v[16:19]
    s_add_u32 s33, s33, 163840
    v_mfma_f32_16x16x32_bf16 v[48:51], v[148:151], a[84:87], v[48:51]
    ds_read_b64_tr_b16 v[176:177], v4 offset:16896
    ds_read_b64_tr_b16 v[178:179], v4 offset:17408
    v_mfma_f32_16x16x32_bf16 v[48:51], v[144:147], a[68:71], v[48:51]
    buffer_load_dwordx4 a[16:19], v10, s[68:71], s33 offen sc1
    v_mfma_f32_16x16x32_bf16 v[80:83], v[144:147], a[72:75], v[80:83]
    ds_read_b64_tr_b16 v[180:181], v4 offset:33792
    ds_read_b64_tr_b16 v[182:183], v4 offset:34304
    v_mfma_f32_16x16x32_bf16 v[80:83], v[148:151], a[88:91], v[80:83]
    v_mfma_f32_16x16x32_bf16 v[112:115], v[148:151], a[92:95], v[112:115]
    ds_read_b64_tr_b16 v[184:185], v4 offset:16904
    ds_read_b64_tr_b16 v[186:187], v4 offset:17416
    v_mfma_f32_16x16x32_bf16 v[112:115], v[144:147], a[76:79], v[112:115]
    buffer_load_dwordx4 a[20:23], v11, s[68:71], s33 offen sc1
    v_mfma_f32_16x16x32_bf16 v[116:119], v[152:155], a[76:79], v[116:119]
    ds_read_b64_tr_b16 v[188:189], v4 offset:33800
    ds_read_b64_tr_b16 v[190:191], v4 offset:34312
    v_mfma_f32_16x16x32_bf16 v[116:119], v[156:159], a[92:95], v[116:119]
    v_mfma_f32_16x16x32_bf16 v[84:87], v[156:159], a[88:91], v[84:87]
    ds_read_b64_tr_b16 v[192:193], v4 offset:16960
    ds_read_b64_tr_b16 v[194:195], v4 offset:17472
    v_mfma_f32_16x16x32_bf16 v[84:87], v[152:155], a[72:75], v[84:87]
    buffer_load_dwordx4 a[24:27], v252, s[68:71], s33 offen sc1
    v_mfma_f32_16x16x32_bf16 v[52:55], v[152:155], a[68:71], v[52:55]
    ds_read_b64_tr_b16 v[196:197], v4 offset:33856
    ds_read_b64_tr_b16 v[198:199], v4 offset:34368
    v_mfma_f32_16x16x32_bf16 v[52:55], v[156:159], a[84:87], v[52:55]
    v_mfma_f32_16x16x32_bf16 v[20:23], v[156:159], a[80:83], v[20:23]
    ds_read_b64_tr_b16 v[200:201], v4 offset:16968
    ds_read_b64_tr_b16 v[202:203], v4 offset:17480
    v_mfma_f32_16x16x32_bf16 v[20:23], v[152:155], a[64:67], v[20:23]
    buffer_load_dwordx4 a[28:31], v254, s[68:71], s33 offen sc1
    v_mfma_f32_16x16x32_bf16 v[24:27], v[160:163], a[64:67], v[24:27]
    ds_read_b64_tr_b16 v[204:205], v4 offset:33864
    ds_read_b64_tr_b16 v[206:207], v4 offset:34376
    v_mfma_f32_16x16x32_bf16 v[24:27], v[164:167], a[80:83], v[24:27]
    v_mfma_f32_16x16x32_bf16 v[56:59], v[164:167], a[84:87], v[56:59]
    v_mfma_f32_16x16x32_bf16 v[56:59], v[160:163], a[68:71], v[56:59]
    buffer_load_dwordx4 v6, s[48:51], s32 offen offset:0 lds
    v_mfma_f32_16x16x32_bf16 v[88:91], v[160:163], a[72:75], v[88:91]
    v_mfma_f32_16x16x32_bf16 v[88:91], v[164:167], a[88:91], v[88:91]
    v_mfma_f32_16x16x32_bf16 v[120:123], v[164:167], a[92:95], v[120:123]
    buffer_load_dwordx4 v7, s[48:51], s32 offen offset:1056 lds
    v_mfma_f32_16x16x32_bf16 v[120:123], v[160:163], a[76:79], v[120:123]
    v_mfma_f32_16x16x32_bf16 v[124:127], v[168:171], a[76:79], v[124:127]
    v_mfma_f32_16x16x32_bf16 v[124:127], v[172:175], a[92:95], v[124:127]
    buffer_load_dwordx4 v8, s[48:51], s32 offen offset:2112 lds
    v_mfma_f32_16x16x32_bf16 v[92:95], v[172:175], a[88:91], v[92:95]
    v_mfma_f32_16x16x32_bf16 v[92:95], v[168:171], a[72:75], v[92:95]
    v_mfma_f32_16x16x32_bf16 v[60:63], v[168:171], a[68:71], v[60:63]
    buffer_load_dwordx4 v9, s[48:51], s32 offen offset:3168 lds
    v_mfma_f32_16x16x32_bf16 v[60:63], v[172:175], a[84:87], v[60:63]
    v_mfma_f32_16x16x32_bf16 v[28:31], v[172:175], a[80:83], v[28:31]
    v_mfma_f32_16x16x32_bf16 v[28:31], v[168:171], a[64:67], v[28:31]
    s_waitcnt vmcnt(29) lgkmcnt(0)
    s_barrier
    v_mfma_f32_16x16x32_bf16 v[32:35], v[176:179], a[64:67], v[32:35]
    s_add_u32 m0, s30, 67584
    s_add_u32 s32, s32, 65536
    v_mfma_f32_16x16x32_bf16 v[32:35], v[180:183], a[80:83], v[32:35]
    s_add_u32 s33, s33, 163840
    v_mfma_f32_16x16x32_bf16 v[64:67], v[180:183], a[84:87], v[64:67]
    ds_read_b64_tr_b16 v[144:145], v3 offset:50688
    ds_read_b64_tr_b16 v[146:147], v3 offset:51200
    v_mfma_f32_16x16x32_bf16 v[64:67], v[176:179], a[68:71], v[64:67]
    buffer_load_dwordx4 a[32:35], v10, s[68:71], s33 offen sc1
    v_mfma_f32_16x16x32_bf16 v[96:99], v[176:179], a[72:75], v[96:99]
    ds_read_b64_tr_b16 v[148:149], v1 offset:0
    ds_read_b64_tr_b16 v[150:151], v1 offset:512
    v_mfma_f32_16x16x32_bf16 v[96:99], v[180:183], a[88:91], v[96:99]
    v_mfma_f32_16x16x32_bf16 v[128:131], v[180:183], a[92:95], v[128:131]
    ds_read_b64_tr_b16 v[152:153], v3 offset:50696
    ds_read_b64_tr_b16 v[154:155], v3 offset:51208
    v_mfma_f32_16x16x32_bf16 v[128:131], v[176:179], a[76:79], v[128:131]
    buffer_load_dwordx4 a[36:39], v11, s[68:71], s33 offen sc1
    v_mfma_f32_16x16x32_bf16 v[132:135], v[184:187], a[76:79], v[132:135]
    ds_read_b64_tr_b16 v[156:157], v1 offset:8
    ds_read_b64_tr_b16 v[158:159], v1 offset:520
    v_mfma_f32_16x16x32_bf16 v[132:135], v[188:191], a[92:95], v[132:135]
    v_mfma_f32_16x16x32_bf16 v[100:103], v[188:191], a[88:91], v[100:103]
    ds_read_b64_tr_b16 v[160:161], v3 offset:50752
    ds_read_b64_tr_b16 v[162:163], v3 offset:51264
    v_mfma_f32_16x16x32_bf16 v[100:103], v[184:187], a[72:75], v[100:103]
    buffer_load_dwordx4 a[40:43], v252, s[68:71], s33 offen sc1
    v_mfma_f32_16x16x32_bf16 v[68:71], v[184:187], a[68:71], v[68:71]
    ds_read_b64_tr_b16 v[164:165], v1 offset:64
    ds_read_b64_tr_b16 v[166:167], v1 offset:576
    v_mfma_f32_16x16x32_bf16 v[68:71], v[188:191], a[84:87], v[68:71]
    v_mfma_f32_16x16x32_bf16 v[36:39], v[188:191], a[80:83], v[36:39]
    ds_read_b64_tr_b16 v[168:169], v3 offset:50760
    ds_read_b64_tr_b16 v[170:171], v3 offset:51272
    v_mfma_f32_16x16x32_bf16 v[36:39], v[184:187], a[64:67], v[36:39]
    buffer_load_dwordx4 a[44:47], v254, s[68:71], s33 offen sc1
    v_mfma_f32_16x16x32_bf16 v[40:43], v[192:195], a[64:67], v[40:43]
    ds_read_b64_tr_b16 v[172:173], v1 offset:72
    ds_read_b64_tr_b16 v[174:175], v1 offset:584
    v_mfma_f32_16x16x32_bf16 v[40:43], v[196:199], a[80:83], v[40:43]
    v_mfma_f32_16x16x32_bf16 v[72:75], v[196:199], a[84:87], v[72:75]
    v_mfma_f32_16x16x32_bf16 v[72:75], v[192:195], a[68:71], v[72:75]
    buffer_load_dwordx4 v6, s[48:51], s32 offen offset:0 lds
    v_mfma_f32_16x16x32_bf16 v[104:107], v[192:195], a[72:75], v[104:107]
    v_mfma_f32_16x16x32_bf16 v[104:107], v[196:199], a[88:91], v[104:107]
    v_mfma_f32_16x16x32_bf16 v[136:139], v[196:199], a[92:95], v[136:139]
    buffer_load_dwordx4 v7, s[48:51], s32 offen offset:1056 lds
    v_mfma_f32_16x16x32_bf16 v[136:139], v[192:195], a[76:79], v[136:139]
    v_mfma_f32_16x16x32_bf16 v[140:143], v[200:203], a[76:79], v[140:143]
    v_mfma_f32_16x16x32_bf16 v[140:143], v[204:207], a[92:95], v[140:143]
    buffer_load_dwordx4 v8, s[48:51], s32 offen offset:2112 lds
    v_mfma_f32_16x16x32_bf16 v[108:111], v[204:207], a[88:91], v[108:111]
    v_mfma_f32_16x16x32_bf16 v[108:111], v[200:203], a[72:75], v[108:111]
    v_mfma_f32_16x16x32_bf16 v[76:79], v[200:203], a[68:71], v[76:79]
    buffer_load_dwordx4 v9, s[48:51], s32 offen offset:3168 lds
    v_mfma_f32_16x16x32_bf16 v[76:79], v[204:207], a[84:87], v[76:79]
    v_mfma_f32_16x16x32_bf16 v[44:47], v[204:207], a[80:83], v[44:47]
    v_mfma_f32_16x16x32_bf16 v[44:47], v[200:203], a[64:67], v[44:47]
    s_waitcnt vmcnt(31) lgkmcnt(0)
    v_mfma_f32_16x16x32_bf16 v[16:19], v[144:147], a[96:99], v[16:19]
    s_add_u32 m0, s30, 84480
    s_add_u32 s32, s32, 65536
    v_mfma_f32_16x16x32_bf16 v[16:19], v[148:151], a[112:115], v[16:19]
    s_add_u32 s33, s33, 163840
    v_mfma_f32_16x16x32_bf16 v[48:51], v[148:151], a[116:119], v[48:51]
    ds_read_b64_tr_b16 v[176:177], v4 offset:50688
    ds_read_b64_tr_b16 v[178:179], v4 offset:51200
    v_mfma_f32_16x16x32_bf16 v[48:51], v[144:147], a[100:103], v[48:51]
    buffer_load_dwordx4 a[48:51], v10, s[68:71], s33 offen sc1
    v_mfma_f32_16x16x32_bf16 v[80:83], v[144:147], a[104:107], v[80:83]
    ds_read_b64_tr_b16 v[180:181], v2 offset:0
    ds_read_b64_tr_b16 v[182:183], v2 offset:512
    v_mfma_f32_16x16x32_bf16 v[80:83], v[148:151], a[120:123], v[80:83]
    v_mfma_f32_16x16x32_bf16 v[112:115], v[148:151], a[124:127], v[112:115]
    ds_read_b64_tr_b16 v[184:185], v4 offset:50696
    ds_read_b64_tr_b16 v[186:187], v4 offset:51208
    v_mfma_f32_16x16x32_bf16 v[112:115], v[144:147], a[108:111], v[112:115]
    buffer_load_dwordx4 a[52:55], v11, s[68:71], s33 offen sc1
    v_mfma_f32_16x16x32_bf16 v[116:119], v[152:155], a[108:111], v[116:119]
    ds_read_b64_tr_b16 v[188:189], v2 offset:8
    ds_read_b64_tr_b16 v[190:191], v2 offset:520
    v_mfma_f32_16x16x32_bf16 v[116:119], v[156:159], a[124:127], v[116:119]
    v_mfma_f32_16x16x32_bf16 v[84:87], v[156:159], a[120:123], v[84:87]
    ds_read_b64_tr_b16 v[192:193], v4 offset:50752
    ds_read_b64_tr_b16 v[194:195], v4 offset:51264
    v_mfma_f32_16x16x32_bf16 v[84:87], v[152:155], a[104:107], v[84:87]
    buffer_load_dwordx4 a[56:59], v252, s[68:71], s33 offen sc1
    v_mfma_f32_16x16x32_bf16 v[52:55], v[152:155], a[100:103], v[52:55]
    ds_read_b64_tr_b16 v[196:197], v2 offset:64
    ds_read_b64_tr_b16 v[198:199], v2 offset:576
    v_mfma_f32_16x16x32_bf16 v[52:55], v[156:159], a[116:119], v[52:55]
    v_mfma_f32_16x16x32_bf16 v[20:23], v[156:159], a[112:115], v[20:23]
    ds_read_b64_tr_b16 v[200:201], v4 offset:50760
    ds_read_b64_tr_b16 v[202:203], v4 offset:51272
    v_mfma_f32_16x16x32_bf16 v[20:23], v[152:155], a[96:99], v[20:23]
    buffer_load_dwordx4 a[60:63], v254, s[68:71], s33 offen sc1
    v_mfma_f32_16x16x32_bf16 v[24:27], v[160:163], a[96:99], v[24:27]
    ds_read_b64_tr_b16 v[204:205], v2 offset:72
    ds_read_b64_tr_b16 v[206:207], v2 offset:584
    v_mfma_f32_16x16x32_bf16 v[24:27], v[164:167], a[112:115], v[24:27]
    v_mfma_f32_16x16x32_bf16 v[56:59], v[164:167], a[116:119], v[56:59]
    v_mfma_f32_16x16x32_bf16 v[56:59], v[160:163], a[100:103], v[56:59]
    buffer_load_dwordx4 v6, s[48:51], s32 offen offset:0 lds
    v_mfma_f32_16x16x32_bf16 v[88:91], v[160:163], a[104:107], v[88:91]
    v_mfma_f32_16x16x32_bf16 v[88:91], v[164:167], a[120:123], v[88:91]
    v_mfma_f32_16x16x32_bf16 v[120:123], v[164:167], a[124:127], v[120:123]
    buffer_load_dwordx4 v7, s[48:51], s32 offen offset:1056 lds
    v_mfma_f32_16x16x32_bf16 v[120:123], v[160:163], a[108:111], v[120:123]
    v_mfma_f32_16x16x32_bf16 v[124:127], v[168:171], a[108:111], v[124:127]
    v_mfma_f32_16x16x32_bf16 v[124:127], v[172:175], a[124:127], v[124:127]
    buffer_load_dwordx4 v8, s[48:51], s32 offen offset:2112 lds
    v_mfma_f32_16x16x32_bf16 v[92:95], v[172:175], a[120:123], v[92:95]
    v_mfma_f32_16x16x32_bf16 v[92:95], v[168:171], a[104:107], v[92:95]
    v_mfma_f32_16x16x32_bf16 v[60:63], v[168:171], a[100:103], v[60:63]
    buffer_load_dwordx4 v9, s[48:51], s32 offen offset:3168 lds
    v_mfma_f32_16x16x32_bf16 v[60:63], v[172:175], a[116:119], v[60:63]
    v_mfma_f32_16x16x32_bf16 v[28:31], v[172:175], a[112:115], v[28:31]
    v_mfma_f32_16x16x32_bf16 v[28:31], v[168:171], a[96:99], v[28:31]
    s_waitcnt vmcnt(24) lgkmcnt(0)
    s_barrier
    v_mfma_f32_16x16x32_bf16 v[32:35], v[176:179], a[96:99], v[32:35]
    s_add_u32 m0, s30, 101376
    s_add_u32 s32, s32, 65536
    v_mfma_f32_16x16x32_bf16 v[32:35], v[180:183], a[112:115], v[32:35]
    s_add_u32 s33, s33, 163840
    v_mfma_f32_16x16x32_bf16 v[64:67], v[180:183], a[116:119], v[64:67]
    ds_read_b64_tr_b16 v[144:145], v1 offset:16896
    ds_read_b64_tr_b16 v[146:147], v1 offset:17408
    v_mfma_f32_16x16x32_bf16 v[64:67], v[176:179], a[100:103], v[64:67]
    buffer_load_dwordx4 a[64:67], v10, s[68:71], s33 offen sc1
    v_mfma_f32_16x16x32_bf16 v[96:99], v[176:179], a[104:107], v[96:99]
    ds_read_b64_tr_b16 v[148:149], v1 offset:33792
    ds_read_b64_tr_b16 v[150:151], v1 offset:34304
    v_mfma_f32_16x16x32_bf16 v[96:99], v[180:183], a[120:123], v[96:99]
    v_mfma_f32_16x16x32_bf16 v[128:131], v[180:183], a[124:127], v[128:131]
    ds_read_b64_tr_b16 v[152:153], v1 offset:16904
    ds_read_b64_tr_b16 v[154:155], v1 offset:17416
    v_mfma_f32_16x16x32_bf16 v[128:131], v[176:179], a[108:111], v[128:131]
    buffer_load_dwordx4 a[68:71], v11, s[68:71], s33 offen sc1
    v_mfma_f32_16x16x32_bf16 v[132:135], v[184:187], a[108:111], v[132:135]
    ds_read_b64_tr_b16 v[156:157], v1 offset:33800
    ds_read_b64_tr_b16 v[158:159], v1 offset:34312
    v_mfma_f32_16x16x32_bf16 v[132:135], v[188:191], a[124:127], v[132:135]
    v_mfma_f32_16x16x32_bf16 v[100:103], v[188:191], a[120:123], v[100:103]
    ds_read_b64_tr_b16 v[160:161], v1 offset:16960
    ds_read_b64_tr_b16 v[162:163], v1 offset:17472
    v_mfma_f32_16x16x32_bf16 v[100:103], v[184:187], a[104:107], v[100:103]
    buffer_load_dwordx4 a[72:75], v252, s[68:71], s33 offen sc1
    v_mfma_f32_16x16x32_bf16 v[68:71], v[184:187], a[100:103], v[68:71]
    ds_read_b64_tr_b16 v[164:165], v1 offset:33856
    ds_read_b64_tr_b16 v[166:167], v1 offset:34368
    v_mfma_f32_16x16x32_bf16 v[68:71], v[188:191], a[116:119], v[68:71]
    v_mfma_f32_16x16x32_bf16 v[36:39], v[188:191], a[112:115], v[36:39]
    ds_read_b64_tr_b16 v[168:169], v1 offset:16968
    ds_read_b64_tr_b16 v[170:171], v1 offset:17480
    v_mfma_f32_16x16x32_bf16 v[36:39], v[184:187], a[96:99], v[36:39]
    buffer_load_dwordx4 a[76:79], v254, s[68:71], s33 offen sc1
    v_mfma_f32_16x16x32_bf16 v[40:43], v[192:195], a[96:99], v[40:43]
    ds_read_b64_tr_b16 v[172:173], v1 offset:33864
    ds_read_b64_tr_b16 v[174:175], v1 offset:34376
    v_mfma_f32_16x16x32_bf16 v[40:43], v[196:199], a[112:115], v[40:43]
    v_mfma_f32_16x16x32_bf16 v[72:75], v[196:199], a[116:119], v[72:75]
    v_mfma_f32_16x16x32_bf16 v[72:75], v[192:195], a[100:103], v[72:75]
    buffer_load_dwordx4 v6, s[48:51], s32 offen offset:0 lds
    v_mfma_f32_16x16x32_bf16 v[104:107], v[192:195], a[104:107], v[104:107]
    v_mfma_f32_16x16x32_bf16 v[104:107], v[196:199], a[120:123], v[104:107]
    v_mfma_f32_16x16x32_bf16 v[136:139], v[196:199], a[124:127], v[136:139]
    buffer_load_dwordx4 v7, s[48:51], s32 offen offset:1056 lds
    v_mfma_f32_16x16x32_bf16 v[136:139], v[192:195], a[108:111], v[136:139]
    v_mfma_f32_16x16x32_bf16 v[140:143], v[200:203], a[108:111], v[140:143]
    v_mfma_f32_16x16x32_bf16 v[140:143], v[204:207], a[124:127], v[140:143]
    buffer_load_dwordx4 v8, s[48:51], s32 offen offset:2112 lds
    v_mfma_f32_16x16x32_bf16 v[108:111], v[204:207], a[120:123], v[108:111]
    v_mfma_f32_16x16x32_bf16 v[108:111], v[200:203], a[104:107], v[108:111]
    v_mfma_f32_16x16x32_bf16 v[76:79], v[200:203], a[100:103], v[76:79]
    buffer_load_dwordx4 v9, s[48:51], s32 offen offset:3168 lds
    v_mfma_f32_16x16x32_bf16 v[76:79], v[204:207], a[116:119], v[76:79]
    v_mfma_f32_16x16x32_bf16 v[44:47], v[204:207], a[112:115], v[44:47]
    v_mfma_f32_16x16x32_bf16 v[44:47], v[200:203], a[96:99], v[44:47]
    s_waitcnt vmcnt(28) lgkmcnt(0)
    v_mfma_f32_16x16x32_bf16 v[16:19], v[144:147], a[0:3], v[16:19]
    s_add_u32 m0, s30, 118272
    s_add_u32 s32, s32, 65536
    v_mfma_f32_16x16x32_bf16 v[16:19], v[148:151], a[16:19], v[16:19]
    s_add_u32 s33, s33, 163840
    v_mfma_f32_16x16x32_bf16 v[48:51], v[148:151], a[20:23], v[48:51]
    ds_read_b64_tr_b16 v[176:177], v2 offset:16896
    ds_read_b64_tr_b16 v[178:179], v2 offset:17408
    v_mfma_f32_16x16x32_bf16 v[48:51], v[144:147], a[4:7], v[48:51]
    buffer_load_dwordx4 a[80:83], v10, s[68:71], s33 offen sc1
    v_mfma_f32_16x16x32_bf16 v[80:83], v[144:147], a[8:11], v[80:83]
    ds_read_b64_tr_b16 v[180:181], v2 offset:33792
    ds_read_b64_tr_b16 v[182:183], v2 offset:34304
    v_mfma_f32_16x16x32_bf16 v[80:83], v[148:151], a[24:27], v[80:83]
    v_mfma_f32_16x16x32_bf16 v[112:115], v[148:151], a[28:31], v[112:115]
    ds_read_b64_tr_b16 v[184:185], v2 offset:16904
    ds_read_b64_tr_b16 v[186:187], v2 offset:17416
    v_mfma_f32_16x16x32_bf16 v[112:115], v[144:147], a[12:15], v[112:115]
    buffer_load_dwordx4 a[84:87], v11, s[68:71], s33 offen sc1
    v_mfma_f32_16x16x32_bf16 v[116:119], v[152:155], a[12:15], v[116:119]
    ds_read_b64_tr_b16 v[188:189], v2 offset:33800
    ds_read_b64_tr_b16 v[190:191], v2 offset:34312
    v_mfma_f32_16x16x32_bf16 v[116:119], v[156:159], a[28:31], v[116:119]
    v_mfma_f32_16x16x32_bf16 v[84:87], v[156:159], a[24:27], v[84:87]
    ds_read_b64_tr_b16 v[192:193], v2 offset:16960
    ds_read_b64_tr_b16 v[194:195], v2 offset:17472
    v_mfma_f32_16x16x32_bf16 v[84:87], v[152:155], a[8:11], v[84:87]
    buffer_load_dwordx4 a[88:91], v252, s[68:71], s33 offen sc1
    v_mfma_f32_16x16x32_bf16 v[52:55], v[152:155], a[4:7], v[52:55]
    ds_read_b64_tr_b16 v[196:197], v2 offset:33856
    ds_read_b64_tr_b16 v[198:199], v2 offset:34368
    v_mfma_f32_16x16x32_bf16 v[52:55], v[156:159], a[20:23], v[52:55]
    v_mfma_f32_16x16x32_bf16 v[20:23], v[156:159], a[16:19], v[20:23]
    ds_read_b64_tr_b16 v[200:201], v2 offset:16968
    ds_read_b64_tr_b16 v[202:203], v2 offset:17480
    v_mfma_f32_16x16x32_bf16 v[20:23], v[152:155], a[0:3], v[20:23]
    buffer_load_dwordx4 a[92:95], v254, s[68:71], s33 offen sc1
    v_mfma_f32_16x16x32_bf16 v[24:27], v[160:163], a[0:3], v[24:27]
    ds_read_b64_tr_b16 v[204:205], v2 offset:33864
    ds_read_b64_tr_b16 v[206:207], v2 offset:34376
    v_mfma_f32_16x16x32_bf16 v[24:27], v[164:167], a[16:19], v[24:27]
    v_mfma_f32_16x16x32_bf16 v[56:59], v[164:167], a[20:23], v[56:59]
    v_mfma_f32_16x16x32_bf16 v[56:59], v[160:163], a[4:7], v[56:59]
    buffer_load_dwordx4 v6, s[48:51], s32 offen offset:0 lds
    v_mfma_f32_16x16x32_bf16 v[88:91], v[160:163], a[8:11], v[88:91]
    v_mfma_f32_16x16x32_bf16 v[88:91], v[164:167], a[24:27], v[88:91]
    v_mfma_f32_16x16x32_bf16 v[120:123], v[164:167], a[28:31], v[120:123]
    buffer_load_dwordx4 v7, s[48:51], s32 offen offset:1056 lds
    v_mfma_f32_16x16x32_bf16 v[120:123], v[160:163], a[12:15], v[120:123]
    v_mfma_f32_16x16x32_bf16 v[124:127], v[168:171], a[12:15], v[124:127]
    v_mfma_f32_16x16x32_bf16 v[124:127], v[172:175], a[28:31], v[124:127]
    buffer_load_dwordx4 v8, s[48:51], s32 offen offset:2112 lds
    v_mfma_f32_16x16x32_bf16 v[92:95], v[172:175], a[24:27], v[92:95]
    v_mfma_f32_16x16x32_bf16 v[92:95], v[168:171], a[8:11], v[92:95]
    v_mfma_f32_16x16x32_bf16 v[60:63], v[168:171], a[4:7], v[60:63]
    buffer_load_dwordx4 v9, s[48:51], s32 offen offset:3168 lds
    v_mfma_f32_16x16x32_bf16 v[60:63], v[172:175], a[20:23], v[60:63]
    v_mfma_f32_16x16x32_bf16 v[28:31], v[172:175], a[16:19], v[28:31]
    v_mfma_f32_16x16x32_bf16 v[28:31], v[168:171], a[0:3], v[28:31]
    s_waitcnt vmcnt(48)
    v_xor_b32 v248, s85, v248
    v_xor_b32 v249, s85, v249
    v_or_b32 v248, v248, v249
    v_cmp_ne_u32 vcc, 0, v248
    v_mov_b32 v249, 0
    s_nop 0
    v_cndmask_b32 v248, 0, -1, vcc
    v_max_u32 v250, v232, v233
    v_max_u32 v251, v234, v235
    v_max3_u32 v250, v250, v236, v237
    v_max3_u32 v251, v251, v238, v239
    v_max3_u32 v250, v250, v240, v241
    v_max3_u32 v251, v251, v242, v243
    v_max3_u32 v250, v250, v244, v245
    v_max3_u32 v251, v251, v246, v247
    v_max3_u32 v250, v250, v248, v249
    v_max_u32 v250, v250, v251
    v_cmp_eq_u32 vcc, -1, v250
    s_mov_b32 s4, 0
    s_nop 0
    s_cbranch_vccnz attn_p5_r
attn_p5_k:
    s_waitcnt vmcnt(24) lgkmcnt(0)
    s_barrier
    v_mfma_f32_16x16x32_bf16 v[32:35], v[176:179], a[0:3], v[32:35]
    s_add_u32 m0, s30, 0
    s_add_u32 s32, s32, 65536
    v_mfma_f32_16x16x32_bf16 v[32:35], v[180:183], a[16:19], v[32:35]
    s_add_u32 s33, s33, 163840
    v_mfma_f32_16x16x32_bf16 v[64:67], v[180:183], a[20:23], v[64:67]
    ds_read_b64_tr_b16 v[144:145], v1 offset:50688
    ds_read_b64_tr_b16 v[146:147], v1 offset:51200
    v_mfma_f32_16x16x32_bf16 v[64:67], v[176:179], a[4:7], v[64:67]
    buffer_load_dwordx4 a[96:99], v10, s[68:71], s33 offen sc1
    v_mfma_f32_16x16x32_bf16 v[96:99], v[176:179], a[8:11], v[96:99]
    ds_read_b64_tr_b16 v[148:149], v3 offset:0
    ds_read_b64_tr_b16 v[150:151], v3 offset:512
    v_mfma_f32_16x16x32_bf16 v[96:99], v[180:183], a[24:27], v[96:99]
    v_add_f32 v232, v232, v236
    v_add_f32 v233, v233, v237
    v_mfma_f32_16x16x32_bf16 v[128:131], v[180:183], a[28:31], v[128:131]
    ds_read_b64_tr_b16 v[152:153], v1 offset:50696
    ds_read_b64_tr_b16 v[154:155], v1 offset:51208
    v_mfma_f32_16x16x32_bf16 v[128:131], v[176:179], a[12:15], v[128:131]
    buffer_load_dwordx4 a[100:103], v11, s[68:71], s33 offen sc1
    v_mfma_f32_16x16x32_bf16 v[132:135], v[184:187], a[12:15], v[132:135]
    ds_read_b64_tr_b16 v[156:157], v3 offset:8
    ds_read_b64_tr_b16 v[158:159], v3 offset:520
    v_mfma_f32_16x16x32_bf16 v[132:135], v[188:191], a[28:31], v[132:135]
    v_add_f32 v234, v234, v238
    v_add_f32 v235, v235, v239
    v_mfma_f32_16x16x32_bf16 v[100:103], v[188:191], a[24:27], v[100:103]
    ds_read_b64_tr_b16 v[160:161], v1 offset:50752
    ds_read_b64_tr_b16 v[162:163], v1 offset:51264
    v_mfma_f32_16x16x32_bf16 v[100:103], v[184:187], a[8:11], v[100:103]
    buffer_load_dwordx4 a[104:107], v252, s[68:71], s33 offen sc1
    v_mfma_f32_16x16x32_bf16 v[68:71], v[184:187], a[4:7], v[68:71]
    ds_read_b64_tr_b16 v[164:165], v3 offset:64
    ds_read_b64_tr_b16 v[166:167], v3 offset:576
    v_mfma_f32_16x16x32_bf16 v[68:71], v[188:191], a[20:23], v[68:71]
    v_add_f32 v240, v240, v244
    v_add_f32 v241, v241, v245
    v_mfma_f32_16x16x32_bf16 v[36:39], v[188:191], a[16:19], v[36:39]
    ds_read_b64_tr_b16 v[168:169], v1 offset:50760
    ds_read_b64_tr_b16 v[170:171], v1 offset:51272
    v_mfma_f32_16x16x32_bf16 v[36:39], v[184:187], a[0:3], v[36:39]
    buffer_load_dwordx4 a[108:111], v254, s[68:71], s33 offen sc1
    v_mfma_f32_16x16x32_bf16 v[40:43], v[192:195], a[0:3], v[40:43]
    ds_read_b64_tr_b16 v[172:173], v3 offset:72
    ds_read_b64_tr_b16 v[174:175], v3 offset:584
    v_mfma_f32_16x16x32_bf16 v[40:43], v[196:199], a[16:19], v[40:43]
    v_add_f32 v242, v242, v246
    v_add_f32 v243, v243, v247
    v_mfma_f32_16x16x32_bf16 v[72:75], v[196:199], a[20:23], v[72:75]
    v_add_f32 v232, v232, v240
    v_add_f32 v233, v233, v241
    v_mfma_f32_16x16x32_bf16 v[72:75], v[192:195], a[4:7], v[72:75]
    buffer_load_dwordx4 v6, s[48:51], s32 offen offset:0 lds
    v_mfma_f32_16x16x32_bf16 v[104:107], v[192:195], a[8:11], v[104:107]
    v_add_f32 v234, v234, v242
    v_add_f32 v235, v235, v243
    v_mfma_f32_16x16x32_bf16 v[104:107], v[196:199], a[24:27], v[104:107]
    v_mov_b32 v236, v232
    v_mov_b32 v237, v233
    v_mfma_f32_16x16x32_bf16 v[136:139], v[196:199], a[28:31], v[136:139]
    buffer_load_dwordx4 v7, s[48:51], s32 offen offset:1056 lds
    v_mfma_f32_16x16x32_bf16 v[136:139], v[192:195], a[12:15], v[136:139]
    v_mov_b32 v238, v234
    v_mov_b32 v239, v235
    v_mfma_f32_16x16x32_bf16 v[140:143], v[200:203], a[12:15], v[140:143]
    v_permlane16_swap_b32 v232, v236
    v_permlane16_swap_b32 v233, v237
    v_mfma_f32_16x16x32_bf16 v[140:143], v[204:207], a[28:31], v[140:143]
    buffer_load_dwordx4 v8, s[48:51], s32 offen offset:2112 lds
    v_mfma_f32_16x16x32_bf16 v[108:111], v[204:207], a[24:27], v[108:111]
    v_permlane16_swap_b32 v234, v238
    v_permlane16_swap_b32 v235, v239
    v_mfma_f32_16x16x32_bf16 v[108:111], v[200:203], a[8:11], v[108:111]
    v_add_f32 v232, v232, v236
    v_add_f32 v233, v233, v237
    v_mfma_f32_16x16x32_bf16 v[76:79], v[200:203], a[4:7], v[76:79]
    buffer_load_dwordx4 v9, s[48:51], s32 offen offset:3168 lds
    v_mfma_f32_16x16x32_bf16 v[76:79], v[204:207], a[20:23], v[76:79]
    v_add_f32 v234, v234, v238
    v_add_f32 v235, v235, v239
    v_mfma_f32_16x16x32_bf16 v[44:47], v[204:207], a[16:19], v[44:47]
    v_mov_b32 v236, v232
    v_mov_b32 v237, v233
    v_mfma_f32_16x16x32_bf16 v[44:47], v[200:203], a[0:3], v[44:47]
    v_mov_b32 v238, v234
    v_mov_b32 v239, v235
    s_waitcnt vmcnt(28) lgkmcnt(0)
    v_mfma_f32_16x16x32_bf16 v[16:19], v[144:147], a[32:35], v[16:19]
    s_add_u32 m0, s30, 16896
    s_add_u32 s32, s32, 4128768
    v_mfma_f32_16x16x32_bf16 v[16:19], v[148:151], a[48:51], v[16:19]
    s_add_u32 s33, s33, 163840
    v_mfma_f32_16x16x32_bf16 v[48:51], v[148:151], a[52:55], v[48:51]
    ds_read_b64_tr_b16 v[176:177], v2 offset:50688
    ds_read_b64_tr_b16 v[178:179], v2 offset:51200
    v_mfma_f32_16x16x32_bf16 v[48:51], v[144:147], a[36:39], v[48:51]
    buffer_load_dwordx4 a[112:115], v10, s[68:71], s33 offen sc1
    v_mfma_f32_16x16x32_bf16 v[80:83], v[144:147], a[40:43], v[80:83]
    ds_read_b64_tr_b16 v[180:181], v4 offset:0
    ds_read_b64_tr_b16 v[182:183], v4 offset:512
    v_mfma_f32_16x16x32_bf16 v[80:83], v[148:151], a[56:59], v[80:83]
    v_permlane32_swap_b32 v232, v236
    v_permlane32_swap_b32 v233, v237
    v_mfma_f32_16x16x32_bf16 v[112:115], v[148:151], a[60:63], v[112:115]
    ds_read_b64_tr_b16 v[184:185], v2 offset:50696
    ds_read_b64_tr_b16 v[186:187], v2 offset:51208
    v_mfma_f32_16x16x32_bf16 v[112:115], v[144:147], a[44:47], v[112:115]
    buffer_load_dwordx4 a[116:119], v11, s[68:71], s33 offen sc1
    v_mfma_f32_16x16x32_bf16 v[116:119], v[152:155], a[44:47], v[116:119]
    ds_read_b64_tr_b16 v[188:189], v4 offset:8
    ds_read_b64_tr_b16 v[190:191], v4 offset:520
    v_mfma_f32_16x16x32_bf16 v[116:119], v[156:159], a[60:63], v[116:119]
    v_permlane32_swap_b32 v234, v238
    v_permlane32_swap_b32 v235, v239
    v_mfma_f32_16x16x32_bf16 v[84:87], v[156:159], a[56:59], v[84:87]
    ds_read_b64_tr_b16 v[192:193], v2 offset:50752
    ds_read_b64_tr_b16 v[194:195], v2 offset:51264
    v_mfma_f32_16x16x32_bf16 v[84:87], v[152:155], a[40:43], v[84:87]
    buffer_load_dwordx4 a[120:123], v252, s[68:71], s33 offen sc1
    v_mfma_f32_16x16x32_bf16 v[52:55], v[152:155], a[36:39], v[52:55]
    ds_read_b64_tr_b16 v[196:197], v4 offset:64
    ds_read_b64_tr_b16 v[198:199], v4 offset:576
    v_mfma_f32_16x16x32_bf16 v[52:55], v[156:159], a[52:55], v[52:55]
    v_add_f32 v232, v232, v236
    v_add_f32 v233, v233, v237
    v_mfma_f32_16x16x32_bf16 v[20:23], v[156:159], a[48:51], v[20:23]
    ds_read_b64_tr_b16 v[200:201], v2 offset:50760
    ds_read_b64_tr_b16 v[202:203], v2 offset:51272
    v_mfma_f32_16x16x32_bf16 v[20:23], v[152:155], a[32:35], v[20:23]
    buffer_load_dwordx4 a[124:127], v254, s[68:71], s33 offen sc1
    v_mfma_f32_16x16x32_bf16 v[24:27], v[160:163], a[32:35], v[24:27]
    ds_read_b64_tr_b16 v[204:205], v4 offset:72
    ds_read_b64_tr_b16 v[206:207], v4 offset:584
    v_mfma_f32_16x16x32_bf16 v[24:27], v[164:167], a[48:51], v[24:27]
    v_add_f32 v234, v234, v238
    v_add_f32 v235, v235, v239
    v_mfma_f32_16x16x32_bf16 v[56:59], v[164:167], a[52:55], v[56:59]
    v_cvt_pk_bf16_f32 v236, v232, v233
    v_cvt_pk_bf16_f32 v237, v234, v235
    v_mfma_f32_16x16x32_bf16 v[56:59], v[160:163], a[36:39], v[56:59]
    buffer_load_dwordx4 v6, s[48:51], s32 offen offset:0 lds
    v_mfma_f32_16x16x32_bf16 v[88:91], v[160:163], a[40:43], v[88:91]
    v_lshlrev_b32 v232, 16, v236
    v_and_b32 v233, 0xffff0000, v236
    v_mfma_f32_16x16x32_bf16 v[88:91], v[164:167], a[56:59], v[88:91]
    v_lshlrev_b32 v234, 16, v237
    v_and_b32 v235, 0xffff0000, v237
    v_mfma_f32_16x16x32_bf16 v[120:123], v[164:167], a[60:63], v[120:123]
    buffer_load_dwordx4 v7, s[48:51], s32 offen offset:1056 lds
    v_mfma_f32_16x16x32_bf16 v[120:123], v[160:163], a[44:47], v[120:123]
    s_cmp_eq_u32 s28, 2
    s_cselect_b32 s36, 1.0, 0
    v_mfma_f32_16x16x32_bf16 v[124:127], v[168:171], a[44:47], v[124:127]
    v_add_f32 v232, s36, v232
    v_add_f32 v233, s36, v233
    v_mfma_f32_16x16x32_bf16 v[124:127], v[172:175], a[60:63], v[124:127]
    buffer_load_dwordx4 v8, s[48:51], s32 offen offset:2112 lds
    v_mfma_f32_16x16x32_bf16 v[92:95], v[172:175], a[56:59], v[92:95]
    v_add_f32 v234, s36, v234
    v_add_f32 v235, s36, v235
    v_mfma_f32_16x16x32_bf16 v[92:95], v[168:171], a[40:43], v[92:95]
    v_cvt_pk_bf16_f32 v236, v232, v233
    v_cvt_pk_bf16_f32 v237, v234, v235
    v_mfma_f32_16x16x32_bf16 v[60:63], v[168:171], a[36:39], v[60:63]
    buffer_load_dwordx4 v9, s[48:51], s32 offen offset:3168 lds
    v_mfma_f32_16x16x32_bf16 v[60:63], v[172:175], a[52:55], v[60:63]
    v_lshlrev_b32 v232, 16, v236
    v_and_b32 v233, 0xffff0000, v236
    v_mfma_f32_16x16x32_bf16 v[28:31], v[172:175], a[48:51], v[28:31]
    v_lshlrev_b32 v234, 16, v237
    v_and_b32 v235, 0xffff0000, v237
    v_mfma_f32_16x16x32_bf16 v[28:31], v[168:171], a[32:35], v[28:31]
    s_lshl_b32 s36, s28, 8
    s_add_u32 s36, s36, 135168
    s_waitcnt vmcnt(24) lgkmcnt(0)
    s_barrier
    v_mfma_f32_16x16x32_bf16 v[32:35], v[176:179], a[32:35], v[32:35]
    s_add_u32 m0, s30, 33792
    s_add_u32 s32, s32, 65536
    v_mfma_f32_16x16x32_bf16 v[32:35], v[180:183], a[48:51], v[32:35]
    s_add_u32 s33, s33, 10321920
    v_mfma_f32_16x16x32_bf16 v[64:67], v[180:183], a[52:55], v[64:67]
    ds_read_b64_tr_b16 v[144:145], v4 offset:16896
    ds_read_b64_tr_b16 v[146:147], v4 offset:17408
    v_mfma_f32_16x16x32_bf16 v[64:67], v[176:179], a[36:39], v[64:67]
    buffer_load_dwordx4 a[0:3], v10, s[68:71], s33 offen sc1
    v_mfma_f32_16x16x32_bf16 v[96:99], v[176:179], a[40:43], v[96:99]
    ds_read_b64_tr_b16 v[148:149], v4 offset:33792
    ds_read_b64_tr_b16 v[150:151], v4 offset:34304
    v_mfma_f32_16x16x32_bf16 v[96:99], v[180:183], a[56:59], v[96:99]
    v_lshl_add_u32 v230, v15, 4, s36
    ds_write_b128 v230, v[232:235]
    v_mfma_f32_16x16x32_bf16 v[128:131], v[180:183], a[60:63], v[128:131]
    ds_read_b64_tr_b16 v[152:153], v4 offset:16904
    ds_read_b64_tr_b16 v[154:155], v4 offset:17416
    v_mfma_f32_16x16x32_bf16 v[128:131], v[176:179], a[44:47], v[128:131]
    buffer_load_dwordx4 a[4:7], v11, s[68:71], s33 offen sc1
    v_mfma_f32_16x16x32_bf16 v[132:135], v[184:187], a[44:47], v[132:135]
    ds_read_b64_tr_b16 v[156:157], v4 offset:33800
    ds_read_b64_tr_b16 v[158:159], v4 offset:34312
    v_mfma_f32_16x16x32_bf16 v[132:135], v[188:191], a[60:63], v[132:135]
    v_lshlrev_b32 v236, 16, v224
    v_and_b32 v237, 0xffff0000, v224
    v_mfma_f32_16x16x32_bf16 v[100:103], v[188:191], a[56:59], v[100:103]
    ds_read_b64_tr_b16 v[160:161], v4 offset:16960
    ds_read_b64_tr_b16 v[162:163], v4 offset:17472
    v_mfma_f32_16x16x32_bf16 v[100:103], v[184:187], a[40:43], v[100:103]
    buffer_load_dwordx4 a[8:11], v252, s[68:71], s33 offen sc1
    v_mfma_f32_16x16x32_bf16 v[68:71], v[184:187], a[36:39], v[68:71]
    ds_read_b64_tr_b16 v[164:165], v4 offset:33856
    ds_read_b64_tr_b16 v[166:167], v4 offset:34368
    v_mfma_f32_16x16x32_bf16 v[68:71], v[188:191], a[52:55], v[68:71]
    v_lshlrev_b32 v238, 16, v225
    v_and_b32 v239, 0xffff0000, v225
    v_mfma_f32_16x16x32_bf16 v[36:39], v[188:191], a[48:51], v[36:39]
    ds_read_b64_tr_b16 v[168:169], v4 offset:16968
    ds_read_b64_tr_b16 v[170:171], v4 offset:17480
    v_mfma_f32_16x16x32_bf16 v[36:39], v[184:187], a[32:35], v[36:39]
    buffer_load_dwordx4 a[12:15], v254, s[68:71], s33 offen sc1
    v_mfma_f32_16x16x32_bf16 v[40:43], v[192:195], a[32:35], v[40:43]
    ds_read_b64_tr_b16 v[172:173], v4 offset:33864
    ds_read_b64_tr_b16 v[174:175], v4 offset:34376
    v_mfma_f32_16x16x32_bf16 v[40:43], v[196:199], a[48:51], v[40:43]
    v_mul_f32 v236, v232, v236
    v_mul_f32 v237, v233, v237
    v_mfma_f32_16x16x32_bf16 v[72:75], v[196:199], a[52:55], v[72:75]
    v_mul_f32 v238, v234, v238
    v_mul_f32 v239, v235, v239
    v_mfma_f32_16x16x32_bf16 v[72:75], v[192:195], a[36:39], v[72:75]
    buffer_load_dwordx4 v6, s[48:51], s32 offen offset:0 lds
    v_mfma_f32_16x16x32_bf16 v[104:107], v[192:195], a[40:43], v[104:107]
    ds_write_b128 v230, v[236:239] offset:1024
    v_add_f32 v240, v236, v237
    v_mfma_f32_16x16x32_bf16 v[104:107], v[196:199], a[56:59], v[104:107]
    v_add_f32 v241, v238, v239
    v_add_f32 v240, v240, v241
    v_mfma_f32_16x16x32_bf16 v[136:139], v[196:199], a[60:63], v[136:139]
    buffer_load_dwordx4 v7, s[48:51], s32 offen offset:1056 lds
    v_mfma_f32_16x16x32_bf16 v[136:139], v[192:195], a[44:47], v[136:139]
    s_nop 1
    v_add_f32_dpp v240, v240, v240 row_ror:8 row_mask:0xf bank_mask:0xf
    v_mfma_f32_16x16x32_bf16 v[140:143], v[200:203], a[44:47], v[140:143]
    s_nop 1
    v_add_f32_dpp v240, v240, v240 row_ror:4 row_mask:0xf bank_mask:0xf
    v_mfma_f32_16x16x32_bf16 v[140:143], v[204:207], a[60:63], v[140:143]
    buffer_load_dwordx4 v8, s[48:51], s32 offen offset:2112 lds
    v_mfma_f32_16x16x32_bf16 v[108:111], v[204:207], a[56:59], v[108:111]
    s_nop 1
    v_add_f32_dpp v240, v240, v240 row_ror:2 row_mask:0xf bank_mask:0xf
    v_mfma_f32_16x16x32_bf16 v[108:111], v[200:203], a[40:43], v[108:111]
    s_nop 1
    v_add_f32_dpp v240, v240, v240 row_ror:1 row_mask:0xf bank_mask:0xf
    v_mfma_f32_16x16x32_bf16 v[76:79], v[200:203], a[36:39], v[76:79]
    buffer_load_dwordx4 v9, s[48:51], s32 offen offset:3168 lds
    v_mfma_f32_16x16x32_bf16 v[76:79], v[204:207], a[52:55], v[76:79]
    v_mul_f32 v240, 1048576000, v240
    ds_write_b32 v230, v240 offset:2048
    v_mfma_f32_16x16x32_bf16 v[44:47], v[204:207], a[48:51], v[44:47]
    v_mfma_f32_16x16x32_bf16 v[44:47], v[200:203], a[32:35], v[44:47]
    s_waitcnt vmcnt(16) lgkmcnt(0)
    s_barrier
    v_mfma_f32_16x16x32_bf16 v[32:35], v[144:147], a[64:67], v[32:35]
    v_mfma_f32_16x16x32_bf16 v[32:35], v[148:151], a[80:83], v[32:35]
    s_add_u32 s33, s33, 163840
    v_mfma_f32_16x16x32_bf16 v[64:67], v[148:151], a[84:87], v[64:67]
    ds_read_b64_tr_b16 v[176:177], v4 offset:50688
    ds_read_b64_tr_b16 v[178:179], v4 offset:51200
    v_mfma_f32_16x16x32_bf16 v[64:67], v[144:147], a[68:71], v[64:67]
    buffer_load_dwordx4 a[16:19], v10, s[68:71], s33 offen sc1
    v_mfma_f32_16x16x32_bf16 v[96:99], v[144:147], a[72:75], v[96:99]
    ds_read_b64_tr_b16 v[180:181], v2 offset:0
    ds_read_b64_tr_b16 v[182:183], v2 offset:512
    v_mfma_f32_16x16x32_bf16 v[96:99], v[148:151], a[88:91], v[96:99]
    v_mfma_f32_16x16x32_bf16 v[128:131], v[148:151], a[92:95], v[128:131]
    ds_read_b64_tr_b16 v[184:185], v4 offset:50696
    ds_read_b64_tr_b16 v[186:187], v4 offset:51208
    v_mfma_f32_16x16x32_bf16 v[128:131], v[144:147], a[76:79], v[128:131]
    buffer_load_dwordx4 a[20:23], v11, s[68:71], s33 offen sc1
    v_mfma_f32_16x16x32_bf16 v[132:135], v[152:155], a[76:79], v[132:135]
    ds_read_b64_tr_b16 v[188:189], v2 offset:8
    ds_read_b64_tr_b16 v[190:191], v2 offset:520
    v_mfma_f32_16x16x32_bf16 v[132:135], v[156:159], a[92:95], v[132:135]
    v_mfma_f32_16x16x32_bf16 v[100:103], v[156:159], a[88:91], v[100:103]
    ds_read_b64_tr_b16 v[192:193], v4 offset:50752
    ds_read_b64_tr_b16 v[194:195], v4 offset:51264
    v_mfma_f32_16x16x32_bf16 v[100:103], v[152:155], a[72:75], v[100:103]
    buffer_load_dwordx4 a[24:27], v252, s[68:71], s33 offen sc1
    v_mfma_f32_16x16x32_bf16 v[68:71], v[152:155], a[68:71], v[68:71]
    ds_read_b64_tr_b16 v[196:197], v2 offset:64
    ds_read_b64_tr_b16 v[198:199], v2 offset:576
    v_mfma_f32_16x16x32_bf16 v[68:71], v[156:159], a[84:87], v[68:71]
    v_mfma_f32_16x16x32_bf16 v[36:39], v[156:159], a[80:83], v[36:39]
    ds_read_b64_tr_b16 v[200:201], v4 offset:50760
    ds_read_b64_tr_b16 v[202:203], v4 offset:51272
    v_mfma_f32_16x16x32_bf16 v[36:39], v[152:155], a[64:67], v[36:39]
    buffer_load_dwordx4 a[28:31], v254, s[68:71], s33 offen sc1
    v_mfma_f32_16x16x32_bf16 v[40:43], v[160:163], a[64:67], v[40:43]
    ds_read_b64_tr_b16 v[204:205], v2 offset:72
    ds_read_b64_tr_b16 v[206:207], v2 offset:584
    v_mfma_f32_16x16x32_bf16 v[40:43], v[164:167], a[80:83], v[40:43]
    s_and_b32 s36, s28, 1
    s_lshl_b32 s36, s36, 13
    v_mfma_f32_16x16x32_bf16 v[72:75], v[164:167], a[84:87], v[72:75]
    s_cmp_ge_u32 s28, 2
    s_cselect_b32 s37, 16896, 0
    v_mfma_f32_16x16x32_bf16 v[72:75], v[160:163], a[68:71], v[72:75]
    s_add_u32 s37, s37, 50688
    s_sub_u32 s7, 118272, s37
    v_mfma_f32_16x16x32_bf16 v[104:107], v[160:163], a[72:75], v[104:107]
    v_add_u32 v8, s36, v12
    v_add_u32 v7, s37, v8
    v_mfma_f32_16x16x32_bf16 v[104:107], v[164:167], a[88:91], v[104:107]
    v_add_u32 v8, s7, v8
    s_xor_b32 s37, s77, 8192
    v_mfma_f32_16x16x32_bf16 v[136:139], v[164:167], a[92:95], v[136:139]
    v_lshlrev_b32 v9, 1, v5
    v_add_u32 v9, 135168, v9
    v_mfma_f32_16x16x32_bf16 v[136:139], v[160:163], a[76:79], v[136:139]
    v_mov_b32 v6, 137216
    s_lshl_b32 s60, s18, 7
    v_mfma_f32_16x16x32_bf16 v[140:143], v[168:171], a[76:79], v[140:143]
    s_add_u32 s60, s60, 30547968
    s_lshl_b32 s61, s17, 2
    v_mfma_f32_16x16x32_bf16 v[140:143], v[172:175], a[92:95], v[140:143]
    s_add_u32 s61, s61, s60
    v_and_b32 v226, 0, v0
    v_mfma_f32_16x16x32_bf16 v[108:111], v[172:175], a[88:91], v[108:111]
    v_lshlrev_b32 v226, 2, v226
    v_mov_b32 v228, s85
    v_mfma_f32_16x16x32_bf16 v[108:111], v[168:171], a[72:75], v[108:111]
    v_mfma_f32_16x16x32_bf16 v[76:79], v[168:171], a[68:71], v[76:79]
    v_mfma_f32_16x16x32_bf16 v[76:79], v[172:175], a[84:87], v[76:79]
    v_mfma_f32_16x16x32_bf16 v[44:47], v[172:175], a[80:83], v[44:47]
    v_mfma_f32_16x16x32_bf16 v[44:47], v[168:171], a[64:67], v[44:47]
    s_waitcnt vmcnt(4) lgkmcnt(0)
    s_barrier
    v_mfma_f32_16x16x32_bf16 v[32:35], v[176:179], a[96:99], v[32:35]
    v_mfma_f32_16x16x32_bf16 v[32:35], v[180:183], a[112:115], v[32:35]
    buffer_load_dwordx4 v[208:211], v13, s[40:43], s20 offen offset:0
    v_mfma_f32_16x16x32_bf16 v[64:67], v[180:183], a[116:119], v[64:67]
    ds_read_b64_tr_b16 v[144:145], v2 offset:16896
    ds_read_b64_tr_b16 v[146:147], v2 offset:17408
    v_mfma_f32_16x16x32_bf16 v[64:67], v[176:179], a[100:103], v[64:67]
    buffer_load_dwordx4 v[212:215], v13, s[40:43], s20 offen offset:64
    v_mfma_f32_16x16x32_bf16 v[96:99], v[176:179], a[104:107], v[96:99]
    ds_read_b64_tr_b16 v[148:149], v2 offset:33792
    ds_read_b64_tr_b16 v[150:151], v2 offset:34304
    v_mfma_f32_16x16x32_bf16 v[96:99], v[180:183], a[120:123], v[96:99]
    buffer_load_dwordx4 v[216:219], v13, s[40:43], s21 offen offset:0
    v_mfma_f32_16x16x32_bf16 v[128:131], v[180:183], a[124:127], v[128:131]
    ds_read_b64_tr_b16 v[152:153], v2 offset:16904
    ds_read_b64_tr_b16 v[154:155], v2 offset:17416
    v_mfma_f32_16x16x32_bf16 v[128:131], v[176:179], a[108:111], v[128:131]
    buffer_load_dwordx4 v[220:223], v13, s[40:43], s21 offen offset:64
    v_mfma_f32_16x16x32_bf16 v[132:135], v[184:187], a[108:111], v[132:135]
    ds_read_b64_tr_b16 v[156:157], v2 offset:33800
    ds_read_b64_tr_b16 v[158:159], v2 offset:34312
    v_mfma_f32_16x16x32_bf16 v[132:135], v[188:191], a[124:127], v[132:135]
    v_mfma_f32_16x16x32_bf16 v[100:103], v[188:191], a[120:123], v[100:103]
    ds_read_b64_tr_b16 v[160:161], v2 offset:16960
    ds_read_b64_tr_b16 v[162:163], v2 offset:17472
    v_mfma_f32_16x16x32_bf16 v[100:103], v[184:187], a[104:107], v[100:103]
    v_mfma_f32_16x16x32_bf16 v[68:71], v[184:187], a[100:103], v[68:71]
    ds_read_b64_tr_b16 v[164:165], v2 offset:33856
    ds_read_b64_tr_b16 v[166:167], v2 offset:34368
    v_mfma_f32_16x16x32_bf16 v[68:71], v[188:191], a[116:119], v[68:71]
    v_mfma_f32_16x16x32_bf16 v[36:39], v[188:191], a[112:115], v[36:39]
    ds_read_b64_tr_b16 v[168:169], v2 offset:16968
    ds_read_b64_tr_b16 v[170:171], v2 offset:17480
    v_mfma_f32_16x16x32_bf16 v[36:39], v[184:187], a[96:99], v[36:39]
    v_mfma_f32_16x16x32_bf16 v[40:43], v[192:195], a[96:99], v[40:43]
    ds_read_b64_tr_b16 v[172:173], v2 offset:33864
    ds_read_b64_tr_b16 v[174:175], v2 offset:34376
    v_mfma_f32_16x16x32_bf16 v[40:43], v[196:199], a[112:115], v[40:43]
    v_mfma_f32_16x16x32_bf16 v[72:75], v[196:199], a[116:119], v[72:75]
    v_mfma_f32_16x16x32_bf16 v[72:75], v[192:195], a[100:103], v[72:75]
    v_mfma_f32_16x16x32_bf16 v[104:107], v[192:195], a[104:107], v[104:107]
    v_mfma_f32_16x16x32_bf16 v[104:107], v[196:199], a[120:123], v[104:107]
    v_mfma_f32_16x16x32_bf16 v[136:139], v[196:199], a[124:127], v[136:139]
    v_mfma_f32_16x16x32_bf16 v[136:139], v[192:195], a[108:111], v[136:139]
    v_mfma_f32_16x16x32_bf16 v[140:143], v[200:203], a[108:111], v[140:143]
    v_mfma_f32_16x16x32_bf16 v[140:143], v[204:207], a[124:127], v[140:143]
    v_mfma_f32_16x16x32_bf16 v[108:111], v[204:207], a[120:123], v[108:111]
    v_mfma_f32_16x16x32_bf16 v[108:111], v[200:203], a[104:107], v[108:111]
    v_mfma_f32_16x16x32_bf16 v[76:79], v[200:203], a[100:103], v[76:79]
    v_mfma_f32_16x16x32_bf16 v[76:79], v[204:207], a[116:119], v[76:79]
    v_mfma_f32_16x16x32_bf16 v[44:47], v[204:207], a[112:115], v[44:47]
    v_mfma_f32_16x16x32_bf16 v[44:47], v[200:203], a[96:99], v[44:47]
    s_waitcnt vmcnt(4) lgkmcnt(0)
    v_mfma_f32_16x16x32_bf16 v[96:99], v[144:147], a[8:11], v[96:99]
    v_mfma_f32_16x16x32_bf16 v[96:99], v[148:151], a[24:27], v[96:99]
    v_mfma_f32_16x16x32_bf16 v[100:103], v[156:159], a[24:27], v[100:103]
    ds_read_b64_tr_b16 v[176:177], v3 offset:16896
    ds_read_b64_tr_b16 v[178:179], v3 offset:17408
    v_mfma_f32_16x16x32_bf16 v[100:103], v[152:155], a[8:11], v[100:103]
    v_mfma_f32_16x16x32_bf16 v[104:107], v[160:163], a[8:11], v[104:107]
    ds_read_b64_tr_b16 v[180:181], v3 offset:33792
    ds_read_b64_tr_b16 v[182:183], v3 offset:34304
    v_mfma_f32_16x16x32_bf16 v[104:107], v[164:167], a[24:27], v[104:107]
    v_mfma_f32_16x16x32_bf16 v[108:111], v[172:175], a[24:27], v[108:111]
    ds_read_b64_tr_b16 v[184:185], v3 offset:16904
    ds_read_b64_tr_b16 v[186:187], v3 offset:17416
    v_mfma_f32_16x16x32_bf16 v[108:111], v[168:171], a[8:11], v[108:111]
    v_mfma_f32_16x16x32_bf16 v[140:143], v[168:171], a[12:15], v[140:143]
    ds_read_b64_tr_b16 v[188:189], v3 offset:33800
    ds_read_b64_tr_b16 v[190:191], v3 offset:34312
    v_mfma_f32_16x16x32_bf16 v[140:143], v[172:175], a[28:31], v[140:143]
    v_mfma_f32_16x16x32_bf16 v[136:139], v[164:167], a[28:31], v[136:139]
    ds_read_b64_tr_b16 v[192:193], v3 offset:16960
    ds_read_b64_tr_b16 v[194:195], v3 offset:17472
    v_mfma_f32_16x16x32_bf16 v[136:139], v[160:163], a[12:15], v[136:139]
    v_mfma_f32_16x16x32_bf16 v[132:135], v[152:155], a[12:15], v[132:135]
    ds_read_b64_tr_b16 v[196:197], v3 offset:33856
    ds_read_b64_tr_b16 v[198:199], v3 offset:34368
    v_mfma_f32_16x16x32_bf16 v[132:135], v[156:159], a[28:31], v[132:135]
    v_mfma_f32_16x16x32_bf16 v[128:131], v[148:151], a[28:31], v[128:131]
    ds_read_b64_tr_b16 v[200:201], v3 offset:16968
    ds_read_b64_tr_b16 v[202:203], v3 offset:17480
    v_mfma_f32_16x16x32_bf16 v[128:131], v[144:147], a[12:15], v[128:131]
    v_mfma_f32_16x16x32_bf16 v[32:35], v[144:147], a[0:3], v[32:35]
    ds_read_b64_tr_b16 v[204:205], v3 offset:33864
    ds_read_b64_tr_b16 v[206:207], v3 offset:34376
    v_mfma_f32_16x16x32_bf16 v[32:35], v[148:151], a[16:19], v[32:35]
    v_mfma_f32_16x16x32_bf16 v[36:39], v[156:159], a[16:19], v[36:39]
    v_mfma_f32_16x16x32_bf16 v[36:39], v[152:155], a[0:3], v[36:39]
    ds_write_b128 v7, v[96:99] offset:0
    v_mfma_f32_16x16x32_bf16 v[40:43], v[160:163], a[0:3], v[40:43]
    ds_write_b128 v7, v[128:131] offset:4096
    v_mfma_f32_16x16x32_bf16 v[40:43], v[164:167], a[16:19], v[40:43]
    v_mfma_f32_16x16x32_bf16 v[44:47], v[172:175], a[16:19], v[44:47]
    ds_write_b128 v7, v[100:103] offset:1024
    v_mfma_f32_16x16x32_bf16 v[44:47], v[168:171], a[0:3], v[44:47]
    ds_write_b128 v7, v[132:135] offset:5120
    v_mfma_f32_16x16x32_bf16 v[76:79], v[168:171], a[4:7], v[76:79]
    v_mfma_f32_16x16x32_bf16 v[76:79], v[172:175], a[20:23], v[76:79]
    ds_write_b128 v7, v[104:107] offset:2048
    v_mfma_f32_16x16x32_bf16 v[72:75], v[164:167], a[20:23], v[72:75]
    ds_write_b128 v7, v[136:139] offset:6144
    v_mfma_f32_16x16x32_bf16 v[72:75], v[160:163], a[4:7], v[72:75]
    v_mfma_f32_16x16x32_bf16 v[68:71], v[152:155], a[4:7], v[68:71]
    ds_write_b128 v7, v[108:111] offset:3072
    v_mfma_f32_16x16x32_bf16 v[68:71], v[156:159], a[20:23], v[68:71]
    ds_write_b128 v7, v[140:143] offset:7168
    v_mfma_f32_16x16x32_bf16 v[64:67], v[148:151], a[20:23], v[64:67]
    v_mfma_f32_16x16x32_bf16 v[64:67], v[144:147], a[4:7], v[64:67]
    s_waitcnt vmcnt(24) lgkmcnt(0)
    s_barrier
    v_mfma_f32_16x16x32_bf16 v[16:19], v[176:179], a[64:67], v[16:19]
    ds_read_b128 v[96:99], v8 offset:0
    ds_read_b128 v[100:103], v8 offset:1024
    v_mfma_f32_16x16x32_bf16 v[16:19], v[180:183], a[80:83], v[16:19]
    ds_read_b128 v[104:107], v8 offset:2048
    ds_read_b128 v[108:111], v8 offset:3072
    v_mfma_f32_16x16x32_bf16 v[48:51], v[180:183], a[84:87], v[48:51]
    ds_read_b64_tr_b16 v[144:145], v3 offset:50688
    ds_read_b64_tr_b16 v[146:147], v3 offset:51200
    v_mfma_f32_16x16x32_bf16 v[48:51], v[176:179], a[68:71], v[48:51]
    ds_read_b128 v[128:131], v8 offset:4096
    ds_read_b128 v[132:135], v8 offset:5120
    v_mfma_f32_16x16x32_bf16 v[80:83], v[176:179], a[72:75], v[80:83]
    ds_read_b64_tr_b16 v[148:149], v1 offset:0
    ds_read_b64_tr_b16 v[150:151], v1 offset:512
    v_mfma_f32_16x16x32_bf16 v[80:83], v[180:183], a[88:91], v[80:83]
    ds_read_b128 v[136:139], v8 offset:6144
    ds_read_b128 v[140:143], v8 offset:7168
    v_mfma_f32_16x16x32_bf16 v[112:115], v[180:183], a[92:95], v[112:115]
    ds_read_b64_tr_b16 v[152:153], v3 offset:50696
    ds_read_b64_tr_b16 v[154:155], v3 offset:51208
    v_mfma_f32_16x16x32_bf16 v[112:115], v[176:179], a[76:79], v[112:115]
    v_mfma_f32_16x16x32_bf16 v[116:119], v[184:187], a[76:79], v[116:119]
    ds_read_b64_tr_b16 v[156:157], v1 offset:8
    ds_read_b64_tr_b16 v[158:159], v1 offset:520
    v_mfma_f32_16x16x32_bf16 v[116:119], v[188:191], a[92:95], v[116:119]
    s_waitcnt lgkmcnt(4)
    v_mfma_f32_16x16x32_bf16 v[84:87], v[188:191], a[88:91], v[84:87]
    ds_read_b64_tr_b16 v[160:161], v3 offset:50752
    ds_read_b64_tr_b16 v[162:163], v3 offset:51264
    v_mfma_f32_16x16x32_bf16 v[84:87], v[184:187], a[72:75], v[84:87]
    v_add_f32 v32, v32, v96
    v_add_f32 v33, v33, v97
    v_mfma_f32_16x16x32_bf16 v[52:55], v[184:187], a[68:71], v[52:55]
    ds_read_b64_tr_b16 v[164:165], v1 offset:64
    ds_read_b64_tr_b16 v[166:167], v1 offset:576
    v_mfma_f32_16x16x32_bf16 v[52:55], v[188:191], a[84:87], v[52:55]
    v_add_f32 v34, v34, v98
    v_add_f32 v35, v35, v99
    v_mfma_f32_16x16x32_bf16 v[20:23], v[188:191], a[80:83], v[20:23]
    ds_read_b64_tr_b16 v[168:169], v3 offset:50760
    ds_read_b64_tr_b16 v[170:171], v3 offset:51272
    v_mfma_f32_16x16x32_bf16 v[20:23], v[184:187], a[64:67], v[20:23]
    v_add_f32 v36, v36, v100
    v_add_f32 v37, v37, v101
    v_mfma_f32_16x16x32_bf16 v[24:27], v[192:195], a[64:67], v[24:27]
    ds_read_b64_tr_b16 v[172:173], v1 offset:72
    ds_read_b64_tr_b16 v[174:175], v1 offset:584
    v_mfma_f32_16x16x32_bf16 v[24:27], v[196:199], a[80:83], v[24:27]
    v_add_f32 v38, v38, v102
    v_add_f32 v39, v39, v103
    v_mfma_f32_16x16x32_bf16 v[56:59], v[196:199], a[84:87], v[56:59]
    v_add_f32 v40, v40, v104
    v_add_f32 v41, v41, v105
    v_mfma_f32_16x16x32_bf16 v[56:59], v[192:195], a[68:71], v[56:59]
    v_add_f32 v42, v42, v106
    v_add_f32 v43, v43, v107
    v_mfma_f32_16x16x32_bf16 v[88:91], v[192:195], a[72:75], v[88:91]
    v_add_f32 v44, v44, v108
    v_add_f32 v45, v45, v109
    v_mfma_f32_16x16x32_bf16 v[88:91], v[196:199], a[88:91], v[88:91]
    v_add_f32 v46, v46, v110
    v_add_f32 v47, v47, v111
    v_mfma_f32_16x16x32_bf16 v[120:123], v[196:199], a[92:95], v[120:123]
    v_cvt_pk_bf16_f32 v96, v32, v33
    v_cvt_pk_bf16_f32 v97, v34, v35
    v_mfma_f32_16x16x32_bf16 v[120:123], v[192:195], a[76:79], v[120:123]
    v_cvt_pk_bf16_f32 v98, v36, v37
    v_cvt_pk_bf16_f32 v99, v38, v39
    v_mfma_f32_16x16x32_bf16 v[124:127], v[200:203], a[76:79], v[124:127]
    v_cvt_pk_bf16_f32 v100, v40, v41
    v_cvt_pk_bf16_f32 v101, v42, v43
    v_mfma_f32_16x16x32_bf16 v[124:127], v[204:207], a[92:95], v[124:127]
    v_cvt_pk_bf16_f32 v102, v44, v45
    v_cvt_pk_bf16_f32 v103, v46, v47
    v_mfma_f32_16x16x32_bf16 v[92:95], v[204:207], a[88:91], v[92:95]
    buffer_store_dwordx4 v[96:99], v12, s[68:71], s37 offen offset:0 sc1
    buffer_store_dwordx4 v[100:103], v12, s[68:71], s37 offen offset:1024 sc1
    v_mfma_f32_16x16x32_bf16 v[92:95], v[200:203], a[72:75], v[92:95]
    v_add_f32 v64, v64, v128
    v_add_f32 v65, v65, v129
    v_mfma_f32_16x16x32_bf16 v[60:63], v[200:203], a[68:71], v[60:63]
    v_add_f32 v66, v66, v130
    v_add_f32 v67, v67, v131
    v_mfma_f32_16x16x32_bf16 v[60:63], v[204:207], a[84:87], v[60:63]
    v_add_f32 v68, v68, v132
    v_add_f32 v69, v69, v133
    v_mfma_f32_16x16x32_bf16 v[28:31], v[204:207], a[80:83], v[28:31]
    v_add_f32 v70, v70, v134
    v_add_f32 v71, v71, v135
    v_mfma_f32_16x16x32_bf16 v[28:31], v[200:203], a[64:67], v[28:31]
    v_add_f32 v72, v72, v136
    v_add_f32 v73, v73, v137
    s_waitcnt vmcnt(10) lgkmcnt(0)
    v_mfma_f32_16x16x32_bf16 v[16:19], v[144:147], a[96:99], v[16:19]
    v_add_f32 v74, v74, v138
    v_add_f32 v75, v75, v139
    v_mfma_f32_16x16x32_bf16 v[16:19], v[148:151], a[112:115], v[16:19]
    v_add_f32 v76, v76, v140
    v_add_f32 v77, v77, v141
    v_mfma_f32_16x16x32_bf16 v[48:51], v[148:151], a[116:119], v[48:51]
    ds_read_b64_tr_b16 v[176:177], v1 offset:16896
    ds_read_b64_tr_b16 v[178:179], v1 offset:17408
    v_mfma_f32_16x16x32_bf16 v[48:51], v[144:147], a[100:103], v[48:51]
    v_add_f32 v78, v78, v142
    v_add_f32 v79, v79, v143
    v_mfma_f32_16x16x32_bf16 v[80:83], v[144:147], a[104:107], v[80:83]
    ds_read_b64_tr_b16 v[180:181], v1 offset:33792
    ds_read_b64_tr_b16 v[182:183], v1 offset:34304
    v_mfma_f32_16x16x32_bf16 v[80:83], v[148:151], a[120:123], v[80:83]
    v_cvt_pk_bf16_f32 v128, v64, v65
    v_cvt_pk_bf16_f32 v129, v66, v67
    v_mfma_f32_16x16x32_bf16 v[112:115], v[148:151], a[124:127], v[112:115]
    ds_read_b64_tr_b16 v[184:185], v1 offset:16904
    ds_read_b64_tr_b16 v[186:187], v1 offset:17416
    v_mfma_f32_16x16x32_bf16 v[112:115], v[144:147], a[108:111], v[112:115]
    v_cvt_pk_bf16_f32 v130, v68, v69
    v_cvt_pk_bf16_f32 v131, v70, v71
    v_mfma_f32_16x16x32_bf16 v[116:119], v[152:155], a[108:111], v[116:119]
    ds_read_b64_tr_b16 v[188:189], v1 offset:33800
    ds_read_b64_tr_b16 v[190:191], v1 offset:34312
    v_mfma_f32_16x16x32_bf16 v[116:119], v[156:159], a[124:127], v[116:119]
    v_cvt_pk_bf16_f32 v132, v72, v73
    v_cvt_pk_bf16_f32 v133, v74, v75
    v_mfma_f32_16x16x32_bf16 v[84:87], v[156:159], a[120:123], v[84:87]
    ds_read_b64_tr_b16 v[192:193], v1 offset:16960
    ds_read_b64_tr_b16 v[194:195], v1 offset:17472
    v_mfma_f32_16x16x32_bf16 v[84:87], v[152:155], a[104:107], v[84:87]
    v_cvt_pk_bf16_f32 v134, v76, v77
    v_cvt_pk_bf16_f32 v135, v78, v79
    v_mfma_f32_16x16x32_bf16 v[52:55], v[152:155], a[100:103], v[52:55]
    ds_read_b64_tr_b16 v[196:197], v1 offset:33856
    ds_read_b64_tr_b16 v[198:199], v1 offset:34368
    v_mfma_f32_16x16x32_bf16 v[52:55], v[156:159], a[116:119], v[52:55]
    buffer_store_dwordx4 v[128:131], v12, s[68:71], s37 offen offset:2048 sc1
    buffer_store_dwordx4 v[132:135], v12, s[68:71], s37 offen offset:3072 sc1
    v_mfma_f32_16x16x32_bf16 v[20:23], v[156:159], a[112:115], v[20:23]
    ds_read_b64_tr_b16 v[200:201], v1 offset:16968
    ds_read_b64_tr_b16 v[202:203], v1 offset:17480
    v_mfma_f32_16x16x32_bf16 v[20:23], v[152:155], a[96:99], v[20:23]
    v_mfma_f32_16x16x32_bf16 v[24:27], v[160:163], a[96:99], v[24:27]
    ds_read_b64_tr_b16 v[204:205], v1 offset:33864
    ds_read_b64_tr_b16 v[206:207], v1 offset:34376
    v_mfma_f32_16x16x32_bf16 v[24:27], v[164:167], a[112:115], v[24:27]
    v_mfma_f32_16x16x32_bf16 v[56:59], v[164:167], a[116:119], v[56:59]
    v_mfma_f32_16x16x32_bf16 v[56:59], v[160:163], a[100:103], v[56:59]
    v_mfma_f32_16x16x32_bf16 v[88:91], v[160:163], a[104:107], v[88:91]
    v_mfma_f32_16x16x32_bf16 v[88:91], v[164:167], a[120:123], v[88:91]
    v_mfma_f32_16x16x32_bf16 v[120:123], v[164:167], a[124:127], v[120:123]
    v_mfma_f32_16x16x32_bf16 v[120:123], v[160:163], a[108:111], v[120:123]
    v_mfma_f32_16x16x32_bf16 v[124:127], v[168:171], a[108:111], v[124:127]
    v_mfma_f32_16x16x32_bf16 v[124:127], v[172:175], a[124:127], v[124:127]
    v_mfma_f32_16x16x32_bf16 v[92:95], v[172:175], a[120:123], v[92:95]
    v_mfma_f32_16x16x32_bf16 v[92:95], v[168:171], a[104:107], v[92:95]
    v_mfma_f32_16x16x32_bf16 v[60:63], v[168:171], a[100:103], v[60:63]
    v_mfma_f32_16x16x32_bf16 v[60:63], v[172:175], a[116:119], v[60:63]
    v_mfma_f32_16x16x32_bf16 v[28:31], v[172:175], a[112:115], v[28:31]
    v_mfma_f32_16x16x32_bf16 v[28:31], v[168:171], a[96:99], v[28:31]
    s_waitcnt vmcnt(4) lgkmcnt(0)
    s_barrier
    v_mfma_f32_16x16x32_bf16 v[80:83], v[176:179], a[8:11], v[80:83]
    ds_read_b128 v[144:147], v9 offset:0
    ds_read_b128 v[148:151], v9 offset:16
    v_mfma_f32_16x16x32_bf16 v[80:83], v[180:183], a[24:27], v[80:83]
    ds_read_b128 v[152:155], v9 offset:128
    ds_read_b128 v[156:159], v9 offset:144
    v_mfma_f32_16x16x32_bf16 v[84:87], v[188:191], a[24:27], v[84:87]
    ds_read_b128 v[160:163], v9 offset:1536
    ds_read_b128 v[164:167], v9 offset:1552
    v_mfma_f32_16x16x32_bf16 v[84:87], v[184:187], a[8:11], v[84:87]
    ds_read_b128 v[168:171], v9 offset:1664
    ds_read_b128 v[172:175], v9 offset:1680
    v_mfma_f32_16x16x32_bf16 v[88:91], v[192:195], a[8:11], v[88:91]
    v_lshlrev_b32 v64, 16, v208
    v_and_b32 v65, 0xffff0000, v208
    v_mfma_f32_16x16x32_bf16 v[88:91], v[196:199], a[24:27], v[88:91]
    v_lshlrev_b32 v66, 16, v209
    v_and_b32 v67, 0xffff0000, v209
    v_mfma_f32_16x16x32_bf16 v[92:95], v[204:207], a[24:27], v[92:95]
    v_lshlrev_b32 v68, 16, v210
    v_and_b32 v69, 0xffff0000, v210
    v_mfma_f32_16x16x32_bf16 v[92:95], v[200:203], a[8:11], v[92:95]
    v_lshlrev_b32 v70, 16, v211
    v_and_b32 v71, 0xffff0000, v211
    v_mfma_f32_16x16x32_bf16 v[124:127], v[200:203], a[12:15], v[124:127]
    v_lshlrev_b32 v72, 16, v212
    v_and_b32 v73, 0xffff0000, v212
    v_mfma_f32_16x16x32_bf16 v[124:127], v[204:207], a[28:31], v[124:127]
    v_lshlrev_b32 v74, 16, v213
    v_and_b32 v75, 0xffff0000, v213
    v_mfma_f32_16x16x32_bf16 v[120:123], v[196:199], a[28:31], v[120:123]
    v_lshlrev_b32 v76, 16, v214
    v_and_b32 v77, 0xffff0000, v214
    v_mfma_f32_16x16x32_bf16 v[120:123], v[192:195], a[12:15], v[120:123]
    v_lshlrev_b32 v78, 16, v215
    v_and_b32 v79, 0xffff0000, v215
    v_mfma_f32_16x16x32_bf16 v[116:119], v[184:187], a[12:15], v[116:119]
    v_lshlrev_b32 v96, 16, v216
    v_and_b32 v97, 0xffff0000, v216
    ds_write_b128 v7, v[80:83] offset:0
    v_mfma_f32_16x16x32_bf16 v[116:119], v[188:191], a[28:31], v[116:119]
    v_lshlrev_b32 v98, 16, v217
    v_and_b32 v99, 0xffff0000, v217
    ds_write_b128 v7, v[84:87] offset:1024
    v_mfma_f32_16x16x32_bf16 v[112:115], v[180:183], a[28:31], v[112:115]
    v_lshlrev_b32 v100, 16, v218
    v_and_b32 v101, 0xffff0000, v218
    ds_write_b128 v7, v[88:91] offset:2048
    v_mfma_f32_16x16x32_bf16 v[112:115], v[176:179], a[12:15], v[112:115]
    v_lshlrev_b32 v102, 16, v219
    v_and_b32 v103, 0xffff0000, v219
    ds_write_b128 v7, v[92:95] offset:3072
    v_mfma_f32_16x16x32_bf16 v[16:19], v[176:179], a[0:3], v[16:19]
    v_lshlrev_b32 v104, 16, v220
    v_and_b32 v105, 0xffff0000, v220
    v_mfma_f32_16x16x32_bf16 v[16:19], v[180:183], a[16:19], v[16:19]
    v_lshlrev_b32 v106, 16, v221
    v_and_b32 v107, 0xffff0000, v221
    v_mfma_f32_16x16x32_bf16 v[20:23], v[188:191], a[16:19], v[20:23]
    v_lshlrev_b32 v108, 16, v222
    v_and_b32 v109, 0xffff0000, v222
    v_mfma_f32_16x16x32_bf16 v[20:23], v[184:187], a[0:3], v[20:23]
    v_mfma_f32_16x16x32_bf16 v[24:27], v[192:195], a[0:3], v[24:27]
    v_mfma_f32_16x16x32_bf16 v[24:27], v[196:199], a[16:19], v[24:27]
    v_lshlrev_b32 v110, 16, v223
    v_and_b32 v111, 0xffff0000, v223
    ds_write_b128 v7, v[112:115] offset:4096
    v_mfma_f32_16x16x32_bf16 v[28:31], v[204:207], a[16:19], v[28:31]
    ds_write_b128 v7, v[116:119] offset:5120
    v_mfma_f32_16x16x32_bf16 v[28:31], v[200:203], a[0:3], v[28:31]
    ds_write_b128 v7, v[120:123] offset:6144
    v_mfma_f32_16x16x32_bf16 v[60:63], v[200:203], a[4:7], v[60:63]
    ds_read2st64_b32 v[224:225], v6 offset0:2 offset1:1
    ds_write_b128 v7, v[124:127] offset:7168
    v_mfma_f32_16x16x32_bf16 v[60:63], v[204:207], a[20:23], v[60:63]
    v_mfma_f32_16x16x32_bf16 v[56:59], v[196:199], a[20:23], v[56:59]
    v_mfma_f32_16x16x32_bf16 v[56:59], v[192:195], a[4:7], v[56:59]
    v_mfma_f32_16x16x32_bf16 v[52:55], v[184:187], a[4:7], v[52:55]
    s_waitcnt lgkmcnt(0)
    s_barrier
    v_mfma_f32_16x16x32_bf16 v[52:55], v[188:191], a[20:23], v[52:55]
    ds_read_b128 v[80:83], v8 offset:0
    ds_read_b128 v[84:87], v8 offset:1024
    v_mfma_f32_16x16x32_bf16 v[48:51], v[180:183], a[20:23], v[48:51]
    ds_read_b128 v[88:91], v8 offset:2048
    ds_read_b128 v[92:95], v8 offset:3072
    v_mfma_f32_16x16x32_bf16 v[48:51], v[176:179], a[4:7], v[48:51]
    ds_read_b128 v[112:115], v8 offset:4096
    ds_read_b128 v[116:119], v8 offset:5120
    buffer_load_dwordx4 v[232:235], v12, s[68:71], s77 offen offset:0 sc1
    buffer_load_dwordx4 v[236:239], v12, s[68:71], s77 offen offset:1024 sc1
    buffer_load_dwordx4 v[240:243], v12, s[68:71], s77 offen offset:2048 sc1
    buffer_load_dwordx4 v[244:247], v12, s[68:71], s77 offen offset:3072 sc1
    s_branch attn_oj
attn_p7_r:
    buffer_load_dwordx4 v[232:235], v12, s[68:71], s77 offen offset:0 sc1
    buffer_load_dwordx4 v[236:239], v12, s[68:71], s77 offen offset:1024 sc1
    buffer_load_dwordx4 v[240:243], v12, s[68:71], s77 offen offset:2048 sc1
    buffer_load_dwordx4 v[244:247], v12, s[68:71], s77 offen offset:3072 sc1
    s_waitcnt vmcnt(0)
    v_max_u32 v8, v232, v233
    v_max_u32 v6, v234, v235
    v_max3_u32 v8, v8, v236, v237
    v_max3_u32 v6, v6, v238, v239
    v_max3_u32 v8, v8, v240, v241
    v_max3_u32 v6, v6, v242, v243
    v_max3_u32 v8, v8, v244, v245
    v_max3_u32 v6, v6, v246, v247
    v_max_u32 v8, v8, v6
    v_cmp_eq_u32 vcc, -1, v8
    s_add_u32 s4, s4, 1
    s_cmp_ge_u32 s4, 400000
    s_cbranch_scc1 attn_p7_k
    s_cbranch_vccnz attn_p7_r
    s_branch attn_p7_k
attn_p8_r:
    v_mov_b32 v8, 0
    s_mov_b64 exec, 0xffff
    buffer_atomic_or v8, v6, s[68:71], s60 offen sc0 sc1
    s_mov_b64 exec, -1
    s_waitcnt vmcnt(0)
    v_cmp_ne_u32 vcc, s85, v8
    s_and_b64 vcc, vcc, 0xffff
    s_add_u32 s4, s4, 1
    s_cmp_ge_u32 s4, 400000
    s_cbranch_scc1 attn_p8_k
    s_cbranch_vccnz attn_p8_r
    s_branch attn_p8_k
attn_p9_r:
    buffer_load_dwordx2 v[48:49], v7, s[68:71], s36 offen offset:0 sc1
    buffer_load_dwordx2 v[50:51], v7, s[68:71], s36 offen offset:512 sc1
    buffer_load_dwordx2 v[52:53], v7, s[68:71], s36 offen offset:1024 sc1
    buffer_load_dwordx2 v[54:55], v7, s[68:71], s36 offen offset:1536 sc1
    buffer_load_dwordx2 v[56:57], v7, s[68:71], s36 offen offset:2048 sc1
    buffer_load_dwordx2 v[58:59], v7, s[68:71], s36 offen offset:2560 sc1
    buffer_load_dwordx2 v[60:61], v7, s[68:71], s36 offen offset:3072 sc1
    buffer_load_dwordx2 v[62:63], v7, s[68:71], s36 offen offset:3584 sc1
    buffer_load_dwordx2 v[64:65], v7, s[68:71], s37 offen offset:0 sc1
    buffer_load_dwordx2 v[66:67], v7, s[68:71], s37 offen offset:512 sc1
    buffer_load_dwordx2 v[68:69], v7, s[68:71], s37 offen offset:1024 sc1
    buffer_load_dwordx2 v[70:71], v7, s[68:71], s37 offen offset:1536 sc1
    buffer_load_dwordx2 v[72:73], v7, s[68:71], s37 offen offset:2048 sc1
    buffer_load_dwordx2 v[74:75], v7, s[68:71], s37 offen offset:2560 sc1
    buffer_load_dwordx2 v[76:77], v7, s[68:71], s37 offen offset:3072 sc1
    buffer_load_dwordx2 v[78:79], v7, s[68:71], s37 offen offset:3584 sc1
    s_waitcnt vmcnt(0)
    v_max_u32 v8, v48, v49
    v_max_u32 v9, v50, v51
    v_max3_u32 v8, v8, v52, v53
    v_max3_u32 v9, v9, v54, v55
    v_max3_u32 v8, v8, v56, v57
    v_max3_u32 v9, v9, v58, v59
    v_max3_u32 v8, v8, v60, v61
    v_max3_u32 v9, v9, v62, v63
    v_max3_u32 v8, v8, v64, v65
    v_max3_u32 v9, v9, v66, v67
    v_max3_u32 v8, v8, v68, v69
    v_max3_u32 v9, v9, v70, v71
    v_max3_u32 v8, v8, v72, v73
    v_max3_u32 v9, v9, v74, v75
    v_max3_u32 v8, v8, v76, v77
    v_max3_u32 v9, v9, v78, v79
    v_max_u32 v8, v8, v9
    v_cmp_eq_u32 vcc, -1, v8
    s_add_u32 s4, s4, 1
    s_cmp_ge_u32 s4, 400000
    s_cbranch_scc1 attn_p9_k
    s_cbranch_vccnz attn_p9_r
    s_branch attn_p9_k
attn_p10_r:
    v_mov_b64 v[248:249], 0
    buffer_atomic_or_x2 v[248:249], v7, s[68:71], s37 offen sc0 sc1
    s_waitcnt vmcnt(0)
    v_max3_u32 v8, v248, v249, v249
    v_cmp_eq_u32 vcc, -1, v8
    s_add_u32 s4, s4, 1
    s_cmp_ge_u32 s4, 400000
    s_cbranch_scc1 attn_p10_k
    s_cbranch_vccnz attn_p10_r
    s_branch attn_p10_k
attn_p11_r:
    buffer_load_dwordx4 v[112:115], v6, s[68:71], s60 offen offset:0 sc1
    buffer_load_dwordx4 v[116:119], v6, s[68:71], s60 offen offset:64 sc1
    buffer_load_dwordx4 v[120:123], v6, s[68:71], s61 offen offset:256 sc1
    buffer_load_dwordx4 v[124:127], v6, s[68:71], s61 offen offset:320 sc1
    buffer_load_dwordx4 v[128:131], v6, s[68:71], s62 offen offset:512 sc1
    buffer_load_dwordx4 v[132:135], v6, s[68:71], s62 offen offset:576 sc1
    buffer_load_dwordx4 v[136:139], v6, s[68:71], s63 offen offset:768 sc1
    buffer_load_dwordx4 v[140:143], v6, s[68:71], s63 offen offset:832 sc1
    s_waitcnt vmcnt(0)
    v_mfma_f32_16x16x32_bf16 v[224:227], a[148:151], v[112:115], 0
    v_max_u32 v8, v112, v113
    v_max_u32 v9, v114, v115
    v_mfma_f32_16x16x32_bf16 v[228:231], a[152:155], v[112:115], 0
    v_max3_u32 v8, v8, v116, v117
    v_max3_u32 v9, v9, v118, v119
    v_mfma_f32_16x16x32_bf16 v[224:227], a[156:159], v[116:119], v[224:227]
    v_max3_u32 v8, v8, v120, v121
    v_max3_u32 v9, v9, v122, v123
    v_mfma_f32_16x16x32_bf16 v[228:231], a[160:163], v[116:119], v[228:231]
    v_max3_u32 v8, v8, v124, v125
    v_max3_u32 v9, v9, v126, v127
    v_mfma_f32_16x16x32_bf16 v[224:227], a[164:167], v[120:123], v[224:227]
    v_max3_u32 v8, v8, v128, v129
    v_max3_u32 v9, v9, v130, v131
    v_mfma_f32_16x16x32_bf16 v[228:231], a[168:171], v[120:123], v[228:231]
    v_max3_u32 v8, v8, v132, v133
    v_max3_u32 v9, v9, v134, v135
    v_mfma_f32_16x16x32_bf16 v[224:227], a[172:175], v[124:127], v[224:227]
    v_max3_u32 v8, v8, v136, v137
    v_max3_u32 v9, v9, v138, v139
    v_mfma_f32_16x16x32_bf16 v[228:231], a[176:179], v[124:127], v[228:231]
    v_max3_u32 v8, v8, v140, v141
    v_max3_u32 v9, v9, v142, v143
    v_mfma_f32_16x16x32_bf16 v[224:227], a[180:183], v[128:131], v[224:227]
    v_max_u32 v8, v8, v9
    v_cmp_eq_u32 vcc, -1, v8
    v_mfma_f32_16x16x32_bf16 v[228:231], a[184:187], v[128:131], v[228:231]
    v_mfma_f32_16x16x32_bf16 v[224:227], a[188:191], v[132:135], v[224:227]
    v_mfma_f32_16x16x32_bf16 v[228:231], a[192:195], v[132:135], v[228:231]
    v_mfma_f32_16x16x32_bf16 v[224:227], a[196:199], v[136:139], v[224:227]
    v_mfma_f32_16x16x32_bf16 v[228:231], a[200:203], v[136:139], v[228:231]
    v_mfma_f32_16x16x32_bf16 v[224:227], a[204:207], v[140:143], v[224:227]
    v_mfma_f32_16x16x32_bf16 v[228:231], a[208:211], v[140:143], v[228:231]
    s_add_u32 s4, s4, 1
    s_cmp_ge_u32 s4, 400000
    s_cbranch_scc1 attn_p11_k
    s_cbranch_vccnz attn_p11_r
    s_branch attn_p11_k
attn_p12_r:
    s_mov_b32 s36, s15
    buffer_load_dwordx4 v[152:155], v12, s[68:71], s36 offen sc1
    s_add_u32 s36, s36, 8192
    buffer_load_dwordx4 v[156:159], v12, s[68:71], s36 offen sc1
    s_add_u32 s36, s36, 8192
    buffer_load_dwordx4 v[160:163], v12, s[68:71], s36 offen sc1
    s_add_u32 s36, s36, 8192
    buffer_load_dwordx4 v[164:167], v12, s[68:71], s36 offen sc1
    s_add_u32 s36, s36, 8192
    buffer_load_dwordx4 v[168:171], v12, s[68:71], s36 offen sc1
    s_add_u32 s36, s36, 8192
    buffer_load_dwordx4 v[172:175], v12, s[68:71], s36 offen sc1
    s_add_u32 s36, s36, 8192
    buffer_load_dwordx4 v[176:179], v12, s[68:71], s36 offen sc1
    s_add_u32 s36, s36, 8192
    s_waitcnt vmcnt(0)
    v_mfma_f32_16x16x32_bf16 v[96:99], v[180:183], v[152:155], 0
    v_max_u32 v8, v152, v153
    v_max_u32 v9, v154, v155
    v_mfma_f32_16x16x32_bf16 v[96:99], v[180:183], v[156:159], v[96:99]
    v_max3_u32 v8, v8, v156, v157
    v_max3_u32 v9, v9, v158, v159
    v_mfma_f32_16x16x32_bf16 v[96:99], v[180:183], v[160:163], v[96:99]
    v_max3_u32 v8, v8, v160, v161
    v_max3_u32 v9, v9, v162, v163
    v_mfma_f32_16x16x32_bf16 v[96:99], v[180:183], v[164:167], v[96:99]
    v_max3_u32 v8, v8, v164, v165
    v_max3_u32 v9, v9, v166, v167
    v_mfma_f32_16x16x32_bf16 v[96:99], v[180:183], v[168:171], v[96:99]
    v_max3_u32 v8, v8, v168, v169
    v_max3_u32 v9, v9, v170, v171
    v_mfma_f32_16x16x32_bf16 v[96:99], v[180:183], v[172:175], v[96:99]
    v_max3_u32 v8, v8, v172, v173
    v_max3_u32 v9, v9, v174, v175
    v_mfma_f32_16x16x32_bf16 v[96:99], v[180:183], v[176:179], v[96:99]
    v_max3_u32 v8, v8, v176, v177
    v_max3_u32 v9, v9, v178, v179
    v_max_u32 v8, v8, v9
    v_cmp_eq_u32 vcc, -1, v8
    s_add_u32 s4, s4, 1
    s_cmp_ge_u32 s4, 400000
    s_cbranch_scc1 attn_p12_k
    s_cbranch_vccnz attn_p12_r
    s_branch attn_p12_k
attn_slow:
    s_waitcnt vmcnt(0) lgkmcnt(0)
    s_mul_i32 s5, s28, 12288
    s_add_u32 s5, s5, 114688
    v_lshl_add_u32 v13, v0, 3, s5
    v_lshrrev_b32 v14, 4, v0
    v_mul_u32_u24 v14, 3072, v14
    v_bfe_u32 v15, v0, 2, 2
    v_lshl_add_u32 v14, v15, 7, v14
    v_and_b32 v15, 3, v0
    v_lshl_add_u32 v14, v15, 3, v14
    v_add_u32 v14, s5, v14
    ds_read_b64_tr_b16 a[228:229], v14 offset:0
    ds_read_b64_tr_b16 a[230:231], v14 offset:512
    ds_read_b64_tr_b16 a[232:233], v14 offset:32
    ds_read_b64_tr_b16 a[234:235], v14 offset:544
    ds_read_b64_tr_b16 a[236:237], v14 offset:64
    ds_read_b64_tr_b16 a[238:239], v14 offset:576
    ds_read_b64_tr_b16 a[240:241], v14 offset:96
    ds_read_b64_tr_b16 a[242:243], v14 offset:608
    ds_read_b64_tr_b16 a[180:181], v13 offset:1024
    ds_read_b64_tr_b16 a[182:183], v13 offset:1536
    ds_read_b64_tr_b16 a[184:185], v13 offset:2048
    ds_read_b64_tr_b16 a[186:187], v13 offset:2560
    s_waitcnt lgkmcnt(2)
    ds_read_b64_tr_b16 a[188:189], v13 offset:4096
    ds_read_b64_tr_b16 a[190:191], v13 offset:4608
    ds_read_b64_tr_b16 a[192:193], v13 offset:5120
    ds_read_b64_tr_b16 a[194:195], v13 offset:5632
    ds_read_b64_tr_b16 a[196:197], v13 offset:7168
    ds_read_b64_tr_b16 a[198:199], v13 offset:7680
    ds_read_b64_tr_b16 a[200:201], v13 offset:8192
    ds_read_b64_tr_b16 a[202:203], v13 offset:8704
    ds_read_b64_tr_b16 a[204:205], v13 offset:10240
    ds_read_b64_tr_b16 a[206:207], v13 offset:10752
    ds_read_b64_tr_b16 a[208:209], v13 offset:11264
    ds_read_b64_tr_b16 a[210:211], v13 offset:11776
    s_mov_b32 s6, 1
    v_and_b32 v13, 15, v0
    v_lshlrev_b32 v1, 8, v13
    v_add_u32 v1, v1, v5
    v_add_u32 v1, 4096, v1
    v_add_u32 v3, 4096, v1
    v_lshlrev_b32 v2, 7, v5
    v_lshl_add_u32 v2, v13, 4, v2
    v_add_u32 v2, 12288, v2
    v_bfe_u32 v13, v0, 2, 3
    v_mul_u32_u24 v4, 1056, v13
    v_lshrrev_b32 v13, 5, v0
    v_lshl_add_u32 v4, v13, 8, v4
    v_and_b32 v13, 3, v0
    v_lshl_add_u32 v4, v13, 3, v4
    v_add_u32 v4, s5, v4
    s_mov_b32 s31, 0
    s_waitcnt lgkmcnt(0)
    v_mov_b32 v240, 0xff800000
    v_mov_b32 v241, 0xff800000
    v_mov_b32 v242, 0xff800000
    v_mov_b32 v243, 0xff800000
attn_s1:
    buffer_load_dwordx4 a[64:67], v1, s[8:11], s31 offen offset:0
    buffer_load_dwordx4 a[68:71], v1, s[8:11], s31 offen offset:64
    buffer_load_dwordx4 a[72:75], v1, s[8:11], s31 offen offset:128
    buffer_load_dwordx4 a[76:79], v1, s[8:11], s31 offen offset:192
    buffer_load_dwordx4 a[80:83], v3, s[8:11], s31 offen offset:0
    buffer_load_dwordx4 a[84:87], v3, s[8:11], s31 offen offset:64
    buffer_load_dwordx4 a[88:91], v3, s[8:11], s31 offen offset:128
    buffer_load_dwordx4 a[92:95], v3, s[8:11], s31 offen offset:192
    s_waitcnt vmcnt(0)
    v_mfma_f32_16x16x32_bf16 v[144:147], a[64:67], a[0:3], 0
    v_mfma_f32_16x16x32_bf16 v[144:147], a[68:71], a[4:7], v[144:147]
    v_mfma_f32_16x16x32_bf16 v[144:147], a[72:75], a[8:11], v[144:147]
    v_mfma_f32_16x16x32_bf16 v[144:147], a[76:79], a[12:15], v[144:147]
    v_mfma_f32_16x16x32_bf16 v[152:155], a[64:67], a[16:19], 0
    v_mfma_f32_16x16x32_bf16 v[152:155], a[68:71], a[20:23], v[152:155]
    v_mfma_f32_16x16x32_bf16 v[152:155], a[72:75], a[24:27], v[152:155]
    v_mfma_f32_16x16x32_bf16 v[152:155], a[76:79], a[28:31], v[152:155]
    v_mfma_f32_16x16x32_bf16 v[160:163], a[64:67], a[32:35], 0
    v_mfma_f32_16x16x32_bf16 v[160:163], a[68:71], a[36:39], v[160:163]
    v_mfma_f32_16x16x32_bf16 v[160:163], a[72:75], a[40:43], v[160:163]
    v_mfma_f32_16x16x32_bf16 v[160:163], a[76:79], a[44:47], v[160:163]
    v_mfma_f32_16x16x32_bf16 v[168:171], a[64:67], a[48:51], 0
    v_mfma_f32_16x16x32_bf16 v[168:171], a[68:71], a[52:55], v[168:171]
    v_mfma_f32_16x16x32_bf16 v[168:171], a[72:75], a[56:59], v[168:171]
    v_mfma_f32_16x16x32_bf16 v[168:171], a[76:79], a[60:63], v[168:171]
    v_mfma_f32_16x16x32_bf16 v[148:151], a[80:83], a[0:3], 0
    v_mfma_f32_16x16x32_bf16 v[148:151], a[84:87], a[4:7], v[148:151]
    v_mfma_f32_16x16x32_bf16 v[148:151], a[88:91], a[8:11], v[148:151]
    v_mfma_f32_16x16x32_bf16 v[148:151], a[92:95], a[12:15], v[148:151]
    v_mfma_f32_16x16x32_bf16 v[156:159], a[80:83], a[16:19], 0
    v_mfma_f32_16x16x32_bf16 v[156:159], a[84:87], a[20:23], v[156:159]
    v_mfma_f32_16x16x32_bf16 v[156:159], a[88:91], a[24:27], v[156:159]
    v_mfma_f32_16x16x32_bf16 v[156:159], a[92:95], a[28:31], v[156:159]
    v_mfma_f32_16x16x32_bf16 v[164:167], a[80:83], a[32:35], 0
    v_mfma_f32_16x16x32_bf16 v[164:167], a[84:87], a[36:39], v[164:167]
    v_mfma_f32_16x16x32_bf16 v[164:167], a[88:91], a[40:43], v[164:167]
    v_mfma_f32_16x16x32_bf16 v[164:167], a[92:95], a[44:47], v[164:167]
    v_mfma_f32_16x16x32_bf16 v[172:175], a[80:83], a[48:51], 0
    v_mfma_f32_16x16x32_bf16 v[172:175], a[84:87], a[52:55], v[172:175]
    v_mfma_f32_16x16x32_bf16 v[172:175], a[88:91], a[56:59], v[172:175]
    v_mfma_f32_16x16x32_bf16 v[172:175], a[92:95], a[60:63], v[172:175]
    s_nop 7
    v_max3_f32 v240, v240, v144, v145
    v_max3_f32 v240, v240, v146, v147
    v_max3_f32 v240, v240, v148, v149
    v_max3_f32 v240, v240, v150, v151
    v_max3_f32 v241, v241, v152, v153
    v_max3_f32 v241, v241, v154, v155
    v_max3_f32 v241, v241, v156, v157
    v_max3_f32 v241, v241, v158, v159
    v_max3_f32 v242, v242, v160, v161
    v_max3_f32 v242, v242, v162, v163
    v_max3_f32 v242, v242, v164, v165
    v_max3_f32 v242, v242, v166, v167
    v_max3_f32 v243, v243, v168, v169
    v_max3_f32 v243, v243, v170, v171
    v_max3_f32 v243, v243, v172, v173
    v_max3_f32 v243, v243, v174, v175
    s_add_u32 s31, s31, 8192
    s_cmp_lt_u32 s31, 524288
    s_cbranch_scc1 attn_s1
    v_mov_b32 v176, v240
    v_mov_b32 v177, v241
    v_mov_b32 v178, v242
    v_mov_b32 v179, v243
    v_permlane16_swap_b32 v240, v176
    v_permlane16_swap_b32 v241, v177
    v_permlane16_swap_b32 v242, v178
    v_permlane16_swap_b32 v243, v179
    v_max_f32 v240, v240, v176
    v_max_f32 v241, v241, v177
    v_max_f32 v242, v242, v178
    v_max_f32 v243, v243, v179
    v_mov_b32 v176, v240
    v_mov_b32 v177, v241
    v_mov_b32 v178, v242
    v_mov_b32 v179, v243
    v_permlane32_swap_b32 v240, v176
    v_permlane32_swap_b32 v241, v177
    v_permlane32_swap_b32 v242, v178
    v_permlane32_swap_b32 v243, v179
    v_max_f32 v240, v240, v176
    v_max_f32 v241, v241, v177
    v_max_f32 v242, v242, v178
    v_max_f32 v243, v243, v179
    v_sub_f32 v176, 0, v240
    v_sub_f32 v177, 0, v240
    v_sub_f32 v178, 0, v240
    v_sub_f32 v179, 0, v240
    v_sub_f32 v180, 0, v241
    v_sub_f32 v181, 0, v241
    v_sub_f32 v182, 0, v241
    v_sub_f32 v183, 0, v241
    v_sub_f32 v184, 0, v242
    v_sub_f32 v185, 0, v242
    v_sub_f32 v186, 0, v242
    v_sub_f32 v187, 0, v242
    v_sub_f32 v188, 0, v243
    v_sub_f32 v189, 0, v243
    v_sub_f32 v190, 0, v243
    v_sub_f32 v191, 0, v243
    v_mov_b64 v[16:17], 0
    v_mov_b64 v[18:19], 0
    v_mov_b64 v[20:21], 0
    v_mov_b64 v[22:23], 0
    v_mov_b64 v[24:25], 0
    v_mov_b64 v[26:27], 0
    v_mov_b64 v[28:29], 0
    v_mov_b64 v[30:31], 0
    v_mov_b64 v[32:33], 0
    v_mov_b64 v[34:35], 0
    v_mov_b64 v[36:37], 0
    v_mov_b64 v[38:39], 0
    v_mov_b64 v[40:41], 0
    v_mov_b64 v[42:43], 0
    v_mov_b64 v[44:45], 0
    v_mov_b64 v[46:47], 0
    v_mov_b64 v[48:49], 0
    v_mov_b64 v[50:51], 0
    v_mov_b64 v[52:53], 0
    v_mov_b64 v[54:55], 0
    v_mov_b64 v[56:57], 0
    v_mov_b64 v[58:59], 0
    v_mov_b64 v[60:61], 0
    v_mov_b64 v[62:63], 0
    v_mov_b64 v[64:65], 0
    v_mov_b64 v[66:67], 0
    v_mov_b64 v[68:69], 0
    v_mov_b64 v[70:71], 0
    v_mov_b64 v[72:73], 0
    v_mov_b64 v[74:75], 0
    v_mov_b64 v[76:77], 0
    v_mov_b64 v[78:79], 0
    v_mov_b64 v[80:81], 0
    v_mov_b64 v[82:83], 0
    v_mov_b64 v[84:85], 0
    v_mov_b64 v[86:87], 0
    v_mov_b64 v[88:89], 0
    v_mov_b64 v[90:91], 0
    v_mov_b64 v[92:93], 0
    v_mov_b64 v[94:95], 0
    v_mov_b64 v[96:97], 0
    v_mov_b64 v[98:99], 0
    v_mov_b64 v[100:101], 0
    v_mov_b64 v[102:103], 0
    v_mov_b64 v[104:105], 0
    v_mov_b64 v[106:107], 0
    v_mov_b64 v[108:109], 0
    v_mov_b64 v[110:111], 0
    v_mov_b64 v[112:113], 0
    v_mov_b64 v[114:115], 0
    v_mov_b64 v[116:117], 0
    v_mov_b64 v[118:119], 0
    v_mov_b64 v[120:121], 0
    v_mov_b64 v[122:123], 0
    v_mov_b64 v[124:125], 0
    v_mov_b64 v[126:127], 0
    v_mov_b64 v[128:129], 0
    v_mov_b64 v[130:131], 0
    v_mov_b64 v[132:133], 0
    v_mov_b64 v[134:135], 0
    v_mov_b64 v[136:137], 0
    v_mov_b64 v[138:139], 0
    v_mov_b64 v[140:141], 0
    v_mov_b64 v[142:143], 0
    v_accvgpr_write_b32 a128, 0
    v_accvgpr_write_b32 a129, 0
    v_accvgpr_write_b32 a130, 0
    v_accvgpr_write_b32 a131, 0
    v_accvgpr_write_b32 a132, 0
    v_accvgpr_write_b32 a133, 0
    v_accvgpr_write_b32 a134, 0
    v_accvgpr_write_b32 a135, 0
    v_accvgpr_write_b32 a136, 0
    v_accvgpr_write_b32 a137, 0
    v_accvgpr_write_b32 a138, 0
    v_accvgpr_write_b32 a139, 0
    v_accvgpr_write_b32 a140, 0
    v_accvgpr_write_b32 a141, 0
    v_accvgpr_write_b32 a142, 0
    v_accvgpr_write_b32 a143, 0
    s_mov_b32 s31, 0
attn_s2:
    buffer_load_dwordx4 a[64:67], v1, s[8:11], s31 offen offset:0
    buffer_load_dwordx4 a[68:71], v1, s[8:11], s31 offen offset:64
    buffer_load_dwordx4 a[72:75], v1, s[8:11], s31 offen offset:128
    buffer_load_dwordx4 a[76:79], v1, s[8:11], s31 offen offset:192
    buffer_load_dwordx4 a[80:83], v3, s[8:11], s31 offen offset:0
    buffer_load_dwordx4 a[84:87], v3, s[8:11], s31 offen offset:64
    buffer_load_dwordx4 a[88:91], v3, s[8:11], s31 offen offset:128
    buffer_load_dwordx4 a[92:95], v3, s[8:11], s31 offen offset:192
    s_mov_b32 s36, s31
    s_add_u32 m0, s5, 0
    s_nop 0
    buffer_load_dwordx4 v2, s[12:15], s36 offen lds
    s_add_u32 s36, s36, 256
    s_add_u32 m0, s5, 1056
    s_nop 0
    buffer_load_dwordx4 v2, s[12:15], s36 offen lds
    s_add_u32 s36, s36, 256
    s_add_u32 m0, s5, 2112
    s_nop 0
    buffer_load_dwordx4 v2, s[12:15], s36 offen lds
    s_add_u32 s36, s36, 256
    s_add_u32 m0, s5, 3168
    s_nop 0
    buffer_load_dwordx4 v2, s[12:15], s36 offen lds
    s_add_u32 s36, s36, 256
    s_add_u32 m0, s5, 4224
    s_nop 0
    buffer_load_dwordx4 v2, s[12:15], s36 offen lds
    s_add_u32 s36, s36, 256
    s_add_u32 m0, s5, 5280
    s_nop 0
    buffer_load_dwordx4 v2, s[12:15], s36 offen lds
    s_add_u32 s36, s36, 256
    s_add_u32 m0, s5, 6336
    s_nop 0
    buffer_load_dwordx4 v2, s[12:15], s36 offen lds
    s_add_u32 s36, s36, 256
    s_add_u32 m0, s5, 7392
    s_nop 0
    buffer_load_dwordx4 v2, s[12:15], s36 offen lds
    s_add_u32 s36, s36, 256
    s_waitcnt vmcnt(0)
    ds_read_b64_tr_b16 a[96:97], v4 offset:0
    ds_read_b64_tr_b16 a[98:99], v4 offset:512
    ds_read_b64_tr_b16 a[100:101], v4 offset:32
    ds_read_b64_tr_b16 a[102:103], v4 offset:544
    ds_read_b64_tr_b16 a[104:105], v4 offset:64
    ds_read_b64_tr_b16 a[106:107], v4 offset:576
    ds_read_b64_tr_b16 a[108:109], v4 offset:96
    ds_read_b64_tr_b16 a[110:111], v4 offset:608
    v_mfma_f32_16x16x32_bf16 v[144:147], a[64:67], a[0:3], v[176:179]
    v_mfma_f32_16x16x32_bf16 v[144:147], a[68:71], a[4:7], v[144:147]
    v_mfma_f32_16x16x32_bf16 v[144:147], a[72:75], a[8:11], v[144:147]
    v_mfma_f32_16x16x32_bf16 v[144:147], a[76:79], a[12:15], v[144:147]
    v_mfma_f32_16x16x32_bf16 v[152:155], a[64:67], a[16:19], v[180:183]
    v_mfma_f32_16x16x32_bf16 v[152:155], a[68:71], a[20:23], v[152:155]
    v_mfma_f32_16x16x32_bf16 v[152:155], a[72:75], a[24:27], v[152:155]
    v_mfma_f32_16x16x32_bf16 v[152:155], a[76:79], a[28:31], v[152:155]
    v_mfma_f32_16x16x32_bf16 v[160:163], a[64:67], a[32:35], v[184:187]
    v_mfma_f32_16x16x32_bf16 v[160:163], a[68:71], a[36:39], v[160:163]
    v_mfma_f32_16x16x32_bf16 v[160:163], a[72:75], a[40:43], v[160:163]
    v_mfma_f32_16x16x32_bf16 v[160:163], a[76:79], a[44:47], v[160:163]
    v_mfma_f32_16x16x32_bf16 v[168:171], a[64:67], a[48:51], v[188:191]
    v_mfma_f32_16x16x32_bf16 v[168:171], a[68:71], a[52:55], v[168:171]
    v_mfma_f32_16x16x32_bf16 v[168:171], a[72:75], a[56:59], v[168:171]
    v_mfma_f32_16x16x32_bf16 v[168:171], a[76:79], a[60:63], v[168:171]
    v_mfma_f32_16x16x32_bf16 v[148:151], a[80:83], a[0:3], v[176:179]
    v_mfma_f32_16x16x32_bf16 v[148:151], a[84:87], a[4:7], v[148:151]
    v_mfma_f32_16x16x32_bf16 v[148:151], a[88:91], a[8:11], v[148:151]
    v_mfma_f32_16x16x32_bf16 v[148:151], a[92:95], a[12:15], v[148:151]
    v_mfma_f32_16x16x32_bf16 v[156:159], a[80:83], a[16:19], v[180:183]
    v_mfma_f32_16x16x32_bf16 v[156:159], a[84:87], a[20:23], v[156:159]
    v_mfma_f32_16x16x32_bf16 v[156:159], a[88:91], a[24:27], v[156:159]
    v_mfma_f32_16x16x32_bf16 v[156:159], a[92:95], a[28:31], v[156:159]
    v_mfma_f32_16x16x32_bf16 v[164:167], a[80:83], a[32:35], v[184:187]
    v_mfma_f32_16x16x32_bf16 v[164:167], a[84:87], a[36:39], v[164:167]
    v_mfma_f32_16x16x32_bf16 v[164:167], a[88:91], a[40:43], v[164:167]
    v_mfma_f32_16x16x32_bf16 v[164:167], a[92:95], a[44:47], v[164:167]
    v_mfma_f32_16x16x32_bf16 v[172:175], a[80:83], a[48:51], v[188:191]
    v_mfma_f32_16x16x32_bf16 v[172:175], a[84:87], a[52:55], v[172:175]
    v_mfma_f32_16x16x32_bf16 v[172:175], a[88:91], a[56:59], v[172:175]
    v_mfma_f32_16x16x32_bf16 v[172:175], a[92:95], a[60:63], v[172:175]
    ds_read_b64_tr_b16 a[112:113], v4 offset:128
    ds_read_b64_tr_b16 a[114:115], v4 offset:640
    ds_read_b64_tr_b16 a[116:117], v4 offset:160
    ds_read_b64_tr_b16 a[118:119], v4 offset:672
    ds_read_b64_tr_b16 a[120:121], v4 offset:192
    ds_read_b64_tr_b16 a[122:123], v4 offset:704
    ds_read_b64_tr_b16 a[124:125], v4 offset:224
    ds_read_b64_tr_b16 a[126:127], v4 offset:736
    v_exp_f32 v144, v144
    v_exp_f32 v145, v145
    v_exp_f32 v146, v146
    v_exp_f32 v147, v147
    v_exp_f32 v148, v148
    v_exp_f32 v149, v149
    v_exp_f32 v150, v150
    v_exp_f32 v151, v151
    v_exp_f32 v152, v152
    v_exp_f32 v153, v153
    v_exp_f32 v154, v154
    v_exp_f32 v155, v155
    v_exp_f32 v156, v156
    v_exp_f32 v157, v157
    v_exp_f32 v158, v158
    v_exp_f32 v159, v159
    v_exp_f32 v160, v160
    v_exp_f32 v161, v161
    v_exp_f32 v162, v162
    v_exp_f32 v163, v163
    v_exp_f32 v164, v164
    v_exp_f32 v165, v165
    v_exp_f32 v166, v166
    v_exp_f32 v167, v167
    v_exp_f32 v168, v168
    v_exp_f32 v169, v169
    v_exp_f32 v170, v170
    v_exp_f32 v171, v171
    v_exp_f32 v172, v172
    v_exp_f32 v173, v173
    v_exp_f32 v174, v174
    v_exp_f32 v175, v175
    s_nop 0
    v_cvt_pk_bf16_f32 v208, v144, v145
    v_cvt_pk_bf16_f32 v209, v146, v147
    v_cvt_pk_bf16_f32 v210, v148, v149
    v_cvt_pk_bf16_f32 v211, v150, v151
    v_cvt_pk_bf16_f32 v216, v152, v153
    v_cvt_pk_bf16_f32 v217, v154, v155
    v_cvt_pk_bf16_f32 v218, v156, v157
    v_cvt_pk_bf16_f32 v219, v158, v159
    v_cvt_pk_bf16_f32 v224, v160, v161
    v_cvt_pk_bf16_f32 v225, v162, v163
    v_cvt_pk_bf16_f32 v226, v164, v165
    v_cvt_pk_bf16_f32 v227, v166, v167
    v_cvt_pk_bf16_f32 v232, v168, v169
    v_cvt_pk_bf16_f32 v233, v170, v171
    v_cvt_pk_bf16_f32 v234, v172, v173
    v_cvt_pk_bf16_f32 v235, v174, v175
    s_waitcnt lgkmcnt(0)
    s_nop 0
    v_mfma_f32_16x16x32_bf16 a[128:131], a[144:147], v[208:211], a[128:131]
    v_mfma_f32_16x16x32_bf16 a[132:135], a[144:147], v[216:219], a[132:135]
    v_mfma_f32_16x16x32_bf16 a[136:139], a[144:147], v[224:227], a[136:139]
    v_mfma_f32_16x16x32_bf16 a[140:143], a[144:147], v[232:235], a[140:143]
    v_mfma_f32_16x16x32_bf16 v[16:19], a[96:99], v[208:211], v[16:19]
    v_mfma_f32_16x16x32_bf16 v[20:23], a[96:99], v[216:219], v[20:23]
    v_mfma_f32_16x16x32_bf16 v[24:27], a[96:99], v[224:227], v[24:27]
    v_mfma_f32_16x16x32_bf16 v[28:31], a[96:99], v[232:235], v[28:31]
    v_mfma_f32_16x16x32_bf16 v[32:35], a[100:103], v[208:211], v[32:35]
    v_mfma_f32_16x16x32_bf16 v[36:39], a[100:103], v[216:219], v[36:39]
    v_mfma_f32_16x16x32_bf16 v[40:43], a[100:103], v[224:227], v[40:43]
    v_mfma_f32_16x16x32_bf16 v[44:47], a[100:103], v[232:235], v[44:47]
    v_mfma_f32_16x16x32_bf16 v[48:51], a[104:107], v[208:211], v[48:51]
    v_mfma_f32_16x16x32_bf16 v[52:55], a[104:107], v[216:219], v[52:55]
    v_mfma_f32_16x16x32_bf16 v[56:59], a[104:107], v[224:227], v[56:59]
    v_mfma_f32_16x16x32_bf16 v[60:63], a[104:107], v[232:235], v[60:63]
    v_mfma_f32_16x16x32_bf16 v[64:67], a[108:111], v[208:211], v[64:67]
    v_mfma_f32_16x16x32_bf16 v[68:71], a[108:111], v[216:219], v[68:71]
    v_mfma_f32_16x16x32_bf16 v[72:75], a[108:111], v[224:227], v[72:75]
    v_mfma_f32_16x16x32_bf16 v[76:79], a[108:111], v[232:235], v[76:79]
    v_mfma_f32_16x16x32_bf16 v[80:83], a[112:115], v[208:211], v[80:83]
    v_mfma_f32_16x16x32_bf16 v[84:87], a[112:115], v[216:219], v[84:87]
    v_mfma_f32_16x16x32_bf16 v[88:91], a[112:115], v[224:227], v[88:91]
    v_mfma_f32_16x16x32_bf16 v[92:95], a[112:115], v[232:235], v[92:95]
    v_mfma_f32_16x16x32_bf16 v[96:99], a[116:119], v[208:211], v[96:99]
    v_mfma_f32_16x16x32_bf16 v[100:103], a[116:119], v[216:219], v[100:103]
    v_mfma_f32_16x16x32_bf16 v[104:107], a[116:119], v[224:227], v[104:107]
    v_mfma_f32_16x16x32_bf16 v[108:111], a[116:119], v[232:235], v[108:111]
    v_mfma_f32_16x16x32_bf16 v[112:115], a[120:123], v[208:211], v[112:115]
    v_mfma_f32_16x16x32_bf16 v[116:119], a[120:123], v[216:219], v[116:119]
    v_mfma_f32_16x16x32_bf16 v[120:123], a[120:123], v[224:227], v[120:123]
    v_mfma_f32_16x16x32_bf16 v[124:127], a[120:123], v[232:235], v[124:127]
    v_mfma_f32_16x16x32_bf16 v[128:131], a[124:127], v[208:211], v[128:131]
    v_mfma_f32_16x16x32_bf16 v[132:135], a[124:127], v[216:219], v[132:135]
    v_mfma_f32_16x16x32_bf16 v[136:139], a[124:127], v[224:227], v[136:139]
    v_mfma_f32_16x16x32_bf16 v[140:143], a[124:127], v[232:235], v[140:143]
    s_add_u32 s31, s31, 8192
    s_cmp_lt_u32 s31, 524288
    s_cbranch_scc1 attn_s2
    v_accvgpr_read_b32 v240, a128
    v_accvgpr_read_b32 v241, a132
    v_accvgpr_read_b32 v242, a136
    v_accvgpr_read_b32 v243, a140
    v_rcp_f32 v240, v240
    v_rcp_f32 v241, v241
    v_rcp_f32 v242, v242
    v_rcp_f32 v243, v243
    v_not_b32 v1, s85
    s_nop 7
    v_pk_mul_f32 v[16:17], v[16:17], v[240:241] op_sel:[0,0] op_sel_hi:[1,0]
    v_pk_mul_f32 v[18:19], v[18:19], v[240:241] op_sel:[0,0] op_sel_hi:[1,0]
    v_pk_mul_f32 v[32:33], v[32:33], v[240:241] op_sel:[0,0] op_sel_hi:[1,0]
    v_pk_mul_f32 v[34:35], v[34:35], v[240:241] op_sel:[0,0] op_sel_hi:[1,0]
    v_cvt_pk_bf16_f32 v144, v16, v17
    v_cvt_pk_bf16_f32 v145, v18, v19
    v_cvt_pk_bf16_f32 v146, v32, v33
    v_cvt_pk_bf16_f32 v147, v34, v35
    s_add_u32 s36, s21, 0
    buffer_store_dwordx4 v[144:147], v10, s[68:71], s36 offen sc1
    v_pk_mul_f32 v[20:21], v[20:21], v[240:241] op_sel:[0,1] op_sel_hi:[1,1]
    v_pk_mul_f32 v[22:23], v[22:23], v[240:241] op_sel:[0,1] op_sel_hi:[1,1]
    v_pk_mul_f32 v[36:37], v[36:37], v[240:241] op_sel:[0,1] op_sel_hi:[1,1]
    v_pk_mul_f32 v[38:39], v[38:39], v[240:241] op_sel:[0,1] op_sel_hi:[1,1]
    v_cvt_pk_bf16_f32 v148, v20, v21
    v_cvt_pk_bf16_f32 v149, v22, v23
    v_cvt_pk_bf16_f32 v150, v36, v37
    v_cvt_pk_bf16_f32 v151, v38, v39
    s_add_u32 s36, s21, 0
    buffer_store_dwordx4 v[148:151], v11, s[68:71], s36 offen sc1
    v_pk_mul_f32 v[48:49], v[48:49], v[240:241] op_sel:[0,0] op_sel_hi:[1,0]
    v_pk_mul_f32 v[50:51], v[50:51], v[240:241] op_sel:[0,0] op_sel_hi:[1,0]
    v_pk_mul_f32 v[64:65], v[64:65], v[240:241] op_sel:[0,0] op_sel_hi:[1,0]
    v_pk_mul_f32 v[66:67], v[66:67], v[240:241] op_sel:[0,0] op_sel_hi:[1,0]
    v_cvt_pk_bf16_f32 v160, v48, v49
    v_cvt_pk_bf16_f32 v161, v50, v51
    v_cvt_pk_bf16_f32 v162, v64, v65
    v_cvt_pk_bf16_f32 v163, v66, v67
    s_add_u32 s36, s21, 163840
    buffer_store_dwordx4 v[160:163], v10, s[68:71], s36 offen sc1
    v_pk_mul_f32 v[52:53], v[52:53], v[240:241] op_sel:[0,1] op_sel_hi:[1,1]
    v_pk_mul_f32 v[54:55], v[54:55], v[240:241] op_sel:[0,1] op_sel_hi:[1,1]
    v_pk_mul_f32 v[68:69], v[68:69], v[240:241] op_sel:[0,1] op_sel_hi:[1,1]
    v_pk_mul_f32 v[70:71], v[70:71], v[240:241] op_sel:[0,1] op_sel_hi:[1,1]
    v_cvt_pk_bf16_f32 v164, v52, v53
    v_cvt_pk_bf16_f32 v165, v54, v55
    v_cvt_pk_bf16_f32 v166, v68, v69
    v_cvt_pk_bf16_f32 v167, v70, v71
    s_add_u32 s36, s21, 163840
    buffer_store_dwordx4 v[164:167], v11, s[68:71], s36 offen sc1
    s_branch attn_ret
.section .rodata,"a"
.p2align 6
.amdhsa_kernel adaLN_cond__mha_block_cached__moe_arch_mod__prompt_kernel
  .amdhsa_next_free_vgpr 512
  .amdhsa_next_free_sgpr 102
  .amdhsa_accum_offset 256
  .amdhsa_group_segment_fixed_size 0
  .amdhsa_kernarg_size 120
  .amdhsa_user_sgpr_count 2
  .amdhsa_user_sgpr_kernarg_segment_ptr 1
  .amdhsa_system_sgpr_workgroup_id_x 1
  .amdhsa_float_denorm_mode_32 3
.end_amdhsa_kernel
```
